```python
import torch

def _softmax(x, axis=-1):
    return torch.softmax(x, dim=axis)
def _gelu(x):
    return torch.nn.functional.gelu(x, approximate="tanh")
def _silu(x):
    return torch.nn.functional.silu(x)
def _sigmoid(x):
    return torch.sigmoid(x)
def _layernorm(x, axis=-1, eps=1e-5):
    m = x.mean(dim=axis, keepdim=True)
    v = x.var(dim=axis, keepdim=True, unbiased=False)
    return (x - m) / torch.sqrt(v + eps)
def _scatter_add(tgt, idx, src, axis=0):
    return tgt.clone().index_add_(axis, idx, src)
def _segment_sum(src, seg, n):
    out = torch.zeros((n,) + src.shape[1:], dtype=src.dtype)
    return out.index_add_(0, seg, src)
def _pad(x, pw):
    flat = tuple(v for pair in reversed(pw) for v in pair)
    return torch.nn.functional.pad(x, flat)

kernel_name = 'recurrent_scan__compressed_kv_cla__glu_gated_reglu__prompt'

def setup_inputs():

    _w = (lambda a: (lambda t: t.to(torch.bfloat16) if t.is_floating_point() else t)(torch.as_tensor(a)))
    def _A_setup():
        B, H, Sq, Sk, D, M = 1, 32, 2048, 2048, 128, 512
        Dc = 4 * D
        return {
            "x": _w((lambda *s: torch.randn(*s, dtype=torch.bfloat16) * 0.05)(B, Sq, M)),
            "c_kv": _w((lambda *s: torch.randn(*s, dtype=torch.bfloat16) * 1.6)(B, Sk, Dc)),
            "w_q": _w((lambda *s: torch.randn(*s, dtype=torch.bfloat16) * 1.6)(M, H, D) * (M ** -0.5)),
            "w_uk": _w((lambda *s: torch.randn(*s, dtype=torch.bfloat16) * 1.6)(Dc, H, D) * (Dc ** -0.5)),
            "w_uv": _w((lambda *s: torch.randn(*s, dtype=torch.bfloat16) * 1.6)(Dc, H, D) * (Dc ** -0.5)),
            "w_o": _w((lambda *s: torch.randn(*s, dtype=torch.bfloat16) * 1.6)(H, D, M) * ((H * D) ** -0.5)),
        }
    _A_in = _A_setup()

    def _B_setup():
        B, S, D, F = 1, 2048, 512, 1376
        return {
            "x": _w((lambda *s: torch.randn(*s, dtype=torch.bfloat16) * 0.05)(B, S, D)),
            "W_gate": _w((lambda *s: torch.randn(*s, dtype=torch.bfloat16) * 0.2)(D, F) * (2.0 / D) ** 0.5),
            "W_up": _w((lambda *s: torch.randn(*s, dtype=torch.bfloat16) * 0.2)(D, F) * (2.0 / D) ** 0.5),
            "W_down": _w((lambda *s: torch.randn(*s, dtype=torch.bfloat16) * 0.2)(F, D) * (1.0 / F) ** 0.5),
        }
    _B_in = _B_setup()

    return {
        "A_x": _A_in["x"],
        "A_c_kv": _A_in["c_kv"],
        "A_w_q": _A_in["w_q"],
        "A_w_uk": _A_in["w_uk"],
        "A_w_uv": _A_in["w_uv"],
        "A_w_o": _A_in["w_o"],
        "B_x": _B_in["x"],
        "B_W_gate": _B_in["W_gate"],
        "B_W_up": _B_in["W_up"],
        "B_W_down": _B_in["W_down"],
    }

def reference(A_x, A_c_kv, A_w_q, A_w_uk, A_w_uv, A_w_o, B_x, B_W_gate, B_W_up, B_W_down):
    def _A_ref(x, c_kv, w_q, w_uk, w_uv, w_o):
        B, Sq, M = x.shape[0], x.shape[1], x.shape[2]
        Sk = c_kv.shape[1]
        H, D = w_q.shape[1], w_q.shape[2]
        q = torch.einsum("bqm,mhd->bhqd", x, w_q)
        k = torch.einsum("bkc,chd->bhkd", c_kv, w_uk)
        v = torch.einsum("bkc,chd->bhkd", c_kv, w_uv)
        scores = torch.einsum("bhqd,bhkd->bhqk", q, k) * (D ** -0.5)
        off = Sk - Sq
        qi = torch.arange(Sq)[:, None]
        kj = torch.arange(Sk)[None, :]
        cmask = kj <= (qi + off)
        scores = torch.where(cmask[None, None], scores, -1e9)
        p = _softmax(scores, axis=-1)
        ctx = torch.einsum("bhqk,bhkd->bhqd", p, v)
        return torch.einsum("bhqd,hdm->bqm", ctx, w_o)

    def _B_ref(x, W_gate, W_up, W_down):
        gate = torch.einsum("bsd,df->bsf", x, W_gate)
        up = torch.einsum("bsd,df->bsf", x, W_up)
        gate = gate * (lambda x, dt: x.to(dt))(gate > 0, gate.dtype)
        h = gate * up
        return torch.einsum("bsf,fd->bsd", h, W_down)

    x = A_x
    xn = _layernorm(x, axis=-1)
    s = _A_ref(xn, A_c_kv, A_w_q, A_w_uk, A_w_uv, A_w_o)
    g = _silu(_B_ref(xn, B_W_gate, B_W_up, B_W_down))
    return x + s * g
```

```asm
; @launch kernel=k12_kernel grid=(256,1,1) block=(256,1,1) lds=163840
.amdgcn_target "amdgcn-amd-amdhsa--gfx950"
.text
.macro mf a:vararg
 v_mfma_f32_16x16x32_bf16 \a
.endm
.macro trr a:vararg
 ds_read_b64_tr_b16 \a
.endm
.macro bl4 a:vararg
 buffer_load_dwordx4 \a
.endm
.macro bs4 a:vararg
 buffer_store_dwordx4 \a
.endm
.macro cvp a:vararg
 v_cvt_pk_bf16_f32 \a
.endm
.macro dr4 a:vararg
 ds_read_b128 \a
.endm
.macro acw a:vararg
 v_accvgpr_write_b32 \a
.endm
.macro vex a:vararg
 v_exp_f32 \a
.endm
.macro vaf a:vararg
 v_add_f32 \a
.endm
.macro vmf a:vararg
 v_mul_f32 \a
.endm
.macro vsf a:vararg
 v_sub_f32 \a
.endm
.macro sad a:vararg
 s_add_u32 \a
.endm
.macro swc a:vararg
 s_waitcnt \a
.endm
.globl k12_kernel
.p2align 8
.type k12_kernel,@function
k12_kernel:
 s_cmp_ge_u32 s2, 256
 s_cbranch_scc1 K2_END
 s_load_dwordx2 s[26:27], s[0:1], 0
 s_load_dwordx2 s[28:29], s[0:1], 8
 s_load_dwordx2 s[30:31], s[0:1], 16
 s_load_dwordx2 s[32:33], s[0:1], 24
 s_load_dwordx2 s[24:25], s[0:1], 32
 s_load_dwordx2 s[56:57], s[0:1], 56
 s_load_dwordx2 s[60:61], s[0:1], 64
 s_load_dwordx2 s[12:13], s[0:1], 96
 s_load_dwordx2 s[80:81], s[0:1], 88
 s_load_dwordx2 s[40:41], s[0:1], 96
 s_load_dwordx2 s[42:43], s[0:1], 40
 s_load_dwordx2 s[44:45], s[0:1], 72
 v_lshrrev_b32 v1, 6, v0
 v_and_b32 v0, 63, v0
 s_nop 0
 v_readfirstlane_b32 s16, v1
 s_and_b32 s19, s2, 1
 s_lshl_b32 s19, s19, 2
 s_lshr_b32 s20, s2, 3
 s_and_b32 s21, s20, 3
 s_lshr_b32 s18, s20, 2
 s_and_b32 s17, s2, 7
 s_lshl_b32 s17, s17, 2
 sad s17, s17, s21
 sad s21, s21, s19
 s_and_b32 s19, s2, 6
 s_lshl_b32 s22, s19, 2
 sad s22, s22, s18
 s_mov_b32 s15, 0x00020000
 s_mov_b32 s51, 0x00020000
 s_mov_b32 s55, 0x00020000
 s_mov_b32 s59, 0x00020000
 s_mov_b32 s63, 0x00020000
 s_mov_b32 s83, 0x00020000
 s_mov_b32 s7, 0x00020000
 s_mov_b32 s14, 80740352
 s_mov_b32 s50, 0x200000
 s_mov_b32 s82, 256
 s_mov_b32 s6, 0x200000
 s_lshl_b32 s39, s16, 13
 s_lshl_b32 s36, s16, 12
 sad s23, s22, s21
 s_and_b32 s23, s23, 3
 s_lshl_b32 s20, s21, 18
 s_lshl_b32 s19, s16, 16
 sad s34, s20, s19
 sad s19, s23, 0
 s_and_b32 s19, s19, 3
 s_lshl_b32 s20, s19, 8
 sad s96, s34, s20
 s_lshl_b32 s19, s19, 20
 s_lshl_b32 s20, s16, 18
 sad s88, s19, s20
 sad s19, s23, 1
 s_and_b32 s19, s19, 3
 s_lshl_b32 s20, s19, 8
 sad s97, s34, s20
 s_lshl_b32 s19, s19, 20
 s_lshl_b32 s20, s16, 18
 sad s89, s19, s20
 sad s19, s23, 2
 s_and_b32 s19, s19, 3
 s_lshl_b32 s20, s19, 8
 sad s98, s34, s20
 s_lshl_b32 s19, s19, 20
 s_lshl_b32 s20, s16, 18
 sad s90, s19, s20
 sad s19, s23, 3
 s_and_b32 s19, s19, 3
 s_lshl_b32 s20, s19, 8
 sad s99, s34, s20
 s_lshl_b32 s19, s19, 20
 s_lshl_b32 s20, s16, 18
 sad s91, s19, s20
 v_lshlrev_b32 v195, 4, v0
 v_mov_b32 v248, v0
 v_lshrrev_b32 v1, 4, v0
 v_bfe_u32 v2, v0, 2, 2
 v_and_b32 v3, 3, v0
 s_lshl_b32 s19, s2, 13
 s_lshl_b32 s20, s16, 11
 sad s19, s19, s20
 v_lshrrev_b32 v4, 5, v0
 v_lshlrev_b32 v4, 10, v4
 v_and_b32 v5, 31, v0
 v_lshl_add_u32 v4, v5, 4, v4
 v_lshrrev_b32 v5, 3, v0
 v_and_b32 v6, 7, v0
 v_xor_b32 v7, v6, v1
 v_lshlrev_b32 v216, 10, v5
 v_lshl_add_u32 v216, v7, 4, v216
 v_xor_b32 v217, 64, v216
 v_bfe_u32 v7, v0, 4, 1
 v_lshlrev_b32 v7, 1, v7
 v_xor_b32 v6, v6, v7
 v_lshlrev_b32 v5, 13, v5
 v_lshl_add_u32 v192, v6, 4, v5
 v_xor_b32 v193, 64, v192
 s_getpc_b64 s[84:85]
CT1:
 sad s84, s84, (k12_kernel-CT1)&0xffffffff
 s_addc_u32 s85, s85, ((k12_kernel-CT1)>>32)&0xffffffff
 s_lshr_b32 s86, s2, 3
 s_lshl_b32 s86, s86, 2
 sad s86, s86, s16
 s_mul_i32 s86, s86, ((K1_FIN-k12_kernel+16383)/16384)*128
 v_lshlrev_b32 v255, 7, v0
 v_min_u32 v255, ((K1_FIN-k12_kernel+16383)/16384)*128-128, v255
 v_add_u32 v255, s86, v255
 v_min_u32 v255, K1_FIN-k12_kernel-4, v255
 global_load_dword v255, v255, s[84:85]
 swc lgkmcnt(0)
 s_mov_b32 s4, s26
 s_mov_b32 s5, s27
 s_mov_b32 s48, s28
 s_mov_b32 s49, s29
 bl4 v[72:75], v4, s[4:7], s19 offen
 bl4 v[76:79], v4, s[4:7], s19 offen offset:512
 s_cmp_ge_u32 s22, 16
 s_cselect_b32 s52, s24, s32
 s_cselect_b32 s53, s25, s33
 s_and_b32 s19, s22, 15
 s_lshl_b32 s19, s19, 9
 sad s52, s52, s19
 s_addc_u32 s53, s53, 0
 s_sub_u32 s54, 4194304, s19
 sad m0, s39, 98304
 sad s19, s96, 0
 bl4 v216, s[48:51], s19 offen lds
 sad m0, s39, 99328
 sad s19, s96, 8192
 bl4 v217, s[48:51], s19 offen lds
 sad m0, s39, 100352
 sad s19, s96, 16384
 bl4 v216, s[48:51], s19 offen lds
 sad m0, s39, 101376
 sad s19, s96, 24576
 bl4 v217, s[48:51], s19 offen lds
 sad m0, s39, 102400
 sad s19, s96, 32768
 bl4 v216, s[48:51], s19 offen lds
 sad m0, s39, 103424
 sad s19, s96, 40960
 bl4 v217, s[48:51], s19 offen lds
 sad m0, s39, 104448
 sad s19, s96, 49152
 bl4 v216, s[48:51], s19 offen lds
 sad m0, s39, 105472
 sad s19, s96, 57344
 bl4 v217, s[48:51], s19 offen lds
 sad m0, s36, 0
 sad s19, s88, 0
 bl4 v192, s[52:55], s19 offen lds
 sad m0, s36, 1024
 sad s19, s88, 65536
 bl4 v193, s[52:55], s19 offen lds
 sad m0, s36, 2048
 sad s19, s88, 131072
 bl4 v192, s[52:55], s19 offen lds
 sad m0, s36, 3072
 sad s19, s88, 196608
 bl4 v193, s[52:55], s19 offen lds
 sad m0, s39, 131072
 sad s19, s96, 128
 bl4 v216, s[48:51], s19 offen lds
 sad m0, s39, 132096
 sad s19, s96, 8320
 bl4 v217, s[48:51], s19 offen lds
 sad m0, s39, 133120
 sad s19, s96, 16512
 bl4 v216, s[48:51], s19 offen lds
 sad m0, s39, 134144
 sad s19, s96, 24704
 bl4 v217, s[48:51], s19 offen lds
 sad m0, s39, 135168
 sad s19, s96, 32896
 bl4 v216, s[48:51], s19 offen lds
 sad m0, s39, 136192
 sad s19, s96, 41088
 bl4 v217, s[48:51], s19 offen lds
 sad m0, s39, 137216
 sad s19, s96, 49280
 bl4 v216, s[48:51], s19 offen lds
 sad m0, s39, 138240
 sad s19, s96, 57472
 bl4 v217, s[48:51], s19 offen lds
 sad m0, s36, 16384
 sad s19, s89, 0
 bl4 v192, s[52:55], s19 offen lds
 sad m0, s36, 17408
 sad s19, s89, 65536
 bl4 v193, s[52:55], s19 offen lds
 sad m0, s36, 18432
 sad s19, s89, 131072
 bl4 v192, s[52:55], s19 offen lds
 sad m0, s36, 19456
 sad s19, s89, 196608
 bl4 v193, s[52:55], s19 offen lds
 v_lshrrev_b32 v4, 1, v2
 v_and_b32 v5, 1, v1
 v_lshl_add_u32 v4, v5, 1, v4
 v_lshl_add_u32 v6, v1, 3, v2
 v_lshlrev_b32 v7, 7, v6
 v_lshl_add_u32 v7, v3, 3, v7
 v_xor_b32 v254, 0, v4
 v_lshl_add_u32 v168, v254, 5, v7
 v_add_u32 v169, 512, v168
 v_add_u32 v176, 0x10000, v168
 v_add_u32 v177, 0x10000, v169
 v_xor_b32 v254, 1, v4
 v_lshl_add_u32 v170, v254, 5, v7
 v_add_u32 v171, 512, v170
 v_add_u32 v178, 0x10000, v170
 v_add_u32 v179, 0x10000, v171
 v_xor_b32 v254, 2, v4
 v_lshl_add_u32 v172, v254, 5, v7
 v_add_u32 v173, 512, v172
 v_add_u32 v180, 0x10000, v172
 v_add_u32 v181, 0x10000, v173
 v_xor_b32 v254, 3, v4
 v_lshl_add_u32 v174, v254, 5, v7
 v_add_u32 v175, 512, v174
 v_add_u32 v182, 0x10000, v174
 v_add_u32 v183, 0x10000, v175
 v_lshlrev_b32 v7, 6, v6
 v_lshl_add_u32 v7, v3, 3, v7
 v_xor_b32 v254, 0, v5
 v_lshl_add_u32 v254, v254, 5, v7
 v_add_u32 v184, 0, v254
 v_add_u32 v185, 256, v184
 v_xor_b32 v254, 1, v5
 v_lshl_add_u32 v254, v254, 5, v7
 v_add_u32 v186, 0, v254
 v_add_u32 v187, 256, v186
 v_xor_b32 v254, 0, v5
 v_lshl_add_u32 v254, v254, 5, v7
 v_add_u32 v188, 2048, v254
 v_add_u32 v189, 256, v188
 v_xor_b32 v254, 1, v5
 v_lshl_add_u32 v254, v254, 5, v7
 v_add_u32 v190, 2048, v254
 v_add_u32 v191, 256, v190
 v_lshrrev_b32 v4, 2, v0
 v_lshrrev_b32 v6, 5, v0
 v_lshlrev_b32 v6, 1, v6
 v_xor_b32 v5, v3, v6
 v_mul_u32_u24 v4, 2752, v4
 v_lshl_add_u32 v194, v5, 4, v4
 v_and_b32 v4, 15, v0
 v_lshrrev_b32 v5, 1, v4
 v_xor_b32 v5, v5, v1
 v_lshlrev_b32 v4, 7, v4
 v_lshl_add_u32 v4, v5, 4, v4
 sad s20, s39, 98304
 v_add_u32 v218, s20, v4
 v_xor_b32 v219, 64, v218
 v_subrev_u32 v220, 0x10000, v218
 v_subrev_u32 v221, 0x10000, v219
 s_lshl_b32 s19, s17, 6
 sad s56, s56, s19
 s_addc_u32 s57, s57, 0
 sad s60, s60, s19
 s_addc_u32 s61, s61, 0
 s_sub_u32 s58, 1409024, s19
 s_mov_b32 s62, s58
 sad s19, s18, 0
 s_and_b32 s19, s19, 3
 s_lshl_b32 s19, s19, 2
 sad s19, s19, s16
 s_mul_i32 s92, s19, 88064
 sad s19, s18, 1
 s_and_b32 s19, s19, 3
 s_lshl_b32 s19, s19, 2
 sad s19, s19, s16
 s_mul_i32 s93, s19, 88064
 sad s19, s18, 2
 s_and_b32 s19, s19, 3
 s_lshl_b32 s19, s19, 2
 sad s19, s19, s16
 s_mul_i32 s94, s19, 88064
 sad s19, s18, 3
 s_and_b32 s19, s19, 3
 s_lshl_b32 s19, s19, 2
 sad s19, s19, s16
 s_mul_i32 s95, s19, 88064
 s_lshl_b32 s19, s18, 3
 s_lshl_b32 s20, s16, 0
 sad s101, s19, s20
 s_sub_u32 s100, 120, s19
 sad s100, s100, s20
 s_lshl_b32 s35, s21, 17
 s_lshl_b32 s19, s16, 15
 sad s35, s35, s19
 s_and_b32 s19, s22, 15
 s_lshl_b32 s19, s19, 21
 sad s35, s35, s19
 sad s35, s35, 1048576
 swc vmcnt(24)
 v_lshlrev_b32 v8, 16, v72
 v_and_b32 v9, 0xffff0000, v72
 v_lshlrev_b32 v10, 16, v73
 v_and_b32 v11, 0xffff0000, v73
 v_lshlrev_b32 v12, 16, v74
 v_and_b32 v13, 0xffff0000, v74
 v_lshlrev_b32 v14, 16, v75
 v_and_b32 v15, 0xffff0000, v75
 v_lshlrev_b32 v16, 16, v76
 v_and_b32 v17, 0xffff0000, v76
 v_lshlrev_b32 v18, 16, v77
 v_and_b32 v19, 0xffff0000, v77
 v_lshlrev_b32 v20, 16, v78
 v_and_b32 v21, 0xffff0000, v78
 v_lshlrev_b32 v22, 16, v79
 v_and_b32 v23, 0xffff0000, v79
 vaf v24, v8, v16
 vaf v25, v9, v17
 vaf v26, v10, v18
 vaf v27, v11, v19
 vaf v28, v12, v20
 vaf v29, v13, v21
 vaf v30, v14, v22
 vaf v31, v15, v23
 vaf v24, v24, v28
 vaf v25, v25, v29
 vaf v26, v26, v30
 vaf v27, v27, v31
 vaf v24, v24, v26
 vaf v25, v25, v27
 vaf v24, v24, v25
 v_mov_b32 v80, v24
 s_nop 1
 v_add_f32_dpp v80, v80, v80 row_ror:8 row_mask:0xf bank_mask:0xf
 s_nop 1
 v_add_f32_dpp v80, v80, v80 row_ror:4 row_mask:0xf bank_mask:0xf
 s_nop 1
 v_add_f32_dpp v80, v80, v80 row_ror:2 row_mask:0xf bank_mask:0xf
 s_nop 1
 v_add_f32_dpp v80, v80, v80 row_ror:1 row_mask:0xf bank_mask:0xf
 v_mov_b32 v81, v80
 s_nop 1
 v_permlane16_swap_b32 v80, v81
 vaf v80, v80, v81
 vmf v80, 0xbb000000, v80
 vaf v8, v8, v80
 vaf v9, v9, v80
 vaf v10, v10, v80
 vaf v11, v11, v80
 vaf v12, v12, v80
 vaf v13, v13, v80
 vaf v14, v14, v80
 vaf v15, v15, v80
 vaf v16, v16, v80
 vaf v17, v17, v80
 vaf v18, v18, v80
 vaf v19, v19, v80
 vaf v20, v20, v80
 vaf v21, v21, v80
 vaf v22, v22, v80
 vaf v23, v23, v80
 cvp v72, v8, v9
 cvp v73, v10, v11
 cvp v74, v12, v13
 cvp v75, v14, v15
 cvp v76, v16, v17
 cvp v77, v18, v19
 cvp v78, v20, v21
 cvp v79, v22, v23
 vmf v24, v8, v8
 vmf v25, v9, v9
 vmf v26, v10, v10
 vmf v27, v11, v11
 v_fmac_f32 v24, v12, v12
 v_fmac_f32 v25, v13, v13
 v_fmac_f32 v26, v14, v14
 v_fmac_f32 v27, v15, v15
 v_fmac_f32 v24, v16, v16
 v_fmac_f32 v25, v17, v17
 v_fmac_f32 v26, v18, v18
 v_fmac_f32 v27, v19, v19
 v_fmac_f32 v24, v20, v20
 v_fmac_f32 v25, v21, v21
 v_fmac_f32 v26, v22, v22
 v_fmac_f32 v27, v23, v23
 vaf v24, v24, v25
 vaf v26, v26, v27
 vaf v80, v24, v26
 s_nop 1
 v_add_f32_dpp v80, v80, v80 row_ror:8 row_mask:0xf bank_mask:0xf
 s_nop 1
 v_add_f32_dpp v80, v80, v80 row_ror:4 row_mask:0xf bank_mask:0xf
 s_nop 1
 v_add_f32_dpp v80, v80, v80 row_ror:2 row_mask:0xf bank_mask:0xf
 s_nop 1
 v_add_f32_dpp v80, v80, v80 row_ror:1 row_mask:0xf bank_mask:0xf
 v_mov_b32 v81, v80
 s_nop 1
 v_permlane16_swap_b32 v80, v81
 vaf v80, v80, v81
 v_mov_b32 v81, 0x3727c5ac
 v_fmac_f32 v81, 0x3b000000, v80
 v_rsq_f32 v80, v81
 s_and_b32 s19, s2, 1
 s_lshl_b32 s19, s19, 3
 s_lshl_b32 s20, s16, 1
 sad s19, s19, s20
 v_lshrrev_b32 v4, 5, v0
 v_add_u32 v4, s19, v4
 v_bfe_u32 v5, v0, 2, 3
 v_lshlrev_b32 v5, 10, v5
 v_lshl_add_u32 v5, v3, 8, v5
 v_lshl_add_u32 v5, v4, 4, v5
 v_lshlrev_b32 v4, 2, v4
 s_lshr_b32 s19, s2, 1
 s_lshl_b32 s20, s19, 14
 sad s20, s20, 58720256
 sad s3, s20, 8192
 s_lshl_b32 s19, s19, 6
 sad s19, s19, 60817408
 bs4 v[72:75], v5, s[12:15], s20 offen sc1
 bs4 v[76:79], v5, s[12:15], s3 offen sc1
 buffer_store_dword v80, v4, s[12:15], s19 offen sc1
 s_cmp_ge_u32 s2, 2
 s_cbranch_scc1 K1_NOZ
 s_lshl_b32 s19, s2, 13
 sad s19, s19, 61865984
 v_lshlrev_b32 v4, 7, v0
 v_mov_b32 v5, 0
 buffer_store_dword v5, v4, s[12:15], s19 offen sc1
K1_NOZ:
 s_and_b32 s19, s2, 15
 s_lshl_b32 s19, s19, 2
 v_mov_b32 v4, s19
 v_mov_b32 v5, 1
 v_and_b32 v253, 15, v0
 v_lshlrev_b32 v253, 2, v253
 swc vmcnt(15)
 s_barrier
 s_cmp_ge_u32 s22, 16
 s_cbranch_scc1 K1_V
K1_K:
 v_add_u32 v196, 0, v195
 v_add_u32 v197, 4096, v195
 v_add_u32 v198, 16384, v195
 v_add_u32 v199, 20480, v195
 dr4 a[0:3], v218 offset:0
 dr4 a[4:7], v219 offset:0
 dr4 a[64:67], v218 offset:2048
 dr4 a[68:71], v219 offset:2048
 dr4 a[128:131], v218 offset:4096
 dr4 a[132:135], v219 offset:4096
 dr4 a[192:195], v218 offset:6144
 dr4 a[196:199], v219 offset:6144
 trr v[136:137], v168 offset:0
 trr v[138:139], v169 offset:0
 trr v[140:141], v170 offset:0
 trr v[142:143], v171 offset:0
 trr v[144:145], v172 offset:0
 trr v[146:147], v173 offset:0
 trr v[148:149], v174 offset:0
 trr v[150:151], v175 offset:0
 trr v[152:153], v168 offset:4096
 trr v[154:155], v169 offset:4096
 trr v[156:157], v170 offset:4096
 trr v[158:159], v171 offset:4096
 trr v[160:161], v172 offset:4096
 trr v[162:163], v173 offset:4096
 trr v[164:165], v174 offset:4096
 trr v[166:167], v175 offset:4096
 swc lgkmcnt(12)
 mf v[8:11], v[136:139], a[0:3], 0
 mf v[12:15], v[136:139], a[64:67], 0
 sad m0, s39, 98304
 sad s19, s97, 0
 mf v[16:19], v[136:139], a[128:131], 0
 bl4 v216, s[48:51], s19 offen lds
 sad m0, s39, 99328
 sad s19, s97, 8192
 mf v[20:23], v[136:139], a[192:195], 0
 trr v[136:137], v168 offset:8192
 trr v[138:139], v169 offset:8192
 mf v[24:27], v[140:143], a[0:3], 0
 bl4 v217, s[48:51], s19 offen lds
 sad m0, s39, 100352
 sad s19, s97, 16384
 mf v[28:31], v[140:143], a[64:67], 0
 bl4 v216, s[48:51], s19 offen lds
 sad m0, s39, 101376
 sad s19, s97, 24576
 mf v[32:35], v[140:143], a[128:131], 0
 bl4 v217, s[48:51], s19 offen lds
 swc lgkmcnt(10)
 sad m0, s39, 102400
 sad s19, s97, 32768
 mf v[36:39], v[140:143], a[192:195], 0
 trr v[140:141], v170 offset:8192
 trr v[142:143], v171 offset:8192
 mf v[40:43], v[144:147], a[0:3], 0
 bl4 v216, s[48:51], s19 offen lds
 sad m0, s39, 103424
 sad s19, s97, 40960
 mf v[44:47], v[144:147], a[64:67], 0
 bl4 v217, s[48:51], s19 offen lds
 sad m0, s39, 104448
 sad s19, s97, 49152
 mf v[48:51], v[144:147], a[128:131], 0
 bl4 v216, s[48:51], s19 offen lds
 sad m0, s39, 105472
 sad s19, s97, 57344
 mf v[52:55], v[144:147], a[192:195], 0
 trr v[144:145], v172 offset:8192
 trr v[146:147], v173 offset:8192
 mf v[56:59], v[148:151], a[0:3], 0
 bl4 v217, s[48:51], s19 offen lds
 sad m0, s36, 32768
 sad s19, s90, 0
 mf v[60:63], v[148:151], a[64:67], 0
 bl4 v192, s[52:55], s19 offen lds
 sad m0, s36, 33792
 sad s19, s90, 65536
 mf v[64:67], v[148:151], a[128:131], 0
 bl4 v193, s[52:55], s19 offen lds
 swc lgkmcnt(10)
 sad m0, s36, 34816
 sad s19, s90, 131072
 mf v[68:71], v[148:151], a[192:195], 0
 trr v[148:149], v174 offset:8192
 trr v[150:151], v175 offset:8192
 mf v[8:11], v[152:155], a[4:7], v[8:11]
 bl4 v192, s[52:55], s19 offen lds
 sad m0, s36, 35840
 sad s19, s90, 196608
 mf v[12:15], v[152:155], a[68:71], v[12:15]
 bl4 v193, s[52:55], s19 offen lds
 mf v[16:19], v[152:155], a[132:135], v[16:19]
 mf v[20:23], v[152:155], a[196:199], v[20:23]
 trr v[152:153], v168 offset:12288
 trr v[154:155], v169 offset:12288
 mf v[24:27], v[156:159], a[4:7], v[24:27]
 mf v[28:31], v[156:159], a[68:71], v[28:31]
 mf v[32:35], v[156:159], a[132:135], v[32:35]
 swc lgkmcnt(10)
 mf v[36:39], v[156:159], a[196:199], v[36:39]
 trr v[156:157], v170 offset:12288
 trr v[158:159], v171 offset:12288
 swc vmcnt(19)
 mf v[40:43], v[160:163], a[4:7], v[40:43]
 dr4 a[8:11], v218 offset:32768
 dr4 a[12:15], v219 offset:32768
 mf v[44:47], v[160:163], a[68:71], v[44:47]
 dr4 a[72:75], v218 offset:34816
 dr4 a[76:79], v219 offset:34816
 mf v[48:51], v[160:163], a[132:135], v[48:51]
 dr4 a[136:139], v218 offset:36864
 dr4 a[140:143], v219 offset:36864
 mf v[52:55], v[160:163], a[196:199], v[52:55]
 trr v[160:161], v172 offset:12288
 trr v[162:163], v173 offset:12288
 mf v[56:59], v[164:167], a[4:7], v[56:59]
 dr4 a[200:203], v218 offset:38912
 dr4 a[204:207], v219 offset:38912
 mf v[60:63], v[164:167], a[68:71], v[60:63]
 mf v[64:67], v[164:167], a[132:135], v[64:67]
 swc lgkmcnt(10)
 mf v[68:71], v[164:167], a[196:199], v[68:71]
 trr v[164:165], v174 offset:12288
 trr v[166:167], v175 offset:12288
 swc lgkmcnt(2)
 mf v[8:11], v[136:139], a[8:11], v[8:11]
 swc vmcnt(15)
 s_barrier
 mf v[12:15], v[136:139], a[72:75], v[12:15]
 sad m0, s39, 131072
 sad s19, s97, 128
 mf v[16:19], v[136:139], a[136:139], v[16:19]
 bl4 v216, s[48:51], s19 offen lds
 sad m0, s39, 132096
 sad s19, s97, 8320
 mf v[20:23], v[136:139], a[200:203], v[20:23]
 trr v[136:137], v168 offset:16384
 trr v[138:139], v169 offset:16384
 mf v[24:27], v[140:143], a[8:11], v[24:27]
 bl4 v217, s[48:51], s19 offen lds
 sad m0, s39, 133120
 sad s19, s97, 16512
 mf v[28:31], v[140:143], a[72:75], v[28:31]
 bl4 v216, s[48:51], s19 offen lds
 sad m0, s39, 134144
 sad s19, s97, 24704
 mf v[32:35], v[140:143], a[136:139], v[32:35]
 bl4 v217, s[48:51], s19 offen lds
 swc lgkmcnt(10)
 sad m0, s39, 135168
 sad s19, s97, 32896
 mf v[36:39], v[140:143], a[200:203], v[36:39]
 trr v[140:141], v170 offset:16384
 trr v[142:143], v171 offset:16384
 mf v[40:43], v[144:147], a[8:11], v[40:43]
 bl4 v216, s[48:51], s19 offen lds
 sad m0, s39, 136192
 sad s19, s97, 41088
 mf v[44:47], v[144:147], a[72:75], v[44:47]
 bl4 v217, s[48:51], s19 offen lds
 sad m0, s39, 137216
 sad s19, s97, 49280
 mf v[48:51], v[144:147], a[136:139], v[48:51]
 bl4 v216, s[48:51], s19 offen lds
 sad m0, s39, 138240
 sad s19, s97, 57472
 mf v[52:55], v[144:147], a[200:203], v[52:55]
 trr v[144:145], v172 offset:16384
 trr v[146:147], v173 offset:16384
 mf v[56:59], v[148:151], a[8:11], v[56:59]
 bl4 v217, s[48:51], s19 offen lds
 sad m0, s36, 49152
 sad s19, s91, 0
 mf v[60:63], v[148:151], a[72:75], v[60:63]
 bl4 v192, s[52:55], s19 offen lds
 sad m0, s36, 50176
 sad s19, s91, 65536
 mf v[64:67], v[148:151], a[136:139], v[64:67]
 bl4 v193, s[52:55], s19 offen lds
 swc lgkmcnt(10)
 sad m0, s36, 51200
 sad s19, s91, 131072
 mf v[68:71], v[148:151], a[200:203], v[68:71]
 trr v[148:149], v174 offset:16384
 trr v[150:151], v175 offset:16384
 mf v[8:11], v[152:155], a[12:15], v[8:11]
 bl4 v192, s[52:55], s19 offen lds
 sad m0, s36, 52224
 sad s19, s91, 196608
 mf v[12:15], v[152:155], a[76:79], v[12:15]
 bl4 v193, s[52:55], s19 offen lds
 mf v[16:19], v[152:155], a[140:143], v[16:19]
 mf v[20:23], v[152:155], a[204:207], v[20:23]
 trr v[152:153], v168 offset:20480
 trr v[154:155], v169 offset:20480
 mf v[24:27], v[156:159], a[12:15], v[24:27]
 mf v[28:31], v[156:159], a[76:79], v[28:31]
 mf v[32:35], v[156:159], a[140:143], v[32:35]
 swc lgkmcnt(10)
 mf v[36:39], v[156:159], a[204:207], v[36:39]
 trr v[156:157], v170 offset:20480
 trr v[158:159], v171 offset:20480
 swc vmcnt(16)
 mf v[40:43], v[160:163], a[12:15], v[40:43]
 dr4 a[16:19], v218 offset:0
 dr4 a[20:23], v219 offset:0
 mf v[44:47], v[160:163], a[76:79], v[44:47]
 dr4 a[80:83], v218 offset:2048
 dr4 a[84:87], v219 offset:2048
 mf v[48:51], v[160:163], a[140:143], v[48:51]
 dr4 a[144:147], v218 offset:4096
 dr4 a[148:151], v219 offset:4096
 mf v[52:55], v[160:163], a[204:207], v[52:55]
 trr v[160:161], v172 offset:20480
 trr v[162:163], v173 offset:20480
 mf v[56:59], v[164:167], a[12:15], v[56:59]
 dr4 a[208:211], v218 offset:6144
 dr4 a[212:215], v219 offset:6144
 mf v[60:63], v[164:167], a[76:79], v[60:63]
 mf v[64:67], v[164:167], a[140:143], v[64:67]
 swc lgkmcnt(10)
 mf v[68:71], v[164:167], a[204:207], v[68:71]
 trr v[164:165], v174 offset:20480
 trr v[166:167], v175 offset:20480
 swc lgkmcnt(2)
 mf v[8:11], v[136:139], a[16:19], v[8:11]
 swc vmcnt(12)
 s_barrier
 mf v[12:15], v[136:139], a[80:83], v[12:15]
 sad m0, s39, 98304
 sad s19, s98, 0
 mf v[16:19], v[136:139], a[144:147], v[16:19]
 bl4 v216, s[48:51], s19 offen lds
 sad m0, s39, 99328
 sad s19, s98, 8192
 mf v[20:23], v[136:139], a[208:211], v[20:23]
 trr v[136:137], v168 offset:24576
 trr v[138:139], v169 offset:24576
 mf v[24:27], v[140:143], a[16:19], v[24:27]
 bl4 v217, s[48:51], s19 offen lds
 sad m0, s39, 100352
 sad s19, s98, 16384
 mf v[28:31], v[140:143], a[80:83], v[28:31]
 bl4 v216, s[48:51], s19 offen lds
 sad m0, s39, 101376
 sad s19, s98, 24576
 mf v[32:35], v[140:143], a[144:147], v[32:35]
 bl4 v217, s[48:51], s19 offen lds
 swc lgkmcnt(10)
 sad m0, s39, 102400
 sad s19, s98, 32768
 mf v[36:39], v[140:143], a[208:211], v[36:39]
 trr v[140:141], v170 offset:24576
 trr v[142:143], v171 offset:24576
 mf v[40:43], v[144:147], a[16:19], v[40:43]
 bl4 v216, s[48:51], s19 offen lds
 sad m0, s39, 103424
 sad s19, s98, 40960
 mf v[44:47], v[144:147], a[80:83], v[44:47]
 bl4 v217, s[48:51], s19 offen lds
 sad m0, s39, 104448
 sad s19, s98, 49152
 mf v[48:51], v[144:147], a[144:147], v[48:51]
 bl4 v216, s[48:51], s19 offen lds
 sad m0, s39, 105472
 sad s19, s98, 57344
 mf v[52:55], v[144:147], a[208:211], v[52:55]
 trr v[144:145], v172 offset:24576
 trr v[146:147], v173 offset:24576
 mf v[56:59], v[148:151], a[16:19], v[56:59]
 bl4 v217, s[48:51], s19 offen lds
 sad m0, s36, 65536
 sad s19, s88, 128
 mf v[60:63], v[148:151], a[80:83], v[60:63]
 bl4 v192, s[52:55], s19 offen lds
 sad m0, s36, 66560
 sad s19, s88, 65664
 mf v[64:67], v[148:151], a[144:147], v[64:67]
 bl4 v193, s[52:55], s19 offen lds
 swc lgkmcnt(10)
 sad m0, s36, 67584
 sad s19, s88, 131200
 mf v[68:71], v[148:151], a[208:211], v[68:71]
 trr v[148:149], v174 offset:24576
 trr v[150:151], v175 offset:24576
 mf v[8:11], v[152:155], a[20:23], v[8:11]
 bl4 v192, s[52:55], s19 offen lds
 sad m0, s36, 68608
 sad s19, s88, 196736
 mf v[12:15], v[152:155], a[84:87], v[12:15]
 bl4 v193, s[52:55], s19 offen lds
 mf v[16:19], v[152:155], a[148:151], v[16:19]
 mf v[20:23], v[152:155], a[212:215], v[20:23]
 trr v[152:153], v168 offset:28672
 trr v[154:155], v169 offset:28672
 mf v[24:27], v[156:159], a[20:23], v[24:27]
 mf v[28:31], v[156:159], a[84:87], v[28:31]
 mf v[32:35], v[156:159], a[148:151], v[32:35]
 swc lgkmcnt(10)
 mf v[36:39], v[156:159], a[212:215], v[36:39]
 trr v[156:157], v170 offset:28672
 trr v[158:159], v171 offset:28672
 swc vmcnt(16)
 mf v[40:43], v[160:163], a[20:23], v[40:43]
 dr4 a[24:27], v218 offset:32768
 dr4 a[28:31], v219 offset:32768
 mf v[44:47], v[160:163], a[84:87], v[44:47]
 dr4 a[88:91], v218 offset:34816
 dr4 a[92:95], v219 offset:34816
 mf v[48:51], v[160:163], a[148:151], v[48:51]
 dr4 a[152:155], v218 offset:36864
 dr4 a[156:159], v219 offset:36864
 mf v[52:55], v[160:163], a[212:215], v[52:55]
 trr v[160:161], v172 offset:28672
 trr v[162:163], v173 offset:28672
 mf v[56:59], v[164:167], a[20:23], v[56:59]
 dr4 a[216:219], v218 offset:38912
 dr4 a[220:223], v219 offset:38912
 mf v[60:63], v[164:167], a[84:87], v[60:63]
 mf v[64:67], v[164:167], a[148:151], v[64:67]
 swc lgkmcnt(10)
 mf v[68:71], v[164:167], a[212:215], v[68:71]
 trr v[164:165], v174 offset:28672
 trr v[166:167], v175 offset:28672
 swc lgkmcnt(2)
 mf v[8:11], v[136:139], a[24:27], v[8:11]
 mf v[12:15], v[136:139], a[88:91], v[12:15]
 sad m0, s39, 131072
 sad s19, s98, 128
 mf v[16:19], v[136:139], a[152:155], v[16:19]
 bl4 v216, s[48:51], s19 offen lds
 sad m0, s39, 132096
 sad s19, s98, 8320
 mf v[20:23], v[136:139], a[216:219], v[20:23]
 trr v[136:137], v168 offset:32768
 trr v[138:139], v169 offset:32768
 mf v[24:27], v[140:143], a[24:27], v[24:27]
 bl4 v217, s[48:51], s19 offen lds
 sad m0, s39, 133120
 sad s19, s98, 16512
 mf v[28:31], v[140:143], a[88:91], v[28:31]
 bl4 v216, s[48:51], s19 offen lds
 sad m0, s39, 134144
 sad s19, s98, 24704
 mf v[32:35], v[140:143], a[152:155], v[32:35]
 bl4 v217, s[48:51], s19 offen lds
 swc lgkmcnt(10)
 sad m0, s39, 135168
 sad s19, s98, 32896
 mf v[36:39], v[140:143], a[216:219], v[36:39]
 trr v[140:141], v170 offset:32768
 trr v[142:143], v171 offset:32768
 mf v[40:43], v[144:147], a[24:27], v[40:43]
 bl4 v216, s[48:51], s19 offen lds
 sad m0, s39, 136192
 sad s19, s98, 41088
 mf v[44:47], v[144:147], a[88:91], v[44:47]
 bl4 v217, s[48:51], s19 offen lds
 sad m0, s39, 137216
 sad s19, s98, 49280
 mf v[48:51], v[144:147], a[152:155], v[48:51]
 bl4 v216, s[48:51], s19 offen lds
 sad m0, s39, 138240
 sad s19, s98, 57472
 mf v[52:55], v[144:147], a[216:219], v[52:55]
 trr v[144:145], v172 offset:32768
 trr v[146:147], v173 offset:32768
 mf v[56:59], v[148:151], a[24:27], v[56:59]
 bl4 v217, s[48:51], s19 offen lds
 sad m0, s36, 81920
 sad s19, s89, 128
 mf v[60:63], v[148:151], a[88:91], v[60:63]
 bl4 v192, s[52:55], s19 offen lds
 sad m0, s36, 82944
 sad s19, s89, 65664
 mf v[64:67], v[148:151], a[152:155], v[64:67]
 bl4 v193, s[52:55], s19 offen lds
 swc lgkmcnt(10)
 sad m0, s36, 83968
 sad s19, s89, 131200
 mf v[68:71], v[148:151], a[216:219], v[68:71]
 trr v[148:149], v174 offset:32768
 trr v[150:151], v175 offset:32768
 mf v[8:11], v[152:155], a[28:31], v[8:11]
 bl4 v192, s[52:55], s19 offen lds
 sad m0, s36, 84992
 sad s19, s89, 196736
 mf v[12:15], v[152:155], a[92:95], v[12:15]
 bl4 v193, s[52:55], s19 offen lds
 mf v[16:19], v[152:155], a[156:159], v[16:19]
 mf v[20:23], v[152:155], a[220:223], v[20:23]
 trr v[152:153], v168 offset:36864
 trr v[154:155], v169 offset:36864
 mf v[24:27], v[156:159], a[28:31], v[24:27]
 mf v[28:31], v[156:159], a[92:95], v[28:31]
 mf v[32:35], v[156:159], a[156:159], v[32:35]
 swc lgkmcnt(10)
 mf v[36:39], v[156:159], a[220:223], v[36:39]
 trr v[156:157], v170 offset:36864
 trr v[158:159], v171 offset:36864
 swc vmcnt(16)
 mf v[40:43], v[160:163], a[28:31], v[40:43]
 dr4 a[32:35], v218 offset:0
 dr4 a[36:39], v219 offset:0
 mf v[44:47], v[160:163], a[92:95], v[44:47]
 dr4 a[96:99], v218 offset:2048
 dr4 a[100:103], v219 offset:2048
 mf v[48:51], v[160:163], a[156:159], v[48:51]
 dr4 a[160:163], v218 offset:4096
 dr4 a[164:167], v219 offset:4096
 mf v[52:55], v[160:163], a[220:223], v[52:55]
 trr v[160:161], v172 offset:36864
 trr v[162:163], v173 offset:36864
 mf v[56:59], v[164:167], a[28:31], v[56:59]
 dr4 a[224:227], v218 offset:6144
 dr4 a[228:231], v219 offset:6144
 mf v[60:63], v[164:167], a[92:95], v[60:63]
 mf v[64:67], v[164:167], a[156:159], v[64:67]
 swc lgkmcnt(10)
 mf v[68:71], v[164:167], a[220:223], v[68:71]
 trr v[164:165], v174 offset:36864
 trr v[166:167], v175 offset:36864
 swc lgkmcnt(2)
 mf v[8:11], v[136:139], a[32:35], v[8:11]
 swc vmcnt(24)
 s_barrier
 mf v[12:15], v[136:139], a[96:99], v[12:15]
 sad m0, s39, 98304
 sad s19, s99, 0
 mf v[16:19], v[136:139], a[160:163], v[16:19]
 bl4 v216, s[48:51], s19 offen lds
 sad m0, s39, 99328
 sad s19, s99, 8192
 mf v[20:23], v[136:139], a[224:227], v[20:23]
 trr v[136:137], v168 offset:40960
 trr v[138:139], v169 offset:40960
 mf v[24:27], v[140:143], a[32:35], v[24:27]
 bl4 v217, s[48:51], s19 offen lds
 sad m0, s39, 100352
 sad s19, s99, 16384
 mf v[28:31], v[140:143], a[96:99], v[28:31]
 bl4 v216, s[48:51], s19 offen lds
 sad m0, s39, 101376
 sad s19, s99, 24576
 mf v[32:35], v[140:143], a[160:163], v[32:35]
 bl4 v217, s[48:51], s19 offen lds
 swc lgkmcnt(10)
 sad m0, s39, 102400
 sad s19, s99, 32768
 mf v[36:39], v[140:143], a[224:227], v[36:39]
 trr v[140:141], v170 offset:40960
 trr v[142:143], v171 offset:40960
 mf v[40:43], v[144:147], a[32:35], v[40:43]
 bl4 v216, s[48:51], s19 offen lds
 sad m0, s39, 103424
 sad s19, s99, 40960
 mf v[44:47], v[144:147], a[96:99], v[44:47]
 bl4 v217, s[48:51], s19 offen lds
 sad m0, s39, 104448
 sad s19, s99, 49152
 mf v[48:51], v[144:147], a[160:163], v[48:51]
 bl4 v216, s[48:51], s19 offen lds
 sad m0, s39, 105472
 sad s19, s99, 57344
 mf v[52:55], v[144:147], a[224:227], v[52:55]
 trr v[144:145], v172 offset:40960
 trr v[146:147], v173 offset:40960
 mf v[56:59], v[148:151], a[32:35], v[56:59]
 bl4 v217, s[48:51], s19 offen lds
 mf v[60:63], v[148:151], a[96:99], v[60:63]
 mf v[64:67], v[148:151], a[160:163], v[64:67]
 swc lgkmcnt(10)
 mf v[68:71], v[148:151], a[224:227], v[68:71]
 trr v[148:149], v174 offset:40960
 trr v[150:151], v175 offset:40960
 mf v[8:11], v[152:155], a[36:39], v[8:11]
 mf v[12:15], v[152:155], a[100:103], v[12:15]
 mf v[16:19], v[152:155], a[164:167], v[16:19]
 mf v[20:23], v[152:155], a[228:231], v[20:23]
 trr v[152:153], v168 offset:45056
 trr v[154:155], v169 offset:45056
 mf v[24:27], v[156:159], a[36:39], v[24:27]
 mf v[28:31], v[156:159], a[100:103], v[28:31]
 mf v[32:35], v[156:159], a[164:167], v[32:35]
 swc lgkmcnt(10)
 mf v[36:39], v[156:159], a[228:231], v[36:39]
 trr v[156:157], v170 offset:45056
 trr v[158:159], v171 offset:45056
 swc vmcnt(12)
 mf v[40:43], v[160:163], a[36:39], v[40:43]
 dr4 a[40:43], v218 offset:32768
 dr4 a[44:47], v219 offset:32768
 mf v[44:47], v[160:163], a[100:103], v[44:47]
 dr4 a[104:107], v218 offset:34816
 dr4 a[108:111], v219 offset:34816
 mf v[48:51], v[160:163], a[164:167], v[48:51]
 dr4 a[168:171], v218 offset:36864
 dr4 a[172:175], v219 offset:36864
 mf v[52:55], v[160:163], a[228:231], v[52:55]
 trr v[160:161], v172 offset:45056
 trr v[162:163], v173 offset:45056
 mf v[56:59], v[164:167], a[36:39], v[56:59]
 dr4 a[232:235], v218 offset:38912
 dr4 a[236:239], v219 offset:38912
 mf v[60:63], v[164:167], a[100:103], v[60:63]
 mf v[64:67], v[164:167], a[164:167], v[64:67]
 swc lgkmcnt(10)
 mf v[68:71], v[164:167], a[228:231], v[68:71]
 trr v[164:165], v174 offset:45056
 trr v[166:167], v175 offset:45056
 swc lgkmcnt(2)
 mf v[8:11], v[136:139], a[40:43], v[8:11]
 mf v[12:15], v[136:139], a[104:107], v[12:15]
 sad m0, s39, 131072
 sad s19, s99, 128
 mf v[16:19], v[136:139], a[168:171], v[16:19]
 bl4 v216, s[48:51], s19 offen lds
 sad m0, s39, 132096
 sad s19, s99, 8320
 mf v[20:23], v[136:139], a[232:235], v[20:23]
 trr v[136:137], v168 offset:49152
 trr v[138:139], v169 offset:49152
 mf v[24:27], v[140:143], a[40:43], v[24:27]
 bl4 v217, s[48:51], s19 offen lds
 sad m0, s39, 133120
 sad s19, s99, 16512
 mf v[28:31], v[140:143], a[104:107], v[28:31]
 bl4 v216, s[48:51], s19 offen lds
 sad m0, s39, 134144
 sad s19, s99, 24704
 mf v[32:35], v[140:143], a[168:171], v[32:35]
 bl4 v217, s[48:51], s19 offen lds
 swc lgkmcnt(10)
 sad m0, s39, 135168
 sad s19, s99, 32896
 mf v[36:39], v[140:143], a[232:235], v[36:39]
 trr v[140:141], v170 offset:49152
 trr v[142:143], v171 offset:49152
 mf v[40:43], v[144:147], a[40:43], v[40:43]
 bl4 v216, s[48:51], s19 offen lds
 sad m0, s39, 136192
 sad s19, s99, 41088
 mf v[44:47], v[144:147], a[104:107], v[44:47]
 bl4 v217, s[48:51], s19 offen lds
 sad m0, s39, 137216
 sad s19, s99, 49280
 mf v[48:51], v[144:147], a[168:171], v[48:51]
 bl4 v216, s[48:51], s19 offen lds
 sad m0, s39, 138240
 sad s19, s99, 57472
 mf v[52:55], v[144:147], a[232:235], v[52:55]
 trr v[144:145], v172 offset:49152
 trr v[146:147], v173 offset:49152
 mf v[56:59], v[148:151], a[40:43], v[56:59]
 bl4 v217, s[48:51], s19 offen lds
 mf v[60:63], v[148:151], a[104:107], v[60:63]
 mf v[64:67], v[148:151], a[168:171], v[64:67]
 swc lgkmcnt(10)
 mf v[68:71], v[148:151], a[232:235], v[68:71]
 trr v[148:149], v174 offset:49152
 trr v[150:151], v175 offset:49152
 mf v[8:11], v[152:155], a[44:47], v[8:11]
 mf v[12:15], v[152:155], a[108:111], v[12:15]
 mf v[16:19], v[152:155], a[172:175], v[16:19]
 mf v[20:23], v[152:155], a[236:239], v[20:23]
 trr v[152:153], v168 offset:53248
 trr v[154:155], v169 offset:53248
 mf v[24:27], v[156:159], a[44:47], v[24:27]
 mf v[28:31], v[156:159], a[108:111], v[28:31]
 mf v[32:35], v[156:159], a[172:175], v[32:35]
 swc lgkmcnt(10)
 mf v[36:39], v[156:159], a[236:239], v[36:39]
 trr v[156:157], v170 offset:53248
 trr v[158:159], v171 offset:53248
 swc vmcnt(8)
 mf v[40:43], v[160:163], a[44:47], v[40:43]
 dr4 a[48:51], v218 offset:0
 dr4 a[52:55], v219 offset:0
 mf v[44:47], v[160:163], a[108:111], v[44:47]
 dr4 a[112:115], v218 offset:2048
 dr4 a[116:119], v219 offset:2048
 mf v[48:51], v[160:163], a[172:175], v[48:51]
 dr4 a[176:179], v218 offset:4096
 dr4 a[180:183], v219 offset:4096
 mf v[52:55], v[160:163], a[236:239], v[52:55]
 trr v[160:161], v172 offset:53248
 trr v[162:163], v173 offset:53248
 mf v[56:59], v[164:167], a[44:47], v[56:59]
 dr4 a[240:243], v218 offset:6144
 dr4 a[244:247], v219 offset:6144
 mf v[60:63], v[164:167], a[108:111], v[60:63]
 mf v[64:67], v[164:167], a[172:175], v[64:67]
 swc lgkmcnt(10)
 mf v[68:71], v[164:167], a[236:239], v[68:71]
 trr v[164:165], v174 offset:53248
 trr v[166:167], v175 offset:53248
 swc lgkmcnt(2)
 mf v[8:11], v[136:139], a[48:51], v[8:11]
 swc vmcnt(28)
 s_barrier
 mf v[12:15], v[136:139], a[112:115], v[12:15]
 mf v[16:19], v[136:139], a[176:179], v[16:19]
 mf v[20:23], v[136:139], a[240:243], v[20:23]
 trr v[136:137], v168 offset:57344
 trr v[138:139], v169 offset:57344
 mf v[24:27], v[140:143], a[48:51], v[24:27]
 mf v[28:31], v[140:143], a[112:115], v[28:31]
 mf v[32:35], v[140:143], a[176:179], v[32:35]
 swc lgkmcnt(10)
 mf v[36:39], v[140:143], a[240:243], v[36:39]
 trr v[140:141], v170 offset:57344
 trr v[142:143], v171 offset:57344
 mf v[40:43], v[144:147], a[48:51], v[40:43]
 mf v[44:47], v[144:147], a[112:115], v[44:47]
 mf v[48:51], v[144:147], a[176:179], v[48:51]
 mf v[52:55], v[144:147], a[240:243], v[52:55]
 trr v[144:145], v172 offset:57344
 trr v[146:147], v173 offset:57344
 mf v[56:59], v[148:151], a[48:51], v[56:59]
 mf v[60:63], v[148:151], a[112:115], v[60:63]
 mf v[64:67], v[148:151], a[176:179], v[64:67]
 swc lgkmcnt(10)
 mf v[68:71], v[148:151], a[240:243], v[68:71]
 trr v[148:149], v174 offset:57344
 trr v[150:151], v175 offset:57344
 mf v[8:11], v[152:155], a[52:55], v[8:11]
 mf v[12:15], v[152:155], a[116:119], v[12:15]
 mf v[16:19], v[152:155], a[180:183], v[16:19]
 mf v[20:23], v[152:155], a[244:247], v[20:23]
 trr v[152:153], v168 offset:61440
 trr v[154:155], v169 offset:61440
 mf v[24:27], v[156:159], a[52:55], v[24:27]
 mf v[28:31], v[156:159], a[116:119], v[28:31]
 mf v[32:35], v[156:159], a[180:183], v[32:35]
 swc lgkmcnt(10)
 mf v[36:39], v[156:159], a[244:247], v[36:39]
 trr v[156:157], v170 offset:61440
 trr v[158:159], v171 offset:61440
 swc vmcnt(0)
 mf v[40:43], v[160:163], a[52:55], v[40:43]
 dr4 a[56:59], v218 offset:32768
 dr4 a[60:63], v219 offset:32768
 mf v[44:47], v[160:163], a[116:119], v[44:47]
 dr4 a[120:123], v218 offset:34816
 dr4 a[124:127], v219 offset:34816
 mf v[48:51], v[160:163], a[180:183], v[48:51]
 dr4 a[184:187], v218 offset:36864
 dr4 a[188:191], v219 offset:36864
 mf v[52:55], v[160:163], a[244:247], v[52:55]
 trr v[160:161], v172 offset:61440
 trr v[162:163], v173 offset:61440
 mf v[56:59], v[164:167], a[52:55], v[56:59]
 dr4 a[248:251], v218 offset:38912
 dr4 a[252:255], v219 offset:38912
 mf v[60:63], v[164:167], a[116:119], v[60:63]
 mf v[64:67], v[164:167], a[180:183], v[64:67]
 swc lgkmcnt(10)
 mf v[68:71], v[164:167], a[244:247], v[68:71]
 trr v[164:165], v174 offset:61440
 trr v[166:167], v175 offset:61440
 swc lgkmcnt(2)
 mf v[8:11], v[136:139], a[56:59], v[8:11]
 s_barrier
 mf v[12:15], v[136:139], a[120:123], v[12:15]
 sad m0, s36, 98304
 sad s19, s90, 128
 mf v[16:19], v[136:139], a[184:187], v[16:19]
 bl4 v192, s[52:55], s19 offen lds
 sad m0, s36, 99328
 sad s19, s90, 65664
 mf v[20:23], v[136:139], a[248:251], v[20:23]
 trr v[136:137], v176 offset:0
 trr v[138:139], v177 offset:0
 mf v[24:27], v[140:143], a[56:59], v[24:27]
 bl4 v193, s[52:55], s19 offen lds
 sad m0, s36, 100352
 sad s19, s90, 131200
 mf v[28:31], v[140:143], a[120:123], v[28:31]
 bl4 v192, s[52:55], s19 offen lds
 sad m0, s36, 101376
 sad s19, s90, 196736
 mf v[32:35], v[140:143], a[184:187], v[32:35]
 bl4 v193, s[52:55], s19 offen lds
 swc lgkmcnt(10)
 sad m0, s36, 114688
 sad s19, s91, 128
 mf v[36:39], v[140:143], a[248:251], v[36:39]
 trr v[140:141], v176 offset:4096
 trr v[142:143], v177 offset:4096
 mf v[40:43], v[144:147], a[56:59], v[40:43]
 bl4 v192, s[52:55], s19 offen lds
 sad m0, s36, 115712
 sad s19, s91, 65664
 mf v[44:47], v[144:147], a[120:123], v[44:47]
 bl4 v193, s[52:55], s19 offen lds
 sad m0, s36, 116736
 sad s19, s91, 131200
 mf v[48:51], v[144:147], a[184:187], v[48:51]
 bl4 v192, s[52:55], s19 offen lds
 sad m0, s36, 117760
 sad s19, s91, 196736
 mf v[52:55], v[144:147], a[248:251], v[52:55]
 trr v[144:145], v176 offset:8192
 trr v[146:147], v177 offset:8192
 mf v[56:59], v[148:151], a[56:59], v[56:59]
 bl4 v193, s[52:55], s19 offen lds
 sad m0, s36, 0
 sad s19, s88, 256
 mf v[60:63], v[148:151], a[120:123], v[60:63]
 bl4 v192, s[52:55], s19 offen lds
 sad m0, s36, 1024
 sad s19, s88, 65792
 mf v[64:67], v[148:151], a[184:187], v[64:67]
 bl4 v193, s[52:55], s19 offen lds
 swc lgkmcnt(10)
 sad m0, s36, 2048
 sad s19, s88, 131328
 mf v[68:71], v[148:151], a[248:251], v[68:71]
 trr v[148:149], v176 offset:12288
 trr v[150:151], v177 offset:12288
 mf v[8:11], v[152:155], a[60:63], v[8:11]
 bl4 v192, s[52:55], s19 offen lds
 sad m0, s36, 3072
 sad s19, s88, 196864
 mf v[12:15], v[152:155], a[124:127], v[12:15]
 bl4 v193, s[52:55], s19 offen lds
 sad m0, s36, 16384
 sad s19, s89, 256
 mf v[16:19], v[152:155], a[188:191], v[16:19]
 bl4 v192, s[52:55], s19 offen lds
 sad m0, s36, 17408
 sad s19, s89, 65792
 mf v[20:23], v[152:155], a[252:255], v[20:23]
 trr v[152:153], v178 offset:0
 trr v[154:155], v179 offset:0
 mf v[24:27], v[156:159], a[60:63], v[24:27]
 bl4 v193, s[52:55], s19 offen lds
 sad m0, s36, 18432
 sad s19, s89, 131328
 mf v[28:31], v[156:159], a[124:127], v[28:31]
 bl4 v192, s[52:55], s19 offen lds
 sad m0, s36, 19456
 sad s19, s89, 196864
 mf v[32:35], v[156:159], a[188:191], v[32:35]
 bl4 v193, s[52:55], s19 offen lds
 swc lgkmcnt(10)
 sad m0, s36, 32768
 sad s19, s90, 256
 mf v[36:39], v[156:159], a[252:255], v[36:39]
 trr v[156:157], v178 offset:4096
 trr v[158:159], v179 offset:4096
 mf v[40:43], v[160:163], a[60:63], v[40:43]
 bl4 v192, s[52:55], s19 offen lds
 sad m0, s36, 33792
 sad s19, s90, 65792
 mf v[44:47], v[160:163], a[124:127], v[44:47]
 bl4 v193, s[52:55], s19 offen lds
 sad m0, s36, 34816
 sad s19, s90, 131328
 mf v[48:51], v[160:163], a[188:191], v[48:51]
 bl4 v192, s[52:55], s19 offen lds
 sad m0, s36, 35840
 sad s19, s90, 196864
 mf v[52:55], v[160:163], a[252:255], v[52:55]
 trr v[160:161], v178 offset:8192
 trr v[162:163], v179 offset:8192
 mf v[56:59], v[164:167], a[60:63], v[56:59]
 bl4 v193, s[52:55], s19 offen lds
 mf v[60:63], v[164:167], a[124:127], v[60:63]
 mf v[64:67], v[164:167], a[188:191], v[64:67]
 swc lgkmcnt(6)
 mf v[68:71], v[164:167], a[252:255], v[68:71]
 trr v[164:165], v178 offset:12288
 trr v[166:167], v179 offset:12288
 mf v[72:75], v[136:139], a[0:3], 0
 swc vmcnt(36)
 s_barrier
 mf v[72:75], v[140:143], a[4:7], v[72:75]
 sad m0, s36, 49152
 sad s19, s91, 256
 mf v[72:75], v[144:147], a[8:11], v[72:75]
 mf v[72:75], v[148:151], a[12:15], v[72:75]
 mf v[76:79], v[136:139], a[64:67], 0
 bl4 v192, s[52:55], s19 offen lds
 mf v[76:79], v[140:143], a[68:71], v[76:79]
 mf v[76:79], v[144:147], a[72:75], v[76:79]
 sad s34, s35, 0
 mf v[76:79], v[148:151], a[76:79], v[76:79]
 sad m0, s36, 50176
 sad s19, s91, 65792
 mf v[80:83], v[136:139], a[128:131], 0
 mf v[80:83], v[140:143], a[132:135], v[80:83]
 mf v[80:83], v[144:147], a[136:139], v[80:83]
 bl4 v193, s[52:55], s19 offen lds
 cvp v200, v8, v9
 mf v[80:83], v[148:151], a[140:143], v[80:83]
 swc lgkmcnt(0)
 mf v[84:87], v[136:139], a[192:195], 0
 trr v[136:137], v180 offset:0
 trr v[138:139], v181 offset:0
 mf v[84:87], v[140:143], a[196:199], v[84:87]
 trr v[140:141], v180 offset:4096
 trr v[142:143], v181 offset:4096
 mf v[84:87], v[144:147], a[200:203], v[84:87]
 trr v[144:145], v180 offset:8192
 trr v[146:147], v181 offset:8192
 mf v[84:87], v[148:151], a[204:207], v[84:87]
 trr v[148:149], v180 offset:12288
 trr v[150:151], v181 offset:12288
 mf v[88:91], v[152:155], a[0:3], 0
 mf v[88:91], v[156:159], a[4:7], v[88:91]
 mf v[88:91], v[160:163], a[8:11], v[88:91]
 sad m0, s36, 51200
 sad s19, s91, 131328
 mf v[88:91], v[164:167], a[12:15], v[88:91]
 cvp v201, v10, v11
 mf v[92:95], v[152:155], a[64:67], 0
 mf v[92:95], v[156:159], a[68:71], v[92:95]
 bl4 v192, s[52:55], s19 offen lds
 mf v[92:95], v[160:163], a[72:75], v[92:95]
 mf v[92:95], v[164:167], a[76:79], v[92:95]
 cvp v202, v24, v25
 mf v[96:99], v[152:155], a[128:131], 0
 sad m0, s36, 52224
 sad s19, s91, 196864
 mf v[96:99], v[156:159], a[132:135], v[96:99]
 mf v[96:99], v[160:163], a[136:139], v[96:99]
 mf v[96:99], v[164:167], a[140:143], v[96:99]
 swc lgkmcnt(0)
 mf v[100:103], v[152:155], a[192:195], 0
 trr v[152:153], v182 offset:0
 trr v[154:155], v183 offset:0
 mf v[100:103], v[156:159], a[196:199], v[100:103]
 trr v[156:157], v182 offset:4096
 trr v[158:159], v183 offset:4096
 mf v[100:103], v[160:163], a[200:203], v[100:103]
 trr v[160:161], v182 offset:8192
 trr v[162:163], v183 offset:8192
 mf v[100:103], v[164:167], a[204:207], v[100:103]
 trr v[164:165], v182 offset:12288
 trr v[166:167], v183 offset:12288
 mf v[104:107], v[136:139], a[0:3], 0
 bl4 v193, s[52:55], s19 offen lds
 mf v[104:107], v[140:143], a[4:7], v[104:107]
 cvp v203, v26, v27
 mf v[104:107], v[144:147], a[8:11], v[104:107]
 mf v[104:107], v[148:151], a[12:15], v[104:107]
 mf v[108:111], v[136:139], a[64:67], 0
 bs4 v[200:203], v196, s[12:15], s34 offen offset:0 sc1
 mf v[108:111], v[140:143], a[68:71], v[108:111]
 mf v[108:111], v[144:147], a[72:75], v[108:111]
 mf v[108:111], v[148:151], a[76:79], v[108:111]
 mf v[112:115], v[136:139], a[128:131], 0
 cvp v204, v12, v13
 mf v[112:115], v[140:143], a[132:135], v[112:115]
 mf v[112:115], v[144:147], a[136:139], v[112:115]
 mf v[112:115], v[148:151], a[140:143], v[112:115]
 swc lgkmcnt(0)
 cvp v205, v14, v15
 mf v[116:119], v[136:139], a[192:195], 0
 trr v[136:137], v176 offset:16384
 trr v[138:139], v177 offset:16384
 mf v[116:119], v[140:143], a[196:199], v[116:119]
 trr v[140:141], v176 offset:20480
 trr v[142:143], v177 offset:20480
 mf v[116:119], v[144:147], a[200:203], v[116:119]
 trr v[144:145], v176 offset:24576
 trr v[146:147], v177 offset:24576
 mf v[116:119], v[148:151], a[204:207], v[116:119]
 trr v[148:149], v176 offset:28672
 trr v[150:151], v177 offset:28672
 mf v[120:123], v[152:155], a[0:3], 0
 mf v[120:123], v[156:159], a[4:7], v[120:123]
 mf v[120:123], v[160:163], a[8:11], v[120:123]
 mf v[120:123], v[164:167], a[12:15], v[120:123]
 cvp v206, v28, v29
 mf v[124:127], v[152:155], a[64:67], 0
 mf v[124:127], v[156:159], a[68:71], v[124:127]
 mf v[124:127], v[160:163], a[72:75], v[124:127]
 cvp v207, v30, v31
 mf v[124:127], v[164:167], a[76:79], v[124:127]
 mf v[128:131], v[152:155], a[128:131], 0
 mf v[128:131], v[156:159], a[132:135], v[128:131]
 mf v[128:131], v[160:163], a[136:139], v[128:131]
 bs4 v[204:207], v197, s[12:15], s34 offen offset:0 sc1
 mf v[128:131], v[164:167], a[140:143], v[128:131]
 swc lgkmcnt(0)
 mf v[132:135], v[152:155], a[192:195], 0
 trr v[152:153], v178 offset:16384
 trr v[154:155], v179 offset:16384
 mf v[132:135], v[156:159], a[196:199], v[132:135]
 trr v[156:157], v178 offset:20480
 trr v[158:159], v179 offset:20480
 mf v[132:135], v[160:163], a[200:203], v[132:135]
 trr v[160:161], v178 offset:24576
 trr v[162:163], v179 offset:24576
 mf v[132:135], v[164:167], a[204:207], v[132:135]
 trr v[164:165], v178 offset:28672
 trr v[166:167], v179 offset:28672
 mf v[72:75], v[136:139], a[16:19], v[72:75]
 swc vmcnt(22)
 s_barrier
 mf v[72:75], v[140:143], a[20:23], v[72:75]
 sad m0, s36, 65536
 sad s19, s88, 384
 mf v[72:75], v[144:147], a[24:27], v[72:75]
 mf v[72:75], v[148:151], a[28:31], v[72:75]
 mf v[76:79], v[136:139], a[80:83], v[76:79]
 bl4 v192, s[52:55], s19 offen lds
 cvp v200, v16, v17
 mf v[76:79], v[140:143], a[84:87], v[76:79]
 mf v[76:79], v[144:147], a[88:91], v[76:79]
 mf v[76:79], v[148:151], a[92:95], v[76:79]
 sad m0, s36, 66560
 sad s19, s88, 65920
 mf v[80:83], v[136:139], a[144:147], v[80:83]
 mf v[80:83], v[140:143], a[148:151], v[80:83]
 cvp v201, v18, v19
 mf v[80:83], v[144:147], a[152:155], v[80:83]
 bl4 v193, s[52:55], s19 offen lds
 mf v[80:83], v[148:151], a[156:159], v[80:83]
 swc lgkmcnt(0)
 mf v[84:87], v[136:139], a[208:211], v[84:87]
 trr v[136:137], v180 offset:16384
 trr v[138:139], v181 offset:16384
 mf v[84:87], v[140:143], a[212:215], v[84:87]
 trr v[140:141], v180 offset:20480
 trr v[142:143], v181 offset:20480
 mf v[84:87], v[144:147], a[216:219], v[84:87]
 trr v[144:145], v180 offset:24576
 trr v[146:147], v181 offset:24576
 mf v[84:87], v[148:151], a[220:223], v[84:87]
 trr v[148:149], v180 offset:28672
 trr v[150:151], v181 offset:28672
 mf v[88:91], v[152:155], a[16:19], v[88:91]
 mf v[88:91], v[156:159], a[20:23], v[88:91]
 cvp v202, v32, v33
 mf v[88:91], v[160:163], a[24:27], v[88:91]
 sad m0, s36, 67584
 sad s19, s88, 131456
 mf v[88:91], v[164:167], a[28:31], v[88:91]
 mf v[92:95], v[152:155], a[80:83], v[92:95]
 mf v[92:95], v[156:159], a[84:87], v[92:95]
 bl4 v192, s[52:55], s19 offen lds
 mf v[92:95], v[160:163], a[88:91], v[92:95]
 cvp v203, v34, v35
 mf v[92:95], v[164:167], a[92:95], v[92:95]
 mf v[96:99], v[152:155], a[144:147], v[96:99]
 sad m0, s36, 68608
 sad s19, s88, 196992
 mf v[96:99], v[156:159], a[148:151], v[96:99]
 mf v[96:99], v[160:163], a[152:155], v[96:99]
 bs4 v[200:203], v198, s[12:15], s34 offen offset:0 sc1
 mf v[96:99], v[164:167], a[156:159], v[96:99]
 swc lgkmcnt(0)
 mf v[100:103], v[152:155], a[208:211], v[100:103]
 trr v[152:153], v182 offset:16384
 trr v[154:155], v183 offset:16384
 mf v[100:103], v[156:159], a[212:215], v[100:103]
 trr v[156:157], v182 offset:20480
 trr v[158:159], v183 offset:20480
 mf v[100:103], v[160:163], a[216:219], v[100:103]
 trr v[160:161], v182 offset:24576
 trr v[162:163], v183 offset:24576
 mf v[100:103], v[164:167], a[220:223], v[100:103]
 trr v[164:165], v182 offset:28672
 trr v[166:167], v183 offset:28672
 mf v[104:107], v[136:139], a[16:19], v[104:107]
 bl4 v193, s[52:55], s19 offen lds
 mf v[104:107], v[140:143], a[20:23], v[104:107]
 mf v[104:107], v[144:147], a[24:27], v[104:107]
 mf v[104:107], v[148:151], a[28:31], v[104:107]
 sad s20, s18, 0
 s_and_b32 s20, s20, 3
 s_lshl_b32 s96, s20, 12
 mf v[108:111], v[136:139], a[80:83], v[108:111]
 cvp v204, v20, v21
 mf v[108:111], v[140:143], a[84:87], v[108:111]
 mf v[108:111], v[144:147], a[88:91], v[108:111]
 sad s20, s18, 1
 s_and_b32 s20, s20, 3
 s_lshl_b32 s97, s20, 12
 mf v[108:111], v[148:151], a[92:95], v[108:111]
 mf v[112:115], v[136:139], a[144:147], v[112:115]
 cvp v205, v22, v23
 mf v[112:115], v[140:143], a[148:151], v[112:115]
 sad s20, s18, 2
 s_and_b32 s20, s20, 3
 s_lshl_b32 s98, s20, 12
 mf v[112:115], v[144:147], a[152:155], v[112:115]
 mf v[112:115], v[148:151], a[156:159], v[112:115]
 swc lgkmcnt(0)
 mf v[116:119], v[136:139], a[208:211], v[116:119]
 trr v[136:137], v176 offset:32768
 trr v[138:139], v177 offset:32768
 mf v[116:119], v[140:143], a[212:215], v[116:119]
 trr v[140:141], v176 offset:36864
 trr v[142:143], v177 offset:36864
 mf v[116:119], v[144:147], a[216:219], v[116:119]
 trr v[144:145], v176 offset:40960
 trr v[146:147], v177 offset:40960
 mf v[116:119], v[148:151], a[220:223], v[116:119]
 trr v[148:149], v176 offset:45056
 trr v[150:151], v177 offset:45056
 mf v[120:123], v[152:155], a[16:19], v[120:123]
 mf v[120:123], v[156:159], a[20:23], v[120:123]
 sad s20, s18, 3
 s_and_b32 s20, s20, 3
 s_lshl_b32 s99, s20, 12
 mf v[120:123], v[160:163], a[24:27], v[120:123]
 cvp v206, v36, v37
 mf v[120:123], v[164:167], a[28:31], v[120:123]
 mf v[124:127], v[152:155], a[80:83], v[124:127]
 s_lshl_b32 s20, s17, 8
 sad s48, s30, s20
 s_addc_u32 s49, s31, 0
 s_sub_u32 s50, 4194304, s20
 mf v[124:127], v[156:159], a[84:87], v[124:127]
 mf v[124:127], v[160:163], a[88:91], v[124:127]
 cvp v207, v38, v39
 mf v[124:127], v[164:167], a[92:95], v[124:127]
 mf v[128:131], v[152:155], a[144:147], v[128:131]
 mf v[128:131], v[156:159], a[148:151], v[128:131]
 mf v[128:131], v[160:163], a[152:155], v[128:131]
 bs4 v[204:207], v199, s[12:15], s34 offen offset:0 sc1
 mf v[128:131], v[164:167], a[156:159], v[128:131]
 swc lgkmcnt(0)
 mf v[132:135], v[152:155], a[208:211], v[132:135]
 trr v[152:153], v178 offset:32768
 trr v[154:155], v179 offset:32768
 mf v[132:135], v[156:159], a[212:215], v[132:135]
 trr v[156:157], v178 offset:36864
 trr v[158:159], v179 offset:36864
 mf v[132:135], v[160:163], a[216:219], v[132:135]
 trr v[160:161], v178 offset:40960
 trr v[162:163], v179 offset:40960
 mf v[132:135], v[164:167], a[220:223], v[132:135]
 trr v[164:165], v178 offset:45056
 trr v[166:167], v179 offset:45056
 mf v[72:75], v[136:139], a[32:35], v[72:75]
 swc vmcnt(24)
 s_barrier
 s_cmp_lg_u32 s16, 0
 s_cbranch_scc1 K1_NS1K
 s_mov_b64 exec, 1
 buffer_atomic_add v5, v4, s[80:83], 0 offen offset:128 sc1
 s_mov_b64 exec, -1
K1_NS1K:
 mf v[72:75], v[140:143], a[36:39], v[72:75]
 sad m0, s36, 81920
 sad s19, s89, 384
 mf v[72:75], v[144:147], a[40:43], v[72:75]
 mf v[72:75], v[148:151], a[44:47], v[72:75]
 mf v[76:79], v[136:139], a[96:99], v[76:79]
 bl4 v192, s[52:55], s19 offen lds
 cvp v200, v40, v41
 mf v[76:79], v[140:143], a[100:103], v[76:79]
 mf v[76:79], v[144:147], a[104:107], v[76:79]
 mf v[76:79], v[148:151], a[108:111], v[76:79]
 sad m0, s36, 82944
 sad s19, s89, 65920
 mf v[80:83], v[136:139], a[160:163], v[80:83]
 mf v[80:83], v[140:143], a[164:167], v[80:83]
 cvp v201, v42, v43
 mf v[80:83], v[144:147], a[168:171], v[80:83]
 bl4 v193, s[52:55], s19 offen lds
 mf v[80:83], v[148:151], a[172:175], v[80:83]
 swc lgkmcnt(0)
 mf v[84:87], v[136:139], a[224:227], v[84:87]
 trr v[136:137], v180 offset:32768
 trr v[138:139], v181 offset:32768
 mf v[84:87], v[140:143], a[228:231], v[84:87]
 trr v[140:141], v180 offset:36864
 trr v[142:143], v181 offset:36864
 mf v[84:87], v[144:147], a[232:235], v[84:87]
 trr v[144:145], v180 offset:40960
 trr v[146:147], v181 offset:40960
 mf v[84:87], v[148:151], a[236:239], v[84:87]
 trr v[148:149], v180 offset:45056
 trr v[150:151], v181 offset:45056
 mf v[88:91], v[152:155], a[32:35], v[88:91]
 mf v[88:91], v[156:159], a[36:39], v[88:91]
 cvp v202, v56, v57
 mf v[88:91], v[160:163], a[40:43], v[88:91]
 sad m0, s36, 83968
 sad s19, s89, 131456
 mf v[88:91], v[164:167], a[44:47], v[88:91]
 mf v[92:95], v[152:155], a[96:99], v[92:95]
 mf v[92:95], v[156:159], a[100:103], v[92:95]
 bl4 v192, s[52:55], s19 offen lds
 mf v[92:95], v[160:163], a[104:107], v[92:95]
 cvp v203, v58, v59
 mf v[92:95], v[164:167], a[108:111], v[92:95]
 mf v[96:99], v[152:155], a[160:163], v[96:99]
 sad m0, s36, 84992
 sad s19, s89, 196992
 mf v[96:99], v[156:159], a[164:167], v[96:99]
 mf v[96:99], v[160:163], a[168:171], v[96:99]
 bs4 v[200:203], v196, s[12:15], s34 offen offset:1024 sc1
 mf v[96:99], v[164:167], a[172:175], v[96:99]
 swc lgkmcnt(0)
 mf v[100:103], v[152:155], a[224:227], v[100:103]
 trr v[152:153], v182 offset:32768
 trr v[154:155], v183 offset:32768
 mf v[100:103], v[156:159], a[228:231], v[100:103]
 trr v[156:157], v182 offset:36864
 trr v[158:159], v183 offset:36864
 mf v[100:103], v[160:163], a[232:235], v[100:103]
 trr v[160:161], v182 offset:40960
 trr v[162:163], v183 offset:40960
 mf v[100:103], v[164:167], a[236:239], v[100:103]
 trr v[164:165], v182 offset:45056
 trr v[166:167], v183 offset:45056
 mf v[104:107], v[136:139], a[32:35], v[104:107]
 bl4 v193, s[52:55], s19 offen lds
 mf v[104:107], v[140:143], a[36:39], v[104:107]
 mf v[104:107], v[144:147], a[40:43], v[104:107]
 mf v[104:107], v[148:151], a[44:47], v[104:107]
 cvp v204, v44, v45
 mf v[108:111], v[136:139], a[96:99], v[108:111]
 mf v[108:111], v[140:143], a[100:103], v[108:111]
 mf v[108:111], v[144:147], a[104:107], v[108:111]
 cvp v205, v46, v47
 mf v[108:111], v[148:151], a[108:111], v[108:111]
 mf v[112:115], v[136:139], a[160:163], v[112:115]
 mf v[112:115], v[140:143], a[164:167], v[112:115]
 mf v[112:115], v[144:147], a[168:171], v[112:115]
 cvp v206, v60, v61
 mf v[112:115], v[148:151], a[172:175], v[112:115]
 swc lgkmcnt(0)
 mf v[116:119], v[136:139], a[224:227], v[116:119]
 trr v[136:137], v176 offset:49152
 trr v[138:139], v177 offset:49152
 mf v[116:119], v[140:143], a[228:231], v[116:119]
 trr v[140:141], v176 offset:53248
 trr v[142:143], v177 offset:53248
 mf v[116:119], v[144:147], a[232:235], v[116:119]
 trr v[144:145], v176 offset:57344
 trr v[146:147], v177 offset:57344
 mf v[116:119], v[148:151], a[236:239], v[116:119]
 trr v[148:149], v176 offset:61440
 trr v[150:151], v177 offset:61440
 mf v[120:123], v[152:155], a[32:35], v[120:123]
 mf v[120:123], v[156:159], a[36:39], v[120:123]
 mf v[120:123], v[160:163], a[40:43], v[120:123]
 cvp v207, v62, v63
 mf v[120:123], v[164:167], a[44:47], v[120:123]
 mf v[124:127], v[152:155], a[96:99], v[124:127]
 mf v[124:127], v[156:159], a[100:103], v[124:127]
 bs4 v[204:207], v197, s[12:15], s34 offen offset:1024 sc1
 mf v[124:127], v[160:163], a[104:107], v[124:127]
 mf v[124:127], v[164:167], a[108:111], v[124:127]
 mf v[128:131], v[152:155], a[160:163], v[128:131]
 cvp v200, v48, v49
 mf v[128:131], v[156:159], a[164:167], v[128:131]
 mf v[128:131], v[160:163], a[168:171], v[128:131]
 mf v[128:131], v[164:167], a[172:175], v[128:131]
 swc lgkmcnt(0)
 mf v[132:135], v[152:155], a[224:227], v[132:135]
 trr v[152:153], v178 offset:49152
 trr v[154:155], v179 offset:49152
 mf v[132:135], v[156:159], a[228:231], v[132:135]
 trr v[156:157], v178 offset:53248
 trr v[158:159], v179 offset:53248
 mf v[132:135], v[160:163], a[232:235], v[132:135]
 trr v[160:161], v178 offset:57344
 trr v[162:163], v179 offset:57344
 mf v[132:135], v[164:167], a[236:239], v[132:135]
 trr v[164:165], v178 offset:61440
 trr v[166:167], v179 offset:61440
 mf v[72:75], v[136:139], a[48:51], v[72:75]
 swc vmcnt(26)
 s_barrier
 mf v[72:75], v[140:143], a[52:55], v[72:75]
 sad m0, s36, 98304
 sad s19, s90, 384
 mf v[72:75], v[144:147], a[56:59], v[72:75]
 cvp v201, v50, v51
 mf v[72:75], v[148:151], a[60:63], v[72:75]
 mf v[76:79], v[136:139], a[112:115], v[76:79]
 bl4 v192, s[52:55], s19 offen lds
 mf v[76:79], v[140:143], a[116:119], v[76:79]
 mf v[76:79], v[144:147], a[120:123], v[76:79]
 cvp v202, v64, v65
 mf v[76:79], v[148:151], a[124:127], v[76:79]
 sad m0, s36, 99328
 sad s19, s90, 65920
 mf v[80:83], v[136:139], a[176:179], v[80:83]
 mf v[80:83], v[140:143], a[180:183], v[80:83]
 mf v[80:83], v[144:147], a[184:187], v[80:83]
 bl4 v193, s[52:55], s19 offen lds
 mf v[80:83], v[148:151], a[188:191], v[80:83]
 swc lgkmcnt(0)
 mf v[84:87], v[136:139], a[240:243], v[84:87]
 trr v[136:137], v180 offset:49152
 trr v[138:139], v181 offset:49152
 mf v[84:87], v[140:143], a[244:247], v[84:87]
 trr v[140:141], v180 offset:53248
 trr v[142:143], v181 offset:53248
 mf v[84:87], v[144:147], a[248:251], v[84:87]
 trr v[144:145], v180 offset:57344
 trr v[146:147], v181 offset:57344
 mf v[84:87], v[148:151], a[252:255], v[84:87]
 trr v[148:149], v180 offset:61440
 trr v[150:151], v181 offset:61440
 mf v[88:91], v[152:155], a[48:51], v[88:91]
 cvp v203, v66, v67
 mf v[88:91], v[156:159], a[52:55], v[88:91]
 mf v[88:91], v[160:163], a[56:59], v[88:91]
 sad m0, s36, 100352
 sad s19, s90, 131456
 mf v[88:91], v[164:167], a[60:63], v[88:91]
 mf v[92:95], v[152:155], a[112:115], v[92:95]
 bs4 v[200:203], v198, s[12:15], s34 offen offset:1024 sc1
 mf v[92:95], v[156:159], a[116:119], v[92:95]
 bl4 v192, s[52:55], s19 offen lds
 mf v[92:95], v[160:163], a[120:123], v[92:95]
 mf v[92:95], v[164:167], a[124:127], v[92:95]
 mf v[96:99], v[152:155], a[176:179], v[96:99]
 sad m0, s36, 101376
 sad s19, s90, 196992
 mf v[96:99], v[156:159], a[180:183], v[96:99]
 cvp v204, v52, v53
 mf v[96:99], v[160:163], a[184:187], v[96:99]
 mf v[96:99], v[164:167], a[188:191], v[96:99]
 swc lgkmcnt(0)
 mf v[100:103], v[152:155], a[240:243], v[100:103]
 trr v[152:153], v182 offset:49152
 trr v[154:155], v183 offset:49152
 mf v[100:103], v[156:159], a[244:247], v[100:103]
 trr v[156:157], v182 offset:53248
 trr v[158:159], v183 offset:53248
 mf v[100:103], v[160:163], a[248:251], v[100:103]
 trr v[160:161], v182 offset:57344
 trr v[162:163], v183 offset:57344
 mf v[100:103], v[164:167], a[252:255], v[100:103]
 trr v[164:165], v182 offset:61440
 trr v[166:167], v183 offset:61440
 mf v[104:107], v[136:139], a[48:51], v[104:107]
 bl4 v193, s[52:55], s19 offen lds
 mf v[104:107], v[140:143], a[52:55], v[104:107]
 cvp v205, v54, v55
 mf v[104:107], v[144:147], a[56:59], v[104:107]
 mf v[104:107], v[148:151], a[60:63], v[104:107]
 mf v[108:111], v[136:139], a[112:115], v[108:111]
 mf v[108:111], v[140:143], a[116:119], v[108:111]
 cvp v206, v68, v69
 mf v[108:111], v[144:147], a[120:123], v[108:111]
 mf v[108:111], v[148:151], a[124:127], v[108:111]
 mf v[112:115], v[136:139], a[176:179], v[112:115]
 cvp v207, v70, v71
 mf v[112:115], v[140:143], a[180:183], v[112:115]
 mf v[112:115], v[144:147], a[184:187], v[112:115]
 mf v[112:115], v[148:151], a[188:191], v[112:115]
 swc lgkmcnt(0)
 mf v[116:119], v[136:139], a[240:243], v[116:119]
 trr v[136:137], v168 offset:0
 trr v[138:139], v169 offset:0
 mf v[116:119], v[140:143], a[244:247], v[116:119]
 trr v[140:141], v168 offset:4096
 trr v[142:143], v169 offset:4096
 mf v[116:119], v[144:147], a[248:251], v[116:119]
 trr v[144:145], v168 offset:8192
 trr v[146:147], v169 offset:8192
 mf v[116:119], v[148:151], a[252:255], v[116:119]
 trr v[148:149], v168 offset:12288
 trr v[150:151], v169 offset:12288
 mf v[120:123], v[152:155], a[48:51], v[120:123]
 bs4 v[204:207], v199, s[12:15], s34 offen offset:1024 sc1
 mf v[120:123], v[156:159], a[52:55], v[120:123]
 mf v[120:123], v[160:163], a[56:59], v[120:123]
 mf v[120:123], v[164:167], a[60:63], v[120:123]
 mf v[124:127], v[152:155], a[112:115], v[124:127]
 mf v[124:127], v[156:159], a[116:119], v[124:127]
 mf v[124:127], v[160:163], a[120:123], v[124:127]
 mf v[124:127], v[164:167], a[124:127], v[124:127]
 mf v[128:131], v[152:155], a[176:179], v[128:131]
 mf v[128:131], v[156:159], a[180:183], v[128:131]
 mf v[128:131], v[160:163], a[184:187], v[128:131]
 mf v[128:131], v[164:167], a[188:191], v[128:131]
 swc lgkmcnt(0)
 mf v[132:135], v[152:155], a[240:243], v[132:135]
 trr v[152:153], v170 offset:0
 trr v[154:155], v171 offset:0
 mf v[132:135], v[156:159], a[244:247], v[132:135]
 trr v[156:157], v170 offset:4096
 trr v[158:159], v171 offset:4096
 mf v[132:135], v[160:163], a[248:251], v[132:135]
 trr v[160:161], v170 offset:8192
 trr v[162:163], v171 offset:8192
 mf v[132:135], v[164:167], a[252:255], v[132:135]
 trr v[164:165], v170 offset:12288
 trr v[166:167], v171 offset:12288
 s_getpc_b64 s[84:85]
CT2:
 sad s84, s84, (K1_FIN-CT2)&0xffffffff
 s_addc_u32 s85, s85, ((K1_FIN-CT2)>>32)&0xffffffff
 s_lshr_b32 s86, s2, 3
 s_lshl_b32 s86, s86, 2
 sad s86, s86, s16
 s_mul_i32 s86, s86, ((K2_END-K1_FIN+16383)/16384)*128
 v_lshlrev_b32 v7, 7, v0
 v_min_u32 v7, ((K2_END-K1_FIN+16383)/16384)*128-128, v7
 v_add_u32 v7, s86, v7
 v_min_u32 v7, K2_END-K1_FIN-4, v7
 global_load_dword v7, v7, s[84:85]
 mf v[8:11], v[136:139], a[0:3], 0
 swc vmcnt(29)
 s_barrier
 mf v[8:11], v[140:143], a[4:7], v[8:11]
 sad m0, s36, 114688
 sad s19, s91, 384
 mf v[8:11], v[144:147], a[8:11], v[8:11]
 mf v[8:11], v[148:151], a[12:15], v[8:11]
 mf v[12:15], v[136:139], a[64:67], 0
 bl4 v192, s[52:55], s19 offen lds
 mf v[12:15], v[140:143], a[68:71], v[12:15]
 mf v[12:15], v[144:147], a[72:75], v[12:15]
 sad s34, s35, 2048
 mf v[12:15], v[148:151], a[76:79], v[12:15]
 sad m0, s36, 115712
 sad s19, s91, 65920
 mf v[16:19], v[136:139], a[128:131], 0
 mf v[16:19], v[140:143], a[132:135], v[16:19]
 mf v[16:19], v[144:147], a[136:139], v[16:19]
 bl4 v193, s[52:55], s19 offen lds
 cvp v200, v72, v73
 mf v[16:19], v[148:151], a[140:143], v[16:19]
 swc lgkmcnt(0)
 mf v[20:23], v[136:139], a[192:195], 0
 trr v[136:137], v172 offset:0
 trr v[138:139], v173 offset:0
 mf v[20:23], v[140:143], a[196:199], v[20:23]
 trr v[140:141], v172 offset:4096
 trr v[142:143], v173 offset:4096
 mf v[20:23], v[144:147], a[200:203], v[20:23]
 trr v[144:145], v172 offset:8192
 trr v[146:147], v173 offset:8192
 mf v[20:23], v[148:151], a[204:207], v[20:23]
 trr v[148:149], v172 offset:12288
 trr v[150:151], v173 offset:12288
 mf v[24:27], v[152:155], a[0:3], 0
 mf v[24:27], v[156:159], a[4:7], v[24:27]
 mf v[24:27], v[160:163], a[8:11], v[24:27]
 sad m0, s36, 116736
 sad s19, s91, 131456
 mf v[24:27], v[164:167], a[12:15], v[24:27]
 cvp v201, v74, v75
 mf v[28:31], v[152:155], a[64:67], 0
 mf v[28:31], v[156:159], a[68:71], v[28:31]
 bl4 v192, s[52:55], s19 offen lds
 mf v[28:31], v[160:163], a[72:75], v[28:31]
 mf v[28:31], v[164:167], a[76:79], v[28:31]
 cvp v202, v88, v89
 mf v[32:35], v[152:155], a[128:131], 0
 sad m0, s36, 117760
 sad s19, s91, 196992
 mf v[32:35], v[156:159], a[132:135], v[32:35]
 mf v[32:35], v[160:163], a[136:139], v[32:35]
 mf v[32:35], v[164:167], a[140:143], v[32:35]
 swc lgkmcnt(0)
 mf v[36:39], v[152:155], a[192:195], 0
 trr v[152:153], v174 offset:0
 trr v[154:155], v175 offset:0
 mf v[36:39], v[156:159], a[196:199], v[36:39]
 trr v[156:157], v174 offset:4096
 trr v[158:159], v175 offset:4096
 mf v[36:39], v[160:163], a[200:203], v[36:39]
 trr v[160:161], v174 offset:8192
 trr v[162:163], v175 offset:8192
 mf v[36:39], v[164:167], a[204:207], v[36:39]
 trr v[164:165], v174 offset:12288
 trr v[166:167], v175 offset:12288
 mf v[40:43], v[136:139], a[0:3], 0
 bl4 v193, s[52:55], s19 offen lds
 cvp v203, v90, v91
 mf v[40:43], v[140:143], a[4:7], v[40:43]
 mf v[40:43], v[144:147], a[8:11], v[40:43]
 mf v[40:43], v[148:151], a[12:15], v[40:43]
 bs4 v[200:203], v196, s[12:15], s34 offen offset:0 sc1
 mf v[44:47], v[136:139], a[64:67], 0
 mf v[44:47], v[140:143], a[68:71], v[44:47]
 mf v[44:47], v[144:147], a[72:75], v[44:47]
 mf v[44:47], v[148:151], a[76:79], v[44:47]
 cvp v204, v76, v77
 mf v[48:51], v[136:139], a[128:131], 0
 mf v[48:51], v[140:143], a[132:135], v[48:51]
 mf v[48:51], v[144:147], a[136:139], v[48:51]
 cvp v205, v78, v79
 mf v[48:51], v[148:151], a[140:143], v[48:51]
 swc lgkmcnt(0)
 mf v[52:55], v[136:139], a[192:195], 0
 trr v[136:137], v168 offset:16384
 trr v[138:139], v169 offset:16384
 mf v[52:55], v[140:143], a[196:199], v[52:55]
 trr v[140:141], v168 offset:20480
 trr v[142:143], v169 offset:20480
 mf v[52:55], v[144:147], a[200:203], v[52:55]
 trr v[144:145], v168 offset:24576
 trr v[146:147], v169 offset:24576
 mf v[52:55], v[148:151], a[204:207], v[52:55]
 trr v[148:149], v168 offset:28672
 trr v[150:151], v169 offset:28672
 mf v[56:59], v[152:155], a[0:3], 0
 mf v[56:59], v[156:159], a[4:7], v[56:59]
 mf v[56:59], v[160:163], a[8:11], v[56:59]
 cvp v206, v92, v93
 mf v[56:59], v[164:167], a[12:15], v[56:59]
 mf v[60:63], v[152:155], a[64:67], 0
 mf v[60:63], v[156:159], a[68:71], v[60:63]
 cvp v207, v94, v95
 mf v[60:63], v[160:163], a[72:75], v[60:63]
 mf v[60:63], v[164:167], a[76:79], v[60:63]
 mf v[64:67], v[152:155], a[128:131], 0
 bs4 v[204:207], v197, s[12:15], s34 offen offset:0 sc1
 mf v[64:67], v[156:159], a[132:135], v[64:67]
 mf v[64:67], v[160:163], a[136:139], v[64:67]
 mf v[64:67], v[164:167], a[140:143], v[64:67]
 swc lgkmcnt(0)
 mf v[68:71], v[152:155], a[192:195], 0
 trr v[152:153], v170 offset:16384
 trr v[154:155], v171 offset:16384
 mf v[68:71], v[156:159], a[196:199], v[68:71]
 trr v[156:157], v170 offset:20480
 trr v[158:159], v171 offset:20480
 mf v[68:71], v[160:163], a[200:203], v[68:71]
 trr v[160:161], v170 offset:24576
 trr v[162:163], v171 offset:24576
 mf v[68:71], v[164:167], a[204:207], v[68:71]
 trr v[164:165], v170 offset:28672
 trr v[166:167], v171 offset:28672
 mf v[8:11], v[136:139], a[16:19], v[8:11]
 swc vmcnt(31)
 s_barrier
 mf v[8:11], v[140:143], a[20:23], v[8:11]
 sad m0, s36, 0
 sad s19, s92, 0
 mf v[8:11], v[144:147], a[24:27], v[8:11]
 cvp v200, v80, v81
 mf v[8:11], v[148:151], a[28:31], v[8:11]
 bl4 v194, s[56:59], s19 offen lds
 mf v[12:15], v[136:139], a[80:83], v[12:15]
 mf v[12:15], v[140:143], a[84:87], v[12:15]
 sad m0, s36, 1024
 sad s19, s92, 44032
 mf v[12:15], v[144:147], a[88:91], v[12:15]
 mf v[12:15], v[148:151], a[92:95], v[12:15]
 bl4 v194, s[56:59], s19 offen lds
 cvp v201, v82, v83
 mf v[16:19], v[136:139], a[144:147], v[16:19]
 mf v[16:19], v[140:143], a[148:151], v[16:19]
 sad m0, s36, 2048
 sad s19, s92, 0
 mf v[16:19], v[144:147], a[152:155], v[16:19]
 mf v[16:19], v[148:151], a[156:159], v[16:19]
 swc lgkmcnt(0)
 mf v[20:23], v[136:139], a[208:211], v[20:23]
 trr v[136:137], v172 offset:16384
 trr v[138:139], v173 offset:16384
 mf v[20:23], v[140:143], a[212:215], v[20:23]
 trr v[140:141], v172 offset:20480
 trr v[142:143], v173 offset:20480
 mf v[20:23], v[144:147], a[216:219], v[20:23]
 trr v[144:145], v172 offset:24576
 trr v[146:147], v173 offset:24576
 mf v[20:23], v[148:151], a[220:223], v[20:23]
 trr v[148:149], v172 offset:28672
 trr v[150:151], v173 offset:28672
 mf v[24:27], v[152:155], a[16:19], v[24:27]
 bl4 v194, s[60:63], s19 offen lds
 cvp v202, v96, v97
 mf v[24:27], v[156:159], a[20:23], v[24:27]
 mf v[24:27], v[160:163], a[24:27], v[24:27]
 sad m0, s36, 3072
 sad s19, s92, 44032
 mf v[24:27], v[164:167], a[28:31], v[24:27]
 mf v[28:31], v[152:155], a[80:83], v[28:31]
 bl4 v194, s[60:63], s19 offen lds
 mf v[28:31], v[156:159], a[84:87], v[28:31]
 cvp v203, v98, v99
 mf v[28:31], v[160:163], a[88:91], v[28:31]
 s_lshl_b32 s20, s100, 6
 sad s46, s20, 60817408
 mf v[28:31], v[164:167], a[92:95], v[28:31]
 mf v[32:35], v[152:155], a[144:147], v[32:35]
 s_lshl_b32 s20, s101, 6
 sad s47, s20, 60817408
 mf v[32:35], v[156:159], a[148:151], v[32:35]
 mf v[32:35], v[160:163], a[152:155], v[32:35]
 s_lshr_b32 s20, s100, 2
 s_mul_i32 s24, s20, 700416
 mf v[32:35], v[164:167], a[156:159], v[32:35]
 swc lgkmcnt(0)
 mf v[36:39], v[152:155], a[208:211], v[36:39]
 trr v[152:153], v174 offset:16384
 trr v[154:155], v175 offset:16384
 mf v[36:39], v[156:159], a[212:215], v[36:39]
 trr v[156:157], v174 offset:20480
 trr v[158:159], v175 offset:20480
 mf v[36:39], v[160:163], a[216:219], v[36:39]
 trr v[160:161], v174 offset:24576
 trr v[162:163], v175 offset:24576
 mf v[36:39], v[164:167], a[220:223], v[36:39]
 trr v[164:165], v174 offset:28672
 trr v[166:167], v175 offset:28672
 mf v[40:43], v[136:139], a[16:19], v[40:43]
 bs4 v[200:203], v198, s[12:15], s34 offen offset:0 sc1
 mf v[40:43], v[140:143], a[20:23], v[40:43]
 s_lshr_b32 s20, s101, 2
 s_mul_i32 s25, s20, 700416
 mf v[40:43], v[144:147], a[24:27], v[40:43]
 mf v[40:43], v[148:151], a[28:31], v[40:43]
 s_lshl_b32 s100, s100, 14
 sad s100, s100, 58720256
 mf v[44:47], v[136:139], a[80:83], v[44:47]
 mf v[44:47], v[140:143], a[84:87], v[44:47]
 s_lshl_b32 s101, s101, 14
 sad s101, s101, 58720256
 mf v[44:47], v[144:147], a[88:91], v[44:47]
 cvp v204, v84, v85
 mf v[44:47], v[148:151], a[92:95], v[44:47]
 s_lshl_b32 s20, s16, 1
 s_sub_u32 s20, 7, s20
 s_lshl_b32 s3, s20, 14
 v_add_u32 v255, s3, v195
 s_lshl_b32 s3, s20, 6
 v_add_u32 v6, s3, v253
 mf v[48:51], v[136:139], a[144:147], v[48:51]
 mf v[48:51], v[140:143], a[148:151], v[48:51]
 s_lshl_b32 s20, s96, 8
 s_lshl_b32 s3, s16, 18
 sad s88, s20, s3
 mf v[48:51], v[144:147], a[152:155], v[48:51]
 mf v[48:51], v[148:151], a[156:159], v[48:51]
 swc lgkmcnt(0)
 mf v[52:55], v[136:139], a[208:211], v[52:55]
 trr v[136:137], v168 offset:32768
 trr v[138:139], v169 offset:32768
 mf v[52:55], v[140:143], a[212:215], v[52:55]
 trr v[140:141], v168 offset:36864
 trr v[142:143], v169 offset:36864
 mf v[52:55], v[144:147], a[216:219], v[52:55]
 trr v[144:145], v168 offset:40960
 trr v[146:147], v169 offset:40960
 mf v[52:55], v[148:151], a[220:223], v[52:55]
 trr v[148:149], v168 offset:45056
 trr v[150:151], v169 offset:45056
 mf v[56:59], v[152:155], a[16:19], v[56:59]
 s_lshl_b32 s20, s97, 8
 s_lshl_b32 s3, s16, 18
 sad s89, s20, s3
 mf v[56:59], v[156:159], a[20:23], v[56:59]
 cvp v205, v86, v87
 mf v[56:59], v[160:163], a[24:27], v[56:59]
 s_lshl_b32 s20, s98, 8
 s_lshl_b32 s3, s16, 18
 sad s90, s20, s3
 mf v[56:59], v[164:167], a[28:31], v[56:59]
 mf v[60:63], v[152:155], a[80:83], v[60:63]
 s_lshl_b32 s20, s99, 8
 s_lshl_b32 s3, s16, 18
 sad s91, s20, s3
 mf v[60:63], v[156:159], a[84:87], v[60:63]
 mf v[60:63], v[160:163], a[88:91], v[60:63]
 cvp v206, v100, v101
 mf v[60:63], v[164:167], a[92:95], v[60:63]
 mf v[64:67], v[152:155], a[144:147], v[64:67]
 mf v[64:67], v[156:159], a[148:151], v[64:67]
 mf v[64:67], v[160:163], a[152:155], v[64:67]
 cvp v207, v102, v103
 mf v[64:67], v[164:167], a[156:159], v[64:67]
 swc lgkmcnt(0)
 mf v[68:71], v[152:155], a[208:211], v[68:71]
 trr v[152:153], v170 offset:32768
 trr v[154:155], v171 offset:32768
 mf v[68:71], v[156:159], a[212:215], v[68:71]
 trr v[156:157], v170 offset:36864
 trr v[158:159], v171 offset:36864
 mf v[68:71], v[160:163], a[216:219], v[68:71]
 trr v[160:161], v170 offset:40960
 trr v[162:163], v171 offset:40960
 mf v[68:71], v[164:167], a[220:223], v[68:71]
 trr v[164:165], v170 offset:45056
 trr v[166:167], v171 offset:45056
 mf v[8:11], v[136:139], a[32:35], v[8:11]
 swc vmcnt(32)
 s_barrier
 mf v[8:11], v[140:143], a[36:39], v[8:11]
 sad m0, s36, 16384
 sad s19, s93, 0
 mf v[8:11], v[144:147], a[40:43], v[8:11]
 mf v[8:11], v[148:151], a[44:47], v[8:11]
 bs4 v[204:207], v199, s[12:15], s34 offen offset:0 sc1
 mf v[12:15], v[136:139], a[96:99], v[12:15]
 bl4 v194, s[56:59], s19 offen lds
 mf v[12:15], v[140:143], a[100:103], v[12:15]
 mf v[12:15], v[144:147], a[104:107], v[12:15]
 mf v[12:15], v[148:151], a[108:111], v[12:15]
 sad m0, s36, 17408
 sad s19, s93, 44032
 mf v[16:19], v[136:139], a[160:163], v[16:19]
 cvp v200, v104, v105
 mf v[16:19], v[140:143], a[164:167], v[16:19]
 mf v[16:19], v[144:147], a[168:171], v[16:19]
 bl4 v194, s[56:59], s19 offen lds
 mf v[16:19], v[148:151], a[172:175], v[16:19]
 swc lgkmcnt(0)
 mf v[20:23], v[136:139], a[224:227], v[20:23]
 trr v[136:137], v172 offset:32768
 trr v[138:139], v173 offset:32768
 mf v[20:23], v[140:143], a[228:231], v[20:23]
 trr v[140:141], v172 offset:36864
 trr v[142:143], v173 offset:36864
 mf v[20:23], v[144:147], a[232:235], v[20:23]
 trr v[144:145], v172 offset:40960
 trr v[146:147], v173 offset:40960
 mf v[20:23], v[148:151], a[236:239], v[20:23]
 trr v[148:149], v172 offset:45056
 trr v[150:151], v173 offset:45056
 mf v[24:27], v[152:155], a[32:35], v[24:27]
 cvp v201, v106, v107
 mf v[24:27], v[156:159], a[36:39], v[24:27]
 mf v[24:27], v[160:163], a[40:43], v[24:27]
 sad m0, s36, 18432
 sad s19, s93, 0
 mf v[24:27], v[164:167], a[44:47], v[24:27]
 mf v[28:31], v[152:155], a[96:99], v[28:31]
 mf v[28:31], v[156:159], a[100:103], v[28:31]
 bl4 v194, s[60:63], s19 offen lds
 cvp v202, v120, v121
 mf v[28:31], v[160:163], a[104:107], v[28:31]
 mf v[28:31], v[164:167], a[108:111], v[28:31]
 mf v[32:35], v[152:155], a[160:163], v[32:35]
 sad m0, s36, 19456
 sad s19, s93, 44032
 mf v[32:35], v[156:159], a[164:167], v[32:35]
 cvp v203, v122, v123
 mf v[32:35], v[160:163], a[168:171], v[32:35]
 mf v[32:35], v[164:167], a[172:175], v[32:35]
 swc lgkmcnt(0)
 mf v[36:39], v[152:155], a[224:227], v[36:39]
 trr v[152:153], v174 offset:32768
 trr v[154:155], v175 offset:32768
 mf v[36:39], v[156:159], a[228:231], v[36:39]
 trr v[156:157], v174 offset:36864
 trr v[158:159], v175 offset:36864
 mf v[36:39], v[160:163], a[232:235], v[36:39]
 trr v[160:161], v174 offset:40960
 trr v[162:163], v175 offset:40960
 mf v[36:39], v[164:167], a[236:239], v[36:39]
 trr v[164:165], v174 offset:45056
 trr v[166:167], v175 offset:45056
 mf v[40:43], v[136:139], a[32:35], v[40:43]
 bl4 v194, s[60:63], s19 offen lds
 mf v[40:43], v[140:143], a[36:39], v[40:43]
 mf v[40:43], v[144:147], a[40:43], v[40:43]
 bs4 v[200:203], v196, s[12:15], s34 offen offset:1024 sc1
 mf v[40:43], v[148:151], a[44:47], v[40:43]
 mf v[44:47], v[136:139], a[96:99], v[44:47]
 mf v[44:47], v[140:143], a[100:103], v[44:47]
 cvp v204, v108, v109
 mf v[44:47], v[144:147], a[104:107], v[44:47]
 mf v[44:47], v[148:151], a[108:111], v[44:47]
 mf v[48:51], v[136:139], a[160:163], v[48:51]
 cvp v205, v110, v111
 mf v[48:51], v[140:143], a[164:167], v[48:51]
 mf v[48:51], v[144:147], a[168:171], v[48:51]
 mf v[48:51], v[148:151], a[172:175], v[48:51]
 swc lgkmcnt(0)
 mf v[52:55], v[136:139], a[224:227], v[52:55]
 trr v[136:137], v168 offset:49152
 trr v[138:139], v169 offset:49152
 mf v[52:55], v[140:143], a[228:231], v[52:55]
 trr v[140:141], v168 offset:53248
 trr v[142:143], v169 offset:53248
 mf v[52:55], v[144:147], a[232:235], v[52:55]
 trr v[144:145], v168 offset:57344
 trr v[146:147], v169 offset:57344
 mf v[52:55], v[148:151], a[236:239], v[52:55]
 trr v[148:149], v168 offset:61440
 trr v[150:151], v169 offset:61440
 mf v[56:59], v[152:155], a[32:35], v[56:59]
 cvp v206, v124, v125
 mf v[56:59], v[156:159], a[36:39], v[56:59]
 mf v[56:59], v[160:163], a[40:43], v[56:59]
 mf v[56:59], v[164:167], a[44:47], v[56:59]
 cvp v207, v126, v127
 mf v[60:63], v[152:155], a[96:99], v[60:63]
 mf v[60:63], v[156:159], a[100:103], v[60:63]
 mf v[60:63], v[160:163], a[104:107], v[60:63]
 mf v[60:63], v[164:167], a[108:111], v[60:63]
 bs4 v[204:207], v197, s[12:15], s34 offen offset:1024 sc1
 mf v[64:67], v[152:155], a[160:163], v[64:67]
 mf v[64:67], v[156:159], a[164:167], v[64:67]
 mf v[64:67], v[160:163], a[168:171], v[64:67]
 cvp v200, v112, v113
 mf v[64:67], v[164:167], a[172:175], v[64:67]
 swc lgkmcnt(0)
 mf v[68:71], v[152:155], a[224:227], v[68:71]
 trr v[152:153], v170 offset:49152
 trr v[154:155], v171 offset:49152
 mf v[68:71], v[156:159], a[228:231], v[68:71]
 trr v[156:157], v170 offset:53248
 trr v[158:159], v171 offset:53248
 mf v[68:71], v[160:163], a[232:235], v[68:71]
 trr v[160:161], v170 offset:57344
 trr v[162:163], v171 offset:57344
 mf v[68:71], v[164:167], a[236:239], v[68:71]
 trr v[164:165], v170 offset:61440
 trr v[166:167], v171 offset:61440
 mf v[8:11], v[136:139], a[48:51], v[8:11]
 swc vmcnt(32)
 s_barrier
 mf v[8:11], v[140:143], a[52:55], v[8:11]
 sad m0, s36, 32768
 sad s19, s94, 0
 mf v[8:11], v[144:147], a[56:59], v[8:11]
 mf v[8:11], v[148:151], a[60:63], v[8:11]
 mf v[12:15], v[136:139], a[112:115], v[12:15]
 bl4 v194, s[56:59], s19 offen lds
 cvp v201, v114, v115
 mf v[12:15], v[140:143], a[116:119], v[12:15]
 mf v[12:15], v[144:147], a[120:123], v[12:15]
 mf v[12:15], v[148:151], a[124:127], v[12:15]
 sad m0, s36, 33792
 sad s19, s94, 44032
 mf v[16:19], v[136:139], a[176:179], v[16:19]
 cvp v202, v128, v129
 mf v[16:19], v[140:143], a[180:183], v[16:19]
 mf v[16:19], v[144:147], a[184:187], v[16:19]
 bl4 v194, s[56:59], s19 offen lds
 mf v[16:19], v[148:151], a[188:191], v[16:19]
 swc lgkmcnt(0)
 mf v[20:23], v[136:139], a[240:243], v[20:23]
 trr v[136:137], v172 offset:49152
 trr v[138:139], v173 offset:49152
 mf v[20:23], v[140:143], a[244:247], v[20:23]
 trr v[140:141], v172 offset:53248
 trr v[142:143], v173 offset:53248
 mf v[20:23], v[144:147], a[248:251], v[20:23]
 trr v[144:145], v172 offset:57344
 trr v[146:147], v173 offset:57344
 mf v[20:23], v[148:151], a[252:255], v[20:23]
 trr v[148:149], v172 offset:61440
 trr v[150:151], v173 offset:61440
 mf v[24:27], v[152:155], a[48:51], v[24:27]
 mf v[24:27], v[156:159], a[52:55], v[24:27]
 cvp v203, v130, v131
 mf v[24:27], v[160:163], a[56:59], v[24:27]
 sad m0, s36, 34816
 sad s19, s94, 0
 mf v[24:27], v[164:167], a[60:63], v[24:27]
 mf v[28:31], v[152:155], a[112:115], v[28:31]
 mf v[28:31], v[156:159], a[116:119], v[28:31]
 bl4 v194, s[60:63], s19 offen lds
 mf v[28:31], v[160:163], a[120:123], v[28:31]
 bs4 v[200:203], v198, s[12:15], s34 offen offset:1024 sc1
 mf v[28:31], v[164:167], a[124:127], v[28:31]
 mf v[32:35], v[152:155], a[176:179], v[32:35]
 sad m0, s36, 35840
 sad s19, s94, 44032
 mf v[32:35], v[156:159], a[180:183], v[32:35]
 mf v[32:35], v[160:163], a[184:187], v[32:35]
 cvp v204, v116, v117
 mf v[32:35], v[164:167], a[188:191], v[32:35]
 swc lgkmcnt(0)
 mf v[36:39], v[152:155], a[240:243], v[36:39]
 trr v[152:153], v174 offset:49152
 trr v[154:155], v175 offset:49152
 mf v[36:39], v[156:159], a[244:247], v[36:39]
 trr v[156:157], v174 offset:53248
 trr v[158:159], v175 offset:53248
 mf v[36:39], v[160:163], a[248:251], v[36:39]
 trr v[160:161], v174 offset:57344
 trr v[162:163], v175 offset:57344
 mf v[36:39], v[164:167], a[252:255], v[36:39]
 trr v[164:165], v174 offset:61440
 trr v[166:167], v175 offset:61440
 mf v[40:43], v[136:139], a[48:51], v[40:43]
 bl4 v194, s[60:63], s19 offen lds
 mf v[40:43], v[140:143], a[52:55], v[40:43]
 mf v[40:43], v[144:147], a[56:59], v[40:43]
 cvp v205, v118, v119
 mf v[40:43], v[148:151], a[60:63], v[40:43]
 buffer_load_dword v254, v253, s[80:83], 0 offen offset:128 sc1
 mf v[44:47], v[136:139], a[112:115], v[44:47]
 mf v[44:47], v[140:143], a[116:119], v[44:47]
 mf v[44:47], v[144:147], a[120:123], v[44:47]
 cvp v206, v132, v133
 mf v[44:47], v[148:151], a[124:127], v[44:47]
 mf v[48:51], v[136:139], a[176:179], v[48:51]
 mf v[48:51], v[140:143], a[180:183], v[48:51]
 cvp v207, v134, v135
 mf v[48:51], v[144:147], a[184:187], v[48:51]
 mf v[48:51], v[148:151], a[188:191], v[48:51]
 swc lgkmcnt(0)
 mf v[52:55], v[136:139], a[240:243], v[52:55]
 trr v[136:137], v176 offset:0
 trr v[138:139], v177 offset:0
 mf v[52:55], v[140:143], a[244:247], v[52:55]
 trr v[140:141], v176 offset:4096
 trr v[142:143], v177 offset:4096
 mf v[52:55], v[144:147], a[248:251], v[52:55]
 trr v[144:145], v176 offset:8192
 trr v[146:147], v177 offset:8192
 mf v[52:55], v[148:151], a[252:255], v[52:55]
 trr v[148:149], v176 offset:12288
 trr v[150:151], v177 offset:12288
 mf v[56:59], v[152:155], a[48:51], v[56:59]
 mf v[56:59], v[156:159], a[52:55], v[56:59]
 bs4 v[204:207], v199, s[12:15], s34 offen offset:1024 sc1
 mf v[56:59], v[160:163], a[56:59], v[56:59]
 mf v[56:59], v[164:167], a[60:63], v[56:59]
 mf v[60:63], v[152:155], a[112:115], v[60:63]
 mf v[60:63], v[156:159], a[116:119], v[60:63]
 mf v[60:63], v[160:163], a[120:123], v[60:63]
 mf v[60:63], v[164:167], a[124:127], v[60:63]
 mf v[64:67], v[152:155], a[176:179], v[64:67]
 mf v[64:67], v[156:159], a[180:183], v[64:67]
 mf v[64:67], v[160:163], a[184:187], v[64:67]
 mf v[64:67], v[164:167], a[188:191], v[64:67]
 swc lgkmcnt(0)
 mf v[68:71], v[152:155], a[240:243], v[68:71]
 trr v[152:153], v178 offset:0
 trr v[154:155], v179 offset:0
 mf v[68:71], v[156:159], a[244:247], v[68:71]
 trr v[156:157], v178 offset:4096
 trr v[158:159], v179 offset:4096
 mf v[68:71], v[160:163], a[248:251], v[68:71]
 trr v[160:161], v178 offset:8192
 trr v[162:163], v179 offset:8192
 mf v[68:71], v[164:167], a[252:255], v[68:71]
 trr v[164:165], v178 offset:12288
 trr v[166:167], v179 offset:12288
 swc vmcnt(1)
 v_cmp_ne_u32 vcc, 16, v254
 s_cbranch_vccnz K1_XSK
K1_XSK_B:
 mf v[72:75], v[136:139], a[0:3], 0
 swc vmcnt(33)
 s_barrier
 mf v[72:75], v[140:143], a[4:7], v[72:75]
 sad m0, s36, 49152
 sad s19, s95, 0
 mf v[72:75], v[144:147], a[8:11], v[72:75]
 mf v[72:75], v[148:151], a[12:15], v[72:75]
 mf v[76:79], v[136:139], a[64:67], 0
 bl4 v194, s[56:59], s19 offen lds
 mf v[76:79], v[140:143], a[68:71], v[76:79]
 mf v[76:79], v[144:147], a[72:75], v[76:79]
 sad s34, s35, 1048576
 mf v[76:79], v[148:151], a[76:79], v[76:79]
 sad m0, s36, 50176
 sad s19, s95, 44032
 mf v[80:83], v[136:139], a[128:131], 0
 mf v[80:83], v[140:143], a[132:135], v[80:83]
 cvp v200, v8, v9
 mf v[80:83], v[144:147], a[136:139], v[80:83]
 bl4 v194, s[56:59], s19 offen lds
 mf v[80:83], v[148:151], a[140:143], v[80:83]
 swc lgkmcnt(0)
 mf v[84:87], v[136:139], a[192:195], 0
 trr v[136:137], v180 offset:0
 trr v[138:139], v181 offset:0
 mf v[84:87], v[140:143], a[196:199], v[84:87]
 trr v[140:141], v180 offset:4096
 trr v[142:143], v181 offset:4096
 mf v[84:87], v[144:147], a[200:203], v[84:87]
 trr v[144:145], v180 offset:8192
 trr v[146:147], v181 offset:8192
 mf v[84:87], v[148:151], a[204:207], v[84:87]
 trr v[148:149], v180 offset:12288
 trr v[150:151], v181 offset:12288
 mf v[88:91], v[152:155], a[0:3], 0
 mf v[88:91], v[156:159], a[4:7], v[88:91]
 cvp v201, v10, v11
 mf v[88:91], v[160:163], a[8:11], v[88:91]
 sad m0, s36, 51200
 sad s19, s95, 0
 mf v[88:91], v[164:167], a[12:15], v[88:91]
 mf v[92:95], v[152:155], a[64:67], 0
 mf v[92:95], v[156:159], a[68:71], v[92:95]
 bl4 v194, s[60:63], s19 offen lds
 mf v[92:95], v[160:163], a[72:75], v[92:95]
 cvp v202, v24, v25
 mf v[92:95], v[164:167], a[76:79], v[92:95]
 mf v[96:99], v[152:155], a[128:131], 0
 sad m0, s36, 52224
 sad s19, s95, 44032
 mf v[96:99], v[156:159], a[132:135], v[96:99]
 cvp v203, v26, v27
 mf v[96:99], v[160:163], a[136:139], v[96:99]
 mf v[96:99], v[164:167], a[140:143], v[96:99]
 swc lgkmcnt(0)
 mf v[100:103], v[152:155], a[192:195], 0
 trr v[152:153], v182 offset:0
 trr v[154:155], v183 offset:0
 mf v[100:103], v[156:159], a[196:199], v[100:103]
 trr v[156:157], v182 offset:4096
 trr v[158:159], v183 offset:4096
 mf v[100:103], v[160:163], a[200:203], v[100:103]
 trr v[160:161], v182 offset:8192
 trr v[162:163], v183 offset:8192
 mf v[100:103], v[164:167], a[204:207], v[100:103]
 trr v[164:165], v182 offset:12288
 trr v[166:167], v183 offset:12288
 mf v[104:107], v[136:139], a[0:3], 0
 bl4 v194, s[60:63], s19 offen lds
 mf v[104:107], v[140:143], a[4:7], v[104:107]
 bs4 v[200:203], v196, s[12:15], s34 offen offset:0 sc1
 mf v[104:107], v[144:147], a[8:11], v[104:107]
 mf v[104:107], v[148:151], a[12:15], v[104:107]
 s_lshr_b32 s20, s17, 1
 sad s20, s20, 32
 s_sub_u32 s20, s20, s17
 s_lshl_b32 s20, s20, 6
 sad s56, s56, s20
 s_addc_u32 s57, s57, 0
 sad s60, s60, s20
 s_addc_u32 s61, s61, 0
 s_sub_u32 s58, s58, s20
 s_cmp_lt_u32 s17, 22
 s_cselect_b32 s58, s58, 0
 s_mov_b32 s62, s58
 mf v[108:111], v[136:139], a[64:67], 0
 mf v[108:111], v[140:143], a[68:71], v[108:111]
 cvp v204, v12, v13
 mf v[108:111], v[144:147], a[72:75], v[108:111]
 buffer_load_dword v212, v253, s[12:15], s46 offen offset:0 sc1
 mf v[108:111], v[148:151], a[76:79], v[108:111]
 mf v[112:115], v[136:139], a[128:131], 0
 mf v[112:115], v[140:143], a[132:135], v[112:115]
 buffer_load_dword v213, v6, s[12:15], s46 offen offset:0 sc1
 cvp v205, v14, v15
 mf v[112:115], v[144:147], a[136:139], v[112:115]
 mf v[112:115], v[148:151], a[140:143], v[112:115]
 swc lgkmcnt(0)
 mf v[116:119], v[136:139], a[192:195], 0
 trr v[136:137], v176 offset:16384
 trr v[138:139], v177 offset:16384
 mf v[116:119], v[140:143], a[196:199], v[116:119]
 trr v[140:141], v176 offset:20480
 trr v[142:143], v177 offset:20480
 mf v[116:119], v[144:147], a[200:203], v[116:119]
 trr v[144:145], v176 offset:24576
 trr v[146:147], v177 offset:24576
 mf v[116:119], v[148:151], a[204:207], v[116:119]
 trr v[148:149], v176 offset:28672
 trr v[150:151], v177 offset:28672
 mf v[120:123], v[152:155], a[0:3], 0
 cvp v206, v28, v29
 mf v[120:123], v[156:159], a[4:7], v[120:123]
 buffer_load_dword v214, v253, s[12:15], s47 offen offset:0 sc1
 mf v[120:123], v[160:163], a[8:11], v[120:123]
 mf v[120:123], v[164:167], a[12:15], v[120:123]
 mf v[124:127], v[152:155], a[64:67], 0
 buffer_load_dword v215, v6, s[12:15], s47 offen offset:0 sc1
 cvp v207, v30, v31
 mf v[124:127], v[156:159], a[68:71], v[124:127]
 mf v[124:127], v[160:163], a[72:75], v[124:127]
 mf v[124:127], v[164:167], a[76:79], v[124:127]
 bs4 v[204:207], v197, s[12:15], s34 offen offset:0 sc1
 mf v[128:131], v[152:155], a[128:131], 0
 mf v[128:131], v[156:159], a[132:135], v[128:131]
 mf v[128:131], v[160:163], a[136:139], v[128:131]
 cvp v200, v16, v17
 mf v[128:131], v[164:167], a[140:143], v[128:131]
 swc lgkmcnt(0)
 mf v[132:135], v[152:155], a[192:195], 0
 trr v[152:153], v178 offset:16384
 trr v[154:155], v179 offset:16384
 mf v[132:135], v[156:159], a[196:199], v[132:135]
 trr v[156:157], v178 offset:20480
 trr v[158:159], v179 offset:20480
 mf v[132:135], v[160:163], a[200:203], v[132:135]
 trr v[160:161], v178 offset:24576
 trr v[162:163], v179 offset:24576
 mf v[132:135], v[164:167], a[204:207], v[132:135]
 trr v[164:165], v178 offset:28672
 trr v[166:167], v179 offset:28672
 mf v[72:75], v[136:139], a[16:19], v[72:75]
 swc vmcnt(37)
 s_barrier
 mf v[72:75], v[140:143], a[20:23], v[72:75]
 sad m0, s36, 65536
 sad s19, s92, 0
 mf v[72:75], v[144:147], a[24:27], v[72:75]
 bl4 v194, s[56:59], s19 offen lds
 mf v[72:75], v[148:151], a[28:31], v[72:75]
 sad m0, s36, 66560
 sad s19, s92, 44032
 mf v[76:79], v[136:139], a[80:83], v[76:79]
 bl4 v194, s[56:59], s19 offen lds
 mf v[76:79], v[140:143], a[84:87], v[76:79]
 sad m0, s36, 67584
 sad s19, s92, 0
 mf v[76:79], v[144:147], a[88:91], v[76:79]
 bl4 v194, s[60:63], s19 offen lds
 mf v[76:79], v[148:151], a[92:95], v[76:79]
 sad m0, s36, 68608
 sad s19, s92, 44032
 mf v[80:83], v[136:139], a[144:147], v[80:83]
 bl4 v194, s[60:63], s19 offen lds
 cvp v201, v18, v19
 mf v[80:83], v[140:143], a[148:151], v[80:83]
 sad s4, s100, s96
 sad s5, s101, s96
 bl4 a[0:3], v195, s[12:15], s4 offen offset:0 sc1
 mf v[80:83], v[144:147], a[152:155], v[80:83]
 bl4 a[4:7], v195, s[12:15], s4 offen offset:1024 sc1
 mf v[80:83], v[148:151], a[156:159], v[80:83]
 swc lgkmcnt(0)
 mf v[84:87], v[136:139], a[208:211], v[84:87]
 trr v[136:137], v180 offset:16384
 trr v[138:139], v181 offset:16384
 mf v[84:87], v[140:143], a[212:215], v[84:87]
 trr v[140:141], v180 offset:20480
 trr v[142:143], v181 offset:20480
 mf v[84:87], v[144:147], a[216:219], v[84:87]
 trr v[144:145], v180 offset:24576
 trr v[146:147], v181 offset:24576
 mf v[84:87], v[148:151], a[220:223], v[84:87]
 trr v[148:149], v180 offset:28672
 trr v[150:151], v181 offset:28672
 mf v[88:91], v[152:155], a[16:19], v[88:91]
 bl4 a[8:11], v195, s[12:15], s4 offen offset:2048 sc1
 mf v[88:91], v[156:159], a[20:23], v[88:91]
 bl4 a[12:15], v195, s[12:15], s4 offen offset:3072 sc1
 mf v[88:91], v[160:163], a[24:27], v[88:91]
 bl4 a[64:67], v255, s[12:15], s4 offen offset:0 sc1
 mf v[88:91], v[164:167], a[28:31], v[88:91]
 bl4 a[68:71], v255, s[12:15], s4 offen offset:1024 sc1
 cvp v202, v32, v33
 mf v[92:95], v[152:155], a[80:83], v[92:95]
 bl4 a[72:75], v255, s[12:15], s4 offen offset:2048 sc1
 mf v[92:95], v[156:159], a[84:87], v[92:95]
 bl4 a[76:79], v255, s[12:15], s4 offen offset:3072 sc1
 mf v[92:95], v[160:163], a[88:91], v[92:95]
 bl4 a[128:131], v195, s[12:15], s5 offen offset:0 sc1
 mf v[92:95], v[164:167], a[92:95], v[92:95]
 bl4 a[132:135], v195, s[12:15], s5 offen offset:1024 sc1
 mf v[96:99], v[152:155], a[144:147], v[96:99]
 bl4 a[136:139], v195, s[12:15], s5 offen offset:2048 sc1
 mf v[96:99], v[156:159], a[148:151], v[96:99]
 bl4 a[140:143], v195, s[12:15], s5 offen offset:3072 sc1
 cvp v203, v34, v35
 mf v[96:99], v[160:163], a[152:155], v[96:99]
 bl4 a[192:195], v255, s[12:15], s5 offen offset:0 sc1
 mf v[96:99], v[164:167], a[156:159], v[96:99]
 swc lgkmcnt(0)
 mf v[100:103], v[152:155], a[208:211], v[100:103]
 trr v[152:153], v182 offset:16384
 trr v[154:155], v183 offset:16384
 mf v[100:103], v[156:159], a[212:215], v[100:103]
 trr v[156:157], v182 offset:20480
 trr v[158:159], v183 offset:20480
 mf v[100:103], v[160:163], a[216:219], v[100:103]
 trr v[160:161], v182 offset:24576
 trr v[162:163], v183 offset:24576
 mf v[100:103], v[164:167], a[220:223], v[100:103]
 trr v[164:165], v182 offset:28672
 trr v[166:167], v183 offset:28672
 mf v[104:107], v[136:139], a[16:19], v[104:107]
 bl4 a[196:199], v255, s[12:15], s5 offen offset:1024 sc1
 mf v[104:107], v[140:143], a[20:23], v[104:107]
 bl4 a[200:203], v255, s[12:15], s5 offen offset:2048 sc1
 mf v[104:107], v[144:147], a[24:27], v[104:107]
 bl4 a[204:207], v255, s[12:15], s5 offen offset:3072 sc1
 mf v[104:107], v[148:151], a[28:31], v[104:107]
 bs4 v[200:203], v198, s[12:15], s34 offen offset:0 sc1
 mf v[108:111], v[136:139], a[80:83], v[108:111]
 mf v[108:111], v[140:143], a[84:87], v[108:111]
 cvp v204, v20, v21
 mf v[108:111], v[144:147], a[88:91], v[108:111]
 mf v[108:111], v[148:151], a[92:95], v[108:111]
 mf v[112:115], v[136:139], a[144:147], v[112:115]
 cvp v205, v22, v23
 mf v[112:115], v[140:143], a[148:151], v[112:115]
 mf v[112:115], v[144:147], a[152:155], v[112:115]
 mf v[112:115], v[148:151], a[156:159], v[112:115]
 swc lgkmcnt(0)
 mf v[116:119], v[136:139], a[208:211], v[116:119]
 trr v[136:137], v176 offset:32768
 trr v[138:139], v177 offset:32768
 mf v[116:119], v[140:143], a[212:215], v[116:119]
 trr v[140:141], v176 offset:36864
 trr v[142:143], v177 offset:36864
 mf v[116:119], v[144:147], a[216:219], v[116:119]
 trr v[144:145], v176 offset:40960
 trr v[146:147], v177 offset:40960
 mf v[116:119], v[148:151], a[220:223], v[116:119]
 trr v[148:149], v176 offset:45056
 trr v[150:151], v177 offset:45056
 mf v[120:123], v[152:155], a[16:19], v[120:123]
 cvp v206, v36, v37
 mf v[120:123], v[156:159], a[20:23], v[120:123]
 mf v[120:123], v[160:163], a[24:27], v[120:123]
 mf v[120:123], v[164:167], a[28:31], v[120:123]
 cvp v207, v38, v39
 mf v[124:127], v[152:155], a[80:83], v[124:127]
 mf v[124:127], v[156:159], a[84:87], v[124:127]
 bs4 v[204:207], v199, s[12:15], s34 offen offset:0 sc1
 mf v[124:127], v[160:163], a[88:91], v[124:127]
 mf v[124:127], v[164:167], a[92:95], v[124:127]
 mf v[128:131], v[152:155], a[144:147], v[128:131]
 cvp v200, v40, v41
 mf v[128:131], v[156:159], a[148:151], v[128:131]
 mf v[128:131], v[160:163], a[152:155], v[128:131]
 mf v[128:131], v[164:167], a[156:159], v[128:131]
 swc lgkmcnt(0)
 mf v[132:135], v[152:155], a[208:211], v[132:135]
 trr v[152:153], v178 offset:32768
 trr v[154:155], v179 offset:32768
 mf v[132:135], v[156:159], a[212:215], v[132:135]
 trr v[156:157], v178 offset:36864
 trr v[158:159], v179 offset:36864
 mf v[132:135], v[160:163], a[216:219], v[132:135]
 trr v[160:161], v178 offset:40960
 trr v[162:163], v179 offset:40960
 mf v[132:135], v[164:167], a[220:223], v[132:135]
 trr v[164:165], v178 offset:45056
 trr v[166:167], v179 offset:45056
 mf v[72:75], v[136:139], a[32:35], v[72:75]
 swc vmcnt(53)
 s_barrier
 mf v[72:75], v[140:143], a[36:39], v[72:75]
 sad m0, s36, 81920
 sad s19, s93, 0
 mf v[72:75], v[144:147], a[40:43], v[72:75]
 bl4 v194, s[56:59], s19 offen lds
 cvp v201, v42, v43
 mf v[72:75], v[148:151], a[44:47], v[72:75]
 sad m0, s36, 82944
 sad s19, s93, 44032
 mf v[76:79], v[136:139], a[96:99], v[76:79]
 bl4 v194, s[56:59], s19 offen lds
 mf v[76:79], v[140:143], a[100:103], v[76:79]
 sad m0, s36, 83968
 sad s19, s93, 0
 mf v[76:79], v[144:147], a[104:107], v[76:79]
 bl4 v194, s[60:63], s19 offen lds
 mf v[76:79], v[148:151], a[108:111], v[76:79]
 sad m0, s36, 84992
 sad s19, s93, 44032
 mf v[80:83], v[136:139], a[160:163], v[80:83]
 bl4 v194, s[60:63], s19 offen lds
 mf v[80:83], v[140:143], a[164:167], v[80:83]
 sad s6, s100, s97
 sad s7, s101, s97
 bl4 a[16:19], v195, s[12:15], s6 offen offset:0 sc1
 mf v[80:83], v[144:147], a[168:171], v[80:83]
 bl4 a[20:23], v195, s[12:15], s6 offen offset:1024 sc1
 mf v[80:83], v[148:151], a[172:175], v[80:83]
 swc lgkmcnt(0)
 mf v[84:87], v[136:139], a[224:227], v[84:87]
 trr v[136:137], v180 offset:32768
 trr v[138:139], v181 offset:32768
 mf v[84:87], v[140:143], a[228:231], v[84:87]
 trr v[140:141], v180 offset:36864
 trr v[142:143], v181 offset:36864
 mf v[84:87], v[144:147], a[232:235], v[84:87]
 trr v[144:145], v180 offset:40960
 trr v[146:147], v181 offset:40960
 mf v[84:87], v[148:151], a[236:239], v[84:87]
 trr v[148:149], v180 offset:45056
 trr v[150:151], v181 offset:45056
 mf v[88:91], v[152:155], a[32:35], v[88:91]
 bl4 a[24:27], v195, s[12:15], s6 offen offset:2048 sc1
 cvp v202, v56, v57
 mf v[88:91], v[156:159], a[36:39], v[88:91]
 bl4 a[28:31], v195, s[12:15], s6 offen offset:3072 sc1
 mf v[88:91], v[160:163], a[40:43], v[88:91]
 bl4 a[80:83], v255, s[12:15], s6 offen offset:0 sc1
 mf v[88:91], v[164:167], a[44:47], v[88:91]
 bl4 a[84:87], v255, s[12:15], s6 offen offset:1024 sc1
 mf v[92:95], v[152:155], a[96:99], v[92:95]
 bl4 a[88:91], v255, s[12:15], s6 offen offset:2048 sc1
 mf v[92:95], v[156:159], a[100:103], v[92:95]
 bl4 a[92:95], v255, s[12:15], s6 offen offset:3072 sc1
 cvp v203, v58, v59
 mf v[92:95], v[160:163], a[104:107], v[92:95]
 bl4 a[144:147], v195, s[12:15], s7 offen offset:0 sc1
 mf v[92:95], v[164:167], a[108:111], v[92:95]
 bl4 a[148:151], v195, s[12:15], s7 offen offset:1024 sc1
 mf v[96:99], v[152:155], a[160:163], v[96:99]
 bl4 a[152:155], v195, s[12:15], s7 offen offset:2048 sc1
 mf v[96:99], v[156:159], a[164:167], v[96:99]
 bl4 a[156:159], v195, s[12:15], s7 offen offset:3072 sc1
 mf v[96:99], v[160:163], a[168:171], v[96:99]
 bl4 a[208:211], v255, s[12:15], s7 offen offset:0 sc1
 mf v[96:99], v[164:167], a[172:175], v[96:99]
 swc lgkmcnt(0)
 mf v[100:103], v[152:155], a[224:227], v[100:103]
 trr v[152:153], v182 offset:32768
 trr v[154:155], v183 offset:32768
 mf v[100:103], v[156:159], a[228:231], v[100:103]
 trr v[156:157], v182 offset:36864
 trr v[158:159], v183 offset:36864
 mf v[100:103], v[160:163], a[232:235], v[100:103]
 trr v[160:161], v182 offset:40960
 trr v[162:163], v183 offset:40960
 mf v[100:103], v[164:167], a[236:239], v[100:103]
 trr v[164:165], v182 offset:45056
 trr v[166:167], v183 offset:45056
 mf v[104:107], v[136:139], a[32:35], v[104:107]
 bl4 a[212:215], v255, s[12:15], s7 offen offset:1024 sc1
 mf v[104:107], v[140:143], a[36:39], v[104:107]
 bl4 a[216:219], v255, s[12:15], s7 offen offset:2048 sc1
 mf v[104:107], v[144:147], a[40:43], v[104:107]
 bl4 a[220:223], v255, s[12:15], s7 offen offset:3072 sc1
 mf v[104:107], v[148:151], a[44:47], v[104:107]
 bs4 v[200:203], v196, s[12:15], s34 offen offset:1024 sc1
 mf v[108:111], v[136:139], a[96:99], v[108:111]
 mf v[108:111], v[140:143], a[100:103], v[108:111]
 cvp v204, v44, v45
 mf v[108:111], v[144:147], a[104:107], v[108:111]
 mf v[108:111], v[148:151], a[108:111], v[108:111]
 mf v[112:115], v[136:139], a[160:163], v[112:115]
 cvp v205, v46, v47
 mf v[112:115], v[140:143], a[164:167], v[112:115]
 mf v[112:115], v[144:147], a[168:171], v[112:115]
 mf v[112:115], v[148:151], a[172:175], v[112:115]
 swc lgkmcnt(0)
 mf v[116:119], v[136:139], a[224:227], v[116:119]
 trr v[136:137], v176 offset:49152
 trr v[138:139], v177 offset:49152
 mf v[116:119], v[140:143], a[228:231], v[116:119]
 trr v[140:141], v176 offset:53248
 trr v[142:143], v177 offset:53248
 mf v[116:119], v[144:147], a[232:235], v[116:119]
 trr v[144:145], v176 offset:57344
 trr v[146:147], v177 offset:57344
 mf v[116:119], v[148:151], a[236:239], v[116:119]
 trr v[148:149], v176 offset:61440
 trr v[150:151], v177 offset:61440
 mf v[120:123], v[152:155], a[32:35], v[120:123]
 cvp v206, v60, v61
 mf v[120:123], v[156:159], a[36:39], v[120:123]
 mf v[120:123], v[160:163], a[40:43], v[120:123]
 cvp v207, v62, v63
 mf v[120:123], v[164:167], a[44:47], v[120:123]
 mf v[124:127], v[152:155], a[96:99], v[124:127]
 mf v[124:127], v[156:159], a[100:103], v[124:127]
 bs4 v[204:207], v197, s[12:15], s34 offen offset:1024 sc1
 mf v[124:127], v[160:163], a[104:107], v[124:127]
 mf v[124:127], v[164:167], a[108:111], v[124:127]
 mf v[128:131], v[152:155], a[160:163], v[128:131]
 cvp v200, v48, v49
 mf v[128:131], v[156:159], a[164:167], v[128:131]
 mf v[128:131], v[160:163], a[168:171], v[128:131]
 mf v[128:131], v[164:167], a[172:175], v[128:131]
 swc lgkmcnt(0)
 mf v[132:135], v[152:155], a[224:227], v[132:135]
 trr v[152:153], v178 offset:49152
 trr v[154:155], v179 offset:49152
 mf v[132:135], v[156:159], a[228:231], v[132:135]
 trr v[156:157], v178 offset:53248
 trr v[158:159], v179 offset:53248
 mf v[132:135], v[160:163], a[232:235], v[132:135]
 trr v[160:161], v178 offset:57344
 trr v[162:163], v179 offset:57344
 mf v[132:135], v[164:167], a[236:239], v[132:135]
 trr v[164:165], v178 offset:61440
 trr v[166:167], v179 offset:61440
 mf v[72:75], v[136:139], a[48:51], v[72:75]
 swc vmcnt(63)
 s_barrier
 mf v[72:75], v[140:143], a[52:55], v[72:75]
 sad m0, s36, 98304
 sad s19, s94, 0
 mf v[72:75], v[144:147], a[56:59], v[72:75]
 bl4 v194, s[56:59], s19 offen lds
 cvp v201, v50, v51
 mf v[72:75], v[148:151], a[60:63], v[72:75]
 sad m0, s36, 99328
 sad s19, s94, 44032
 mf v[76:79], v[136:139], a[112:115], v[76:79]
 bl4 v194, s[56:59], s19 offen lds
 mf v[76:79], v[140:143], a[116:119], v[76:79]
 sad m0, s36, 100352
 sad s19, s94, 0
 mf v[76:79], v[144:147], a[120:123], v[76:79]
 bl4 v194, s[60:63], s19 offen lds
 mf v[76:79], v[148:151], a[124:127], v[76:79]
 sad m0, s36, 101376
 sad s19, s94, 44032
 mf v[80:83], v[136:139], a[176:179], v[80:83]
 bl4 v194, s[60:63], s19 offen lds
 mf v[80:83], v[140:143], a[180:183], v[80:83]
 sad s4, s100, s98
 sad s5, s101, s98
 bl4 a[32:35], v195, s[12:15], s4 offen offset:0 sc1
 mf v[80:83], v[144:147], a[184:187], v[80:83]
 bl4 a[36:39], v195, s[12:15], s4 offen offset:1024 sc1
 mf v[80:83], v[148:151], a[188:191], v[80:83]
 swc lgkmcnt(0)
 cvp v202, v64, v65
 mf v[84:87], v[136:139], a[240:243], v[84:87]
 trr v[136:137], v180 offset:49152
 trr v[138:139], v181 offset:49152
 mf v[84:87], v[140:143], a[244:247], v[84:87]
 trr v[140:141], v180 offset:53248
 trr v[142:143], v181 offset:53248
 mf v[84:87], v[144:147], a[248:251], v[84:87]
 trr v[144:145], v180 offset:57344
 trr v[146:147], v181 offset:57344
 mf v[84:87], v[148:151], a[252:255], v[84:87]
 trr v[148:149], v180 offset:61440
 trr v[150:151], v181 offset:61440
 mf v[88:91], v[152:155], a[48:51], v[88:91]
 bl4 a[40:43], v195, s[12:15], s4 offen offset:2048 sc1
 mf v[88:91], v[156:159], a[52:55], v[88:91]
 bl4 a[44:47], v195, s[12:15], s4 offen offset:3072 sc1
 mf v[88:91], v[160:163], a[56:59], v[88:91]
 bl4 a[96:99], v255, s[12:15], s4 offen offset:0 sc1
 mf v[88:91], v[164:167], a[60:63], v[88:91]
 bl4 a[100:103], v255, s[12:15], s4 offen offset:1024 sc1
 mf v[92:95], v[152:155], a[112:115], v[92:95]
 bl4 a[104:107], v255, s[12:15], s4 offen offset:2048 sc1
 mf v[92:95], v[156:159], a[116:119], v[92:95]
 bl4 a[108:111], v255, s[12:15], s4 offen offset:3072 sc1
 cvp v203, v66, v67
 mf v[92:95], v[160:163], a[120:123], v[92:95]
 bl4 a[160:163], v195, s[12:15], s5 offen offset:0 sc1
 mf v[92:95], v[164:167], a[124:127], v[92:95]
 bl4 a[164:167], v195, s[12:15], s5 offen offset:1024 sc1
 mf v[96:99], v[152:155], a[176:179], v[96:99]
 bl4 a[168:171], v195, s[12:15], s5 offen offset:2048 sc1
 mf v[96:99], v[156:159], a[180:183], v[96:99]
 bl4 a[172:175], v195, s[12:15], s5 offen offset:3072 sc1
 mf v[96:99], v[160:163], a[184:187], v[96:99]
 bl4 a[224:227], v255, s[12:15], s5 offen offset:0 sc1
 mf v[96:99], v[164:167], a[188:191], v[96:99]
 swc lgkmcnt(0)
 mf v[100:103], v[152:155], a[240:243], v[100:103]
 trr v[152:153], v182 offset:49152
 trr v[154:155], v183 offset:49152
 mf v[100:103], v[156:159], a[244:247], v[100:103]
 trr v[156:157], v182 offset:53248
 trr v[158:159], v183 offset:53248
 mf v[100:103], v[160:163], a[248:251], v[100:103]
 trr v[160:161], v182 offset:57344
 trr v[162:163], v183 offset:57344
 mf v[100:103], v[164:167], a[252:255], v[100:103]
 trr v[164:165], v182 offset:61440
 trr v[166:167], v183 offset:61440
 mf v[104:107], v[136:139], a[48:51], v[104:107]
 bl4 a[228:231], v255, s[12:15], s5 offen offset:1024 sc1
 mf v[104:107], v[140:143], a[52:55], v[104:107]
 bl4 a[232:235], v255, s[12:15], s5 offen offset:2048 sc1
 mf v[104:107], v[144:147], a[56:59], v[104:107]
 bl4 a[236:239], v255, s[12:15], s5 offen offset:3072 sc1
 mf v[104:107], v[148:151], a[60:63], v[104:107]
 bs4 v[200:203], v198, s[12:15], s34 offen offset:1024 sc1
 mf v[108:111], v[136:139], a[112:115], v[108:111]
 mf v[108:111], v[140:143], a[116:119], v[108:111]
 cvp v204, v52, v53
 mf v[108:111], v[144:147], a[120:123], v[108:111]
 mf v[108:111], v[148:151], a[124:127], v[108:111]
 mf v[112:115], v[136:139], a[176:179], v[112:115]
 cvp v205, v54, v55
 mf v[112:115], v[140:143], a[180:183], v[112:115]
 mf v[112:115], v[144:147], a[184:187], v[112:115]
 mf v[112:115], v[148:151], a[188:191], v[112:115]
 swc lgkmcnt(0)
 mf v[116:119], v[136:139], a[240:243], v[116:119]
 trr v[136:137], v184 offset:0
 trr v[138:139], v185 offset:0
 mf v[116:119], v[140:143], a[244:247], v[116:119]
 trr v[140:141], v184 offset:4096
 trr v[142:143], v185 offset:4096
 mf v[116:119], v[144:147], a[248:251], v[116:119]
 trr v[144:145], v184 offset:8192
 trr v[146:147], v185 offset:8192
 mf v[116:119], v[148:151], a[252:255], v[116:119]
 trr v[148:149], v184 offset:12288
 trr v[150:151], v185 offset:12288
 mf v[120:123], v[152:155], a[48:51], v[120:123]
 cvp v206, v68, v69
 mf v[120:123], v[156:159], a[52:55], v[120:123]
 mf v[120:123], v[160:163], a[56:59], v[120:123]
 cvp v207, v70, v71
 mf v[120:123], v[164:167], a[60:63], v[120:123]
 mf v[124:127], v[152:155], a[112:115], v[124:127]
 mf v[124:127], v[156:159], a[116:119], v[124:127]
 bs4 v[204:207], v199, s[12:15], s34 offen offset:1024 sc1
 mf v[124:127], v[160:163], a[120:123], v[124:127]
 mf v[124:127], v[164:167], a[124:127], v[124:127]
 mf v[128:131], v[152:155], a[176:179], v[128:131]
 mf v[128:131], v[156:159], a[180:183], v[128:131]
 mf v[128:131], v[160:163], a[184:187], v[128:131]
 mf v[128:131], v[164:167], a[188:191], v[128:131]
 swc lgkmcnt(0)
 mf v[132:135], v[152:155], a[240:243], v[132:135]
 trr v[152:153], v186 offset:0
 trr v[154:155], v187 offset:0
 mf v[132:135], v[156:159], a[244:247], v[132:135]
 trr v[156:157], v186 offset:4096
 trr v[158:159], v187 offset:4096
 mf v[132:135], v[160:163], a[248:251], v[132:135]
 trr v[160:161], v186 offset:8192
 trr v[162:163], v187 offset:8192
 mf v[132:135], v[164:167], a[252:255], v[132:135]
 trr v[164:165], v186 offset:12288
 trr v[166:167], v187 offset:12288
 swc vmcnt(46)
 mf v[8:11], v[136:139], a[0:3], 0
 swc vmcnt(63)
 s_barrier
 mf v[8:11], v[140:143], a[4:7], v[8:11]
 sad m0, s36, 114688
 sad s19, s95, 0
 mf v[8:11], v[144:147], a[8:11], v[8:11]
 bl4 v194, s[56:59], s19 offen lds
 mf v[8:11], v[148:151], a[12:15], v[8:11]
 sad m0, s36, 115712
 sad s19, s95, 44032
 mf v[12:15], v[136:139], a[64:67], 0
 bl4 v194, s[56:59], s19 offen lds
 mf v[12:15], v[140:143], a[68:71], v[12:15]
 sad m0, s36, 116736
 sad s19, s95, 0
 mf v[12:15], v[144:147], a[72:75], v[12:15]
 bl4 v194, s[60:63], s19 offen lds
 sad s34, s35, 1050624
 mf v[12:15], v[148:151], a[76:79], v[12:15]
 sad m0, s36, 117760
 sad s19, s95, 44032
 mf v[16:19], v[136:139], a[128:131], 0
 bl4 v194, s[60:63], s19 offen lds
 mf v[16:19], v[140:143], a[132:135], v[16:19]
 sad s6, s100, s99
 sad s7, s101, s99
 bl4 a[48:51], v195, s[12:15], s6 offen offset:0 sc1
 mf v[16:19], v[144:147], a[136:139], v[16:19]
 bl4 a[52:55], v195, s[12:15], s6 offen offset:1024 sc1
 mf v[16:19], v[148:151], a[140:143], v[16:19]
 swc lgkmcnt(0)
 mf v[20:23], v[136:139], a[192:195], 0
 trr v[136:137], v188 offset:0
 trr v[138:139], v189 offset:0
 mf v[20:23], v[140:143], a[196:199], v[20:23]
 trr v[140:141], v188 offset:4096
 trr v[142:143], v189 offset:4096
 mf v[20:23], v[144:147], a[200:203], v[20:23]
 trr v[144:145], v188 offset:8192
 trr v[146:147], v189 offset:8192
 mf v[20:23], v[148:151], a[204:207], v[20:23]
 trr v[148:149], v188 offset:12288
 trr v[150:151], v189 offset:12288
 mf v[24:27], v[152:155], a[0:3], 0
 bl4 a[56:59], v195, s[12:15], s6 offen offset:2048 sc1
 mf v[24:27], v[156:159], a[4:7], v[24:27]
 bl4 a[60:63], v195, s[12:15], s6 offen offset:3072 sc1
 cvp v200, v72, v73
 mf v[24:27], v[160:163], a[8:11], v[24:27]
 bl4 a[112:115], v255, s[12:15], s6 offen offset:0 sc1
 mf v[24:27], v[164:167], a[12:15], v[24:27]
 bl4 a[116:119], v255, s[12:15], s6 offen offset:1024 sc1
 mf v[28:31], v[152:155], a[64:67], 0
 bl4 a[120:123], v255, s[12:15], s6 offen offset:2048 sc1
 mf v[28:31], v[156:159], a[68:71], v[28:31]
 bl4 a[124:127], v255, s[12:15], s6 offen offset:3072 sc1
 mf v[28:31], v[160:163], a[72:75], v[28:31]
 bl4 a[176:179], v195, s[12:15], s7 offen offset:0 sc1
 cvp v201, v74, v75
 mf v[28:31], v[164:167], a[76:79], v[28:31]
 bl4 a[180:183], v195, s[12:15], s7 offen offset:1024 sc1
 mf v[32:35], v[152:155], a[128:131], 0
 bl4 a[184:187], v195, s[12:15], s7 offen offset:2048 sc1
 mf v[32:35], v[156:159], a[132:135], v[32:35]
 bl4 a[188:191], v195, s[12:15], s7 offen offset:3072 sc1
 mf v[32:35], v[160:163], a[136:139], v[32:35]
 bl4 a[240:243], v255, s[12:15], s7 offen offset:0 sc1
 mf v[32:35], v[164:167], a[140:143], v[32:35]
 swc lgkmcnt(0)
 cvp v202, v88, v89
 mf v[36:39], v[152:155], a[192:195], 0
 trr v[152:153], v190 offset:0
 trr v[154:155], v191 offset:0
 mf v[36:39], v[156:159], a[196:199], v[36:39]
 trr v[156:157], v190 offset:4096
 trr v[158:159], v191 offset:4096
 mf v[36:39], v[160:163], a[200:203], v[36:39]
 trr v[160:161], v190 offset:8192
 trr v[162:163], v191 offset:8192
 mf v[36:39], v[164:167], a[204:207], v[36:39]
 trr v[164:165], v190 offset:12288
 trr v[166:167], v191 offset:12288
 mf v[40:43], v[136:139], a[0:3], 0
 bl4 a[244:247], v255, s[12:15], s7 offen offset:1024 sc1
 mf v[40:43], v[140:143], a[4:7], v[40:43]
 bl4 a[248:251], v255, s[12:15], s7 offen offset:2048 sc1
 mf v[40:43], v[144:147], a[8:11], v[40:43]
 bl4 a[252:255], v255, s[12:15], s7 offen offset:3072 sc1
 mf v[40:43], v[148:151], a[12:15], v[40:43]
 mf v[44:47], v[136:139], a[64:67], 0
 cvp v203, v90, v91
 mf v[44:47], v[140:143], a[68:71], v[44:47]
 mf v[44:47], v[144:147], a[72:75], v[44:47]
 bs4 v[200:203], v196, s[12:15], s34 offen offset:0 sc1
 mf v[44:47], v[148:151], a[76:79], v[44:47]
 mf v[48:51], v[136:139], a[128:131], 0
 mf v[48:51], v[140:143], a[132:135], v[48:51]
 cvp v204, v76, v77
 mf v[48:51], v[144:147], a[136:139], v[48:51]
 mf v[48:51], v[148:151], a[140:143], v[48:51]
 swc lgkmcnt(0)
 mf v[52:55], v[136:139], a[192:195], 0
 trr v[136:137], v184 offset:16384
 trr v[138:139], v185 offset:16384
 mf v[52:55], v[140:143], a[196:199], v[52:55]
 trr v[140:141], v184 offset:20480
 trr v[142:143], v185 offset:20480
 mf v[52:55], v[144:147], a[200:203], v[52:55]
 trr v[144:145], v184 offset:24576
 trr v[146:147], v185 offset:24576
 mf v[52:55], v[148:151], a[204:207], v[52:55]
 trr v[148:149], v184 offset:28672
 trr v[150:151], v185 offset:28672
 mf v[56:59], v[152:155], a[0:3], 0
 cvp v205, v78, v79
 mf v[56:59], v[156:159], a[4:7], v[56:59]
 mf v[56:59], v[160:163], a[8:11], v[56:59]
 mf v[56:59], v[164:167], a[12:15], v[56:59]
 cvp v206, v92, v93
 mf v[60:63], v[152:155], a[64:67], 0
 mf v[60:63], v[156:159], a[68:71], v[60:63]
 cvp v207, v94, v95
 mf v[60:63], v[160:163], a[72:75], v[60:63]
 mf v[60:63], v[164:167], a[76:79], v[60:63]
 mf v[64:67], v[152:155], a[128:131], 0
 bs4 v[204:207], v197, s[12:15], s34 offen offset:0 sc1
 mf v[64:67], v[156:159], a[132:135], v[64:67]
 mf v[64:67], v[160:163], a[136:139], v[64:67]
 mf v[64:67], v[164:167], a[140:143], v[64:67]
 swc lgkmcnt(0)
 cvp v200, v80, v81
 mf v[68:71], v[152:155], a[192:195], 0
 trr v[152:153], v186 offset:16384
 trr v[154:155], v187 offset:16384
 mf v[68:71], v[156:159], a[196:199], v[68:71]
 trr v[156:157], v186 offset:20480
 trr v[158:159], v187 offset:20480
 mf v[68:71], v[160:163], a[200:203], v[68:71]
 trr v[160:161], v186 offset:24576
 trr v[162:163], v187 offset:24576
 mf v[68:71], v[164:167], a[204:207], v[68:71]
 trr v[164:165], v186 offset:28672
 trr v[166:167], v187 offset:28672
 swc vmcnt(46)
 mf v[8:11], v[136:139], a[16:19], v[8:11]
 swc vmcnt(63)
 s_barrier
 mf v[8:11], v[140:143], a[20:23], v[8:11]
 sad m0, s36, 0
 sad s19, s88, 0
 mf v[8:11], v[144:147], a[24:27], v[8:11]
 mf v[8:11], v[148:151], a[28:31], v[8:11]
 mf v[12:15], v[136:139], a[80:83], v[12:15]
 bl4 v192, s[48:51], s19 offen lds
 cvp v201, v82, v83
 mf v[12:15], v[140:143], a[84:87], v[12:15]
 mf v[12:15], v[144:147], a[88:91], v[12:15]
 mf v[12:15], v[148:151], a[92:95], v[12:15]
 sad m0, s36, 1024
 sad s19, s88, 65536
 mf v[16:19], v[136:139], a[144:147], v[16:19]
 cvp v202, v96, v97
 mf v[16:19], v[140:143], a[148:151], v[16:19]
 mf v[16:19], v[144:147], a[152:155], v[16:19]
 bl4 v193, s[48:51], s19 offen lds
 mf v[16:19], v[148:151], a[156:159], v[16:19]
 swc lgkmcnt(0)
 cvp v203, v98, v99
 mf v[20:23], v[136:139], a[208:211], v[20:23]
 trr v[136:137], v188 offset:16384
 trr v[138:139], v189 offset:16384
 mf v[20:23], v[140:143], a[212:215], v[20:23]
 trr v[140:141], v188 offset:20480
 trr v[142:143], v189 offset:20480
 mf v[20:23], v[144:147], a[216:219], v[20:23]
 trr v[144:145], v188 offset:24576
 trr v[146:147], v189 offset:24576
 mf v[20:23], v[148:151], a[220:223], v[20:23]
 trr v[148:149], v188 offset:28672
 trr v[150:151], v189 offset:28672
 mf v[24:27], v[152:155], a[16:19], v[24:27]
 mf v[24:27], v[156:159], a[20:23], v[24:27]
 mf v[24:27], v[160:163], a[24:27], v[24:27]
 sad m0, s36, 2048
 sad s19, s88, 131072
 mf v[24:27], v[164:167], a[28:31], v[24:27]
 bs4 v[200:203], v198, s[12:15], s34 offen offset:0 sc1
 mf v[28:31], v[152:155], a[80:83], v[28:31]
 mf v[28:31], v[156:159], a[84:87], v[28:31]
 bl4 v192, s[48:51], s19 offen lds
 mf v[28:31], v[160:163], a[88:91], v[28:31]
 cvp v204, v84, v85
 mf v[28:31], v[164:167], a[92:95], v[28:31]
 mf v[32:35], v[152:155], a[144:147], v[32:35]
 sad m0, s36, 3072
 sad s19, s88, 196608
 mf v[32:35], v[156:159], a[148:151], v[32:35]
 mf v[32:35], v[160:163], a[152:155], v[32:35]
 cvp v205, v86, v87
 mf v[32:35], v[164:167], a[156:159], v[32:35]
 swc lgkmcnt(0)
 mf v[36:39], v[152:155], a[208:211], v[36:39]
 trr v[152:153], v190 offset:16384
 trr v[154:155], v191 offset:16384
 mf v[36:39], v[156:159], a[212:215], v[36:39]
 trr v[156:157], v190 offset:20480
 trr v[158:159], v191 offset:20480
 mf v[36:39], v[160:163], a[216:219], v[36:39]
 trr v[160:161], v190 offset:24576
 trr v[162:163], v191 offset:24576
 mf v[36:39], v[164:167], a[220:223], v[36:39]
 trr v[164:165], v190 offset:28672
 trr v[166:167], v191 offset:28672
 mf v[40:43], v[136:139], a[16:19], v[40:43]
 bl4 v193, s[48:51], s19 offen lds
 mf v[40:43], v[140:143], a[20:23], v[40:43]
 mf v[40:43], v[144:147], a[24:27], v[40:43]
 cvp v206, v100, v101
 mf v[40:43], v[148:151], a[28:31], v[40:43]
 swc vmcnt(63)
 vmf v208, v212, v212
 vmf v209, v213, v213
 vmf v210, v214, v214
 vmf v211, v215, v215
 mf v[44:47], v[136:139], a[80:83], v[44:47]
 mf v[44:47], v[140:143], a[84:87], v[44:47]
 cvp v207, v102, v103
 mf v[44:47], v[144:147], a[88:91], v[44:47]
 vmf v212, 0x3e0293ee, v212
 vmf v213, 0x3e0293ee, v213
 vmf v214, 0x3e0293ee, v214
 vmf v215, 0x3e0293ee, v215
 mf v[44:47], v[148:151], a[92:95], v[44:47]
 mf v[48:51], v[136:139], a[144:147], v[48:51]
 mf v[48:51], v[140:143], a[148:151], v[48:51]
 bs4 v[204:207], v199, s[12:15], s34 offen offset:0 sc1
 mf v[48:51], v[144:147], a[152:155], v[48:51]
 mf v[48:51], v[148:151], a[156:159], v[48:51]
 swc lgkmcnt(0)
 mf v[52:55], v[136:139], a[208:211], v[52:55]
 trr v[136:137], v184 offset:32768
 trr v[138:139], v185 offset:32768
 mf v[52:55], v[140:143], a[212:215], v[52:55]
 trr v[140:141], v184 offset:36864
 trr v[142:143], v185 offset:36864
 mf v[52:55], v[144:147], a[216:219], v[52:55]
 trr v[144:145], v184 offset:40960
 trr v[146:147], v185 offset:40960
 mf v[52:55], v[148:151], a[220:223], v[52:55]
 trr v[148:149], v184 offset:45056
 trr v[150:151], v185 offset:45056
 mf v[56:59], v[152:155], a[16:19], v[56:59]
 cvp v200, v104, v105
 mf v[56:59], v[156:159], a[20:23], v[56:59]
 mf v[56:59], v[160:163], a[24:27], v[56:59]
 mf v[56:59], v[164:167], a[28:31], v[56:59]
 cvp v201, v106, v107
 mf v[60:63], v[152:155], a[80:83], v[60:63]
 mf v[60:63], v[156:159], a[84:87], v[60:63]
 cvp v202, v120, v121
 mf v[60:63], v[160:163], a[88:91], v[60:63]
 mf v[60:63], v[164:167], a[92:95], v[60:63]
 mf v[64:67], v[152:155], a[144:147], v[64:67]
 cvp v203, v122, v123
 mf v[64:67], v[156:159], a[148:151], v[64:67]
 mf v[64:67], v[160:163], a[152:155], v[64:67]
 bs4 v[200:203], v196, s[12:15], s34 offen offset:1024 sc1
 mf v[64:67], v[164:167], a[156:159], v[64:67]
 swc lgkmcnt(0)
 mf v[68:71], v[152:155], a[208:211], v[68:71]
 trr v[152:153], v186 offset:32768
 trr v[154:155], v187 offset:32768
 mf v[68:71], v[156:159], a[212:215], v[68:71]
 trr v[156:157], v186 offset:36864
 trr v[158:159], v187 offset:36864
 mf v[68:71], v[160:163], a[216:219], v[68:71]
 trr v[160:161], v186 offset:40960
 trr v[162:163], v187 offset:40960
 mf v[68:71], v[164:167], a[220:223], v[68:71]
 trr v[164:165], v186 offset:45056
 trr v[166:167], v187 offset:45056
 swc vmcnt(31)
 mf v[8:11], v[136:139], a[32:35], v[8:11]
 swc vmcnt(63)
 s_barrier
 mf v[8:11], v[140:143], a[36:39], v[8:11]
 sad m0, s36, 16384
 sad s19, s89, 0
 mf v[8:11], v[144:147], a[40:43], v[8:11]
 mf v[8:11], v[148:151], a[44:47], v[8:11]
 mf v[12:15], v[136:139], a[96:99], v[12:15]
 bl4 v192, s[48:51], s19 offen lds
 cvp v204, v108, v109
 mf v[12:15], v[140:143], a[100:103], v[12:15]
 mf v[12:15], v[144:147], a[104:107], v[12:15]
 mf v[12:15], v[148:151], a[108:111], v[12:15]
 sad m0, s36, 17408
 sad s19, s89, 65536
 mf v[16:19], v[136:139], a[160:163], v[16:19]
 cvp v205, v110, v111
 mf v[16:19], v[140:143], a[164:167], v[16:19]
 mf v[16:19], v[144:147], a[168:171], v[16:19]
 bl4 v193, s[48:51], s19 offen lds
 mf v[16:19], v[148:151], a[172:175], v[16:19]
 swc lgkmcnt(0)
 cvp v206, v124, v125
 mf v[20:23], v[136:139], a[224:227], v[20:23]
 trr v[136:137], v188 offset:32768
 trr v[138:139], v189 offset:32768
 mf v[20:23], v[140:143], a[228:231], v[20:23]
 trr v[140:141], v188 offset:36864
 trr v[142:143], v189 offset:36864
 mf v[20:23], v[144:147], a[232:235], v[20:23]
 trr v[144:145], v188 offset:40960
 trr v[146:147], v189 offset:40960
 mf v[20:23], v[148:151], a[236:239], v[20:23]
 trr v[148:149], v188 offset:45056
 trr v[150:151], v189 offset:45056
 mf v[24:27], v[152:155], a[32:35], v[24:27]
 mf v[24:27], v[156:159], a[36:39], v[24:27]
 mf v[24:27], v[160:163], a[40:43], v[24:27]
 sad m0, s36, 18432
 sad s19, s89, 131072
 mf v[24:27], v[164:167], a[44:47], v[24:27]
 cvp v207, v126, v127
 mf v[28:31], v[152:155], a[96:99], v[28:31]
 mf v[28:31], v[156:159], a[100:103], v[28:31]
 bl4 v192, s[48:51], s19 offen lds
 mf v[28:31], v[160:163], a[104:107], v[28:31]
 bs4 v[204:207], v197, s[12:15], s34 offen offset:1024 sc1
 mf v[28:31], v[164:167], a[108:111], v[28:31]
 mf v[32:35], v[152:155], a[160:163], v[32:35]
 sad m0, s36, 19456
 sad s19, s89, 196608
 mf v[32:35], v[156:159], a[164:167], v[32:35]
 mf v[32:35], v[160:163], a[168:171], v[32:35]
 cvp v200, v112, v113
 mf v[32:35], v[164:167], a[172:175], v[32:35]
 swc lgkmcnt(0)
 mf v[36:39], v[152:155], a[224:227], v[36:39]
 trr v[152:153], v190 offset:32768
 trr v[154:155], v191 offset:32768
 mf v[36:39], v[156:159], a[228:231], v[36:39]
 trr v[156:157], v190 offset:36864
 trr v[158:159], v191 offset:36864
 mf v[36:39], v[160:163], a[232:235], v[36:39]
 trr v[160:161], v190 offset:40960
 trr v[162:163], v191 offset:40960
 mf v[36:39], v[164:167], a[236:239], v[36:39]
 trr v[164:165], v190 offset:45056
 trr v[166:167], v191 offset:45056
 mf v[40:43], v[136:139], a[32:35], v[40:43]
 bl4 v193, s[48:51], s19 offen lds
 mf v[40:43], v[140:143], a[36:39], v[40:43]
 cvp v201, v114, v115
 mf v[40:43], v[144:147], a[40:43], v[40:43]
 mf v[40:43], v[148:151], a[44:47], v[40:43]
 mf v[44:47], v[136:139], a[96:99], v[44:47]
 cvp v202, v128, v129
 mf v[44:47], v[140:143], a[100:103], v[44:47]
 mf v[44:47], v[144:147], a[104:107], v[44:47]
 mf v[44:47], v[148:151], a[108:111], v[44:47]
 cvp v203, v130, v131
 mf v[48:51], v[136:139], a[160:163], v[48:51]
 mf v[48:51], v[140:143], a[164:167], v[48:51]
 bs4 v[200:203], v198, s[12:15], s34 offen offset:1024 sc1
 mf v[48:51], v[144:147], a[168:171], v[48:51]
 mf v[48:51], v[148:151], a[172:175], v[48:51]
 swc lgkmcnt(0)
 mf v[52:55], v[136:139], a[224:227], v[52:55]
 trr v[136:137], v184 offset:49152
 trr v[138:139], v185 offset:49152
 mf v[52:55], v[140:143], a[228:231], v[52:55]
 trr v[140:141], v184 offset:53248
 trr v[142:143], v185 offset:53248
 mf v[52:55], v[144:147], a[232:235], v[52:55]
 trr v[144:145], v184 offset:57344
 trr v[146:147], v185 offset:57344
 mf v[52:55], v[148:151], a[236:239], v[52:55]
 trr v[148:149], v184 offset:61440
 trr v[150:151], v185 offset:61440
 mf v[56:59], v[152:155], a[32:35], v[56:59]
 mf v[56:59], v[156:159], a[36:39], v[56:59]
 cvp v204, v116, v117
 mf v[56:59], v[160:163], a[40:43], v[56:59]
 mf v[56:59], v[164:167], a[44:47], v[56:59]
 cvp v205, v118, v119
 mf v[60:63], v[152:155], a[96:99], v[60:63]
 mf v[60:63], v[156:159], a[100:103], v[60:63]
 mf v[60:63], v[160:163], a[104:107], v[60:63]
 cvp v206, v132, v133
 mf v[60:63], v[164:167], a[108:111], v[60:63]
 mf v[64:67], v[152:155], a[160:163], v[64:67]
 cvp v207, v134, v135
 mf v[64:67], v[156:159], a[164:167], v[64:67]
 mf v[64:67], v[160:163], a[168:171], v[64:67]
 mf v[64:67], v[164:167], a[172:175], v[64:67]
 swc lgkmcnt(0)
 mf v[68:71], v[152:155], a[224:227], v[68:71]
 trr v[152:153], v186 offset:49152
 trr v[154:155], v187 offset:49152
 mf v[68:71], v[156:159], a[228:231], v[68:71]
 trr v[156:157], v186 offset:53248
 trr v[158:159], v187 offset:53248
 mf v[68:71], v[160:163], a[232:235], v[68:71]
 trr v[160:161], v186 offset:57344
 trr v[162:163], v187 offset:57344
 mf v[68:71], v[164:167], a[236:239], v[68:71]
 trr v[164:165], v186 offset:61440
 trr v[166:167], v187 offset:61440
 swc vmcnt(15)
 mf v[8:11], v[136:139], a[48:51], v[8:11]
 swc vmcnt(63)
 s_barrier
 v_xor_b32 v184, 0x10000, v184
 v_xor_b32 v185, 0x10000, v185
 v_xor_b32 v186, 0x10000, v186
 v_xor_b32 v187, 0x10000, v187
 mf v[8:11], v[140:143], a[52:55], v[8:11]
 sad m0, s36, 32768
 sad s19, s90, 0
 mf v[8:11], v[144:147], a[56:59], v[8:11]
 bs4 v[204:207], v199, s[12:15], s34 offen offset:1024 sc1
 mf v[8:11], v[148:151], a[60:63], v[8:11]
 mf v[12:15], v[136:139], a[112:115], v[12:15]
 bl4 v192, s[48:51], s19 offen lds
 mf v[12:15], v[140:143], a[116:119], v[12:15]
 s_lshl_b32 s20, s16, 10
 mf v[12:15], v[144:147], a[120:123], v[12:15]
 mf v[12:15], v[148:151], a[124:127], v[12:15]
 sad m0, s36, 33792
 sad s19, s90, 65536
 mf v[16:19], v[136:139], a[176:179], v[16:19]
 sad s24, s24, s20
 mf v[16:19], v[140:143], a[180:183], v[16:19]
 mf v[16:19], v[144:147], a[184:187], v[16:19]
 bl4 v193, s[48:51], s19 offen lds
 mf v[16:19], v[148:151], a[188:191], v[16:19]
 swc lgkmcnt(0)
 mf v[20:23], v[136:139], a[240:243], v[20:23]
 trr v[136:137], v188 offset:49152
 trr v[138:139], v189 offset:49152
 mf v[20:23], v[140:143], a[244:247], v[20:23]
 trr v[140:141], v188 offset:53248
 trr v[142:143], v189 offset:53248
 mf v[20:23], v[144:147], a[248:251], v[20:23]
 trr v[144:145], v188 offset:57344
 trr v[146:147], v189 offset:57344
 mf v[20:23], v[148:151], a[252:255], v[20:23]
 trr v[148:149], v188 offset:61440
 trr v[150:151], v189 offset:61440
 mf v[24:27], v[152:155], a[48:51], v[24:27]
 sad s25, s25, s20
 v_xor_b32 v188, 0x10000, v188
 v_xor_b32 v189, 0x10000, v189
 mf v[24:27], v[156:159], a[52:55], v[24:27]
 mf v[24:27], v[160:163], a[56:59], v[24:27]
 sad m0, s36, 34816
 sad s19, s90, 131072
 mf v[24:27], v[164:167], a[60:63], v[24:27]
 mf v[28:31], v[152:155], a[112:115], v[28:31]
 v_add_u32 v196, s24, v195
 mf v[28:31], v[156:159], a[116:119], v[28:31]
 bl4 v192, s[48:51], s19 offen lds
 mf v[28:31], v[160:163], a[120:123], v[28:31]
 mf v[28:31], v[164:167], a[124:127], v[28:31]
 v_add_u32 v198, s25, v195
 mf v[32:35], v[152:155], a[176:179], v[32:35]
 sad m0, s36, 35840
 sad s19, s90, 196608
 mf v[32:35], v[156:159], a[180:183], v[32:35]
 mf v[32:35], v[160:163], a[184:187], v[32:35]
 s_lshl_b32 s20, s16, 11
 mf v[32:35], v[164:167], a[188:191], v[32:35]
 swc lgkmcnt(0)
 mf v[36:39], v[152:155], a[240:243], v[36:39]
 trr v[152:153], v190 offset:49152
 trr v[154:155], v191 offset:49152
 mf v[36:39], v[156:159], a[244:247], v[36:39]
 trr v[156:157], v190 offset:53248
 trr v[158:159], v191 offset:53248
 mf v[36:39], v[160:163], a[248:251], v[36:39]
 trr v[160:161], v190 offset:57344
 trr v[162:163], v191 offset:57344
 mf v[36:39], v[164:167], a[252:255], v[36:39]
 trr v[164:165], v190 offset:61440
 trr v[166:167], v191 offset:61440
 mf v[40:43], v[136:139], a[48:51], v[40:43]
 bl4 v193, s[48:51], s19 offen lds
 v_xor_b32 v190, 0x10000, v190
 v_xor_b32 v191, 0x10000, v191
 mf v[40:43], v[140:143], a[52:55], v[40:43]
 mf v[40:43], v[144:147], a[56:59], v[40:43]
 s_sub_u32 s20, 703488, s20
 mf v[40:43], v[148:151], a[60:63], v[40:43]
 mf v[44:47], v[136:139], a[112:115], v[44:47]
 mf v[44:47], v[140:143], a[116:119], v[44:47]
 v_add_u32 v197, s20, v196
 mf v[44:47], v[144:147], a[120:123], v[44:47]
 mf v[44:47], v[148:151], a[124:127], v[44:47]
 v_add_u32 v199, s20, v198
 mf v[48:51], v[136:139], a[176:179], v[48:51]
 mf v[48:51], v[140:143], a[180:183], v[48:51]
 mf v[48:51], v[144:147], a[184:187], v[48:51]
 s_lshl_b32 s37, s17, 12
 mf v[48:51], v[148:151], a[188:191], v[48:51]
 swc lgkmcnt(0)
 mf v[52:55], v[136:139], a[240:243], v[52:55]
 trr v[136:137], v184 offset:0
 trr v[138:139], v185 offset:0
 mf v[52:55], v[140:143], a[244:247], v[52:55]
 trr v[140:141], v184 offset:4096
 trr v[142:143], v185 offset:4096
 mf v[52:55], v[144:147], a[248:251], v[52:55]
 trr v[144:145], v184 offset:8192
 trr v[146:147], v185 offset:8192
 mf v[52:55], v[148:151], a[252:255], v[52:55]
 trr v[148:149], v184 offset:12288
 trr v[150:151], v185 offset:12288
 mf v[56:59], v[152:155], a[48:51], v[56:59]
 mf v[56:59], v[156:159], a[52:55], v[56:59]
 sad s37, s37, 35127296
 mf v[56:59], v[160:163], a[56:59], v[56:59]
 mf v[56:59], v[164:167], a[60:63], v[56:59]
 mf v[60:63], v[152:155], a[112:115], v[60:63]
 mf v[60:63], v[156:159], a[116:119], v[60:63]
 mf v[60:63], v[160:163], a[120:123], v[60:63]
 mf v[60:63], v[164:167], a[124:127], v[60:63]
 mf v[64:67], v[152:155], a[176:179], v[64:67]
 mf v[64:67], v[156:159], a[180:183], v[64:67]
 mf v[64:67], v[160:163], a[184:187], v[64:67]
 mf v[64:67], v[164:167], a[188:191], v[64:67]
 swc lgkmcnt(0)
 mf v[68:71], v[152:155], a[240:243], v[68:71]
 trr v[152:153], v186 offset:0
 trr v[154:155], v187 offset:0
 mf v[68:71], v[156:159], a[244:247], v[68:71]
 trr v[156:157], v186 offset:4096
 trr v[158:159], v187 offset:4096
 mf v[68:71], v[160:163], a[248:251], v[68:71]
 trr v[160:161], v186 offset:8192
 trr v[162:163], v187 offset:8192
 mf v[68:71], v[164:167], a[252:255], v[68:71]
 trr v[164:165], v186 offset:12288
 trr v[166:167], v187 offset:12288
 s_branch K1_COMMON
K1_V:
 v_add_u32 v196, 8192, v195
 v_add_u32 v197, 24576, v195
 v_add_u32 v198, 8192, v195
 v_add_u32 v199, 24576, v195
 dr4 a[0:3], v218 offset:0
 dr4 a[4:7], v219 offset:0
 dr4 a[64:67], v218 offset:2048
 dr4 a[68:71], v219 offset:2048
 dr4 a[128:131], v218 offset:4096
 dr4 a[132:135], v219 offset:4096
 dr4 a[192:195], v218 offset:6144
 dr4 a[196:199], v219 offset:6144
 trr v[136:137], v168 offset:0
 trr v[138:139], v169 offset:0
 trr v[140:141], v170 offset:0
 trr v[142:143], v171 offset:0
 trr v[144:145], v172 offset:0
 trr v[146:147], v173 offset:0
 trr v[148:149], v174 offset:0
 trr v[150:151], v175 offset:0
 trr v[152:153], v168 offset:4096
 trr v[154:155], v169 offset:4096
 trr v[156:157], v170 offset:4096
 trr v[158:159], v171 offset:4096
 trr v[160:161], v172 offset:4096
 trr v[162:163], v173 offset:4096
 trr v[164:165], v174 offset:4096
 trr v[166:167], v175 offset:4096
 swc lgkmcnt(12)
 mf v[8:11], a[0:3], v[136:139], 0
 mf v[12:15], a[64:67], v[136:139], 0
 sad m0, s39, 98304
 sad s19, s97, 0
 mf v[16:19], a[128:131], v[136:139], 0
 bl4 v216, s[48:51], s19 offen lds
 sad m0, s39, 99328
 sad s19, s97, 8192
 mf v[20:23], a[192:195], v[136:139], 0
 trr v[136:137], v168 offset:8192
 trr v[138:139], v169 offset:8192
 mf v[24:27], a[0:3], v[140:143], 0
 bl4 v217, s[48:51], s19 offen lds
 sad m0, s39, 100352
 sad s19, s97, 16384
 mf v[28:31], a[64:67], v[140:143], 0
 bl4 v216, s[48:51], s19 offen lds
 sad m0, s39, 101376
 sad s19, s97, 24576
 mf v[32:35], a[128:131], v[140:143], 0
 bl4 v217, s[48:51], s19 offen lds
 swc lgkmcnt(10)
 sad m0, s39, 102400
 sad s19, s97, 32768
 mf v[36:39], a[192:195], v[140:143], 0
 trr v[140:141], v170 offset:8192
 trr v[142:143], v171 offset:8192
 mf v[40:43], a[0:3], v[144:147], 0
 bl4 v216, s[48:51], s19 offen lds
 sad m0, s39, 103424
 sad s19, s97, 40960
 mf v[44:47], a[64:67], v[144:147], 0
 bl4 v217, s[48:51], s19 offen lds
 sad m0, s39, 104448
 sad s19, s97, 49152
 mf v[48:51], a[128:131], v[144:147], 0
 bl4 v216, s[48:51], s19 offen lds
 sad m0, s39, 105472
 sad s19, s97, 57344
 mf v[52:55], a[192:195], v[144:147], 0
 trr v[144:145], v172 offset:8192
 trr v[146:147], v173 offset:8192
 mf v[56:59], a[0:3], v[148:151], 0
 bl4 v217, s[48:51], s19 offen lds
 sad m0, s36, 32768
 sad s19, s90, 0
 mf v[60:63], a[64:67], v[148:151], 0
 bl4 v192, s[52:55], s19 offen lds
 sad m0, s36, 33792
 sad s19, s90, 65536
 mf v[64:67], a[128:131], v[148:151], 0
 bl4 v193, s[52:55], s19 offen lds
 swc lgkmcnt(10)
 sad m0, s36, 34816
 sad s19, s90, 131072
 mf v[68:71], a[192:195], v[148:151], 0
 trr v[148:149], v174 offset:8192
 trr v[150:151], v175 offset:8192
 mf v[8:11], a[4:7], v[152:155], v[8:11]
 bl4 v192, s[52:55], s19 offen lds
 sad m0, s36, 35840
 sad s19, s90, 196608
 mf v[12:15], a[68:71], v[152:155], v[12:15]
 bl4 v193, s[52:55], s19 offen lds
 mf v[16:19], a[132:135], v[152:155], v[16:19]
 mf v[20:23], a[196:199], v[152:155], v[20:23]
 trr v[152:153], v168 offset:12288
 trr v[154:155], v169 offset:12288
 mf v[24:27], a[4:7], v[156:159], v[24:27]
 mf v[28:31], a[68:71], v[156:159], v[28:31]
 mf v[32:35], a[132:135], v[156:159], v[32:35]
 swc lgkmcnt(10)
 mf v[36:39], a[196:199], v[156:159], v[36:39]
 trr v[156:157], v170 offset:12288
 trr v[158:159], v171 offset:12288
 swc vmcnt(19)
 mf v[40:43], a[4:7], v[160:163], v[40:43]
 dr4 a[8:11], v218 offset:32768
 dr4 a[12:15], v219 offset:32768
 mf v[44:47], a[68:71], v[160:163], v[44:47]
 dr4 a[72:75], v218 offset:34816
 dr4 a[76:79], v219 offset:34816
 mf v[48:51], a[132:135], v[160:163], v[48:51]
 dr4 a[136:139], v218 offset:36864
 dr4 a[140:143], v219 offset:36864
 mf v[52:55], a[196:199], v[160:163], v[52:55]
 trr v[160:161], v172 offset:12288
 trr v[162:163], v173 offset:12288
 mf v[56:59], a[4:7], v[164:167], v[56:59]
 dr4 a[200:203], v218 offset:38912
 dr4 a[204:207], v219 offset:38912
 mf v[60:63], a[68:71], v[164:167], v[60:63]
 mf v[64:67], a[132:135], v[164:167], v[64:67]
 swc lgkmcnt(10)
 mf v[68:71], a[196:199], v[164:167], v[68:71]
 trr v[164:165], v174 offset:12288
 trr v[166:167], v175 offset:12288
 swc lgkmcnt(2)
 mf v[8:11], a[8:11], v[136:139], v[8:11]
 swc vmcnt(15)
 s_barrier
 mf v[12:15], a[72:75], v[136:139], v[12:15]
 sad m0, s39, 131072
 sad s19, s97, 128
 mf v[16:19], a[136:139], v[136:139], v[16:19]
 bl4 v216, s[48:51], s19 offen lds
 sad m0, s39, 132096
 sad s19, s97, 8320
 mf v[20:23], a[200:203], v[136:139], v[20:23]
 trr v[136:137], v168 offset:16384
 trr v[138:139], v169 offset:16384
 mf v[24:27], a[8:11], v[140:143], v[24:27]
 bl4 v217, s[48:51], s19 offen lds
 sad m0, s39, 133120
 sad s19, s97, 16512
 mf v[28:31], a[72:75], v[140:143], v[28:31]
 bl4 v216, s[48:51], s19 offen lds
 sad m0, s39, 134144
 sad s19, s97, 24704
 mf v[32:35], a[136:139], v[140:143], v[32:35]
 bl4 v217, s[48:51], s19 offen lds
 swc lgkmcnt(10)
 sad m0, s39, 135168
 sad s19, s97, 32896
 mf v[36:39], a[200:203], v[140:143], v[36:39]
 trr v[140:141], v170 offset:16384
 trr v[142:143], v171 offset:16384
 mf v[40:43], a[8:11], v[144:147], v[40:43]
 bl4 v216, s[48:51], s19 offen lds
 sad m0, s39, 136192
 sad s19, s97, 41088
 mf v[44:47], a[72:75], v[144:147], v[44:47]
 bl4 v217, s[48:51], s19 offen lds
 sad m0, s39, 137216
 sad s19, s97, 49280
 mf v[48:51], a[136:139], v[144:147], v[48:51]
 bl4 v216, s[48:51], s19 offen lds
 sad m0, s39, 138240
 sad s19, s97, 57472
 mf v[52:55], a[200:203], v[144:147], v[52:55]
 trr v[144:145], v172 offset:16384
 trr v[146:147], v173 offset:16384
 mf v[56:59], a[8:11], v[148:151], v[56:59]
 bl4 v217, s[48:51], s19 offen lds
 sad m0, s36, 49152
 sad s19, s91, 0
 mf v[60:63], a[72:75], v[148:151], v[60:63]
 bl4 v192, s[52:55], s19 offen lds
 sad m0, s36, 50176
 sad s19, s91, 65536
 mf v[64:67], a[136:139], v[148:151], v[64:67]
 bl4 v193, s[52:55], s19 offen lds
 swc lgkmcnt(10)
 sad m0, s36, 51200
 sad s19, s91, 131072
 mf v[68:71], a[200:203], v[148:151], v[68:71]
 trr v[148:149], v174 offset:16384
 trr v[150:151], v175 offset:16384
 mf v[8:11], a[12:15], v[152:155], v[8:11]
 bl4 v192, s[52:55], s19 offen lds
 sad m0, s36, 52224
 sad s19, s91, 196608
 mf v[12:15], a[76:79], v[152:155], v[12:15]
 bl4 v193, s[52:55], s19 offen lds
 mf v[16:19], a[140:143], v[152:155], v[16:19]
 mf v[20:23], a[204:207], v[152:155], v[20:23]
 trr v[152:153], v168 offset:20480
 trr v[154:155], v169 offset:20480
 mf v[24:27], a[12:15], v[156:159], v[24:27]
 mf v[28:31], a[76:79], v[156:159], v[28:31]
 mf v[32:35], a[140:143], v[156:159], v[32:35]
 swc lgkmcnt(10)
 mf v[36:39], a[204:207], v[156:159], v[36:39]
 trr v[156:157], v170 offset:20480
 trr v[158:159], v171 offset:20480
 swc vmcnt(16)
 mf v[40:43], a[12:15], v[160:163], v[40:43]
 dr4 a[16:19], v218 offset:0
 dr4 a[20:23], v219 offset:0
 mf v[44:47], a[76:79], v[160:163], v[44:47]
 dr4 a[80:83], v218 offset:2048
 dr4 a[84:87], v219 offset:2048
 mf v[48:51], a[140:143], v[160:163], v[48:51]
 dr4 a[144:147], v218 offset:4096
 dr4 a[148:151], v219 offset:4096
 mf v[52:55], a[204:207], v[160:163], v[52:55]
 trr v[160:161], v172 offset:20480
 trr v[162:163], v173 offset:20480
 mf v[56:59], a[12:15], v[164:167], v[56:59]
 dr4 a[208:211], v218 offset:6144
 dr4 a[212:215], v219 offset:6144
 mf v[60:63], a[76:79], v[164:167], v[60:63]
 mf v[64:67], a[140:143], v[164:167], v[64:67]
 swc lgkmcnt(10)
 mf v[68:71], a[204:207], v[164:167], v[68:71]
 trr v[164:165], v174 offset:20480
 trr v[166:167], v175 offset:20480
 swc lgkmcnt(2)
 mf v[8:11], a[16:19], v[136:139], v[8:11]
 swc vmcnt(12)
 s_barrier
 mf v[12:15], a[80:83], v[136:139], v[12:15]
 sad m0, s39, 98304
 sad s19, s98, 0
 mf v[16:19], a[144:147], v[136:139], v[16:19]
 bl4 v216, s[48:51], s19 offen lds
 sad m0, s39, 99328
 sad s19, s98, 8192
 mf v[20:23], a[208:211], v[136:139], v[20:23]
 trr v[136:137], v168 offset:24576
 trr v[138:139], v169 offset:24576
 mf v[24:27], a[16:19], v[140:143], v[24:27]
 bl4 v217, s[48:51], s19 offen lds
 sad m0, s39, 100352
 sad s19, s98, 16384
 mf v[28:31], a[80:83], v[140:143], v[28:31]
 bl4 v216, s[48:51], s19 offen lds
 sad m0, s39, 101376
 sad s19, s98, 24576
 mf v[32:35], a[144:147], v[140:143], v[32:35]
 bl4 v217, s[48:51], s19 offen lds
 swc lgkmcnt(10)
 sad m0, s39, 102400
 sad s19, s98, 32768
 mf v[36:39], a[208:211], v[140:143], v[36:39]
 trr v[140:141], v170 offset:24576
 trr v[142:143], v171 offset:24576
 mf v[40:43], a[16:19], v[144:147], v[40:43]
 bl4 v216, s[48:51], s19 offen lds
 sad m0, s39, 103424
 sad s19, s98, 40960
 mf v[44:47], a[80:83], v[144:147], v[44:47]
 bl4 v217, s[48:51], s19 offen lds
 sad m0, s39, 104448
 sad s19, s98, 49152
 mf v[48:51], a[144:147], v[144:147], v[48:51]
 bl4 v216, s[48:51], s19 offen lds
 sad m0, s39, 105472
 sad s19, s98, 57344
 mf v[52:55], a[208:211], v[144:147], v[52:55]
 trr v[144:145], v172 offset:24576
 trr v[146:147], v173 offset:24576
 mf v[56:59], a[16:19], v[148:151], v[56:59]
 bl4 v217, s[48:51], s19 offen lds
 sad m0, s36, 65536
 sad s19, s88, 128
 mf v[60:63], a[80:83], v[148:151], v[60:63]
 bl4 v192, s[52:55], s19 offen lds
 sad m0, s36, 66560
 sad s19, s88, 65664
 mf v[64:67], a[144:147], v[148:151], v[64:67]
 bl4 v193, s[52:55], s19 offen lds
 swc lgkmcnt(10)
 sad m0, s36, 67584
 sad s19, s88, 131200
 mf v[68:71], a[208:211], v[148:151], v[68:71]
 trr v[148:149], v174 offset:24576
 trr v[150:151], v175 offset:24576
 mf v[8:11], a[20:23], v[152:155], v[8:11]
 bl4 v192, s[52:55], s19 offen lds
 sad m0, s36, 68608
 sad s19, s88, 196736
 mf v[12:15], a[84:87], v[152:155], v[12:15]
 bl4 v193, s[52:55], s19 offen lds
 mf v[16:19], a[148:151], v[152:155], v[16:19]
 mf v[20:23], a[212:215], v[152:155], v[20:23]
 trr v[152:153], v168 offset:28672
 trr v[154:155], v169 offset:28672
 mf v[24:27], a[20:23], v[156:159], v[24:27]
 mf v[28:31], a[84:87], v[156:159], v[28:31]
 mf v[32:35], a[148:151], v[156:159], v[32:35]
 swc lgkmcnt(10)
 mf v[36:39], a[212:215], v[156:159], v[36:39]
 trr v[156:157], v170 offset:28672
 trr v[158:159], v171 offset:28672
 swc vmcnt(16)
 mf v[40:43], a[20:23], v[160:163], v[40:43]
 dr4 a[24:27], v218 offset:32768
 dr4 a[28:31], v219 offset:32768
 mf v[44:47], a[84:87], v[160:163], v[44:47]
 dr4 a[88:91], v218 offset:34816
 dr4 a[92:95], v219 offset:34816
 mf v[48:51], a[148:151], v[160:163], v[48:51]
 dr4 a[152:155], v218 offset:36864
 dr4 a[156:159], v219 offset:36864
 mf v[52:55], a[212:215], v[160:163], v[52:55]
 trr v[160:161], v172 offset:28672
 trr v[162:163], v173 offset:28672
 mf v[56:59], a[20:23], v[164:167], v[56:59]
 dr4 a[216:219], v218 offset:38912
 dr4 a[220:223], v219 offset:38912
 mf v[60:63], a[84:87], v[164:167], v[60:63]
 mf v[64:67], a[148:151], v[164:167], v[64:67]
 swc lgkmcnt(10)
 mf v[68:71], a[212:215], v[164:167], v[68:71]
 trr v[164:165], v174 offset:28672
 trr v[166:167], v175 offset:28672
 swc lgkmcnt(2)
 mf v[8:11], a[24:27], v[136:139], v[8:11]
 mf v[12:15], a[88:91], v[136:139], v[12:15]
 sad m0, s39, 131072
 sad s19, s98, 128
 mf v[16:19], a[152:155], v[136:139], v[16:19]
 bl4 v216, s[48:51], s19 offen lds
 sad m0, s39, 132096
 sad s19, s98, 8320
 mf v[20:23], a[216:219], v[136:139], v[20:23]
 trr v[136:137], v168 offset:32768
 trr v[138:139], v169 offset:32768
 mf v[24:27], a[24:27], v[140:143], v[24:27]
 bl4 v217, s[48:51], s19 offen lds
 sad m0, s39, 133120
 sad s19, s98, 16512
 mf v[28:31], a[88:91], v[140:143], v[28:31]
 bl4 v216, s[48:51], s19 offen lds
 sad m0, s39, 134144
 sad s19, s98, 24704
 mf v[32:35], a[152:155], v[140:143], v[32:35]
 bl4 v217, s[48:51], s19 offen lds
 swc lgkmcnt(10)
 sad m0, s39, 135168
 sad s19, s98, 32896
 mf v[36:39], a[216:219], v[140:143], v[36:39]
 trr v[140:141], v170 offset:32768
 trr v[142:143], v171 offset:32768
 mf v[40:43], a[24:27], v[144:147], v[40:43]
 bl4 v216, s[48:51], s19 offen lds
 sad m0, s39, 136192
 sad s19, s98, 41088
 mf v[44:47], a[88:91], v[144:147], v[44:47]
 bl4 v217, s[48:51], s19 offen lds
 sad m0, s39, 137216
 sad s19, s98, 49280
 mf v[48:51], a[152:155], v[144:147], v[48:51]
 bl4 v216, s[48:51], s19 offen lds
 sad m0, s39, 138240
 sad s19, s98, 57472
 mf v[52:55], a[216:219], v[144:147], v[52:55]
 trr v[144:145], v172 offset:32768
 trr v[146:147], v173 offset:32768
 mf v[56:59], a[24:27], v[148:151], v[56:59]
 bl4 v217, s[48:51], s19 offen lds
 sad m0, s36, 81920
 sad s19, s89, 128
 mf v[60:63], a[88:91], v[148:151], v[60:63]
 bl4 v192, s[52:55], s19 offen lds
 sad m0, s36, 82944
 sad s19, s89, 65664
 mf v[64:67], a[152:155], v[148:151], v[64:67]
 bl4 v193, s[52:55], s19 offen lds
 swc lgkmcnt(10)
 sad m0, s36, 83968
 sad s19, s89, 131200
 mf v[68:71], a[216:219], v[148:151], v[68:71]
 trr v[148:149], v174 offset:32768
 trr v[150:151], v175 offset:32768
 mf v[8:11], a[28:31], v[152:155], v[8:11]
 bl4 v192, s[52:55], s19 offen lds
 sad m0, s36, 84992
 sad s19, s89, 196736
 mf v[12:15], a[92:95], v[152:155], v[12:15]
 bl4 v193, s[52:55], s19 offen lds
 mf v[16:19], a[156:159], v[152:155], v[16:19]
 mf v[20:23], a[220:223], v[152:155], v[20:23]
 trr v[152:153], v168 offset:36864
 trr v[154:155], v169 offset:36864
 mf v[24:27], a[28:31], v[156:159], v[24:27]
 mf v[28:31], a[92:95], v[156:159], v[28:31]
 mf v[32:35], a[156:159], v[156:159], v[32:35]
 swc lgkmcnt(10)
 mf v[36:39], a[220:223], v[156:159], v[36:39]
 trr v[156:157], v170 offset:36864
 trr v[158:159], v171 offset:36864
 swc vmcnt(16)
 mf v[40:43], a[28:31], v[160:163], v[40:43]
 dr4 a[32:35], v218 offset:0
 dr4 a[36:39], v219 offset:0
 mf v[44:47], a[92:95], v[160:163], v[44:47]
 dr4 a[96:99], v218 offset:2048
 dr4 a[100:103], v219 offset:2048
 mf v[48:51], a[156:159], v[160:163], v[48:51]
 dr4 a[160:163], v218 offset:4096
 dr4 a[164:167], v219 offset:4096
 mf v[52:55], a[220:223], v[160:163], v[52:55]
 trr v[160:161], v172 offset:36864
 trr v[162:163], v173 offset:36864
 mf v[56:59], a[28:31], v[164:167], v[56:59]
 dr4 a[224:227], v218 offset:6144
 dr4 a[228:231], v219 offset:6144
 mf v[60:63], a[92:95], v[164:167], v[60:63]
 mf v[64:67], a[156:159], v[164:167], v[64:67]
 swc lgkmcnt(10)
 mf v[68:71], a[220:223], v[164:167], v[68:71]
 trr v[164:165], v174 offset:36864
 trr v[166:167], v175 offset:36864
 swc lgkmcnt(2)
 mf v[8:11], a[32:35], v[136:139], v[8:11]
 swc vmcnt(24)
 s_barrier
 mf v[12:15], a[96:99], v[136:139], v[12:15]
 sad m0, s39, 98304
 sad s19, s99, 0
 mf v[16:19], a[160:163], v[136:139], v[16:19]
 bl4 v216, s[48:51], s19 offen lds
 sad m0, s39, 99328
 sad s19, s99, 8192
 mf v[20:23], a[224:227], v[136:139], v[20:23]
 trr v[136:137], v168 offset:40960
 trr v[138:139], v169 offset:40960
 mf v[24:27], a[32:35], v[140:143], v[24:27]
 bl4 v217, s[48:51], s19 offen lds
 sad m0, s39, 100352
 sad s19, s99, 16384
 mf v[28:31], a[96:99], v[140:143], v[28:31]
 bl4 v216, s[48:51], s19 offen lds
 sad m0, s39, 101376
 sad s19, s99, 24576
 mf v[32:35], a[160:163], v[140:143], v[32:35]
 bl4 v217, s[48:51], s19 offen lds
 swc lgkmcnt(10)
 sad m0, s39, 102400
 sad s19, s99, 32768
 mf v[36:39], a[224:227], v[140:143], v[36:39]
 trr v[140:141], v170 offset:40960
 trr v[142:143], v171 offset:40960
 mf v[40:43], a[32:35], v[144:147], v[40:43]
 bl4 v216, s[48:51], s19 offen lds
 sad m0, s39, 103424
 sad s19, s99, 40960
 mf v[44:47], a[96:99], v[144:147], v[44:47]
 bl4 v217, s[48:51], s19 offen lds
 sad m0, s39, 104448
 sad s19, s99, 49152
 mf v[48:51], a[160:163], v[144:147], v[48:51]
 bl4 v216, s[48:51], s19 offen lds
 sad m0, s39, 105472
 sad s19, s99, 57344
 mf v[52:55], a[224:227], v[144:147], v[52:55]
 trr v[144:145], v172 offset:40960
 trr v[146:147], v173 offset:40960
 mf v[56:59], a[32:35], v[148:151], v[56:59]
 bl4 v217, s[48:51], s19 offen lds
 mf v[60:63], a[96:99], v[148:151], v[60:63]
 mf v[64:67], a[160:163], v[148:151], v[64:67]
 swc lgkmcnt(10)
 mf v[68:71], a[224:227], v[148:151], v[68:71]
 trr v[148:149], v174 offset:40960
 trr v[150:151], v175 offset:40960
 mf v[8:11], a[36:39], v[152:155], v[8:11]
 mf v[12:15], a[100:103], v[152:155], v[12:15]
 mf v[16:19], a[164:167], v[152:155], v[16:19]
 mf v[20:23], a[228:231], v[152:155], v[20:23]
 trr v[152:153], v168 offset:45056
 trr v[154:155], v169 offset:45056
 mf v[24:27], a[36:39], v[156:159], v[24:27]
 mf v[28:31], a[100:103], v[156:159], v[28:31]
 mf v[32:35], a[164:167], v[156:159], v[32:35]
 swc lgkmcnt(10)
 mf v[36:39], a[228:231], v[156:159], v[36:39]
 trr v[156:157], v170 offset:45056
 trr v[158:159], v171 offset:45056
 swc vmcnt(12)
 mf v[40:43], a[36:39], v[160:163], v[40:43]
 dr4 a[40:43], v218 offset:32768
 dr4 a[44:47], v219 offset:32768
 mf v[44:47], a[100:103], v[160:163], v[44:47]
 dr4 a[104:107], v218 offset:34816
 dr4 a[108:111], v219 offset:34816
 mf v[48:51], a[164:167], v[160:163], v[48:51]
 dr4 a[168:171], v218 offset:36864
 dr4 a[172:175], v219 offset:36864
 mf v[52:55], a[228:231], v[160:163], v[52:55]
 trr v[160:161], v172 offset:45056
 trr v[162:163], v173 offset:45056
 mf v[56:59], a[36:39], v[164:167], v[56:59]
 dr4 a[232:235], v218 offset:38912
 dr4 a[236:239], v219 offset:38912
 mf v[60:63], a[100:103], v[164:167], v[60:63]
 mf v[64:67], a[164:167], v[164:167], v[64:67]
 swc lgkmcnt(10)
 mf v[68:71], a[228:231], v[164:167], v[68:71]
 trr v[164:165], v174 offset:45056
 trr v[166:167], v175 offset:45056
 swc lgkmcnt(2)
 mf v[8:11], a[40:43], v[136:139], v[8:11]
 mf v[12:15], a[104:107], v[136:139], v[12:15]
 sad m0, s39, 131072
 sad s19, s99, 128
 mf v[16:19], a[168:171], v[136:139], v[16:19]
 bl4 v216, s[48:51], s19 offen lds
 sad m0, s39, 132096
 sad s19, s99, 8320
 mf v[20:23], a[232:235], v[136:139], v[20:23]
 trr v[136:137], v168 offset:49152
 trr v[138:139], v169 offset:49152
 mf v[24:27], a[40:43], v[140:143], v[24:27]
 bl4 v217, s[48:51], s19 offen lds
 sad m0, s39, 133120
 sad s19, s99, 16512
 mf v[28:31], a[104:107], v[140:143], v[28:31]
 bl4 v216, s[48:51], s19 offen lds
 sad m0, s39, 134144
 sad s19, s99, 24704
 mf v[32:35], a[168:171], v[140:143], v[32:35]
 bl4 v217, s[48:51], s19 offen lds
 swc lgkmcnt(10)
 sad m0, s39, 135168
 sad s19, s99, 32896
 mf v[36:39], a[232:235], v[140:143], v[36:39]
 trr v[140:141], v170 offset:49152
 trr v[142:143], v171 offset:49152
 mf v[40:43], a[40:43], v[144:147], v[40:43]
 bl4 v216, s[48:51], s19 offen lds
 sad m0, s39, 136192
 sad s19, s99, 41088
 mf v[44:47], a[104:107], v[144:147], v[44:47]
 bl4 v217, s[48:51], s19 offen lds
 sad m0, s39, 137216
 sad s19, s99, 49280
 mf v[48:51], a[168:171], v[144:147], v[48:51]
 bl4 v216, s[48:51], s19 offen lds
 sad m0, s39, 138240
 sad s19, s99, 57472
 mf v[52:55], a[232:235], v[144:147], v[52:55]
 trr v[144:145], v172 offset:49152
 trr v[146:147], v173 offset:49152
 mf v[56:59], a[40:43], v[148:151], v[56:59]
 bl4 v217, s[48:51], s19 offen lds
 mf v[60:63], a[104:107], v[148:151], v[60:63]
 mf v[64:67], a[168:171], v[148:151], v[64:67]
 swc lgkmcnt(10)
 mf v[68:71], a[232:235], v[148:151], v[68:71]
 trr v[148:149], v174 offset:49152
 trr v[150:151], v175 offset:49152
 mf v[8:11], a[44:47], v[152:155], v[8:11]
 mf v[12:15], a[108:111], v[152:155], v[12:15]
 mf v[16:19], a[172:175], v[152:155], v[16:19]
 mf v[20:23], a[236:239], v[152:155], v[20:23]
 trr v[152:153], v168 offset:53248
 trr v[154:155], v169 offset:53248
 mf v[24:27], a[44:47], v[156:159], v[24:27]
 mf v[28:31], a[108:111], v[156:159], v[28:31]
 mf v[32:35], a[172:175], v[156:159], v[32:35]
 swc lgkmcnt(10)
 mf v[36:39], a[236:239], v[156:159], v[36:39]
 trr v[156:157], v170 offset:53248
 trr v[158:159], v171 offset:53248
 swc vmcnt(8)
 mf v[40:43], a[44:47], v[160:163], v[40:43]
 dr4 a[48:51], v218 offset:0
 dr4 a[52:55], v219 offset:0
 mf v[44:47], a[108:111], v[160:163], v[44:47]
 dr4 a[112:115], v218 offset:2048
 dr4 a[116:119], v219 offset:2048
 mf v[48:51], a[172:175], v[160:163], v[48:51]
 dr4 a[176:179], v218 offset:4096
 dr4 a[180:183], v219 offset:4096
 mf v[52:55], a[236:239], v[160:163], v[52:55]
 trr v[160:161], v172 offset:53248
 trr v[162:163], v173 offset:53248
 mf v[56:59], a[44:47], v[164:167], v[56:59]
 dr4 a[240:243], v218 offset:6144
 dr4 a[244:247], v219 offset:6144
 mf v[60:63], a[108:111], v[164:167], v[60:63]
 mf v[64:67], a[172:175], v[164:167], v[64:67]
 swc lgkmcnt(10)
 mf v[68:71], a[236:239], v[164:167], v[68:71]
 trr v[164:165], v174 offset:53248
 trr v[166:167], v175 offset:53248
 swc lgkmcnt(2)
 mf v[8:11], a[48:51], v[136:139], v[8:11]
 swc vmcnt(28)
 s_barrier
 mf v[12:15], a[112:115], v[136:139], v[12:15]
 mf v[16:19], a[176:179], v[136:139], v[16:19]
 mf v[20:23], a[240:243], v[136:139], v[20:23]
 trr v[136:137], v168 offset:57344
 trr v[138:139], v169 offset:57344
 mf v[24:27], a[48:51], v[140:143], v[24:27]
 mf v[28:31], a[112:115], v[140:143], v[28:31]
 mf v[32:35], a[176:179], v[140:143], v[32:35]
 swc lgkmcnt(10)
 mf v[36:39], a[240:243], v[140:143], v[36:39]
 trr v[140:141], v170 offset:57344
 trr v[142:143], v171 offset:57344
 mf v[40:43], a[48:51], v[144:147], v[40:43]
 mf v[44:47], a[112:115], v[144:147], v[44:47]
 mf v[48:51], a[176:179], v[144:147], v[48:51]
 mf v[52:55], a[240:243], v[144:147], v[52:55]
 trr v[144:145], v172 offset:57344
 trr v[146:147], v173 offset:57344
 mf v[56:59], a[48:51], v[148:151], v[56:59]
 mf v[60:63], a[112:115], v[148:151], v[60:63]
 mf v[64:67], a[176:179], v[148:151], v[64:67]
 swc lgkmcnt(10)
 mf v[68:71], a[240:243], v[148:151], v[68:71]
 trr v[148:149], v174 offset:57344
 trr v[150:151], v175 offset:57344
 mf v[8:11], a[52:55], v[152:155], v[8:11]
 mf v[12:15], a[116:119], v[152:155], v[12:15]
 mf v[16:19], a[180:183], v[152:155], v[16:19]
 mf v[20:23], a[244:247], v[152:155], v[20:23]
 trr v[152:153], v168 offset:61440
 trr v[154:155], v169 offset:61440
 mf v[24:27], a[52:55], v[156:159], v[24:27]
 mf v[28:31], a[116:119], v[156:159], v[28:31]
 mf v[32:35], a[180:183], v[156:159], v[32:35]
 swc lgkmcnt(10)
 mf v[36:39], a[244:247], v[156:159], v[36:39]
 trr v[156:157], v170 offset:61440
 trr v[158:159], v171 offset:61440
 swc vmcnt(0)
 mf v[40:43], a[52:55], v[160:163], v[40:43]
 dr4 a[56:59], v218 offset:32768
 dr4 a[60:63], v219 offset:32768
 mf v[44:47], a[116:119], v[160:163], v[44:47]
 dr4 a[120:123], v218 offset:34816
 dr4 a[124:127], v219 offset:34816
 mf v[48:51], a[180:183], v[160:163], v[48:51]
 dr4 a[184:187], v218 offset:36864
 dr4 a[188:191], v219 offset:36864
 mf v[52:55], a[244:247], v[160:163], v[52:55]
 trr v[160:161], v172 offset:61440
 trr v[162:163], v173 offset:61440
 mf v[56:59], a[52:55], v[164:167], v[56:59]
 dr4 a[248:251], v218 offset:38912
 dr4 a[252:255], v219 offset:38912
 mf v[60:63], a[116:119], v[164:167], v[60:63]
 mf v[64:67], a[180:183], v[164:167], v[64:67]
 swc lgkmcnt(10)
 mf v[68:71], a[244:247], v[164:167], v[68:71]
 trr v[164:165], v174 offset:61440
 trr v[166:167], v175 offset:61440
 swc lgkmcnt(2)
 mf v[8:11], a[56:59], v[136:139], v[8:11]
 s_barrier
 mf v[12:15], a[120:123], v[136:139], v[12:15]
 sad m0, s36, 98304
 sad s19, s90, 128
 mf v[16:19], a[184:187], v[136:139], v[16:19]
 bl4 v192, s[52:55], s19 offen lds
 sad m0, s36, 99328
 sad s19, s90, 65664
 mf v[20:23], a[248:251], v[136:139], v[20:23]
 trr v[136:137], v176 offset:0
 trr v[138:139], v177 offset:0
 mf v[24:27], a[56:59], v[140:143], v[24:27]
 bl4 v193, s[52:55], s19 offen lds
 sad m0, s36, 100352
 sad s19, s90, 131200
 mf v[28:31], a[120:123], v[140:143], v[28:31]
 bl4 v192, s[52:55], s19 offen lds
 sad m0, s36, 101376
 sad s19, s90, 196736
 mf v[32:35], a[184:187], v[140:143], v[32:35]
 bl4 v193, s[52:55], s19 offen lds
 swc lgkmcnt(10)
 sad m0, s36, 114688
 sad s19, s91, 128
 mf v[36:39], a[248:251], v[140:143], v[36:39]
 trr v[140:141], v176 offset:4096
 trr v[142:143], v177 offset:4096
 mf v[40:43], a[56:59], v[144:147], v[40:43]
 bl4 v192, s[52:55], s19 offen lds
 sad m0, s36, 115712
 sad s19, s91, 65664
 mf v[44:47], a[120:123], v[144:147], v[44:47]
 bl4 v193, s[52:55], s19 offen lds
 sad m0, s36, 116736
 sad s19, s91, 131200
 mf v[48:51], a[184:187], v[144:147], v[48:51]
 bl4 v192, s[52:55], s19 offen lds
 sad m0, s36, 117760
 sad s19, s91, 196736
 mf v[52:55], a[248:251], v[144:147], v[52:55]
 trr v[144:145], v176 offset:8192
 trr v[146:147], v177 offset:8192
 mf v[56:59], a[56:59], v[148:151], v[56:59]
 bl4 v193, s[52:55], s19 offen lds
 sad m0, s36, 0
 sad s19, s88, 256
 mf v[60:63], a[120:123], v[148:151], v[60:63]
 bl4 v192, s[52:55], s19 offen lds
 sad m0, s36, 1024
 sad s19, s88, 65792
 mf v[64:67], a[184:187], v[148:151], v[64:67]
 bl4 v193, s[52:55], s19 offen lds
 swc lgkmcnt(10)
 sad m0, s36, 2048
 sad s19, s88, 131328
 mf v[68:71], a[248:251], v[148:151], v[68:71]
 trr v[148:149], v176 offset:12288
 trr v[150:151], v177 offset:12288
 mf v[8:11], a[60:63], v[152:155], v[8:11]
 bl4 v192, s[52:55], s19 offen lds
 sad m0, s36, 3072
 sad s19, s88, 196864
 mf v[12:15], a[124:127], v[152:155], v[12:15]
 bl4 v193, s[52:55], s19 offen lds
 sad m0, s36, 16384
 sad s19, s89, 256
 mf v[16:19], a[188:191], v[152:155], v[16:19]
 bl4 v192, s[52:55], s19 offen lds
 sad m0, s36, 17408
 sad s19, s89, 65792
 mf v[20:23], a[252:255], v[152:155], v[20:23]
 trr v[152:153], v178 offset:0
 trr v[154:155], v179 offset:0
 mf v[24:27], a[60:63], v[156:159], v[24:27]
 bl4 v193, s[52:55], s19 offen lds
 sad m0, s36, 18432
 sad s19, s89, 131328
 mf v[28:31], a[124:127], v[156:159], v[28:31]
 bl4 v192, s[52:55], s19 offen lds
 sad m0, s36, 19456
 sad s19, s89, 196864
 mf v[32:35], a[188:191], v[156:159], v[32:35]
 bl4 v193, s[52:55], s19 offen lds
 swc lgkmcnt(10)
 sad m0, s36, 32768
 sad s19, s90, 256
 mf v[36:39], a[252:255], v[156:159], v[36:39]
 trr v[156:157], v178 offset:4096
 trr v[158:159], v179 offset:4096
 mf v[40:43], a[60:63], v[160:163], v[40:43]
 bl4 v192, s[52:55], s19 offen lds
 sad m0, s36, 33792
 sad s19, s90, 65792
 mf v[44:47], a[124:127], v[160:163], v[44:47]
 bl4 v193, s[52:55], s19 offen lds
 sad m0, s36, 34816
 sad s19, s90, 131328
 mf v[48:51], a[188:191], v[160:163], v[48:51]
 bl4 v192, s[52:55], s19 offen lds
 sad m0, s36, 35840
 sad s19, s90, 196864
 mf v[52:55], a[252:255], v[160:163], v[52:55]
 trr v[160:161], v178 offset:8192
 trr v[162:163], v179 offset:8192
 mf v[56:59], a[60:63], v[164:167], v[56:59]
 bl4 v193, s[52:55], s19 offen lds
 mf v[60:63], a[124:127], v[164:167], v[60:63]
 mf v[64:67], a[188:191], v[164:167], v[64:67]
 swc lgkmcnt(6)
 mf v[68:71], a[252:255], v[164:167], v[68:71]
 trr v[164:165], v178 offset:12288
 trr v[166:167], v179 offset:12288
 mf v[72:75], a[0:3], v[136:139], 0
 swc vmcnt(36)
 s_barrier
 mf v[72:75], a[4:7], v[140:143], v[72:75]
 sad m0, s36, 49152
 sad s19, s91, 256
 mf v[72:75], a[8:11], v[144:147], v[72:75]
 mf v[72:75], a[12:15], v[148:151], v[72:75]
 mf v[76:79], a[64:67], v[136:139], 0
 bl4 v192, s[52:55], s19 offen lds
 mf v[76:79], a[68:71], v[140:143], v[76:79]
 mf v[76:79], a[72:75], v[144:147], v[76:79]
 sad s34, s35, 0
 mf v[76:79], a[76:79], v[148:151], v[76:79]
 sad m0, s36, 50176
 sad s19, s91, 65792
 mf v[80:83], a[128:131], v[136:139], 0
 mf v[80:83], a[132:135], v[140:143], v[80:83]
 mf v[80:83], a[136:139], v[144:147], v[80:83]
 bl4 v193, s[52:55], s19 offen lds
 cvp v200, v8, v9
 mf v[80:83], a[140:143], v[148:151], v[80:83]
 swc lgkmcnt(0)
 mf v[84:87], a[192:195], v[136:139], 0
 trr v[136:137], v180 offset:0
 trr v[138:139], v181 offset:0
 mf v[84:87], a[196:199], v[140:143], v[84:87]
 trr v[140:141], v180 offset:4096
 trr v[142:143], v181 offset:4096
 mf v[84:87], a[200:203], v[144:147], v[84:87]
 trr v[144:145], v180 offset:8192
 trr v[146:147], v181 offset:8192
 mf v[84:87], a[204:207], v[148:151], v[84:87]
 trr v[148:149], v180 offset:12288
 trr v[150:151], v181 offset:12288
 mf v[88:91], a[0:3], v[152:155], 0
 mf v[88:91], a[4:7], v[156:159], v[88:91]
 mf v[88:91], a[8:11], v[160:163], v[88:91]
 sad m0, s36, 51200
 sad s19, s91, 131328
 mf v[88:91], a[12:15], v[164:167], v[88:91]
 cvp v201, v10, v11
 mf v[92:95], a[64:67], v[152:155], 0
 mf v[92:95], a[68:71], v[156:159], v[92:95]
 bl4 v192, s[52:55], s19 offen lds
 mf v[92:95], a[72:75], v[160:163], v[92:95]
 mf v[92:95], a[76:79], v[164:167], v[92:95]
 cvp v202, v12, v13
 mf v[96:99], a[128:131], v[152:155], 0
 sad m0, s36, 52224
 sad s19, s91, 196864
 mf v[96:99], a[132:135], v[156:159], v[96:99]
 mf v[96:99], a[136:139], v[160:163], v[96:99]
 mf v[96:99], a[140:143], v[164:167], v[96:99]
 swc lgkmcnt(0)
 mf v[100:103], a[192:195], v[152:155], 0
 trr v[152:153], v182 offset:0
 trr v[154:155], v183 offset:0
 mf v[100:103], a[196:199], v[156:159], v[100:103]
 trr v[156:157], v182 offset:4096
 trr v[158:159], v183 offset:4096
 mf v[100:103], a[200:203], v[160:163], v[100:103]
 trr v[160:161], v182 offset:8192
 trr v[162:163], v183 offset:8192
 mf v[100:103], a[204:207], v[164:167], v[100:103]
 trr v[164:165], v182 offset:12288
 trr v[166:167], v183 offset:12288
 mf v[104:107], a[0:3], v[136:139], 0
 bl4 v193, s[52:55], s19 offen lds
 mf v[104:107], a[4:7], v[140:143], v[104:107]
 cvp v203, v14, v15
 mf v[104:107], a[8:11], v[144:147], v[104:107]
 mf v[104:107], a[12:15], v[148:151], v[104:107]
 mf v[108:111], a[64:67], v[136:139], 0
 bs4 v[200:203], v196, s[12:15], s34 offen offset:0 sc1
 mf v[108:111], a[68:71], v[140:143], v[108:111]
 mf v[108:111], a[72:75], v[144:147], v[108:111]
 mf v[108:111], a[76:79], v[148:151], v[108:111]
 mf v[112:115], a[128:131], v[136:139], 0
 cvp v204, v16, v17
 mf v[112:115], a[132:135], v[140:143], v[112:115]
 mf v[112:115], a[136:139], v[144:147], v[112:115]
 mf v[112:115], a[140:143], v[148:151], v[112:115]
 swc lgkmcnt(0)
 cvp v205, v18, v19
 mf v[116:119], a[192:195], v[136:139], 0
 trr v[136:137], v176 offset:16384
 trr v[138:139], v177 offset:16384
 mf v[116:119], a[196:199], v[140:143], v[116:119]
 trr v[140:141], v176 offset:20480
 trr v[142:143], v177 offset:20480
 mf v[116:119], a[200:203], v[144:147], v[116:119]
 trr v[144:145], v176 offset:24576
 trr v[146:147], v177 offset:24576
 mf v[116:119], a[204:207], v[148:151], v[116:119]
 trr v[148:149], v176 offset:28672
 trr v[150:151], v177 offset:28672
 mf v[120:123], a[0:3], v[152:155], 0
 mf v[120:123], a[4:7], v[156:159], v[120:123]
 mf v[120:123], a[8:11], v[160:163], v[120:123]
 mf v[120:123], a[12:15], v[164:167], v[120:123]
 cvp v206, v20, v21
 mf v[124:127], a[64:67], v[152:155], 0
 mf v[124:127], a[68:71], v[156:159], v[124:127]
 mf v[124:127], a[72:75], v[160:163], v[124:127]
 cvp v207, v22, v23
 mf v[124:127], a[76:79], v[164:167], v[124:127]
 mf v[128:131], a[128:131], v[152:155], 0
 mf v[128:131], a[132:135], v[156:159], v[128:131]
 mf v[128:131], a[136:139], v[160:163], v[128:131]
 bs4 v[204:207], v197, s[12:15], s34 offen offset:0 sc1
 mf v[128:131], a[140:143], v[164:167], v[128:131]
 swc lgkmcnt(0)
 mf v[132:135], a[192:195], v[152:155], 0
 trr v[152:153], v178 offset:16384
 trr v[154:155], v179 offset:16384
 mf v[132:135], a[196:199], v[156:159], v[132:135]
 trr v[156:157], v178 offset:20480
 trr v[158:159], v179 offset:20480
 mf v[132:135], a[200:203], v[160:163], v[132:135]
 trr v[160:161], v178 offset:24576
 trr v[162:163], v179 offset:24576
 mf v[132:135], a[204:207], v[164:167], v[132:135]
 trr v[164:165], v178 offset:28672
 trr v[166:167], v179 offset:28672
 mf v[72:75], a[16:19], v[136:139], v[72:75]
 swc vmcnt(22)
 s_barrier
 mf v[72:75], a[20:23], v[140:143], v[72:75]
 sad m0, s36, 65536
 sad s19, s88, 384
 mf v[72:75], a[24:27], v[144:147], v[72:75]
 mf v[72:75], a[28:31], v[148:151], v[72:75]
 mf v[76:79], a[80:83], v[136:139], v[76:79]
 bl4 v192, s[52:55], s19 offen lds
 cvp v200, v24, v25
 mf v[76:79], a[84:87], v[140:143], v[76:79]
 mf v[76:79], a[88:91], v[144:147], v[76:79]
 mf v[76:79], a[92:95], v[148:151], v[76:79]
 sad m0, s36, 66560
 sad s19, s88, 65920
 mf v[80:83], a[144:147], v[136:139], v[80:83]
 mf v[80:83], a[148:151], v[140:143], v[80:83]
 cvp v201, v26, v27
 mf v[80:83], a[152:155], v[144:147], v[80:83]
 bl4 v193, s[52:55], s19 offen lds
 mf v[80:83], a[156:159], v[148:151], v[80:83]
 swc lgkmcnt(0)
 mf v[84:87], a[208:211], v[136:139], v[84:87]
 trr v[136:137], v180 offset:16384
 trr v[138:139], v181 offset:16384
 mf v[84:87], a[212:215], v[140:143], v[84:87]
 trr v[140:141], v180 offset:20480
 trr v[142:143], v181 offset:20480
 mf v[84:87], a[216:219], v[144:147], v[84:87]
 trr v[144:145], v180 offset:24576
 trr v[146:147], v181 offset:24576
 mf v[84:87], a[220:223], v[148:151], v[84:87]
 trr v[148:149], v180 offset:28672
 trr v[150:151], v181 offset:28672
 mf v[88:91], a[16:19], v[152:155], v[88:91]
 mf v[88:91], a[20:23], v[156:159], v[88:91]
 cvp v202, v28, v29
 mf v[88:91], a[24:27], v[160:163], v[88:91]
 sad m0, s36, 67584
 sad s19, s88, 131456
 mf v[88:91], a[28:31], v[164:167], v[88:91]
 mf v[92:95], a[80:83], v[152:155], v[92:95]
 mf v[92:95], a[84:87], v[156:159], v[92:95]
 bl4 v192, s[52:55], s19 offen lds
 mf v[92:95], a[88:91], v[160:163], v[92:95]
 cvp v203, v30, v31
 mf v[92:95], a[92:95], v[164:167], v[92:95]
 mf v[96:99], a[144:147], v[152:155], v[96:99]
 sad m0, s36, 68608
 sad s19, s88, 196992
 mf v[96:99], a[148:151], v[156:159], v[96:99]
 mf v[96:99], a[152:155], v[160:163], v[96:99]
 bs4 v[200:203], v196, s[12:15], s34 offen offset:1024 sc1
 mf v[96:99], a[156:159], v[164:167], v[96:99]
 swc lgkmcnt(0)
 mf v[100:103], a[208:211], v[152:155], v[100:103]
 trr v[152:153], v182 offset:16384
 trr v[154:155], v183 offset:16384
 mf v[100:103], a[212:215], v[156:159], v[100:103]
 trr v[156:157], v182 offset:20480
 trr v[158:159], v183 offset:20480
 mf v[100:103], a[216:219], v[160:163], v[100:103]
 trr v[160:161], v182 offset:24576
 trr v[162:163], v183 offset:24576
 mf v[100:103], a[220:223], v[164:167], v[100:103]
 trr v[164:165], v182 offset:28672
 trr v[166:167], v183 offset:28672
 mf v[104:107], a[16:19], v[136:139], v[104:107]
 bl4 v193, s[52:55], s19 offen lds
 mf v[104:107], a[20:23], v[140:143], v[104:107]
 mf v[104:107], a[24:27], v[144:147], v[104:107]
 mf v[104:107], a[28:31], v[148:151], v[104:107]
 sad s20, s18, 0
 s_and_b32 s20, s20, 3
 s_lshl_b32 s96, s20, 12
 mf v[108:111], a[80:83], v[136:139], v[108:111]
 cvp v204, v32, v33
 mf v[108:111], a[84:87], v[140:143], v[108:111]
 mf v[108:111], a[88:91], v[144:147], v[108:111]
 sad s20, s18, 1
 s_and_b32 s20, s20, 3
 s_lshl_b32 s97, s20, 12
 mf v[108:111], a[92:95], v[148:151], v[108:111]
 mf v[112:115], a[144:147], v[136:139], v[112:115]
 cvp v205, v34, v35
 mf v[112:115], a[148:151], v[140:143], v[112:115]
 sad s20, s18, 2
 s_and_b32 s20, s20, 3
 s_lshl_b32 s98, s20, 12
 mf v[112:115], a[152:155], v[144:147], v[112:115]
 mf v[112:115], a[156:159], v[148:151], v[112:115]
 swc lgkmcnt(0)
 mf v[116:119], a[208:211], v[136:139], v[116:119]
 trr v[136:137], v176 offset:32768
 trr v[138:139], v177 offset:32768
 mf v[116:119], a[212:215], v[140:143], v[116:119]
 trr v[140:141], v176 offset:36864
 trr v[142:143], v177 offset:36864
 mf v[116:119], a[216:219], v[144:147], v[116:119]
 trr v[144:145], v176 offset:40960
 trr v[146:147], v177 offset:40960
 mf v[116:119], a[220:223], v[148:151], v[116:119]
 trr v[148:149], v176 offset:45056
 trr v[150:151], v177 offset:45056
 mf v[120:123], a[16:19], v[152:155], v[120:123]
 mf v[120:123], a[20:23], v[156:159], v[120:123]
 sad s20, s18, 3
 s_and_b32 s20, s20, 3
 s_lshl_b32 s99, s20, 12
 mf v[120:123], a[24:27], v[160:163], v[120:123]
 cvp v206, v36, v37
 mf v[120:123], a[28:31], v[164:167], v[120:123]
 mf v[124:127], a[80:83], v[152:155], v[124:127]
 s_lshl_b32 s20, s17, 8
 sad s48, s30, s20
 s_addc_u32 s49, s31, 0
 s_sub_u32 s50, 4194304, s20
 mf v[124:127], a[84:87], v[156:159], v[124:127]
 mf v[124:127], a[88:91], v[160:163], v[124:127]
 cvp v207, v38, v39
 mf v[124:127], a[92:95], v[164:167], v[124:127]
 mf v[128:131], a[144:147], v[152:155], v[128:131]
 mf v[128:131], a[148:151], v[156:159], v[128:131]
 mf v[128:131], a[152:155], v[160:163], v[128:131]
 bs4 v[204:207], v197, s[12:15], s34 offen offset:1024 sc1
 mf v[128:131], a[156:159], v[164:167], v[128:131]
 swc lgkmcnt(0)
 mf v[132:135], a[208:211], v[152:155], v[132:135]
 trr v[152:153], v178 offset:32768
 trr v[154:155], v179 offset:32768
 mf v[132:135], a[212:215], v[156:159], v[132:135]
 trr v[156:157], v178 offset:36864
 trr v[158:159], v179 offset:36864
 mf v[132:135], a[216:219], v[160:163], v[132:135]
 trr v[160:161], v178 offset:40960
 trr v[162:163], v179 offset:40960
 mf v[132:135], a[220:223], v[164:167], v[132:135]
 trr v[164:165], v178 offset:45056
 trr v[166:167], v179 offset:45056
 mf v[72:75], a[32:35], v[136:139], v[72:75]
 swc vmcnt(24)
 s_barrier
 s_cmp_lg_u32 s16, 0
 s_cbranch_scc1 K1_NS1V
 s_mov_b64 exec, 1
 buffer_atomic_add v5, v4, s[80:83], 0 offen offset:128 sc1
 s_mov_b64 exec, -1
K1_NS1V:
 mf v[72:75], a[36:39], v[140:143], v[72:75]
 sad m0, s36, 81920
 sad s19, s89, 384
 mf v[72:75], a[40:43], v[144:147], v[72:75]
 mf v[72:75], a[44:47], v[148:151], v[72:75]
 mf v[76:79], a[96:99], v[136:139], v[76:79]
 bl4 v192, s[52:55], s19 offen lds
 cvp v200, v40, v41
 mf v[76:79], a[100:103], v[140:143], v[76:79]
 mf v[76:79], a[104:107], v[144:147], v[76:79]
 mf v[76:79], a[108:111], v[148:151], v[76:79]
 sad m0, s36, 82944
 sad s19, s89, 65920
 mf v[80:83], a[160:163], v[136:139], v[80:83]
 mf v[80:83], a[164:167], v[140:143], v[80:83]
 cvp v201, v42, v43
 mf v[80:83], a[168:171], v[144:147], v[80:83]
 bl4 v193, s[52:55], s19 offen lds
 mf v[80:83], a[172:175], v[148:151], v[80:83]
 swc lgkmcnt(0)
 mf v[84:87], a[224:227], v[136:139], v[84:87]
 trr v[136:137], v180 offset:32768
 trr v[138:139], v181 offset:32768
 mf v[84:87], a[228:231], v[140:143], v[84:87]
 trr v[140:141], v180 offset:36864
 trr v[142:143], v181 offset:36864
 mf v[84:87], a[232:235], v[144:147], v[84:87]
 trr v[144:145], v180 offset:40960
 trr v[146:147], v181 offset:40960
 mf v[84:87], a[236:239], v[148:151], v[84:87]
 trr v[148:149], v180 offset:45056
 trr v[150:151], v181 offset:45056
 mf v[88:91], a[32:35], v[152:155], v[88:91]
 mf v[88:91], a[36:39], v[156:159], v[88:91]
 cvp v202, v44, v45
 mf v[88:91], a[40:43], v[160:163], v[88:91]
 sad m0, s36, 83968
 sad s19, s89, 131456
 mf v[88:91], a[44:47], v[164:167], v[88:91]
 mf v[92:95], a[96:99], v[152:155], v[92:95]
 mf v[92:95], a[100:103], v[156:159], v[92:95]
 bl4 v192, s[52:55], s19 offen lds
 mf v[92:95], a[104:107], v[160:163], v[92:95]
 cvp v203, v46, v47
 mf v[92:95], a[108:111], v[164:167], v[92:95]
 mf v[96:99], a[160:163], v[152:155], v[96:99]
 sad m0, s36, 84992
 sad s19, s89, 196992
 mf v[96:99], a[164:167], v[156:159], v[96:99]
 mf v[96:99], a[168:171], v[160:163], v[96:99]
 bs4 v[200:203], v196, s[12:15], s34 offen offset:2048 sc1
 mf v[96:99], a[172:175], v[164:167], v[96:99]
 swc lgkmcnt(0)
 mf v[100:103], a[224:227], v[152:155], v[100:103]
 trr v[152:153], v182 offset:32768
 trr v[154:155], v183 offset:32768
 mf v[100:103], a[228:231], v[156:159], v[100:103]
 trr v[156:157], v182 offset:36864
 trr v[158:159], v183 offset:36864
 mf v[100:103], a[232:235], v[160:163], v[100:103]
 trr v[160:161], v182 offset:40960
 trr v[162:163], v183 offset:40960
 mf v[100:103], a[236:239], v[164:167], v[100:103]
 trr v[164:165], v182 offset:45056
 trr v[166:167], v183 offset:45056
 mf v[104:107], a[32:35], v[136:139], v[104:107]
 bl4 v193, s[52:55], s19 offen lds
 mf v[104:107], a[36:39], v[140:143], v[104:107]
 mf v[104:107], a[40:43], v[144:147], v[104:107]
 mf v[104:107], a[44:47], v[148:151], v[104:107]
 cvp v204, v48, v49
 mf v[108:111], a[96:99], v[136:139], v[108:111]
 mf v[108:111], a[100:103], v[140:143], v[108:111]
 mf v[108:111], a[104:107], v[144:147], v[108:111]
 cvp v205, v50, v51
 mf v[108:111], a[108:111], v[148:151], v[108:111]
 mf v[112:115], a[160:163], v[136:139], v[112:115]
 mf v[112:115], a[164:167], v[140:143], v[112:115]
 mf v[112:115], a[168:171], v[144:147], v[112:115]
 cvp v206, v52, v53
 mf v[112:115], a[172:175], v[148:151], v[112:115]
 swc lgkmcnt(0)
 mf v[116:119], a[224:227], v[136:139], v[116:119]
 trr v[136:137], v176 offset:49152
 trr v[138:139], v177 offset:49152
 mf v[116:119], a[228:231], v[140:143], v[116:119]
 trr v[140:141], v176 offset:53248
 trr v[142:143], v177 offset:53248
 mf v[116:119], a[232:235], v[144:147], v[116:119]
 trr v[144:145], v176 offset:57344
 trr v[146:147], v177 offset:57344
 mf v[116:119], a[236:239], v[148:151], v[116:119]
 trr v[148:149], v176 offset:61440
 trr v[150:151], v177 offset:61440
 mf v[120:123], a[32:35], v[152:155], v[120:123]
 mf v[120:123], a[36:39], v[156:159], v[120:123]
 mf v[120:123], a[40:43], v[160:163], v[120:123]
 cvp v207, v54, v55
 mf v[120:123], a[44:47], v[164:167], v[120:123]
 mf v[124:127], a[96:99], v[152:155], v[124:127]
 mf v[124:127], a[100:103], v[156:159], v[124:127]
 bs4 v[204:207], v197, s[12:15], s34 offen offset:2048 sc1
 mf v[124:127], a[104:107], v[160:163], v[124:127]
 mf v[124:127], a[108:111], v[164:167], v[124:127]
 mf v[128:131], a[160:163], v[152:155], v[128:131]
 cvp v200, v56, v57
 mf v[128:131], a[164:167], v[156:159], v[128:131]
 mf v[128:131], a[168:171], v[160:163], v[128:131]
 mf v[128:131], a[172:175], v[164:167], v[128:131]
 swc lgkmcnt(0)
 mf v[132:135], a[224:227], v[152:155], v[132:135]
 trr v[152:153], v178 offset:49152
 trr v[154:155], v179 offset:49152
 mf v[132:135], a[228:231], v[156:159], v[132:135]
 trr v[156:157], v178 offset:53248
 trr v[158:159], v179 offset:53248
 mf v[132:135], a[232:235], v[160:163], v[132:135]
 trr v[160:161], v178 offset:57344
 trr v[162:163], v179 offset:57344
 mf v[132:135], a[236:239], v[164:167], v[132:135]
 trr v[164:165], v178 offset:61440
 trr v[166:167], v179 offset:61440
 mf v[72:75], a[48:51], v[136:139], v[72:75]
 swc vmcnt(26)
 s_barrier
 mf v[72:75], a[52:55], v[140:143], v[72:75]
 sad m0, s36, 98304
 sad s19, s90, 384
 mf v[72:75], a[56:59], v[144:147], v[72:75]
 cvp v201, v58, v59
 mf v[72:75], a[60:63], v[148:151], v[72:75]
 mf v[76:79], a[112:115], v[136:139], v[76:79]
 bl4 v192, s[52:55], s19 offen lds
 mf v[76:79], a[116:119], v[140:143], v[76:79]
 mf v[76:79], a[120:123], v[144:147], v[76:79]
 cvp v202, v60, v61
 mf v[76:79], a[124:127], v[148:151], v[76:79]
 sad m0, s36, 99328
 sad s19, s90, 65920
 mf v[80:83], a[176:179], v[136:139], v[80:83]
 mf v[80:83], a[180:183], v[140:143], v[80:83]
 mf v[80:83], a[184:187], v[144:147], v[80:83]
 bl4 v193, s[52:55], s19 offen lds
 mf v[80:83], a[188:191], v[148:151], v[80:83]
 swc lgkmcnt(0)
 mf v[84:87], a[240:243], v[136:139], v[84:87]
 trr v[136:137], v180 offset:49152
 trr v[138:139], v181 offset:49152
 mf v[84:87], a[244:247], v[140:143], v[84:87]
 trr v[140:141], v180 offset:53248
 trr v[142:143], v181 offset:53248
 mf v[84:87], a[248:251], v[144:147], v[84:87]
 trr v[144:145], v180 offset:57344
 trr v[146:147], v181 offset:57344
 mf v[84:87], a[252:255], v[148:151], v[84:87]
 trr v[148:149], v180 offset:61440
 trr v[150:151], v181 offset:61440
 mf v[88:91], a[48:51], v[152:155], v[88:91]
 cvp v203, v62, v63
 mf v[88:91], a[52:55], v[156:159], v[88:91]
 mf v[88:91], a[56:59], v[160:163], v[88:91]
 sad m0, s36, 100352
 sad s19, s90, 131456
 mf v[88:91], a[60:63], v[164:167], v[88:91]
 mf v[92:95], a[112:115], v[152:155], v[92:95]
 bs4 v[200:203], v196, s[12:15], s34 offen offset:3072 sc1
 mf v[92:95], a[116:119], v[156:159], v[92:95]
 bl4 v192, s[52:55], s19 offen lds
 mf v[92:95], a[120:123], v[160:163], v[92:95]
 mf v[92:95], a[124:127], v[164:167], v[92:95]
 mf v[96:99], a[176:179], v[152:155], v[96:99]
 sad m0, s36, 101376
 sad s19, s90, 196992
 mf v[96:99], a[180:183], v[156:159], v[96:99]
 cvp v204, v64, v65
 mf v[96:99], a[184:187], v[160:163], v[96:99]
 mf v[96:99], a[188:191], v[164:167], v[96:99]
 swc lgkmcnt(0)
 mf v[100:103], a[240:243], v[152:155], v[100:103]
 trr v[152:153], v182 offset:49152
 trr v[154:155], v183 offset:49152
 mf v[100:103], a[244:247], v[156:159], v[100:103]
 trr v[156:157], v182 offset:53248
 trr v[158:159], v183 offset:53248
 mf v[100:103], a[248:251], v[160:163], v[100:103]
 trr v[160:161], v182 offset:57344
 trr v[162:163], v183 offset:57344
 mf v[100:103], a[252:255], v[164:167], v[100:103]
 trr v[164:165], v182 offset:61440
 trr v[166:167], v183 offset:61440
 mf v[104:107], a[48:51], v[136:139], v[104:107]
 bl4 v193, s[52:55], s19 offen lds
 mf v[104:107], a[52:55], v[140:143], v[104:107]
 cvp v205, v66, v67
 mf v[104:107], a[56:59], v[144:147], v[104:107]
 mf v[104:107], a[60:63], v[148:151], v[104:107]
 mf v[108:111], a[112:115], v[136:139], v[108:111]
 mf v[108:111], a[116:119], v[140:143], v[108:111]
 cvp v206, v68, v69
 mf v[108:111], a[120:123], v[144:147], v[108:111]
 mf v[108:111], a[124:127], v[148:151], v[108:111]
 mf v[112:115], a[176:179], v[136:139], v[112:115]
 cvp v207, v70, v71
 mf v[112:115], a[180:183], v[140:143], v[112:115]
 mf v[112:115], a[184:187], v[144:147], v[112:115]
 mf v[112:115], a[188:191], v[148:151], v[112:115]
 swc lgkmcnt(0)
 mf v[116:119], a[240:243], v[136:139], v[116:119]
 trr v[136:137], v168 offset:0
 trr v[138:139], v169 offset:0
 mf v[116:119], a[244:247], v[140:143], v[116:119]
 trr v[140:141], v168 offset:4096
 trr v[142:143], v169 offset:4096
 mf v[116:119], a[248:251], v[144:147], v[116:119]
 trr v[144:145], v168 offset:8192
 trr v[146:147], v169 offset:8192
 mf v[116:119], a[252:255], v[148:151], v[116:119]
 trr v[148:149], v168 offset:12288
 trr v[150:151], v169 offset:12288
 mf v[120:123], a[48:51], v[152:155], v[120:123]
 bs4 v[204:207], v197, s[12:15], s34 offen offset:3072 sc1
 mf v[120:123], a[52:55], v[156:159], v[120:123]
 mf v[120:123], a[56:59], v[160:163], v[120:123]
 mf v[120:123], a[60:63], v[164:167], v[120:123]
 mf v[124:127], a[112:115], v[152:155], v[124:127]
 mf v[124:127], a[116:119], v[156:159], v[124:127]
 mf v[124:127], a[120:123], v[160:163], v[124:127]
 mf v[124:127], a[124:127], v[164:167], v[124:127]
 mf v[128:131], a[176:179], v[152:155], v[128:131]
 mf v[128:131], a[180:183], v[156:159], v[128:131]
 mf v[128:131], a[184:187], v[160:163], v[128:131]
 mf v[128:131], a[188:191], v[164:167], v[128:131]
 swc lgkmcnt(0)
 mf v[132:135], a[240:243], v[152:155], v[132:135]
 trr v[152:153], v170 offset:0
 trr v[154:155], v171 offset:0
 mf v[132:135], a[244:247], v[156:159], v[132:135]
 trr v[156:157], v170 offset:4096
 trr v[158:159], v171 offset:4096
 mf v[132:135], a[248:251], v[160:163], v[132:135]
 trr v[160:161], v170 offset:8192
 trr v[162:163], v171 offset:8192
 mf v[132:135], a[252:255], v[164:167], v[132:135]
 trr v[164:165], v170 offset:12288
 trr v[166:167], v171 offset:12288
 s_getpc_b64 s[84:85]
CT3:
 sad s84, s84, (K1_FIN-CT3)&0xffffffff
 s_addc_u32 s85, s85, ((K1_FIN-CT3)>>32)&0xffffffff
 s_lshr_b32 s86, s2, 3
 s_lshl_b32 s86, s86, 2
 sad s86, s86, s16
 s_mul_i32 s86, s86, ((K2_END-K1_FIN+16383)/16384)*128
 v_lshlrev_b32 v7, 7, v0
 v_min_u32 v7, ((K2_END-K1_FIN+16383)/16384)*128-128, v7
 v_add_u32 v7, s86, v7
 v_min_u32 v7, K2_END-K1_FIN-4, v7
 global_load_dword v7, v7, s[84:85]
 mf v[8:11], a[0:3], v[136:139], 0
 swc vmcnt(29)
 s_barrier
 mf v[8:11], a[4:7], v[140:143], v[8:11]
 sad m0, s36, 114688
 sad s19, s91, 384
 mf v[8:11], a[8:11], v[144:147], v[8:11]
 mf v[8:11], a[12:15], v[148:151], v[8:11]
 mf v[12:15], a[64:67], v[136:139], 0
 bl4 v192, s[52:55], s19 offen lds
 mf v[12:15], a[68:71], v[140:143], v[12:15]
 mf v[12:15], a[72:75], v[144:147], v[12:15]
 sad s34, s35, 4096
 mf v[12:15], a[76:79], v[148:151], v[12:15]
 sad m0, s36, 115712
 sad s19, s91, 65920
 mf v[16:19], a[128:131], v[136:139], 0
 mf v[16:19], a[132:135], v[140:143], v[16:19]
 mf v[16:19], a[136:139], v[144:147], v[16:19]
 bl4 v193, s[52:55], s19 offen lds
 cvp v200, v72, v73
 mf v[16:19], a[140:143], v[148:151], v[16:19]
 swc lgkmcnt(0)
 mf v[20:23], a[192:195], v[136:139], 0
 trr v[136:137], v172 offset:0
 trr v[138:139], v173 offset:0
 mf v[20:23], a[196:199], v[140:143], v[20:23]
 trr v[140:141], v172 offset:4096
 trr v[142:143], v173 offset:4096
 mf v[20:23], a[200:203], v[144:147], v[20:23]
 trr v[144:145], v172 offset:8192
 trr v[146:147], v173 offset:8192
 mf v[20:23], a[204:207], v[148:151], v[20:23]
 trr v[148:149], v172 offset:12288
 trr v[150:151], v173 offset:12288
 mf v[24:27], a[0:3], v[152:155], 0
 mf v[24:27], a[4:7], v[156:159], v[24:27]
 mf v[24:27], a[8:11], v[160:163], v[24:27]
 sad m0, s36, 116736
 sad s19, s91, 131456
 mf v[24:27], a[12:15], v[164:167], v[24:27]
 cvp v201, v74, v75
 mf v[28:31], a[64:67], v[152:155], 0
 mf v[28:31], a[68:71], v[156:159], v[28:31]
 bl4 v192, s[52:55], s19 offen lds
 mf v[28:31], a[72:75], v[160:163], v[28:31]
 mf v[28:31], a[76:79], v[164:167], v[28:31]
 cvp v202, v76, v77
 mf v[32:35], a[128:131], v[152:155], 0
 sad m0, s36, 117760
 sad s19, s91, 196992
 mf v[32:35], a[132:135], v[156:159], v[32:35]
 mf v[32:35], a[136:139], v[160:163], v[32:35]
 mf v[32:35], a[140:143], v[164:167], v[32:35]
 swc lgkmcnt(0)
 mf v[36:39], a[192:195], v[152:155], 0
 trr v[152:153], v174 offset:0
 trr v[154:155], v175 offset:0
 mf v[36:39], a[196:199], v[156:159], v[36:39]
 trr v[156:157], v174 offset:4096
 trr v[158:159], v175 offset:4096
 mf v[36:39], a[200:203], v[160:163], v[36:39]
 trr v[160:161], v174 offset:8192
 trr v[162:163], v175 offset:8192
 mf v[36:39], a[204:207], v[164:167], v[36:39]
 trr v[164:165], v174 offset:12288
 trr v[166:167], v175 offset:12288
 mf v[40:43], a[0:3], v[136:139], 0
 bl4 v193, s[52:55], s19 offen lds
 cvp v203, v78, v79
 mf v[40:43], a[4:7], v[140:143], v[40:43]
 mf v[40:43], a[8:11], v[144:147], v[40:43]
 mf v[40:43], a[12:15], v[148:151], v[40:43]
 bs4 v[200:203], v196, s[12:15], s34 offen offset:0 sc1
 mf v[44:47], a[64:67], v[136:139], 0
 mf v[44:47], a[68:71], v[140:143], v[44:47]
 mf v[44:47], a[72:75], v[144:147], v[44:47]
 mf v[44:47], a[76:79], v[148:151], v[44:47]
 cvp v204, v80, v81
 mf v[48:51], a[128:131], v[136:139], 0
 mf v[48:51], a[132:135], v[140:143], v[48:51]
 mf v[48:51], a[136:139], v[144:147], v[48:51]
 cvp v205, v82, v83
 mf v[48:51], a[140:143], v[148:151], v[48:51]
 swc lgkmcnt(0)
 mf v[52:55], a[192:195], v[136:139], 0
 trr v[136:137], v168 offset:16384
 trr v[138:139], v169 offset:16384
 mf v[52:55], a[196:199], v[140:143], v[52:55]
 trr v[140:141], v168 offset:20480
 trr v[142:143], v169 offset:20480
 mf v[52:55], a[200:203], v[144:147], v[52:55]
 trr v[144:145], v168 offset:24576
 trr v[146:147], v169 offset:24576
 mf v[52:55], a[204:207], v[148:151], v[52:55]
 trr v[148:149], v168 offset:28672
 trr v[150:151], v169 offset:28672
 mf v[56:59], a[0:3], v[152:155], 0
 mf v[56:59], a[4:7], v[156:159], v[56:59]
 mf v[56:59], a[8:11], v[160:163], v[56:59]
 cvp v206, v84, v85
 mf v[56:59], a[12:15], v[164:167], v[56:59]
 mf v[60:63], a[64:67], v[152:155], 0
 mf v[60:63], a[68:71], v[156:159], v[60:63]
 cvp v207, v86, v87
 mf v[60:63], a[72:75], v[160:163], v[60:63]
 mf v[60:63], a[76:79], v[164:167], v[60:63]
 mf v[64:67], a[128:131], v[152:155], 0
 bs4 v[204:207], v197, s[12:15], s34 offen offset:0 sc1
 mf v[64:67], a[132:135], v[156:159], v[64:67]
 mf v[64:67], a[136:139], v[160:163], v[64:67]
 mf v[64:67], a[140:143], v[164:167], v[64:67]
 swc lgkmcnt(0)
 mf v[68:71], a[192:195], v[152:155], 0
 trr v[152:153], v170 offset:16384
 trr v[154:155], v171 offset:16384
 mf v[68:71], a[196:199], v[156:159], v[68:71]
 trr v[156:157], v170 offset:20480
 trr v[158:159], v171 offset:20480
 mf v[68:71], a[200:203], v[160:163], v[68:71]
 trr v[160:161], v170 offset:24576
 trr v[162:163], v171 offset:24576
 mf v[68:71], a[204:207], v[164:167], v[68:71]
 trr v[164:165], v170 offset:28672
 trr v[166:167], v171 offset:28672
 mf v[8:11], a[16:19], v[136:139], v[8:11]
 swc vmcnt(31)
 s_barrier
 mf v[8:11], a[20:23], v[140:143], v[8:11]
 sad m0, s36, 0
 sad s19, s92, 0
 mf v[8:11], a[24:27], v[144:147], v[8:11]
 cvp v200, v88, v89
 mf v[8:11], a[28:31], v[148:151], v[8:11]
 bl4 v194, s[56:59], s19 offen lds
 mf v[12:15], a[80:83], v[136:139], v[12:15]
 mf v[12:15], a[84:87], v[140:143], v[12:15]
 sad m0, s36, 1024
 sad s19, s92, 44032
 mf v[12:15], a[88:91], v[144:147], v[12:15]
 mf v[12:15], a[92:95], v[148:151], v[12:15]
 bl4 v194, s[56:59], s19 offen lds
 cvp v201, v90, v91
 mf v[16:19], a[144:147], v[136:139], v[16:19]
 mf v[16:19], a[148:151], v[140:143], v[16:19]
 sad m0, s36, 2048
 sad s19, s92, 0
 mf v[16:19], a[152:155], v[144:147], v[16:19]
 mf v[16:19], a[156:159], v[148:151], v[16:19]
 swc lgkmcnt(0)
 mf v[20:23], a[208:211], v[136:139], v[20:23]
 trr v[136:137], v172 offset:16384
 trr v[138:139], v173 offset:16384
 mf v[20:23], a[212:215], v[140:143], v[20:23]
 trr v[140:141], v172 offset:20480
 trr v[142:143], v173 offset:20480
 mf v[20:23], a[216:219], v[144:147], v[20:23]
 trr v[144:145], v172 offset:24576
 trr v[146:147], v173 offset:24576
 mf v[20:23], a[220:223], v[148:151], v[20:23]
 trr v[148:149], v172 offset:28672
 trr v[150:151], v173 offset:28672
 mf v[24:27], a[16:19], v[152:155], v[24:27]
 bl4 v194, s[60:63], s19 offen lds
 cvp v202, v92, v93
 mf v[24:27], a[20:23], v[156:159], v[24:27]
 mf v[24:27], a[24:27], v[160:163], v[24:27]
 sad m0, s36, 3072
 sad s19, s92, 44032
 mf v[24:27], a[28:31], v[164:167], v[24:27]
 mf v[28:31], a[80:83], v[152:155], v[28:31]
 bl4 v194, s[60:63], s19 offen lds
 mf v[28:31], a[84:87], v[156:159], v[28:31]
 cvp v203, v94, v95
 mf v[28:31], a[88:91], v[160:163], v[28:31]
 s_lshl_b32 s20, s100, 6
 sad s46, s20, 60817408
 mf v[28:31], a[92:95], v[164:167], v[28:31]
 mf v[32:35], a[144:147], v[152:155], v[32:35]
 s_lshl_b32 s20, s101, 6
 sad s47, s20, 60817408
 mf v[32:35], a[148:151], v[156:159], v[32:35]
 mf v[32:35], a[152:155], v[160:163], v[32:35]
 s_lshr_b32 s20, s100, 2
 s_mul_i32 s24, s20, 700416
 mf v[32:35], a[156:159], v[164:167], v[32:35]
 swc lgkmcnt(0)
 mf v[36:39], a[208:211], v[152:155], v[36:39]
 trr v[152:153], v174 offset:16384
 trr v[154:155], v175 offset:16384
 mf v[36:39], a[212:215], v[156:159], v[36:39]
 trr v[156:157], v174 offset:20480
 trr v[158:159], v175 offset:20480
 mf v[36:39], a[216:219], v[160:163], v[36:39]
 trr v[160:161], v174 offset:24576
 trr v[162:163], v175 offset:24576
 mf v[36:39], a[220:223], v[164:167], v[36:39]
 trr v[164:165], v174 offset:28672
 trr v[166:167], v175 offset:28672
 mf v[40:43], a[16:19], v[136:139], v[40:43]
 bs4 v[200:203], v196, s[12:15], s34 offen offset:1024 sc1
 mf v[40:43], a[20:23], v[140:143], v[40:43]
 s_lshr_b32 s20, s101, 2
 s_mul_i32 s25, s20, 700416
 mf v[40:43], a[24:27], v[144:147], v[40:43]
 mf v[40:43], a[28:31], v[148:151], v[40:43]
 s_lshl_b32 s100, s100, 14
 sad s100, s100, 58720256
 mf v[44:47], a[80:83], v[136:139], v[44:47]
 mf v[44:47], a[84:87], v[140:143], v[44:47]
 s_lshl_b32 s101, s101, 14
 sad s101, s101, 58720256
 mf v[44:47], a[88:91], v[144:147], v[44:47]
 cvp v204, v96, v97
 mf v[44:47], a[92:95], v[148:151], v[44:47]
 s_lshl_b32 s20, s16, 1
 s_sub_u32 s20, 7, s20
 s_lshl_b32 s3, s20, 14
 v_add_u32 v255, s3, v195
 s_lshl_b32 s3, s20, 6
 v_add_u32 v6, s3, v253
 mf v[48:51], a[144:147], v[136:139], v[48:51]
 mf v[48:51], a[148:151], v[140:143], v[48:51]
 s_lshl_b32 s20, s96, 8
 s_lshl_b32 s3, s16, 18
 sad s88, s20, s3
 mf v[48:51], a[152:155], v[144:147], v[48:51]
 mf v[48:51], a[156:159], v[148:151], v[48:51]
 swc lgkmcnt(0)
 mf v[52:55], a[208:211], v[136:139], v[52:55]
 trr v[136:137], v168 offset:32768
 trr v[138:139], v169 offset:32768
 mf v[52:55], a[212:215], v[140:143], v[52:55]
 trr v[140:141], v168 offset:36864
 trr v[142:143], v169 offset:36864
 mf v[52:55], a[216:219], v[144:147], v[52:55]
 trr v[144:145], v168 offset:40960
 trr v[146:147], v169 offset:40960
 mf v[52:55], a[220:223], v[148:151], v[52:55]
 trr v[148:149], v168 offset:45056
 trr v[150:151], v169 offset:45056
 mf v[56:59], a[16:19], v[152:155], v[56:59]
 s_lshl_b32 s20, s97, 8
 s_lshl_b32 s3, s16, 18
 sad s89, s20, s3
 mf v[56:59], a[20:23], v[156:159], v[56:59]
 cvp v205, v98, v99
 mf v[56:59], a[24:27], v[160:163], v[56:59]
 s_lshl_b32 s20, s98, 8
 s_lshl_b32 s3, s16, 18
 sad s90, s20, s3
 mf v[56:59], a[28:31], v[164:167], v[56:59]
 mf v[60:63], a[80:83], v[152:155], v[60:63]
 s_lshl_b32 s20, s99, 8
 s_lshl_b32 s3, s16, 18
 sad s91, s20, s3
 mf v[60:63], a[84:87], v[156:159], v[60:63]
 mf v[60:63], a[88:91], v[160:163], v[60:63]
 cvp v206, v100, v101
 mf v[60:63], a[92:95], v[164:167], v[60:63]
 mf v[64:67], a[144:147], v[152:155], v[64:67]
 mf v[64:67], a[148:151], v[156:159], v[64:67]
 mf v[64:67], a[152:155], v[160:163], v[64:67]
 cvp v207, v102, v103
 mf v[64:67], a[156:159], v[164:167], v[64:67]
 swc lgkmcnt(0)
 mf v[68:71], a[208:211], v[152:155], v[68:71]
 trr v[152:153], v170 offset:32768
 trr v[154:155], v171 offset:32768
 mf v[68:71], a[212:215], v[156:159], v[68:71]
 trr v[156:157], v170 offset:36864
 trr v[158:159], v171 offset:36864
 mf v[68:71], a[216:219], v[160:163], v[68:71]
 trr v[160:161], v170 offset:40960
 trr v[162:163], v171 offset:40960
 mf v[68:71], a[220:223], v[164:167], v[68:71]
 trr v[164:165], v170 offset:45056
 trr v[166:167], v171 offset:45056
 mf v[8:11], a[32:35], v[136:139], v[8:11]
 swc vmcnt(32)
 s_barrier
 mf v[8:11], a[36:39], v[140:143], v[8:11]
 sad m0, s36, 16384
 sad s19, s93, 0
 mf v[8:11], a[40:43], v[144:147], v[8:11]
 mf v[8:11], a[44:47], v[148:151], v[8:11]
 bs4 v[204:207], v197, s[12:15], s34 offen offset:1024 sc1
 mf v[12:15], a[96:99], v[136:139], v[12:15]
 bl4 v194, s[56:59], s19 offen lds
 mf v[12:15], a[100:103], v[140:143], v[12:15]
 mf v[12:15], a[104:107], v[144:147], v[12:15]
 mf v[12:15], a[108:111], v[148:151], v[12:15]
 sad m0, s36, 17408
 sad s19, s93, 44032
 mf v[16:19], a[160:163], v[136:139], v[16:19]
 cvp v200, v104, v105
 mf v[16:19], a[164:167], v[140:143], v[16:19]
 mf v[16:19], a[168:171], v[144:147], v[16:19]
 bl4 v194, s[56:59], s19 offen lds
 mf v[16:19], a[172:175], v[148:151], v[16:19]
 swc lgkmcnt(0)
 mf v[20:23], a[224:227], v[136:139], v[20:23]
 trr v[136:137], v172 offset:32768
 trr v[138:139], v173 offset:32768
 mf v[20:23], a[228:231], v[140:143], v[20:23]
 trr v[140:141], v172 offset:36864
 trr v[142:143], v173 offset:36864
 mf v[20:23], a[232:235], v[144:147], v[20:23]
 trr v[144:145], v172 offset:40960
 trr v[146:147], v173 offset:40960
 mf v[20:23], a[236:239], v[148:151], v[20:23]
 trr v[148:149], v172 offset:45056
 trr v[150:151], v173 offset:45056
 mf v[24:27], a[32:35], v[152:155], v[24:27]
 cvp v201, v106, v107
 mf v[24:27], a[36:39], v[156:159], v[24:27]
 mf v[24:27], a[40:43], v[160:163], v[24:27]
 sad m0, s36, 18432
 sad s19, s93, 0
 mf v[24:27], a[44:47], v[164:167], v[24:27]
 mf v[28:31], a[96:99], v[152:155], v[28:31]
 mf v[28:31], a[100:103], v[156:159], v[28:31]
 bl4 v194, s[60:63], s19 offen lds
 cvp v202, v108, v109
 mf v[28:31], a[104:107], v[160:163], v[28:31]
 mf v[28:31], a[108:111], v[164:167], v[28:31]
 mf v[32:35], a[160:163], v[152:155], v[32:35]
 sad m0, s36, 19456
 sad s19, s93, 44032
 mf v[32:35], a[164:167], v[156:159], v[32:35]
 cvp v203, v110, v111
 mf v[32:35], a[168:171], v[160:163], v[32:35]
 mf v[32:35], a[172:175], v[164:167], v[32:35]
 swc lgkmcnt(0)
 mf v[36:39], a[224:227], v[152:155], v[36:39]
 trr v[152:153], v174 offset:32768
 trr v[154:155], v175 offset:32768
 mf v[36:39], a[228:231], v[156:159], v[36:39]
 trr v[156:157], v174 offset:36864
 trr v[158:159], v175 offset:36864
 mf v[36:39], a[232:235], v[160:163], v[36:39]
 trr v[160:161], v174 offset:40960
 trr v[162:163], v175 offset:40960
 mf v[36:39], a[236:239], v[164:167], v[36:39]
 trr v[164:165], v174 offset:45056
 trr v[166:167], v175 offset:45056
 mf v[40:43], a[32:35], v[136:139], v[40:43]
 bl4 v194, s[60:63], s19 offen lds
 mf v[40:43], a[36:39], v[140:143], v[40:43]
 mf v[40:43], a[40:43], v[144:147], v[40:43]
 bs4 v[200:203], v196, s[12:15], s34 offen offset:2048 sc1
 mf v[40:43], a[44:47], v[148:151], v[40:43]
 mf v[44:47], a[96:99], v[136:139], v[44:47]
 mf v[44:47], a[100:103], v[140:143], v[44:47]
 cvp v204, v112, v113
 mf v[44:47], a[104:107], v[144:147], v[44:47]
 mf v[44:47], a[108:111], v[148:151], v[44:47]
 mf v[48:51], a[160:163], v[136:139], v[48:51]
 cvp v205, v114, v115
 mf v[48:51], a[164:167], v[140:143], v[48:51]
 mf v[48:51], a[168:171], v[144:147], v[48:51]
 mf v[48:51], a[172:175], v[148:151], v[48:51]
 swc lgkmcnt(0)
 mf v[52:55], a[224:227], v[136:139], v[52:55]
 trr v[136:137], v168 offset:49152
 trr v[138:139], v169 offset:49152
 mf v[52:55], a[228:231], v[140:143], v[52:55]
 trr v[140:141], v168 offset:53248
 trr v[142:143], v169 offset:53248
 mf v[52:55], a[232:235], v[144:147], v[52:55]
 trr v[144:145], v168 offset:57344
 trr v[146:147], v169 offset:57344
 mf v[52:55], a[236:239], v[148:151], v[52:55]
 trr v[148:149], v168 offset:61440
 trr v[150:151], v169 offset:61440
 mf v[56:59], a[32:35], v[152:155], v[56:59]
 cvp v206, v116, v117
 mf v[56:59], a[36:39], v[156:159], v[56:59]
 mf v[56:59], a[40:43], v[160:163], v[56:59]
 mf v[56:59], a[44:47], v[164:167], v[56:59]
 cvp v207, v118, v119
 mf v[60:63], a[96:99], v[152:155], v[60:63]
 mf v[60:63], a[100:103], v[156:159], v[60:63]
 mf v[60:63], a[104:107], v[160:163], v[60:63]
 mf v[60:63], a[108:111], v[164:167], v[60:63]
 bs4 v[204:207], v197, s[12:15], s34 offen offset:2048 sc1
 mf v[64:67], a[160:163], v[152:155], v[64:67]
 mf v[64:67], a[164:167], v[156:159], v[64:67]
 mf v[64:67], a[168:171], v[160:163], v[64:67]
 cvp v200, v120, v121
 mf v[64:67], a[172:175], v[164:167], v[64:67]
 swc lgkmcnt(0)
 mf v[68:71], a[224:227], v[152:155], v[68:71]
 trr v[152:153], v170 offset:49152
 trr v[154:155], v171 offset:49152
 mf v[68:71], a[228:231], v[156:159], v[68:71]
 trr v[156:157], v170 offset:53248
 trr v[158:159], v171 offset:53248
 mf v[68:71], a[232:235], v[160:163], v[68:71]
 trr v[160:161], v170 offset:57344
 trr v[162:163], v171 offset:57344
 mf v[68:71], a[236:239], v[164:167], v[68:71]
 trr v[164:165], v170 offset:61440
 trr v[166:167], v171 offset:61440
 mf v[8:11], a[48:51], v[136:139], v[8:11]
 swc vmcnt(32)
 s_barrier
 mf v[8:11], a[52:55], v[140:143], v[8:11]
 sad m0, s36, 32768
 sad s19, s94, 0
 mf v[8:11], a[56:59], v[144:147], v[8:11]
 mf v[8:11], a[60:63], v[148:151], v[8:11]
 mf v[12:15], a[112:115], v[136:139], v[12:15]
 bl4 v194, s[56:59], s19 offen lds
 cvp v201, v122, v123
 mf v[12:15], a[116:119], v[140:143], v[12:15]
 mf v[12:15], a[120:123], v[144:147], v[12:15]
 mf v[12:15], a[124:127], v[148:151], v[12:15]
 sad m0, s36, 33792
 sad s19, s94, 44032
 mf v[16:19], a[176:179], v[136:139], v[16:19]
 cvp v202, v124, v125
 mf v[16:19], a[180:183], v[140:143], v[16:19]
 mf v[16:19], a[184:187], v[144:147], v[16:19]
 bl4 v194, s[56:59], s19 offen lds
 mf v[16:19], a[188:191], v[148:151], v[16:19]
 swc lgkmcnt(0)
 mf v[20:23], a[240:243], v[136:139], v[20:23]
 trr v[136:137], v172 offset:49152
 trr v[138:139], v173 offset:49152
 mf v[20:23], a[244:247], v[140:143], v[20:23]
 trr v[140:141], v172 offset:53248
 trr v[142:143], v173 offset:53248
 mf v[20:23], a[248:251], v[144:147], v[20:23]
 trr v[144:145], v172 offset:57344
 trr v[146:147], v173 offset:57344
 mf v[20:23], a[252:255], v[148:151], v[20:23]
 trr v[148:149], v172 offset:61440
 trr v[150:151], v173 offset:61440
 mf v[24:27], a[48:51], v[152:155], v[24:27]
 mf v[24:27], a[52:55], v[156:159], v[24:27]
 cvp v203, v126, v127
 mf v[24:27], a[56:59], v[160:163], v[24:27]
 sad m0, s36, 34816
 sad s19, s94, 0
 mf v[24:27], a[60:63], v[164:167], v[24:27]
 mf v[28:31], a[112:115], v[152:155], v[28:31]
 mf v[28:31], a[116:119], v[156:159], v[28:31]
 bl4 v194, s[60:63], s19 offen lds
 mf v[28:31], a[120:123], v[160:163], v[28:31]
 bs4 v[200:203], v196, s[12:15], s34 offen offset:3072 sc1
 mf v[28:31], a[124:127], v[164:167], v[28:31]
 mf v[32:35], a[176:179], v[152:155], v[32:35]
 sad m0, s36, 35840
 sad s19, s94, 44032
 mf v[32:35], a[180:183], v[156:159], v[32:35]
 mf v[32:35], a[184:187], v[160:163], v[32:35]
 cvp v204, v128, v129
 mf v[32:35], a[188:191], v[164:167], v[32:35]
 swc lgkmcnt(0)
 mf v[36:39], a[240:243], v[152:155], v[36:39]
 trr v[152:153], v174 offset:49152
 trr v[154:155], v175 offset:49152
 mf v[36:39], a[244:247], v[156:159], v[36:39]
 trr v[156:157], v174 offset:53248
 trr v[158:159], v175 offset:53248
 mf v[36:39], a[248:251], v[160:163], v[36:39]
 trr v[160:161], v174 offset:57344
 trr v[162:163], v175 offset:57344
 mf v[36:39], a[252:255], v[164:167], v[36:39]
 trr v[164:165], v174 offset:61440
 trr v[166:167], v175 offset:61440
 mf v[40:43], a[48:51], v[136:139], v[40:43]
 bl4 v194, s[60:63], s19 offen lds
 mf v[40:43], a[52:55], v[140:143], v[40:43]
 mf v[40:43], a[56:59], v[144:147], v[40:43]
 cvp v205, v130, v131
 mf v[40:43], a[60:63], v[148:151], v[40:43]
 buffer_load_dword v254, v253, s[80:83], 0 offen offset:128 sc1
 mf v[44:47], a[112:115], v[136:139], v[44:47]
 mf v[44:47], a[116:119], v[140:143], v[44:47]
 mf v[44:47], a[120:123], v[144:147], v[44:47]
 cvp v206, v132, v133
 mf v[44:47], a[124:127], v[148:151], v[44:47]
 mf v[48:51], a[176:179], v[136:139], v[48:51]
 mf v[48:51], a[180:183], v[140:143], v[48:51]
 cvp v207, v134, v135
 mf v[48:51], a[184:187], v[144:147], v[48:51]
 mf v[48:51], a[188:191], v[148:151], v[48:51]
 swc lgkmcnt(0)
 mf v[52:55], a[240:243], v[136:139], v[52:55]
 trr v[136:137], v176 offset:0
 trr v[138:139], v177 offset:0
 mf v[52:55], a[244:247], v[140:143], v[52:55]
 trr v[140:141], v176 offset:4096
 trr v[142:143], v177 offset:4096
 mf v[52:55], a[248:251], v[144:147], v[52:55]
 trr v[144:145], v176 offset:8192
 trr v[146:147], v177 offset:8192
 mf v[52:55], a[252:255], v[148:151], v[52:55]
 trr v[148:149], v176 offset:12288
 trr v[150:151], v177 offset:12288
 mf v[56:59], a[48:51], v[152:155], v[56:59]
 mf v[56:59], a[52:55], v[156:159], v[56:59]
 bs4 v[204:207], v197, s[12:15], s34 offen offset:3072 sc1
 mf v[56:59], a[56:59], v[160:163], v[56:59]
 mf v[56:59], a[60:63], v[164:167], v[56:59]
 mf v[60:63], a[112:115], v[152:155], v[60:63]
 mf v[60:63], a[116:119], v[156:159], v[60:63]
 mf v[60:63], a[120:123], v[160:163], v[60:63]
 mf v[60:63], a[124:127], v[164:167], v[60:63]
 mf v[64:67], a[176:179], v[152:155], v[64:67]
 mf v[64:67], a[180:183], v[156:159], v[64:67]
 mf v[64:67], a[184:187], v[160:163], v[64:67]
 mf v[64:67], a[188:191], v[164:167], v[64:67]
 swc lgkmcnt(0)
 mf v[68:71], a[240:243], v[152:155], v[68:71]
 trr v[152:153], v178 offset:0
 trr v[154:155], v179 offset:0
 mf v[68:71], a[244:247], v[156:159], v[68:71]
 trr v[156:157], v178 offset:4096
 trr v[158:159], v179 offset:4096
 mf v[68:71], a[248:251], v[160:163], v[68:71]
 trr v[160:161], v178 offset:8192
 trr v[162:163], v179 offset:8192
 mf v[68:71], a[252:255], v[164:167], v[68:71]
 trr v[164:165], v178 offset:12288
 trr v[166:167], v179 offset:12288
 swc vmcnt(1)
 v_cmp_ne_u32 vcc, 16, v254
 s_cbranch_vccnz K1_XSV
K1_XSV_B:
 mf v[72:75], a[0:3], v[136:139], 0
 swc vmcnt(33)
 s_barrier
 mf v[72:75], a[4:7], v[140:143], v[72:75]
 sad m0, s36, 49152
 sad s19, s95, 0
 mf v[72:75], a[8:11], v[144:147], v[72:75]
 mf v[72:75], a[12:15], v[148:151], v[72:75]
 mf v[76:79], a[64:67], v[136:139], 0
 bl4 v194, s[56:59], s19 offen lds
 mf v[76:79], a[68:71], v[140:143], v[76:79]
 mf v[76:79], a[72:75], v[144:147], v[76:79]
 sad s34, s35, 1048576
 mf v[76:79], a[76:79], v[148:151], v[76:79]
 sad m0, s36, 50176
 sad s19, s95, 44032
 mf v[80:83], a[128:131], v[136:139], 0
 mf v[80:83], a[132:135], v[140:143], v[80:83]
 cvp v200, v8, v9
 mf v[80:83], a[136:139], v[144:147], v[80:83]
 bl4 v194, s[56:59], s19 offen lds
 mf v[80:83], a[140:143], v[148:151], v[80:83]
 swc lgkmcnt(0)
 mf v[84:87], a[192:195], v[136:139], 0
 trr v[136:137], v180 offset:0
 trr v[138:139], v181 offset:0
 mf v[84:87], a[196:199], v[140:143], v[84:87]
 trr v[140:141], v180 offset:4096
 trr v[142:143], v181 offset:4096
 mf v[84:87], a[200:203], v[144:147], v[84:87]
 trr v[144:145], v180 offset:8192
 trr v[146:147], v181 offset:8192
 mf v[84:87], a[204:207], v[148:151], v[84:87]
 trr v[148:149], v180 offset:12288
 trr v[150:151], v181 offset:12288
 mf v[88:91], a[0:3], v[152:155], 0
 mf v[88:91], a[4:7], v[156:159], v[88:91]
 cvp v201, v10, v11
 mf v[88:91], a[8:11], v[160:163], v[88:91]
 sad m0, s36, 51200
 sad s19, s95, 0
 mf v[88:91], a[12:15], v[164:167], v[88:91]
 mf v[92:95], a[64:67], v[152:155], 0
 mf v[92:95], a[68:71], v[156:159], v[92:95]
 bl4 v194, s[60:63], s19 offen lds
 mf v[92:95], a[72:75], v[160:163], v[92:95]
 cvp v202, v12, v13
 mf v[92:95], a[76:79], v[164:167], v[92:95]
 mf v[96:99], a[128:131], v[152:155], 0
 sad m0, s36, 52224
 sad s19, s95, 44032
 mf v[96:99], a[132:135], v[156:159], v[96:99]
 cvp v203, v14, v15
 mf v[96:99], a[136:139], v[160:163], v[96:99]
 mf v[96:99], a[140:143], v[164:167], v[96:99]
 swc lgkmcnt(0)
 mf v[100:103], a[192:195], v[152:155], 0
 trr v[152:153], v182 offset:0
 trr v[154:155], v183 offset:0
 mf v[100:103], a[196:199], v[156:159], v[100:103]
 trr v[156:157], v182 offset:4096
 trr v[158:159], v183 offset:4096
 mf v[100:103], a[200:203], v[160:163], v[100:103]
 trr v[160:161], v182 offset:8192
 trr v[162:163], v183 offset:8192
 mf v[100:103], a[204:207], v[164:167], v[100:103]
 trr v[164:165], v182 offset:12288
 trr v[166:167], v183 offset:12288
 mf v[104:107], a[0:3], v[136:139], 0
 bl4 v194, s[60:63], s19 offen lds
 mf v[104:107], a[4:7], v[140:143], v[104:107]
 bs4 v[200:203], v196, s[12:15], s34 offen offset:0 sc1
 mf v[104:107], a[8:11], v[144:147], v[104:107]
 mf v[104:107], a[12:15], v[148:151], v[104:107]
 s_lshr_b32 s20, s17, 1
 sad s20, s20, 32
 s_sub_u32 s20, s20, s17
 s_lshl_b32 s20, s20, 6
 sad s56, s56, s20
 s_addc_u32 s57, s57, 0
 sad s60, s60, s20
 s_addc_u32 s61, s61, 0
 s_sub_u32 s58, s58, s20
 s_cmp_lt_u32 s17, 22
 s_cselect_b32 s58, s58, 0
 s_mov_b32 s62, s58
 mf v[108:111], a[64:67], v[136:139], 0
 mf v[108:111], a[68:71], v[140:143], v[108:111]
 cvp v204, v16, v17
 mf v[108:111], a[72:75], v[144:147], v[108:111]
 buffer_load_dword v212, v253, s[12:15], s46 offen offset:0 sc1
 mf v[108:111], a[76:79], v[148:151], v[108:111]
 mf v[112:115], a[128:131], v[136:139], 0
 mf v[112:115], a[132:135], v[140:143], v[112:115]
 buffer_load_dword v213, v6, s[12:15], s46 offen offset:0 sc1
 cvp v205, v18, v19
 mf v[112:115], a[136:139], v[144:147], v[112:115]
 mf v[112:115], a[140:143], v[148:151], v[112:115]
 swc lgkmcnt(0)
 mf v[116:119], a[192:195], v[136:139], 0
 trr v[136:137], v176 offset:16384
 trr v[138:139], v177 offset:16384
 mf v[116:119], a[196:199], v[140:143], v[116:119]
 trr v[140:141], v176 offset:20480
 trr v[142:143], v177 offset:20480
 mf v[116:119], a[200:203], v[144:147], v[116:119]
 trr v[144:145], v176 offset:24576
 trr v[146:147], v177 offset:24576
 mf v[116:119], a[204:207], v[148:151], v[116:119]
 trr v[148:149], v176 offset:28672
 trr v[150:151], v177 offset:28672
 mf v[120:123], a[0:3], v[152:155], 0
 cvp v206, v20, v21
 mf v[120:123], a[4:7], v[156:159], v[120:123]
 buffer_load_dword v214, v253, s[12:15], s47 offen offset:0 sc1
 mf v[120:123], a[8:11], v[160:163], v[120:123]
 mf v[120:123], a[12:15], v[164:167], v[120:123]
 mf v[124:127], a[64:67], v[152:155], 0
 buffer_load_dword v215, v6, s[12:15], s47 offen offset:0 sc1
 cvp v207, v22, v23
 mf v[124:127], a[68:71], v[156:159], v[124:127]
 mf v[124:127], a[72:75], v[160:163], v[124:127]
 mf v[124:127], a[76:79], v[164:167], v[124:127]
 bs4 v[204:207], v197, s[12:15], s34 offen offset:0 sc1
 mf v[128:131], a[128:131], v[152:155], 0
 mf v[128:131], a[132:135], v[156:159], v[128:131]
 mf v[128:131], a[136:139], v[160:163], v[128:131]
 cvp v200, v24, v25
 mf v[128:131], a[140:143], v[164:167], v[128:131]
 swc lgkmcnt(0)
 mf v[132:135], a[192:195], v[152:155], 0
 trr v[152:153], v178 offset:16384
 trr v[154:155], v179 offset:16384
 mf v[132:135], a[196:199], v[156:159], v[132:135]
 trr v[156:157], v178 offset:20480
 trr v[158:159], v179 offset:20480
 mf v[132:135], a[200:203], v[160:163], v[132:135]
 trr v[160:161], v178 offset:24576
 trr v[162:163], v179 offset:24576
 mf v[132:135], a[204:207], v[164:167], v[132:135]
 trr v[164:165], v178 offset:28672
 trr v[166:167], v179 offset:28672
 mf v[72:75], a[16:19], v[136:139], v[72:75]
 swc vmcnt(37)
 s_barrier
 mf v[72:75], a[20:23], v[140:143], v[72:75]
 sad m0, s36, 65536
 sad s19, s92, 0
 mf v[72:75], a[24:27], v[144:147], v[72:75]
 bl4 v194, s[56:59], s19 offen lds
 mf v[72:75], a[28:31], v[148:151], v[72:75]
 sad m0, s36, 66560
 sad s19, s92, 44032
 mf v[76:79], a[80:83], v[136:139], v[76:79]
 bl4 v194, s[56:59], s19 offen lds
 mf v[76:79], a[84:87], v[140:143], v[76:79]
 sad m0, s36, 67584
 sad s19, s92, 0
 mf v[76:79], a[88:91], v[144:147], v[76:79]
 bl4 v194, s[60:63], s19 offen lds
 mf v[76:79], a[92:95], v[148:151], v[76:79]
 sad m0, s36, 68608
 sad s19, s92, 44032
 mf v[80:83], a[144:147], v[136:139], v[80:83]
 bl4 v194, s[60:63], s19 offen lds
 cvp v201, v26, v27
 mf v[80:83], a[148:151], v[140:143], v[80:83]
 sad s4, s100, s96
 sad s5, s101, s96
 bl4 a[0:3], v195, s[12:15], s4 offen offset:0 sc1
 mf v[80:83], a[152:155], v[144:147], v[80:83]
 bl4 a[4:7], v195, s[12:15], s4 offen offset:1024 sc1
 mf v[80:83], a[156:159], v[148:151], v[80:83]
 swc lgkmcnt(0)
 mf v[84:87], a[208:211], v[136:139], v[84:87]
 trr v[136:137], v180 offset:16384
 trr v[138:139], v181 offset:16384
 mf v[84:87], a[212:215], v[140:143], v[84:87]
 trr v[140:141], v180 offset:20480
 trr v[142:143], v181 offset:20480
 mf v[84:87], a[216:219], v[144:147], v[84:87]
 trr v[144:145], v180 offset:24576
 trr v[146:147], v181 offset:24576
 mf v[84:87], a[220:223], v[148:151], v[84:87]
 trr v[148:149], v180 offset:28672
 trr v[150:151], v181 offset:28672
 mf v[88:91], a[16:19], v[152:155], v[88:91]
 bl4 a[8:11], v195, s[12:15], s4 offen offset:2048 sc1
 mf v[88:91], a[20:23], v[156:159], v[88:91]
 bl4 a[12:15], v195, s[12:15], s4 offen offset:3072 sc1
 mf v[88:91], a[24:27], v[160:163], v[88:91]
 bl4 a[64:67], v255, s[12:15], s4 offen offset:0 sc1
 mf v[88:91], a[28:31], v[164:167], v[88:91]
 bl4 a[68:71], v255, s[12:15], s4 offen offset:1024 sc1
 cvp v202, v28, v29
 mf v[92:95], a[80:83], v[152:155], v[92:95]
 bl4 a[72:75], v255, s[12:15], s4 offen offset:2048 sc1
 mf v[92:95], a[84:87], v[156:159], v[92:95]
 bl4 a[76:79], v255, s[12:15], s4 offen offset:3072 sc1
 mf v[92:95], a[88:91], v[160:163], v[92:95]
 bl4 a[128:131], v195, s[12:15], s5 offen offset:0 sc1
 mf v[92:95], a[92:95], v[164:167], v[92:95]
 bl4 a[132:135], v195, s[12:15], s5 offen offset:1024 sc1
 mf v[96:99], a[144:147], v[152:155], v[96:99]
 bl4 a[136:139], v195, s[12:15], s5 offen offset:2048 sc1
 mf v[96:99], a[148:151], v[156:159], v[96:99]
 bl4 a[140:143], v195, s[12:15], s5 offen offset:3072 sc1
 cvp v203, v30, v31
 mf v[96:99], a[152:155], v[160:163], v[96:99]
 bl4 a[192:195], v255, s[12:15], s5 offen offset:0 sc1
 mf v[96:99], a[156:159], v[164:167], v[96:99]
 swc lgkmcnt(0)
 mf v[100:103], a[208:211], v[152:155], v[100:103]
 trr v[152:153], v182 offset:16384
 trr v[154:155], v183 offset:16384
 mf v[100:103], a[212:215], v[156:159], v[100:103]
 trr v[156:157], v182 offset:20480
 trr v[158:159], v183 offset:20480
 mf v[100:103], a[216:219], v[160:163], v[100:103]
 trr v[160:161], v182 offset:24576
 trr v[162:163], v183 offset:24576
 mf v[100:103], a[220:223], v[164:167], v[100:103]
 trr v[164:165], v182 offset:28672
 trr v[166:167], v183 offset:28672
 mf v[104:107], a[16:19], v[136:139], v[104:107]
 bl4 a[196:199], v255, s[12:15], s5 offen offset:1024 sc1
 mf v[104:107], a[20:23], v[140:143], v[104:107]
 bl4 a[200:203], v255, s[12:15], s5 offen offset:2048 sc1
 mf v[104:107], a[24:27], v[144:147], v[104:107]
 bl4 a[204:207], v255, s[12:15], s5 offen offset:3072 sc1
 mf v[104:107], a[28:31], v[148:151], v[104:107]
 bs4 v[200:203], v196, s[12:15], s34 offen offset:1024 sc1
 mf v[108:111], a[80:83], v[136:139], v[108:111]
 mf v[108:111], a[84:87], v[140:143], v[108:111]
 cvp v204, v32, v33
 mf v[108:111], a[88:91], v[144:147], v[108:111]
 mf v[108:111], a[92:95], v[148:151], v[108:111]
 mf v[112:115], a[144:147], v[136:139], v[112:115]
 cvp v205, v34, v35
 mf v[112:115], a[148:151], v[140:143], v[112:115]
 mf v[112:115], a[152:155], v[144:147], v[112:115]
 mf v[112:115], a[156:159], v[148:151], v[112:115]
 swc lgkmcnt(0)
 mf v[116:119], a[208:211], v[136:139], v[116:119]
 trr v[136:137], v176 offset:32768
 trr v[138:139], v177 offset:32768
 mf v[116:119], a[212:215], v[140:143], v[116:119]
 trr v[140:141], v176 offset:36864
 trr v[142:143], v177 offset:36864
 mf v[116:119], a[216:219], v[144:147], v[116:119]
 trr v[144:145], v176 offset:40960
 trr v[146:147], v177 offset:40960
 mf v[116:119], a[220:223], v[148:151], v[116:119]
 trr v[148:149], v176 offset:45056
 trr v[150:151], v177 offset:45056
 mf v[120:123], a[16:19], v[152:155], v[120:123]
 cvp v206, v36, v37
 mf v[120:123], a[20:23], v[156:159], v[120:123]
 mf v[120:123], a[24:27], v[160:163], v[120:123]
 mf v[120:123], a[28:31], v[164:167], v[120:123]
 cvp v207, v38, v39
 mf v[124:127], a[80:83], v[152:155], v[124:127]
 mf v[124:127], a[84:87], v[156:159], v[124:127]
 bs4 v[204:207], v197, s[12:15], s34 offen offset:1024 sc1
 mf v[124:127], a[88:91], v[160:163], v[124:127]
 mf v[124:127], a[92:95], v[164:167], v[124:127]
 mf v[128:131], a[144:147], v[152:155], v[128:131]
 cvp v200, v40, v41
 mf v[128:131], a[148:151], v[156:159], v[128:131]
 mf v[128:131], a[152:155], v[160:163], v[128:131]
 mf v[128:131], a[156:159], v[164:167], v[128:131]
 swc lgkmcnt(0)
 mf v[132:135], a[208:211], v[152:155], v[132:135]
 trr v[152:153], v178 offset:32768
 trr v[154:155], v179 offset:32768
 mf v[132:135], a[212:215], v[156:159], v[132:135]
 trr v[156:157], v178 offset:36864
 trr v[158:159], v179 offset:36864
 mf v[132:135], a[216:219], v[160:163], v[132:135]
 trr v[160:161], v178 offset:40960
 trr v[162:163], v179 offset:40960
 mf v[132:135], a[220:223], v[164:167], v[132:135]
 trr v[164:165], v178 offset:45056
 trr v[166:167], v179 offset:45056
 mf v[72:75], a[32:35], v[136:139], v[72:75]
 swc vmcnt(53)
 s_barrier
 mf v[72:75], a[36:39], v[140:143], v[72:75]
 sad m0, s36, 81920
 sad s19, s93, 0
 mf v[72:75], a[40:43], v[144:147], v[72:75]
 bl4 v194, s[56:59], s19 offen lds
 cvp v201, v42, v43
 mf v[72:75], a[44:47], v[148:151], v[72:75]
 sad m0, s36, 82944
 sad s19, s93, 44032
 mf v[76:79], a[96:99], v[136:139], v[76:79]
 bl4 v194, s[56:59], s19 offen lds
 mf v[76:79], a[100:103], v[140:143], v[76:79]
 sad m0, s36, 83968
 sad s19, s93, 0
 mf v[76:79], a[104:107], v[144:147], v[76:79]
 bl4 v194, s[60:63], s19 offen lds
 mf v[76:79], a[108:111], v[148:151], v[76:79]
 sad m0, s36, 84992
 sad s19, s93, 44032
 mf v[80:83], a[160:163], v[136:139], v[80:83]
 bl4 v194, s[60:63], s19 offen lds
 mf v[80:83], a[164:167], v[140:143], v[80:83]
 sad s6, s100, s97
 sad s7, s101, s97
 bl4 a[16:19], v195, s[12:15], s6 offen offset:0 sc1
 mf v[80:83], a[168:171], v[144:147], v[80:83]
 bl4 a[20:23], v195, s[12:15], s6 offen offset:1024 sc1
 mf v[80:83], a[172:175], v[148:151], v[80:83]
 swc lgkmcnt(0)
 mf v[84:87], a[224:227], v[136:139], v[84:87]
 trr v[136:137], v180 offset:32768
 trr v[138:139], v181 offset:32768
 mf v[84:87], a[228:231], v[140:143], v[84:87]
 trr v[140:141], v180 offset:36864
 trr v[142:143], v181 offset:36864
 mf v[84:87], a[232:235], v[144:147], v[84:87]
 trr v[144:145], v180 offset:40960
 trr v[146:147], v181 offset:40960
 mf v[84:87], a[236:239], v[148:151], v[84:87]
 trr v[148:149], v180 offset:45056
 trr v[150:151], v181 offset:45056
 mf v[88:91], a[32:35], v[152:155], v[88:91]
 bl4 a[24:27], v195, s[12:15], s6 offen offset:2048 sc1
 cvp v202, v44, v45
 mf v[88:91], a[36:39], v[156:159], v[88:91]
 bl4 a[28:31], v195, s[12:15], s6 offen offset:3072 sc1
 mf v[88:91], a[40:43], v[160:163], v[88:91]
 bl4 a[80:83], v255, s[12:15], s6 offen offset:0 sc1
 mf v[88:91], a[44:47], v[164:167], v[88:91]
 bl4 a[84:87], v255, s[12:15], s6 offen offset:1024 sc1
 mf v[92:95], a[96:99], v[152:155], v[92:95]
 bl4 a[88:91], v255, s[12:15], s6 offen offset:2048 sc1
 mf v[92:95], a[100:103], v[156:159], v[92:95]
 bl4 a[92:95], v255, s[12:15], s6 offen offset:3072 sc1
 cvp v203, v46, v47
 mf v[92:95], a[104:107], v[160:163], v[92:95]
 bl4 a[144:147], v195, s[12:15], s7 offen offset:0 sc1
 mf v[92:95], a[108:111], v[164:167], v[92:95]
 bl4 a[148:151], v195, s[12:15], s7 offen offset:1024 sc1
 mf v[96:99], a[160:163], v[152:155], v[96:99]
 bl4 a[152:155], v195, s[12:15], s7 offen offset:2048 sc1
 mf v[96:99], a[164:167], v[156:159], v[96:99]
 bl4 a[156:159], v195, s[12:15], s7 offen offset:3072 sc1
 mf v[96:99], a[168:171], v[160:163], v[96:99]
 bl4 a[208:211], v255, s[12:15], s7 offen offset:0 sc1
 mf v[96:99], a[172:175], v[164:167], v[96:99]
 swc lgkmcnt(0)
 mf v[100:103], a[224:227], v[152:155], v[100:103]
 trr v[152:153], v182 offset:32768
 trr v[154:155], v183 offset:32768
 mf v[100:103], a[228:231], v[156:159], v[100:103]
 trr v[156:157], v182 offset:36864
 trr v[158:159], v183 offset:36864
 mf v[100:103], a[232:235], v[160:163], v[100:103]
 trr v[160:161], v182 offset:40960
 trr v[162:163], v183 offset:40960
 mf v[100:103], a[236:239], v[164:167], v[100:103]
 trr v[164:165], v182 offset:45056
 trr v[166:167], v183 offset:45056
 mf v[104:107], a[32:35], v[136:139], v[104:107]
 bl4 a[212:215], v255, s[12:15], s7 offen offset:1024 sc1
 mf v[104:107], a[36:39], v[140:143], v[104:107]
 bl4 a[216:219], v255, s[12:15], s7 offen offset:2048 sc1
 mf v[104:107], a[40:43], v[144:147], v[104:107]
 bl4 a[220:223], v255, s[12:15], s7 offen offset:3072 sc1
 mf v[104:107], a[44:47], v[148:151], v[104:107]
 bs4 v[200:203], v196, s[12:15], s34 offen offset:2048 sc1
 mf v[108:111], a[96:99], v[136:139], v[108:111]
 mf v[108:111], a[100:103], v[140:143], v[108:111]
 cvp v204, v48, v49
 mf v[108:111], a[104:107], v[144:147], v[108:111]
 mf v[108:111], a[108:111], v[148:151], v[108:111]
 mf v[112:115], a[160:163], v[136:139], v[112:115]
 cvp v205, v50, v51
 mf v[112:115], a[164:167], v[140:143], v[112:115]
 mf v[112:115], a[168:171], v[144:147], v[112:115]
 mf v[112:115], a[172:175], v[148:151], v[112:115]
 swc lgkmcnt(0)
 mf v[116:119], a[224:227], v[136:139], v[116:119]
 trr v[136:137], v176 offset:49152
 trr v[138:139], v177 offset:49152
 mf v[116:119], a[228:231], v[140:143], v[116:119]
 trr v[140:141], v176 offset:53248
 trr v[142:143], v177 offset:53248
 mf v[116:119], a[232:235], v[144:147], v[116:119]
 trr v[144:145], v176 offset:57344
 trr v[146:147], v177 offset:57344
 mf v[116:119], a[236:239], v[148:151], v[116:119]
 trr v[148:149], v176 offset:61440
 trr v[150:151], v177 offset:61440
 mf v[120:123], a[32:35], v[152:155], v[120:123]
 cvp v206, v52, v53
 mf v[120:123], a[36:39], v[156:159], v[120:123]
 mf v[120:123], a[40:43], v[160:163], v[120:123]
 cvp v207, v54, v55
 mf v[120:123], a[44:47], v[164:167], v[120:123]
 mf v[124:127], a[96:99], v[152:155], v[124:127]
 mf v[124:127], a[100:103], v[156:159], v[124:127]
 bs4 v[204:207], v197, s[12:15], s34 offen offset:2048 sc1
 mf v[124:127], a[104:107], v[160:163], v[124:127]
 mf v[124:127], a[108:111], v[164:167], v[124:127]
 mf v[128:131], a[160:163], v[152:155], v[128:131]
 cvp v200, v56, v57
 mf v[128:131], a[164:167], v[156:159], v[128:131]
 mf v[128:131], a[168:171], v[160:163], v[128:131]
 mf v[128:131], a[172:175], v[164:167], v[128:131]
 swc lgkmcnt(0)
 mf v[132:135], a[224:227], v[152:155], v[132:135]
 trr v[152:153], v178 offset:49152
 trr v[154:155], v179 offset:49152
 mf v[132:135], a[228:231], v[156:159], v[132:135]
 trr v[156:157], v178 offset:53248
 trr v[158:159], v179 offset:53248
 mf v[132:135], a[232:235], v[160:163], v[132:135]
 trr v[160:161], v178 offset:57344
 trr v[162:163], v179 offset:57344
 mf v[132:135], a[236:239], v[164:167], v[132:135]
 trr v[164:165], v178 offset:61440
 trr v[166:167], v179 offset:61440
 mf v[72:75], a[48:51], v[136:139], v[72:75]
 swc vmcnt(63)
 s_barrier
 mf v[72:75], a[52:55], v[140:143], v[72:75]
 sad m0, s36, 98304
 sad s19, s94, 0
 mf v[72:75], a[56:59], v[144:147], v[72:75]
 bl4 v194, s[56:59], s19 offen lds
 cvp v201, v58, v59
 mf v[72:75], a[60:63], v[148:151], v[72:75]
 sad m0, s36, 99328
 sad s19, s94, 44032
 mf v[76:79], a[112:115], v[136:139], v[76:79]
 bl4 v194, s[56:59], s19 offen lds
 mf v[76:79], a[116:119], v[140:143], v[76:79]
 sad m0, s36, 100352
 sad s19, s94, 0
 mf v[76:79], a[120:123], v[144:147], v[76:79]
 bl4 v194, s[60:63], s19 offen lds
 mf v[76:79], a[124:127], v[148:151], v[76:79]
 sad m0, s36, 101376
 sad s19, s94, 44032
 mf v[80:83], a[176:179], v[136:139], v[80:83]
 bl4 v194, s[60:63], s19 offen lds
 mf v[80:83], a[180:183], v[140:143], v[80:83]
 sad s4, s100, s98
 sad s5, s101, s98
 bl4 a[32:35], v195, s[12:15], s4 offen offset:0 sc1
 mf v[80:83], a[184:187], v[144:147], v[80:83]
 bl4 a[36:39], v195, s[12:15], s4 offen offset:1024 sc1
 mf v[80:83], a[188:191], v[148:151], v[80:83]
 swc lgkmcnt(0)
 cvp v202, v60, v61
 mf v[84:87], a[240:243], v[136:139], v[84:87]
 trr v[136:137], v180 offset:49152
 trr v[138:139], v181 offset:49152
 mf v[84:87], a[244:247], v[140:143], v[84:87]
 trr v[140:141], v180 offset:53248
 trr v[142:143], v181 offset:53248
 mf v[84:87], a[248:251], v[144:147], v[84:87]
 trr v[144:145], v180 offset:57344
 trr v[146:147], v181 offset:57344
 mf v[84:87], a[252:255], v[148:151], v[84:87]
 trr v[148:149], v180 offset:61440
 trr v[150:151], v181 offset:61440
 mf v[88:91], a[48:51], v[152:155], v[88:91]
 bl4 a[40:43], v195, s[12:15], s4 offen offset:2048 sc1
 mf v[88:91], a[52:55], v[156:159], v[88:91]
 bl4 a[44:47], v195, s[12:15], s4 offen offset:3072 sc1
 mf v[88:91], a[56:59], v[160:163], v[88:91]
 bl4 a[96:99], v255, s[12:15], s4 offen offset:0 sc1
 mf v[88:91], a[60:63], v[164:167], v[88:91]
 bl4 a[100:103], v255, s[12:15], s4 offen offset:1024 sc1
 mf v[92:95], a[112:115], v[152:155], v[92:95]
 bl4 a[104:107], v255, s[12:15], s4 offen offset:2048 sc1
 mf v[92:95], a[116:119], v[156:159], v[92:95]
 bl4 a[108:111], v255, s[12:15], s4 offen offset:3072 sc1
 cvp v203, v62, v63
 mf v[92:95], a[120:123], v[160:163], v[92:95]
 bl4 a[160:163], v195, s[12:15], s5 offen offset:0 sc1
 mf v[92:95], a[124:127], v[164:167], v[92:95]
 bl4 a[164:167], v195, s[12:15], s5 offen offset:1024 sc1
 mf v[96:99], a[176:179], v[152:155], v[96:99]
 bl4 a[168:171], v195, s[12:15], s5 offen offset:2048 sc1
 mf v[96:99], a[180:183], v[156:159], v[96:99]
 bl4 a[172:175], v195, s[12:15], s5 offen offset:3072 sc1
 mf v[96:99], a[184:187], v[160:163], v[96:99]
 bl4 a[224:227], v255, s[12:15], s5 offen offset:0 sc1
 mf v[96:99], a[188:191], v[164:167], v[96:99]
 swc lgkmcnt(0)
 mf v[100:103], a[240:243], v[152:155], v[100:103]
 trr v[152:153], v182 offset:49152
 trr v[154:155], v183 offset:49152
 mf v[100:103], a[244:247], v[156:159], v[100:103]
 trr v[156:157], v182 offset:53248
 trr v[158:159], v183 offset:53248
 mf v[100:103], a[248:251], v[160:163], v[100:103]
 trr v[160:161], v182 offset:57344
 trr v[162:163], v183 offset:57344
 mf v[100:103], a[252:255], v[164:167], v[100:103]
 trr v[164:165], v182 offset:61440
 trr v[166:167], v183 offset:61440
 mf v[104:107], a[48:51], v[136:139], v[104:107]
 bl4 a[228:231], v255, s[12:15], s5 offen offset:1024 sc1
 mf v[104:107], a[52:55], v[140:143], v[104:107]
 bl4 a[232:235], v255, s[12:15], s5 offen offset:2048 sc1
 mf v[104:107], a[56:59], v[144:147], v[104:107]
 bl4 a[236:239], v255, s[12:15], s5 offen offset:3072 sc1
 mf v[104:107], a[60:63], v[148:151], v[104:107]
 bs4 v[200:203], v196, s[12:15], s34 offen offset:3072 sc1
 mf v[108:111], a[112:115], v[136:139], v[108:111]
 mf v[108:111], a[116:119], v[140:143], v[108:111]
 cvp v204, v64, v65
 mf v[108:111], a[120:123], v[144:147], v[108:111]
 mf v[108:111], a[124:127], v[148:151], v[108:111]
 mf v[112:115], a[176:179], v[136:139], v[112:115]
 cvp v205, v66, v67
 mf v[112:115], a[180:183], v[140:143], v[112:115]
 mf v[112:115], a[184:187], v[144:147], v[112:115]
 mf v[112:115], a[188:191], v[148:151], v[112:115]
 swc lgkmcnt(0)
 mf v[116:119], a[240:243], v[136:139], v[116:119]
 trr v[136:137], v184 offset:0
 trr v[138:139], v185 offset:0
 mf v[116:119], a[244:247], v[140:143], v[116:119]
 trr v[140:141], v184 offset:4096
 trr v[142:143], v185 offset:4096
 mf v[116:119], a[248:251], v[144:147], v[116:119]
 trr v[144:145], v184 offset:8192
 trr v[146:147], v185 offset:8192
 mf v[116:119], a[252:255], v[148:151], v[116:119]
 trr v[148:149], v184 offset:12288
 trr v[150:151], v185 offset:12288
 mf v[120:123], a[48:51], v[152:155], v[120:123]
 cvp v206, v68, v69
 mf v[120:123], a[52:55], v[156:159], v[120:123]
 mf v[120:123], a[56:59], v[160:163], v[120:123]
 cvp v207, v70, v71
 mf v[120:123], a[60:63], v[164:167], v[120:123]
 mf v[124:127], a[112:115], v[152:155], v[124:127]
 mf v[124:127], a[116:119], v[156:159], v[124:127]
 bs4 v[204:207], v197, s[12:15], s34 offen offset:3072 sc1
 mf v[124:127], a[120:123], v[160:163], v[124:127]
 mf v[124:127], a[124:127], v[164:167], v[124:127]
 mf v[128:131], a[176:179], v[152:155], v[128:131]
 mf v[128:131], a[180:183], v[156:159], v[128:131]
 mf v[128:131], a[184:187], v[160:163], v[128:131]
 mf v[128:131], a[188:191], v[164:167], v[128:131]
 swc lgkmcnt(0)
 mf v[132:135], a[240:243], v[152:155], v[132:135]
 trr v[152:153], v186 offset:0
 trr v[154:155], v187 offset:0
 mf v[132:135], a[244:247], v[156:159], v[132:135]
 trr v[156:157], v186 offset:4096
 trr v[158:159], v187 offset:4096
 mf v[132:135], a[248:251], v[160:163], v[132:135]
 trr v[160:161], v186 offset:8192
 trr v[162:163], v187 offset:8192
 mf v[132:135], a[252:255], v[164:167], v[132:135]
 trr v[164:165], v186 offset:12288
 trr v[166:167], v187 offset:12288
 swc vmcnt(46)
 mf v[8:11], v[136:139], a[0:3], 0
 swc vmcnt(63)
 s_barrier
 mf v[8:11], v[140:143], a[4:7], v[8:11]
 sad m0, s36, 114688
 sad s19, s95, 0
 mf v[8:11], v[144:147], a[8:11], v[8:11]
 bl4 v194, s[56:59], s19 offen lds
 mf v[8:11], v[148:151], a[12:15], v[8:11]
 sad m0, s36, 115712
 sad s19, s95, 44032
 mf v[12:15], v[136:139], a[64:67], 0
 bl4 v194, s[56:59], s19 offen lds
 mf v[12:15], v[140:143], a[68:71], v[12:15]
 sad m0, s36, 116736
 sad s19, s95, 0
 mf v[12:15], v[144:147], a[72:75], v[12:15]
 bl4 v194, s[60:63], s19 offen lds
 sad s34, s35, 1052672
 mf v[12:15], v[148:151], a[76:79], v[12:15]
 sad m0, s36, 117760
 sad s19, s95, 44032
 mf v[16:19], v[136:139], a[128:131], 0
 bl4 v194, s[60:63], s19 offen lds
 mf v[16:19], v[140:143], a[132:135], v[16:19]
 sad s6, s100, s99
 sad s7, s101, s99
 bl4 a[48:51], v195, s[12:15], s6 offen offset:0 sc1
 mf v[16:19], v[144:147], a[136:139], v[16:19]
 bl4 a[52:55], v195, s[12:15], s6 offen offset:1024 sc1
 mf v[16:19], v[148:151], a[140:143], v[16:19]
 swc lgkmcnt(0)
 mf v[20:23], v[136:139], a[192:195], 0
 trr v[136:137], v188 offset:0
 trr v[138:139], v189 offset:0
 mf v[20:23], v[140:143], a[196:199], v[20:23]
 trr v[140:141], v188 offset:4096
 trr v[142:143], v189 offset:4096
 mf v[20:23], v[144:147], a[200:203], v[20:23]
 trr v[144:145], v188 offset:8192
 trr v[146:147], v189 offset:8192
 mf v[20:23], v[148:151], a[204:207], v[20:23]
 trr v[148:149], v188 offset:12288
 trr v[150:151], v189 offset:12288
 mf v[24:27], v[152:155], a[0:3], 0
 bl4 a[56:59], v195, s[12:15], s6 offen offset:2048 sc1
 mf v[24:27], v[156:159], a[4:7], v[24:27]
 bl4 a[60:63], v195, s[12:15], s6 offen offset:3072 sc1
 cvp v200, v72, v73
 mf v[24:27], v[160:163], a[8:11], v[24:27]
 bl4 a[112:115], v255, s[12:15], s6 offen offset:0 sc1
 mf v[24:27], v[164:167], a[12:15], v[24:27]
 bl4 a[116:119], v255, s[12:15], s6 offen offset:1024 sc1
 mf v[28:31], v[152:155], a[64:67], 0
 bl4 a[120:123], v255, s[12:15], s6 offen offset:2048 sc1
 mf v[28:31], v[156:159], a[68:71], v[28:31]
 bl4 a[124:127], v255, s[12:15], s6 offen offset:3072 sc1
 mf v[28:31], v[160:163], a[72:75], v[28:31]
 bl4 a[176:179], v195, s[12:15], s7 offen offset:0 sc1
 cvp v201, v74, v75
 mf v[28:31], v[164:167], a[76:79], v[28:31]
 bl4 a[180:183], v195, s[12:15], s7 offen offset:1024 sc1
 mf v[32:35], v[152:155], a[128:131], 0
 bl4 a[184:187], v195, s[12:15], s7 offen offset:2048 sc1
 mf v[32:35], v[156:159], a[132:135], v[32:35]
 bl4 a[188:191], v195, s[12:15], s7 offen offset:3072 sc1
 mf v[32:35], v[160:163], a[136:139], v[32:35]
 bl4 a[240:243], v255, s[12:15], s7 offen offset:0 sc1
 mf v[32:35], v[164:167], a[140:143], v[32:35]
 swc lgkmcnt(0)
 cvp v202, v76, v77
 mf v[36:39], v[152:155], a[192:195], 0
 trr v[152:153], v190 offset:0
 trr v[154:155], v191 offset:0
 mf v[36:39], v[156:159], a[196:199], v[36:39]
 trr v[156:157], v190 offset:4096
 trr v[158:159], v191 offset:4096
 mf v[36:39], v[160:163], a[200:203], v[36:39]
 trr v[160:161], v190 offset:8192
 trr v[162:163], v191 offset:8192
 mf v[36:39], v[164:167], a[204:207], v[36:39]
 trr v[164:165], v190 offset:12288
 trr v[166:167], v191 offset:12288
 mf v[40:43], v[136:139], a[0:3], 0
 bl4 a[244:247], v255, s[12:15], s7 offen offset:1024 sc1
 mf v[40:43], v[140:143], a[4:7], v[40:43]
 bl4 a[248:251], v255, s[12:15], s7 offen offset:2048 sc1
 mf v[40:43], v[144:147], a[8:11], v[40:43]
 bl4 a[252:255], v255, s[12:15], s7 offen offset:3072 sc1
 mf v[40:43], v[148:151], a[12:15], v[40:43]
 mf v[44:47], v[136:139], a[64:67], 0
 cvp v203, v78, v79
 mf v[44:47], v[140:143], a[68:71], v[44:47]
 mf v[44:47], v[144:147], a[72:75], v[44:47]
 bs4 v[200:203], v196, s[12:15], s34 offen offset:0 sc1
 mf v[44:47], v[148:151], a[76:79], v[44:47]
 mf v[48:51], v[136:139], a[128:131], 0
 mf v[48:51], v[140:143], a[132:135], v[48:51]
 cvp v204, v80, v81
 mf v[48:51], v[144:147], a[136:139], v[48:51]
 mf v[48:51], v[148:151], a[140:143], v[48:51]
 swc lgkmcnt(0)
 mf v[52:55], v[136:139], a[192:195], 0
 trr v[136:137], v184 offset:16384
 trr v[138:139], v185 offset:16384
 mf v[52:55], v[140:143], a[196:199], v[52:55]
 trr v[140:141], v184 offset:20480
 trr v[142:143], v185 offset:20480
 mf v[52:55], v[144:147], a[200:203], v[52:55]
 trr v[144:145], v184 offset:24576
 trr v[146:147], v185 offset:24576
 mf v[52:55], v[148:151], a[204:207], v[52:55]
 trr v[148:149], v184 offset:28672
 trr v[150:151], v185 offset:28672
 mf v[56:59], v[152:155], a[0:3], 0
 cvp v205, v82, v83
 mf v[56:59], v[156:159], a[4:7], v[56:59]
 mf v[56:59], v[160:163], a[8:11], v[56:59]
 mf v[56:59], v[164:167], a[12:15], v[56:59]
 cvp v206, v84, v85
 mf v[60:63], v[152:155], a[64:67], 0
 mf v[60:63], v[156:159], a[68:71], v[60:63]
 cvp v207, v86, v87
 mf v[60:63], v[160:163], a[72:75], v[60:63]
 mf v[60:63], v[164:167], a[76:79], v[60:63]
 mf v[64:67], v[152:155], a[128:131], 0
 bs4 v[204:207], v197, s[12:15], s34 offen offset:0 sc1
 mf v[64:67], v[156:159], a[132:135], v[64:67]
 mf v[64:67], v[160:163], a[136:139], v[64:67]
 mf v[64:67], v[164:167], a[140:143], v[64:67]
 swc lgkmcnt(0)
 cvp v200, v88, v89
 mf v[68:71], v[152:155], a[192:195], 0
 trr v[152:153], v186 offset:16384
 trr v[154:155], v187 offset:16384
 mf v[68:71], v[156:159], a[196:199], v[68:71]
 trr v[156:157], v186 offset:20480
 trr v[158:159], v187 offset:20480
 mf v[68:71], v[160:163], a[200:203], v[68:71]
 trr v[160:161], v186 offset:24576
 trr v[162:163], v187 offset:24576
 mf v[68:71], v[164:167], a[204:207], v[68:71]
 trr v[164:165], v186 offset:28672
 trr v[166:167], v187 offset:28672
 swc vmcnt(46)
 mf v[8:11], v[136:139], a[16:19], v[8:11]
 swc vmcnt(63)
 s_barrier
 mf v[8:11], v[140:143], a[20:23], v[8:11]
 sad m0, s36, 0
 sad s19, s88, 0
 mf v[8:11], v[144:147], a[24:27], v[8:11]
 mf v[8:11], v[148:151], a[28:31], v[8:11]
 mf v[12:15], v[136:139], a[80:83], v[12:15]
 bl4 v192, s[48:51], s19 offen lds
 cvp v201, v90, v91
 mf v[12:15], v[140:143], a[84:87], v[12:15]
 mf v[12:15], v[144:147], a[88:91], v[12:15]
 mf v[12:15], v[148:151], a[92:95], v[12:15]
 sad m0, s36, 1024
 sad s19, s88, 65536
 mf v[16:19], v[136:139], a[144:147], v[16:19]
 cvp v202, v92, v93
 mf v[16:19], v[140:143], a[148:151], v[16:19]
 mf v[16:19], v[144:147], a[152:155], v[16:19]
 bl4 v193, s[48:51], s19 offen lds
 mf v[16:19], v[148:151], a[156:159], v[16:19]
 swc lgkmcnt(0)
 cvp v203, v94, v95
 mf v[20:23], v[136:139], a[208:211], v[20:23]
 trr v[136:137], v188 offset:16384
 trr v[138:139], v189 offset:16384
 mf v[20:23], v[140:143], a[212:215], v[20:23]
 trr v[140:141], v188 offset:20480
 trr v[142:143], v189 offset:20480
 mf v[20:23], v[144:147], a[216:219], v[20:23]
 trr v[144:145], v188 offset:24576
 trr v[146:147], v189 offset:24576
 mf v[20:23], v[148:151], a[220:223], v[20:23]
 trr v[148:149], v188 offset:28672
 trr v[150:151], v189 offset:28672
 mf v[24:27], v[152:155], a[16:19], v[24:27]
 mf v[24:27], v[156:159], a[20:23], v[24:27]
 mf v[24:27], v[160:163], a[24:27], v[24:27]
 sad m0, s36, 2048
 sad s19, s88, 131072
 mf v[24:27], v[164:167], a[28:31], v[24:27]
 bs4 v[200:203], v196, s[12:15], s34 offen offset:1024 sc1
 mf v[28:31], v[152:155], a[80:83], v[28:31]
 mf v[28:31], v[156:159], a[84:87], v[28:31]
 bl4 v192, s[48:51], s19 offen lds
 mf v[28:31], v[160:163], a[88:91], v[28:31]
 cvp v204, v96, v97
 mf v[28:31], v[164:167], a[92:95], v[28:31]
 mf v[32:35], v[152:155], a[144:147], v[32:35]
 sad m0, s36, 3072
 sad s19, s88, 196608
 mf v[32:35], v[156:159], a[148:151], v[32:35]
 mf v[32:35], v[160:163], a[152:155], v[32:35]
 cvp v205, v98, v99
 mf v[32:35], v[164:167], a[156:159], v[32:35]
 swc lgkmcnt(0)
 mf v[36:39], v[152:155], a[208:211], v[36:39]
 trr v[152:153], v190 offset:16384
 trr v[154:155], v191 offset:16384
 mf v[36:39], v[156:159], a[212:215], v[36:39]
 trr v[156:157], v190 offset:20480
 trr v[158:159], v191 offset:20480
 mf v[36:39], v[160:163], a[216:219], v[36:39]
 trr v[160:161], v190 offset:24576
 trr v[162:163], v191 offset:24576
 mf v[36:39], v[164:167], a[220:223], v[36:39]
 trr v[164:165], v190 offset:28672
 trr v[166:167], v191 offset:28672
 mf v[40:43], v[136:139], a[16:19], v[40:43]
 bl4 v193, s[48:51], s19 offen lds
 mf v[40:43], v[140:143], a[20:23], v[40:43]
 mf v[40:43], v[144:147], a[24:27], v[40:43]
 cvp v206, v100, v101
 mf v[40:43], v[148:151], a[28:31], v[40:43]
 swc vmcnt(63)
 vmf v208, v212, v212
 vmf v209, v213, v213
 vmf v210, v214, v214
 vmf v211, v215, v215
 mf v[44:47], v[136:139], a[80:83], v[44:47]
 mf v[44:47], v[140:143], a[84:87], v[44:47]
 cvp v207, v102, v103
 mf v[44:47], v[144:147], a[88:91], v[44:47]
 vmf v212, 0x3e0293ee, v212
 vmf v213, 0x3e0293ee, v213
 vmf v214, 0x3e0293ee, v214
 vmf v215, 0x3e0293ee, v215
 mf v[44:47], v[148:151], a[92:95], v[44:47]
 mf v[48:51], v[136:139], a[144:147], v[48:51]
 mf v[48:51], v[140:143], a[148:151], v[48:51]
 bs4 v[204:207], v197, s[12:15], s34 offen offset:1024 sc1
 mf v[48:51], v[144:147], a[152:155], v[48:51]
 mf v[48:51], v[148:151], a[156:159], v[48:51]
 swc lgkmcnt(0)
 mf v[52:55], v[136:139], a[208:211], v[52:55]
 trr v[136:137], v184 offset:32768
 trr v[138:139], v185 offset:32768
 mf v[52:55], v[140:143], a[212:215], v[52:55]
 trr v[140:141], v184 offset:36864
 trr v[142:143], v185 offset:36864
 mf v[52:55], v[144:147], a[216:219], v[52:55]
 trr v[144:145], v184 offset:40960
 trr v[146:147], v185 offset:40960
 mf v[52:55], v[148:151], a[220:223], v[52:55]
 trr v[148:149], v184 offset:45056
 trr v[150:151], v185 offset:45056
 mf v[56:59], v[152:155], a[16:19], v[56:59]
 cvp v200, v104, v105
 mf v[56:59], v[156:159], a[20:23], v[56:59]
 mf v[56:59], v[160:163], a[24:27], v[56:59]
 mf v[56:59], v[164:167], a[28:31], v[56:59]
 cvp v201, v106, v107
 mf v[60:63], v[152:155], a[80:83], v[60:63]
 mf v[60:63], v[156:159], a[84:87], v[60:63]
 cvp v202, v108, v109
 mf v[60:63], v[160:163], a[88:91], v[60:63]
 mf v[60:63], v[164:167], a[92:95], v[60:63]
 mf v[64:67], v[152:155], a[144:147], v[64:67]
 cvp v203, v110, v111
 mf v[64:67], v[156:159], a[148:151], v[64:67]
 mf v[64:67], v[160:163], a[152:155], v[64:67]
 bs4 v[200:203], v196, s[12:15], s34 offen offset:2048 sc1
 mf v[64:67], v[164:167], a[156:159], v[64:67]
 swc lgkmcnt(0)
 mf v[68:71], v[152:155], a[208:211], v[68:71]
 trr v[152:153], v186 offset:32768
 trr v[154:155], v187 offset:32768
 mf v[68:71], v[156:159], a[212:215], v[68:71]
 trr v[156:157], v186 offset:36864
 trr v[158:159], v187 offset:36864
 mf v[68:71], v[160:163], a[216:219], v[68:71]
 trr v[160:161], v186 offset:40960
 trr v[162:163], v187 offset:40960
 mf v[68:71], v[164:167], a[220:223], v[68:71]
 trr v[164:165], v186 offset:45056
 trr v[166:167], v187 offset:45056
 swc vmcnt(31)
 mf v[8:11], v[136:139], a[32:35], v[8:11]
 swc vmcnt(63)
 s_barrier
 mf v[8:11], v[140:143], a[36:39], v[8:11]
 sad m0, s36, 16384
 sad s19, s89, 0
 mf v[8:11], v[144:147], a[40:43], v[8:11]
 mf v[8:11], v[148:151], a[44:47], v[8:11]
 mf v[12:15], v[136:139], a[96:99], v[12:15]
 bl4 v192, s[48:51], s19 offen lds
 cvp v204, v112, v113
 mf v[12:15], v[140:143], a[100:103], v[12:15]
 mf v[12:15], v[144:147], a[104:107], v[12:15]
 mf v[12:15], v[148:151], a[108:111], v[12:15]
 sad m0, s36, 17408
 sad s19, s89, 65536
 mf v[16:19], v[136:139], a[160:163], v[16:19]
 cvp v205, v114, v115
 mf v[16:19], v[140:143], a[164:167], v[16:19]
 mf v[16:19], v[144:147], a[168:171], v[16:19]
 bl4 v193, s[48:51], s19 offen lds
 mf v[16:19], v[148:151], a[172:175], v[16:19]
 swc lgkmcnt(0)
 cvp v206, v116, v117
 mf v[20:23], v[136:139], a[224:227], v[20:23]
 trr v[136:137], v188 offset:32768
 trr v[138:139], v189 offset:32768
 mf v[20:23], v[140:143], a[228:231], v[20:23]
 trr v[140:141], v188 offset:36864
 trr v[142:143], v189 offset:36864
 mf v[20:23], v[144:147], a[232:235], v[20:23]
 trr v[144:145], v188 offset:40960
 trr v[146:147], v189 offset:40960
 mf v[20:23], v[148:151], a[236:239], v[20:23]
 trr v[148:149], v188 offset:45056
 trr v[150:151], v189 offset:45056
 mf v[24:27], v[152:155], a[32:35], v[24:27]
 mf v[24:27], v[156:159], a[36:39], v[24:27]
 mf v[24:27], v[160:163], a[40:43], v[24:27]
 sad m0, s36, 18432
 sad s19, s89, 131072
 mf v[24:27], v[164:167], a[44:47], v[24:27]
 cvp v207, v118, v119
 mf v[28:31], v[152:155], a[96:99], v[28:31]
 mf v[28:31], v[156:159], a[100:103], v[28:31]
 bl4 v192, s[48:51], s19 offen lds
 mf v[28:31], v[160:163], a[104:107], v[28:31]
 bs4 v[204:207], v197, s[12:15], s34 offen offset:2048 sc1
 mf v[28:31], v[164:167], a[108:111], v[28:31]
 mf v[32:35], v[152:155], a[160:163], v[32:35]
 sad m0, s36, 19456
 sad s19, s89, 196608
 mf v[32:35], v[156:159], a[164:167], v[32:35]
 mf v[32:35], v[160:163], a[168:171], v[32:35]
 cvp v200, v120, v121
 mf v[32:35], v[164:167], a[172:175], v[32:35]
 swc lgkmcnt(0)
 mf v[36:39], v[152:155], a[224:227], v[36:39]
 trr v[152:153], v190 offset:32768
 trr v[154:155], v191 offset:32768
 mf v[36:39], v[156:159], a[228:231], v[36:39]
 trr v[156:157], v190 offset:36864
 trr v[158:159], v191 offset:36864
 mf v[36:39], v[160:163], a[232:235], v[36:39]
 trr v[160:161], v190 offset:40960
 trr v[162:163], v191 offset:40960
 mf v[36:39], v[164:167], a[236:239], v[36:39]
 trr v[164:165], v190 offset:45056
 trr v[166:167], v191 offset:45056
 mf v[40:43], v[136:139], a[32:35], v[40:43]
 bl4 v193, s[48:51], s19 offen lds
 mf v[40:43], v[140:143], a[36:39], v[40:43]
 cvp v201, v122, v123
 mf v[40:43], v[144:147], a[40:43], v[40:43]
 mf v[40:43], v[148:151], a[44:47], v[40:43]
 mf v[44:47], v[136:139], a[96:99], v[44:47]
 cvp v202, v124, v125
 mf v[44:47], v[140:143], a[100:103], v[44:47]
 mf v[44:47], v[144:147], a[104:107], v[44:47]
 mf v[44:47], v[148:151], a[108:111], v[44:47]
 cvp v203, v126, v127
 mf v[48:51], v[136:139], a[160:163], v[48:51]
 mf v[48:51], v[140:143], a[164:167], v[48:51]
 bs4 v[200:203], v196, s[12:15], s34 offen offset:3072 sc1
 mf v[48:51], v[144:147], a[168:171], v[48:51]
 mf v[48:51], v[148:151], a[172:175], v[48:51]
 swc lgkmcnt(0)
 mf v[52:55], v[136:139], a[224:227], v[52:55]
 trr v[136:137], v184 offset:49152
 trr v[138:139], v185 offset:49152
 mf v[52:55], v[140:143], a[228:231], v[52:55]
 trr v[140:141], v184 offset:53248
 trr v[142:143], v185 offset:53248
 mf v[52:55], v[144:147], a[232:235], v[52:55]
 trr v[144:145], v184 offset:57344
 trr v[146:147], v185 offset:57344
 mf v[52:55], v[148:151], a[236:239], v[52:55]
 trr v[148:149], v184 offset:61440
 trr v[150:151], v185 offset:61440
 mf v[56:59], v[152:155], a[32:35], v[56:59]
 mf v[56:59], v[156:159], a[36:39], v[56:59]
 cvp v204, v128, v129
 mf v[56:59], v[160:163], a[40:43], v[56:59]
 mf v[56:59], v[164:167], a[44:47], v[56:59]
 cvp v205, v130, v131
 mf v[60:63], v[152:155], a[96:99], v[60:63]
 mf v[60:63], v[156:159], a[100:103], v[60:63]
 mf v[60:63], v[160:163], a[104:107], v[60:63]
 cvp v206, v132, v133
 mf v[60:63], v[164:167], a[108:111], v[60:63]
 mf v[64:67], v[152:155], a[160:163], v[64:67]
 cvp v207, v134, v135
 mf v[64:67], v[156:159], a[164:167], v[64:67]
 mf v[64:67], v[160:163], a[168:171], v[64:67]
 mf v[64:67], v[164:167], a[172:175], v[64:67]
 swc lgkmcnt(0)
 mf v[68:71], v[152:155], a[224:227], v[68:71]
 trr v[152:153], v186 offset:49152
 trr v[154:155], v187 offset:49152
 mf v[68:71], v[156:159], a[228:231], v[68:71]
 trr v[156:157], v186 offset:53248
 trr v[158:159], v187 offset:53248
 mf v[68:71], v[160:163], a[232:235], v[68:71]
 trr v[160:161], v186 offset:57344
 trr v[162:163], v187 offset:57344
 mf v[68:71], v[164:167], a[236:239], v[68:71]
 trr v[164:165], v186 offset:61440
 trr v[166:167], v187 offset:61440
 swc vmcnt(15)
 mf v[8:11], v[136:139], a[48:51], v[8:11]
 swc vmcnt(63)
 s_barrier
 v_xor_b32 v184, 0x10000, v184
 v_xor_b32 v185, 0x10000, v185
 v_xor_b32 v186, 0x10000, v186
 v_xor_b32 v187, 0x10000, v187
 mf v[8:11], v[140:143], a[52:55], v[8:11]
 sad m0, s36, 32768
 sad s19, s90, 0
 mf v[8:11], v[144:147], a[56:59], v[8:11]
 bs4 v[204:207], v197, s[12:15], s34 offen offset:3072 sc1
 mf v[8:11], v[148:151], a[60:63], v[8:11]
 mf v[12:15], v[136:139], a[112:115], v[12:15]
 bl4 v192, s[48:51], s19 offen lds
 mf v[12:15], v[140:143], a[116:119], v[12:15]
 s_lshl_b32 s20, s16, 10
 mf v[12:15], v[144:147], a[120:123], v[12:15]
 mf v[12:15], v[148:151], a[124:127], v[12:15]
 sad m0, s36, 33792
 sad s19, s90, 65536
 mf v[16:19], v[136:139], a[176:179], v[16:19]
 sad s24, s24, s20
 mf v[16:19], v[140:143], a[180:183], v[16:19]
 mf v[16:19], v[144:147], a[184:187], v[16:19]
 bl4 v193, s[48:51], s19 offen lds
 mf v[16:19], v[148:151], a[188:191], v[16:19]
 swc lgkmcnt(0)
 mf v[20:23], v[136:139], a[240:243], v[20:23]
 trr v[136:137], v188 offset:49152
 trr v[138:139], v189 offset:49152
 mf v[20:23], v[140:143], a[244:247], v[20:23]
 trr v[140:141], v188 offset:53248
 trr v[142:143], v189 offset:53248
 mf v[20:23], v[144:147], a[248:251], v[20:23]
 trr v[144:145], v188 offset:57344
 trr v[146:147], v189 offset:57344
 mf v[20:23], v[148:151], a[252:255], v[20:23]
 trr v[148:149], v188 offset:61440
 trr v[150:151], v189 offset:61440
 mf v[24:27], v[152:155], a[48:51], v[24:27]
 sad s25, s25, s20
 v_xor_b32 v188, 0x10000, v188
 v_xor_b32 v189, 0x10000, v189
 mf v[24:27], v[156:159], a[52:55], v[24:27]
 mf v[24:27], v[160:163], a[56:59], v[24:27]
 sad m0, s36, 34816
 sad s19, s90, 131072
 mf v[24:27], v[164:167], a[60:63], v[24:27]
 mf v[28:31], v[152:155], a[112:115], v[28:31]
 v_add_u32 v196, s24, v195
 mf v[28:31], v[156:159], a[116:119], v[28:31]
 bl4 v192, s[48:51], s19 offen lds
 mf v[28:31], v[160:163], a[120:123], v[28:31]
 mf v[28:31], v[164:167], a[124:127], v[28:31]
 v_add_u32 v198, s25, v195
 mf v[32:35], v[152:155], a[176:179], v[32:35]
 sad m0, s36, 35840
 sad s19, s90, 196608
 mf v[32:35], v[156:159], a[180:183], v[32:35]
 mf v[32:35], v[160:163], a[184:187], v[32:35]
 s_lshl_b32 s20, s16, 11
 mf v[32:35], v[164:167], a[188:191], v[32:35]
 swc lgkmcnt(0)
 mf v[36:39], v[152:155], a[240:243], v[36:39]
 trr v[152:153], v190 offset:49152
 trr v[154:155], v191 offset:49152
 mf v[36:39], v[156:159], a[244:247], v[36:39]
 trr v[156:157], v190 offset:53248
 trr v[158:159], v191 offset:53248
 mf v[36:39], v[160:163], a[248:251], v[36:39]
 trr v[160:161], v190 offset:57344
 trr v[162:163], v191 offset:57344
 mf v[36:39], v[164:167], a[252:255], v[36:39]
 trr v[164:165], v190 offset:61440
 trr v[166:167], v191 offset:61440
 mf v[40:43], v[136:139], a[48:51], v[40:43]
 bl4 v193, s[48:51], s19 offen lds
 v_xor_b32 v190, 0x10000, v190
 v_xor_b32 v191, 0x10000, v191
 mf v[40:43], v[140:143], a[52:55], v[40:43]
 mf v[40:43], v[144:147], a[56:59], v[40:43]
 s_sub_u32 s20, 703488, s20
 mf v[40:43], v[148:151], a[60:63], v[40:43]
 mf v[44:47], v[136:139], a[112:115], v[44:47]
 mf v[44:47], v[140:143], a[116:119], v[44:47]
 v_add_u32 v197, s20, v196
 mf v[44:47], v[144:147], a[120:123], v[44:47]
 mf v[44:47], v[148:151], a[124:127], v[44:47]
 v_add_u32 v199, s20, v198
 mf v[48:51], v[136:139], a[176:179], v[48:51]
 mf v[48:51], v[140:143], a[180:183], v[48:51]
 mf v[48:51], v[144:147], a[184:187], v[48:51]
 s_lshl_b32 s37, s17, 12
 mf v[48:51], v[148:151], a[188:191], v[48:51]
 swc lgkmcnt(0)
 mf v[52:55], v[136:139], a[240:243], v[52:55]
 trr v[136:137], v184 offset:0
 trr v[138:139], v185 offset:0
 mf v[52:55], v[140:143], a[244:247], v[52:55]
 trr v[140:141], v184 offset:4096
 trr v[142:143], v185 offset:4096
 mf v[52:55], v[144:147], a[248:251], v[52:55]
 trr v[144:145], v184 offset:8192
 trr v[146:147], v185 offset:8192
 mf v[52:55], v[148:151], a[252:255], v[52:55]
 trr v[148:149], v184 offset:12288
 trr v[150:151], v185 offset:12288
 mf v[56:59], v[152:155], a[48:51], v[56:59]
 mf v[56:59], v[156:159], a[52:55], v[56:59]
 sad s37, s37, 35127296
 mf v[56:59], v[160:163], a[56:59], v[56:59]
 mf v[56:59], v[164:167], a[60:63], v[56:59]
 mf v[60:63], v[152:155], a[112:115], v[60:63]
 mf v[60:63], v[156:159], a[116:119], v[60:63]
 mf v[60:63], v[160:163], a[120:123], v[60:63]
 mf v[60:63], v[164:167], a[124:127], v[60:63]
 mf v[64:67], v[152:155], a[176:179], v[64:67]
 mf v[64:67], v[156:159], a[180:183], v[64:67]
 mf v[64:67], v[160:163], a[184:187], v[64:67]
 mf v[64:67], v[164:167], a[188:191], v[64:67]
 swc lgkmcnt(0)
 mf v[68:71], v[152:155], a[240:243], v[68:71]
 trr v[152:153], v186 offset:0
 trr v[154:155], v187 offset:0
 mf v[68:71], v[156:159], a[244:247], v[68:71]
 trr v[156:157], v186 offset:4096
 trr v[158:159], v187 offset:4096
 mf v[68:71], v[160:163], a[248:251], v[68:71]
 trr v[160:161], v186 offset:8192
 trr v[162:163], v187 offset:8192
 mf v[68:71], v[164:167], a[252:255], v[68:71]
 trr v[164:165], v186 offset:12288
 trr v[166:167], v187 offset:12288
K1_COMMON:
 s_bitcmp1_b32 s17, 0
 s_cbranch_scc1 K1_H1
K1_H0:
 swc lgkmcnt(8)
 mf v[216:219], v[136:139], a[0:3], 0
 swc vmcnt(63)
 s_barrier
 mf v[216:219], v[140:143], a[4:7], v[216:219]
 sad m0, s36, 49152
 sad s19, s91, 0
 mf v[216:219], v[144:147], a[8:11], v[216:219]
 bl4 v192, s[48:51], s19 offen lds
 mf v[216:219], v[148:151], a[12:15], v[216:219]
 sad m0, s36, 50176
 sad s19, s91, 65536
 mf v[220:223], v[136:139], a[64:67], 0
 trr v[136:137], v188 offset:0
 trr v[138:139], v189 offset:0
 mf v[220:223], v[140:143], a[68:71], v[220:223]
 trr v[140:141], v188 offset:4096
 trr v[142:143], v189 offset:4096
 mf v[220:223], v[144:147], a[72:75], v[220:223]
 trr v[144:145], v188 offset:8192
 trr v[146:147], v189 offset:8192
 mf v[220:223], v[148:151], a[76:79], v[220:223]
 trr v[148:149], v188 offset:12288
 trr v[150:151], v189 offset:12288
 swc lgkmcnt(8)
 mf v[224:227], v[152:155], a[0:3], 0
 bl4 v193, s[48:51], s19 offen lds
 v_max_f32 v8, 0, v8
 v_max_f32 v9, 0, v9
 mf v[224:227], v[156:159], a[4:7], v[224:227]
 sad m0, s36, 51200
 sad s19, s91, 131072
 v_max_f32 v10, 0, v10
 v_max_f32 v11, 0, v11
 mf v[224:227], v[160:163], a[8:11], v[224:227]
 bl4 v192, s[48:51], s19 offen lds
 vmf v40, v40, v208
 vmf v41, v41, v208
 mf v[224:227], v[164:167], a[12:15], v[224:227]
 sad m0, s36, 52224
 sad s19, s91, 196608
 vmf v42, v42, v208
 mf v[228:231], v[152:155], a[64:67], 0
 trr v[152:153], v190 offset:0
 trr v[154:155], v191 offset:0
 mf v[228:231], v[156:159], a[68:71], v[228:231]
 trr v[156:157], v190 offset:4096
 trr v[158:159], v191 offset:4096
 mf v[228:231], v[160:163], a[72:75], v[228:231]
 trr v[160:161], v190 offset:8192
 trr v[162:163], v191 offset:8192
 mf v[228:231], v[164:167], a[76:79], v[228:231]
 trr v[164:165], v190 offset:12288
 trr v[166:167], v191 offset:12288
 swc lgkmcnt(8)
 mf v[232:235], v[136:139], a[0:3], 0
 bl4 v193, s[48:51], s19 offen lds
 vmf v43, v43, v208
 vmf v8, v8, v40
 mf v[232:235], v[140:143], a[4:7], v[232:235]
 v_mov_b32 v249, v196
 v_mov_b32 v251, v208
 vmf v9, v9, v41
 mf v[232:235], v[144:147], a[8:11], v[232:235]
 v_mov_b32 v250, v197
 v_mov_b32 v252, v209
 vmf v10, v10, v42
 vmf v11, v11, v43
 mf v[232:235], v[148:151], a[12:15], v[232:235]
 cvp v200, v8, v9
 cvp v201, v10, v11
 mf v[236:239], v[136:139], a[64:67], 0
 trr v[136:137], v184 offset:16384
 trr v[138:139], v185 offset:16384
 mf v[236:239], v[140:143], a[68:71], v[236:239]
 trr v[140:141], v184 offset:20480
 trr v[142:143], v185 offset:20480
 mf v[236:239], v[144:147], a[72:75], v[236:239]
 trr v[144:145], v184 offset:24576
 trr v[146:147], v185 offset:24576
 mf v[236:239], v[148:151], a[76:79], v[236:239]
 trr v[148:149], v184 offset:28672
 trr v[150:151], v185 offset:28672
 swc lgkmcnt(8)
 mf v[240:243], v[152:155], a[0:3], 0
 v_max_f32 v24, 0, v24
 v_max_f32 v25, 0, v25
 v_max_f32 v26, 0, v26
 mf v[240:243], v[156:159], a[4:7], v[240:243]
 v_max_f32 v27, 0, v27
 vmf v56, v56, v208
 vmf v57, v57, v208
 mf v[240:243], v[160:163], a[8:11], v[240:243]
 vmf v58, v58, v208
 vmf v59, v59, v208
 mf v[240:243], v[164:167], a[12:15], v[240:243]
 vmf v24, v24, v56
 vmf v25, v25, v57
 vmf v26, v26, v58
 mf v[244:247], v[152:155], a[64:67], 0
 trr v[152:153], v186 offset:16384
 trr v[154:155], v187 offset:16384
 mf v[244:247], v[156:159], a[68:71], v[244:247]
 trr v[156:157], v186 offset:20480
 trr v[158:159], v187 offset:20480
 mf v[244:247], v[160:163], a[72:75], v[244:247]
 trr v[160:161], v186 offset:24576
 trr v[162:163], v187 offset:24576
 mf v[244:247], v[164:167], a[76:79], v[244:247]
 trr v[164:165], v186 offset:28672
 trr v[166:167], v187 offset:28672
 swc lgkmcnt(8)
 mf v[216:219], v[136:139], a[16:19], v[216:219]
 swc vmcnt(62)
 s_barrier
 vmf v27, v27, v59
 mf v[216:219], v[140:143], a[20:23], v[216:219]
 sad m0, s36, 65536
 sad s19, s88, 128
 cvp v202, v24, v25
 cvp v203, v26, v27
 mf v[216:219], v[144:147], a[24:27], v[216:219]
 bl4 v192, s[48:51], s19 offen lds
 bs4 v[200:203], v196, s[12:15], s37 offen offset:0 sc1
 v_max_f32 v12, 0, v12
 mf v[216:219], v[148:151], a[28:31], v[216:219]
 sad m0, s36, 66560
 sad s19, s88, 65664
 v_max_f32 v13, 0, v13
 mf v[220:223], v[136:139], a[80:83], v[220:223]
 trr v[136:137], v188 offset:16384
 trr v[138:139], v189 offset:16384
 mf v[220:223], v[140:143], a[84:87], v[220:223]
 trr v[140:141], v188 offset:20480
 trr v[142:143], v189 offset:20480
 mf v[220:223], v[144:147], a[88:91], v[220:223]
 trr v[144:145], v188 offset:24576
 trr v[146:147], v189 offset:24576
 mf v[220:223], v[148:151], a[92:95], v[220:223]
 trr v[148:149], v188 offset:28672
 trr v[150:151], v189 offset:28672
 swc lgkmcnt(8)
 mf v[224:227], v[152:155], a[16:19], v[224:227]
 bl4 v193, s[48:51], s19 offen lds
 v_max_f32 v14, 0, v14
 v_max_f32 v15, 0, v15
 mf v[224:227], v[156:159], a[20:23], v[224:227]
 sad m0, s36, 67584
 sad s19, s88, 131200
 vmf v44, v44, v209
 mf v[224:227], v[160:163], a[24:27], v[224:227]
 bl4 v192, s[48:51], s19 offen lds
 vmf v45, v45, v209
 vmf v46, v46, v209
 mf v[224:227], v[164:167], a[28:31], v[224:227]
 sad m0, s36, 68608
 sad s19, s88, 196736
 vmf v47, v47, v209
 mf v[228:231], v[152:155], a[80:83], v[228:231]
 trr v[152:153], v190 offset:16384
 trr v[154:155], v191 offset:16384
 mf v[228:231], v[156:159], a[84:87], v[228:231]
 trr v[156:157], v190 offset:20480
 trr v[158:159], v191 offset:20480
 mf v[228:231], v[160:163], a[88:91], v[228:231]
 trr v[160:161], v190 offset:24576
 trr v[162:163], v191 offset:24576
 mf v[228:231], v[164:167], a[92:95], v[228:231]
 trr v[164:165], v190 offset:28672
 trr v[166:167], v191 offset:28672
 swc lgkmcnt(8)
 mf v[232:235], v[136:139], a[16:19], v[232:235]
 bl4 v193, s[48:51], s19 offen lds
 vmf v12, v12, v44
 vmf v13, v13, v45
 mf v[232:235], v[140:143], a[20:23], v[232:235]
 vmf v14, v14, v46
 vmf v15, v15, v47
 cvp v204, v12, v13
 mf v[232:235], v[144:147], a[24:27], v[232:235]
 cvp v205, v14, v15
 v_max_f32 v28, 0, v28
 v_max_f32 v29, 0, v29
 mf v[232:235], v[148:151], a[28:31], v[232:235]
 v_max_f32 v30, 0, v30
 v_max_f32 v31, 0, v31
 mf v[236:239], v[136:139], a[80:83], v[236:239]
 trr v[136:137], v184 offset:32768
 trr v[138:139], v185 offset:32768
 mf v[236:239], v[140:143], a[84:87], v[236:239]
 trr v[140:141], v184 offset:36864
 trr v[142:143], v185 offset:36864
 mf v[236:239], v[144:147], a[88:91], v[236:239]
 trr v[144:145], v184 offset:40960
 trr v[146:147], v185 offset:40960
 mf v[236:239], v[148:151], a[92:95], v[236:239]
 trr v[148:149], v184 offset:45056
 trr v[150:151], v185 offset:45056
 swc lgkmcnt(8)
 mf v[240:243], v[152:155], a[16:19], v[240:243]
 vmf v60, v60, v209
 vmf v61, v61, v209
 vmf v62, v62, v209
 mf v[240:243], v[156:159], a[20:23], v[240:243]
 vmf v63, v63, v209
 vmf v28, v28, v60
 vmf v29, v29, v61
 mf v[240:243], v[160:163], a[24:27], v[240:243]
 vmf v30, v30, v62
 vmf v31, v31, v63
 mf v[240:243], v[164:167], a[28:31], v[240:243]
 cvp v206, v28, v29
 cvp v207, v30, v31
 bs4 v[204:207], v197, s[12:15], s37 offen offset:0 sc1
 mf v[244:247], v[152:155], a[80:83], v[244:247]
 trr v[152:153], v186 offset:32768
 trr v[154:155], v187 offset:32768
 mf v[244:247], v[156:159], a[84:87], v[244:247]
 trr v[156:157], v186 offset:36864
 trr v[158:159], v187 offset:36864
 mf v[244:247], v[160:163], a[88:91], v[244:247]
 trr v[160:161], v186 offset:40960
 trr v[162:163], v187 offset:40960
 mf v[244:247], v[164:167], a[92:95], v[244:247]
 trr v[164:165], v186 offset:45056
 trr v[166:167], v187 offset:45056
 swc lgkmcnt(8)
 mf v[216:219], v[136:139], a[32:35], v[216:219]
 swc vmcnt(46)
 s_barrier
 v_max_f32 v16, 0, v16
 mf v[216:219], v[140:143], a[36:39], v[216:219]
 sad m0, s36, 81920
 sad s19, s89, 128
 v_max_f32 v17, 0, v17
 v_max_f32 v18, 0, v18
 mf v[216:219], v[144:147], a[40:43], v[216:219]
 bl4 v192, s[48:51], s19 offen lds
 v_max_f32 v19, 0, v19
 vmf v48, v48, v210
 mf v[216:219], v[148:151], a[44:47], v[216:219]
 sad m0, s36, 82944
 sad s19, s89, 65664
 vmf v49, v49, v210
 mf v[220:223], v[136:139], a[96:99], v[220:223]
 trr v[136:137], v188 offset:32768
 trr v[138:139], v189 offset:32768
 mf v[220:223], v[140:143], a[100:103], v[220:223]
 trr v[140:141], v188 offset:36864
 trr v[142:143], v189 offset:36864
 mf v[220:223], v[144:147], a[104:107], v[220:223]
 trr v[144:145], v188 offset:40960
 trr v[146:147], v189 offset:40960
 mf v[220:223], v[148:151], a[108:111], v[220:223]
 trr v[148:149], v188 offset:45056
 trr v[150:151], v189 offset:45056
 swc lgkmcnt(8)
 mf v[224:227], v[152:155], a[32:35], v[224:227]
 bl4 v193, s[48:51], s19 offen lds
 vmf v50, v50, v210
 vmf v51, v51, v210
 mf v[224:227], v[156:159], a[36:39], v[224:227]
 sad m0, s36, 83968
 sad s19, s89, 131200
 vmf v16, v16, v48
 mf v[224:227], v[160:163], a[40:43], v[224:227]
 bl4 v192, s[48:51], s19 offen lds
 vmf v17, v17, v49
 vmf v18, v18, v50
 mf v[224:227], v[164:167], a[44:47], v[224:227]
 sad m0, s36, 84992
 sad s19, s89, 196736
 vmf v19, v19, v51
 mf v[228:231], v[152:155], a[96:99], v[228:231]
 trr v[152:153], v190 offset:32768
 trr v[154:155], v191 offset:32768
 mf v[228:231], v[156:159], a[100:103], v[228:231]
 trr v[156:157], v190 offset:36864
 trr v[158:159], v191 offset:36864
 mf v[228:231], v[160:163], a[104:107], v[228:231]
 trr v[160:161], v190 offset:40960
 trr v[162:163], v191 offset:40960
 mf v[228:231], v[164:167], a[108:111], v[228:231]
 trr v[164:165], v190 offset:45056
 trr v[166:167], v191 offset:45056
 swc lgkmcnt(8)
 mf v[232:235], v[136:139], a[32:35], v[232:235]
 bl4 v193, s[48:51], s19 offen lds
 cvp v200, v16, v17
 cvp v201, v18, v19
 mf v[232:235], v[140:143], a[36:39], v[232:235]
 v_max_f32 v32, 0, v32
 v_max_f32 v33, 0, v33
 v_max_f32 v34, 0, v34
 mf v[232:235], v[144:147], a[40:43], v[232:235]
 v_max_f32 v35, 0, v35
 vmf v64, v64, v210
 vmf v65, v65, v210
 mf v[232:235], v[148:151], a[44:47], v[232:235]
 vmf v66, v66, v210
 vmf v67, v67, v210
 mf v[236:239], v[136:139], a[96:99], v[236:239]
 trr v[136:137], v184 offset:49152
 trr v[138:139], v185 offset:49152
 mf v[236:239], v[140:143], a[100:103], v[236:239]
 trr v[140:141], v184 offset:53248
 trr v[142:143], v185 offset:53248
 mf v[236:239], v[144:147], a[104:107], v[236:239]
 trr v[144:145], v184 offset:57344
 trr v[146:147], v185 offset:57344
 mf v[236:239], v[148:151], a[108:111], v[236:239]
 trr v[148:149], v184 offset:61440
 trr v[150:151], v185 offset:61440
 swc lgkmcnt(8)
 mf v[240:243], v[152:155], a[32:35], v[240:243]
 vmf v32, v32, v64
 vmf v33, v33, v65
 vmf v34, v34, v66
 mf v[240:243], v[156:159], a[36:39], v[240:243]
 vmf v35, v35, v67
 cvp v202, v32, v33
 cvp v203, v34, v35
 mf v[240:243], v[160:163], a[40:43], v[240:243]
 bs4 v[200:203], v198, s[12:15], s37 offen offset:0 sc1
 v_max_f32 v20, 0, v20
 mf v[240:243], v[164:167], a[44:47], v[240:243]
 v_max_f32 v21, 0, v21
 v_max_f32 v22, 0, v22
 v_max_f32 v23, 0, v23
 mf v[244:247], v[152:155], a[96:99], v[244:247]
 trr v[152:153], v186 offset:49152
 trr v[154:155], v187 offset:49152
 mf v[244:247], v[156:159], a[100:103], v[244:247]
 trr v[156:157], v186 offset:53248
 trr v[158:159], v187 offset:53248
 mf v[244:247], v[160:163], a[104:107], v[244:247]
 trr v[160:161], v186 offset:57344
 trr v[162:163], v187 offset:57344
 mf v[244:247], v[164:167], a[108:111], v[244:247]
 trr v[164:165], v186 offset:61440
 trr v[166:167], v187 offset:61440
 swc lgkmcnt(8)
 mf v[216:219], v[136:139], a[48:51], v[216:219]
 swc vmcnt(19)
 s_barrier
 s_cmp_lg_u32 s16, 0
 s_cbranch_scc1 K1_NS20
 s_mov_b64 exec, 1
 buffer_atomic_add v5, v4, s[80:83], 0 offen offset:0 sc1
 s_mov_b64 exec, -1
K1_NS20:
 mf v[216:219], v[140:143], a[52:55], v[216:219]
 sad m0, s36, 98304
 sad s19, s90, 128
 vmf v52, v52, v211
 mf v[216:219], v[144:147], a[56:59], v[216:219]
 bl4 v192, s[48:51], s19 offen lds
 vmf v53, v53, v211
 vmf v54, v54, v211
 mf v[216:219], v[148:151], a[60:63], v[216:219]
 sad m0, s36, 99328
 sad s19, s90, 65664
 vmf v55, v55, v211
 vmf v20, v20, v52
 mf v[220:223], v[136:139], a[112:115], v[220:223]
 trr v[136:137], v188 offset:49152
 trr v[138:139], v189 offset:49152
 mf v[220:223], v[140:143], a[116:119], v[220:223]
 trr v[140:141], v188 offset:53248
 trr v[142:143], v189 offset:53248
 mf v[220:223], v[144:147], a[120:123], v[220:223]
 trr v[144:145], v188 offset:57344
 trr v[146:147], v189 offset:57344
 mf v[220:223], v[148:151], a[124:127], v[220:223]
 trr v[148:149], v188 offset:61440
 trr v[150:151], v189 offset:61440
 swc lgkmcnt(8)
 mf v[224:227], v[152:155], a[48:51], v[224:227]
 bl4 v193, s[48:51], s19 offen lds
 vmf v21, v21, v53
 vmf v22, v22, v54
 mf v[224:227], v[156:159], a[52:55], v[224:227]
 sad m0, s36, 100352
 sad s19, s90, 131200
 vmf v23, v23, v55
 mf v[224:227], v[160:163], a[56:59], v[224:227]
 bl4 v192, s[48:51], s19 offen lds
 cvp v204, v20, v21
 cvp v205, v22, v23
 mf v[224:227], v[164:167], a[60:63], v[224:227]
 sad m0, s36, 101376
 sad s19, s90, 196736
 v_max_f32 v36, 0, v36
 mf v[228:231], v[152:155], a[112:115], v[228:231]
 trr v[152:153], v190 offset:49152
 trr v[154:155], v191 offset:49152
 mf v[228:231], v[156:159], a[116:119], v[228:231]
 trr v[156:157], v190 offset:53248
 trr v[158:159], v191 offset:53248
 mf v[228:231], v[160:163], a[120:123], v[228:231]
 trr v[160:161], v190 offset:57344
 trr v[162:163], v191 offset:57344
 mf v[228:231], v[164:167], a[124:127], v[228:231]
 trr v[164:165], v190 offset:61440
 trr v[166:167], v191 offset:61440
 swc lgkmcnt(8)
 mf v[232:235], v[136:139], a[48:51], v[232:235]
 bl4 v193, s[48:51], s19 offen lds
 v_max_f32 v37, 0, v37
 v_max_f32 v38, 0, v38
 mf v[232:235], v[140:143], a[52:55], v[232:235]
 v_max_f32 v39, 0, v39
 vmf v68, v68, v211
 vmf v69, v69, v211
 mf v[232:235], v[144:147], a[56:59], v[232:235]
 vmf v70, v70, v211
 vmf v71, v71, v211
 mf v[232:235], v[148:151], a[60:63], v[232:235]
 vmf v36, v36, v68
 vmf v37, v37, v69
 vmf v38, v38, v70
 mf v[236:239], v[136:139], a[112:115], v[236:239]
 trr v[136:137], v168 offset:0
 trr v[138:139], v169 offset:0
 mf v[236:239], v[140:143], a[116:119], v[236:239]
 trr v[140:141], v168 offset:4096
 trr v[142:143], v169 offset:4096
 mf v[236:239], v[144:147], a[120:123], v[236:239]
 trr v[144:145], v168 offset:8192
 trr v[146:147], v169 offset:8192
 mf v[236:239], v[148:151], a[124:127], v[236:239]
 trr v[148:149], v168 offset:12288
 trr v[150:151], v169 offset:12288
 swc lgkmcnt(8)
 mf v[240:243], v[152:155], a[48:51], v[240:243]
 vmf v39, v39, v71
 cvp v206, v36, v37
 cvp v207, v38, v39
 mf v[240:243], v[156:159], a[52:55], v[240:243]
 bs4 v[204:207], v199, s[12:15], s37 offen offset:0 sc1
 mf v[240:243], v[160:163], a[56:59], v[240:243]
 mf v[240:243], v[164:167], a[60:63], v[240:243]
 mf v[244:247], v[152:155], a[112:115], v[244:247]
 trr v[152:153], v170 offset:0
 trr v[154:155], v171 offset:0
 mf v[244:247], v[156:159], a[116:119], v[244:247]
 trr v[156:157], v170 offset:4096
 trr v[158:159], v171 offset:4096
 mf v[244:247], v[160:163], a[120:123], v[244:247]
 trr v[160:161], v170 offset:8192
 trr v[162:163], v171 offset:8192
 mf v[244:247], v[164:167], a[124:127], v[244:247]
 trr v[164:165], v170 offset:12288
 trr v[166:167], v171 offset:12288
 s_branch K1_Q
K1_H1:
 swc lgkmcnt(8)
 mf v[216:219], v[136:139], a[128:131], 0
 swc vmcnt(63)
 s_barrier
 mf v[216:219], v[140:143], a[132:135], v[216:219]
 sad m0, s36, 49152
 sad s19, s91, 0
 mf v[216:219], v[144:147], a[136:139], v[216:219]
 bl4 v192, s[48:51], s19 offen lds
 mf v[216:219], v[148:151], a[140:143], v[216:219]
 sad m0, s36, 50176
 sad s19, s91, 65536
 mf v[220:223], v[136:139], a[192:195], 0
 trr v[136:137], v188 offset:0
 trr v[138:139], v189 offset:0
 mf v[220:223], v[140:143], a[196:199], v[220:223]
 trr v[140:141], v188 offset:4096
 trr v[142:143], v189 offset:4096
 mf v[220:223], v[144:147], a[200:203], v[220:223]
 trr v[144:145], v188 offset:8192
 trr v[146:147], v189 offset:8192
 mf v[220:223], v[148:151], a[204:207], v[220:223]
 trr v[148:149], v188 offset:12288
 trr v[150:151], v189 offset:12288
 swc lgkmcnt(8)
 mf v[224:227], v[152:155], a[128:131], 0
 bl4 v193, s[48:51], s19 offen lds
 v_max_f32 v8, 0, v8
 v_max_f32 v9, 0, v9
 mf v[224:227], v[156:159], a[132:135], v[224:227]
 sad m0, s36, 51200
 sad s19, s91, 131072
 v_max_f32 v10, 0, v10
 v_max_f32 v11, 0, v11
 mf v[224:227], v[160:163], a[136:139], v[224:227]
 bl4 v192, s[48:51], s19 offen lds
 vmf v40, v40, v208
 vmf v41, v41, v208
 mf v[224:227], v[164:167], a[140:143], v[224:227]
 sad m0, s36, 52224
 sad s19, s91, 196608
 vmf v42, v42, v208
 mf v[228:231], v[152:155], a[192:195], 0
 trr v[152:153], v190 offset:0
 trr v[154:155], v191 offset:0
 mf v[228:231], v[156:159], a[196:199], v[228:231]
 trr v[156:157], v190 offset:4096
 trr v[158:159], v191 offset:4096
 mf v[228:231], v[160:163], a[200:203], v[228:231]
 trr v[160:161], v190 offset:8192
 trr v[162:163], v191 offset:8192
 mf v[228:231], v[164:167], a[204:207], v[228:231]
 trr v[164:165], v190 offset:12288
 trr v[166:167], v191 offset:12288
 swc lgkmcnt(8)
 mf v[232:235], v[136:139], a[128:131], 0
 bl4 v193, s[48:51], s19 offen lds
 vmf v43, v43, v208
 vmf v8, v8, v40
 mf v[232:235], v[140:143], a[132:135], v[232:235]
 v_mov_b32 v249, v198
 v_mov_b32 v251, v210
 vmf v9, v9, v41
 mf v[232:235], v[144:147], a[136:139], v[232:235]
 v_mov_b32 v250, v199
 v_mov_b32 v252, v211
 vmf v10, v10, v42
 vmf v11, v11, v43
 mf v[232:235], v[148:151], a[140:143], v[232:235]
 cvp v200, v8, v9
 cvp v201, v10, v11
 mf v[236:239], v[136:139], a[192:195], 0
 trr v[136:137], v184 offset:16384
 trr v[138:139], v185 offset:16384
 mf v[236:239], v[140:143], a[196:199], v[236:239]
 trr v[140:141], v184 offset:20480
 trr v[142:143], v185 offset:20480
 mf v[236:239], v[144:147], a[200:203], v[236:239]
 trr v[144:145], v184 offset:24576
 trr v[146:147], v185 offset:24576
 mf v[236:239], v[148:151], a[204:207], v[236:239]
 trr v[148:149], v184 offset:28672
 trr v[150:151], v185 offset:28672
 swc lgkmcnt(8)
 mf v[240:243], v[152:155], a[128:131], 0
 v_max_f32 v24, 0, v24
 v_max_f32 v25, 0, v25
 v_max_f32 v26, 0, v26
 mf v[240:243], v[156:159], a[132:135], v[240:243]
 v_max_f32 v27, 0, v27
 vmf v56, v56, v208
 vmf v57, v57, v208
 mf v[240:243], v[160:163], a[136:139], v[240:243]
 vmf v58, v58, v208
 vmf v59, v59, v208
 mf v[240:243], v[164:167], a[140:143], v[240:243]
 vmf v24, v24, v56
 vmf v25, v25, v57
 vmf v26, v26, v58
 mf v[244:247], v[152:155], a[192:195], 0
 trr v[152:153], v186 offset:16384
 trr v[154:155], v187 offset:16384
 mf v[244:247], v[156:159], a[196:199], v[244:247]
 trr v[156:157], v186 offset:20480
 trr v[158:159], v187 offset:20480
 mf v[244:247], v[160:163], a[200:203], v[244:247]
 trr v[160:161], v186 offset:24576
 trr v[162:163], v187 offset:24576
 mf v[244:247], v[164:167], a[204:207], v[244:247]
 trr v[164:165], v186 offset:28672
 trr v[166:167], v187 offset:28672
 swc lgkmcnt(8)
 mf v[216:219], v[136:139], a[144:147], v[216:219]
 swc vmcnt(62)
 s_barrier
 vmf v27, v27, v59
 mf v[216:219], v[140:143], a[148:151], v[216:219]
 sad m0, s36, 65536
 sad s19, s88, 128
 cvp v202, v24, v25
 cvp v203, v26, v27
 mf v[216:219], v[144:147], a[152:155], v[216:219]
 bl4 v192, s[48:51], s19 offen lds
 bs4 v[200:203], v196, s[12:15], s37 offen offset:0 sc1
 v_max_f32 v12, 0, v12
 mf v[216:219], v[148:151], a[156:159], v[216:219]
 sad m0, s36, 66560
 sad s19, s88, 65664
 v_max_f32 v13, 0, v13
 mf v[220:223], v[136:139], a[208:211], v[220:223]
 trr v[136:137], v188 offset:16384
 trr v[138:139], v189 offset:16384
 mf v[220:223], v[140:143], a[212:215], v[220:223]
 trr v[140:141], v188 offset:20480
 trr v[142:143], v189 offset:20480
 mf v[220:223], v[144:147], a[216:219], v[220:223]
 trr v[144:145], v188 offset:24576
 trr v[146:147], v189 offset:24576
 mf v[220:223], v[148:151], a[220:223], v[220:223]
 trr v[148:149], v188 offset:28672
 trr v[150:151], v189 offset:28672
 swc lgkmcnt(8)
 mf v[224:227], v[152:155], a[144:147], v[224:227]
 bl4 v193, s[48:51], s19 offen lds
 v_max_f32 v14, 0, v14
 v_max_f32 v15, 0, v15
 mf v[224:227], v[156:159], a[148:151], v[224:227]
 sad m0, s36, 67584
 sad s19, s88, 131200
 vmf v44, v44, v209
 mf v[224:227], v[160:163], a[152:155], v[224:227]
 bl4 v192, s[48:51], s19 offen lds
 vmf v45, v45, v209
 vmf v46, v46, v209
 mf v[224:227], v[164:167], a[156:159], v[224:227]
 sad m0, s36, 68608
 sad s19, s88, 196736
 vmf v47, v47, v209
 mf v[228:231], v[152:155], a[208:211], v[228:231]
 trr v[152:153], v190 offset:16384
 trr v[154:155], v191 offset:16384
 mf v[228:231], v[156:159], a[212:215], v[228:231]
 trr v[156:157], v190 offset:20480
 trr v[158:159], v191 offset:20480
 mf v[228:231], v[160:163], a[216:219], v[228:231]
 trr v[160:161], v190 offset:24576
 trr v[162:163], v191 offset:24576
 mf v[228:231], v[164:167], a[220:223], v[228:231]
 trr v[164:165], v190 offset:28672
 trr v[166:167], v191 offset:28672
 swc lgkmcnt(8)
 mf v[232:235], v[136:139], a[144:147], v[232:235]
 bl4 v193, s[48:51], s19 offen lds
 vmf v12, v12, v44
 vmf v13, v13, v45
 mf v[232:235], v[140:143], a[148:151], v[232:235]
 vmf v14, v14, v46
 vmf v15, v15, v47
 cvp v204, v12, v13
 mf v[232:235], v[144:147], a[152:155], v[232:235]
 cvp v205, v14, v15
 v_max_f32 v28, 0, v28
 v_max_f32 v29, 0, v29
 mf v[232:235], v[148:151], a[156:159], v[232:235]
 v_max_f32 v30, 0, v30
 v_max_f32 v31, 0, v31
 mf v[236:239], v[136:139], a[208:211], v[236:239]
 trr v[136:137], v184 offset:32768
 trr v[138:139], v185 offset:32768
 mf v[236:239], v[140:143], a[212:215], v[236:239]
 trr v[140:141], v184 offset:36864
 trr v[142:143], v185 offset:36864
 mf v[236:239], v[144:147], a[216:219], v[236:239]
 trr v[144:145], v184 offset:40960
 trr v[146:147], v185 offset:40960
 mf v[236:239], v[148:151], a[220:223], v[236:239]
 trr v[148:149], v184 offset:45056
 trr v[150:151], v185 offset:45056
 swc lgkmcnt(8)
 mf v[240:243], v[152:155], a[144:147], v[240:243]
 vmf v60, v60, v209
 vmf v61, v61, v209
 vmf v62, v62, v209
 mf v[240:243], v[156:159], a[148:151], v[240:243]
 vmf v63, v63, v209
 vmf v28, v28, v60
 vmf v29, v29, v61
 mf v[240:243], v[160:163], a[152:155], v[240:243]
 vmf v30, v30, v62
 vmf v31, v31, v63
 mf v[240:243], v[164:167], a[156:159], v[240:243]
 cvp v206, v28, v29
 cvp v207, v30, v31
 bs4 v[204:207], v197, s[12:15], s37 offen offset:0 sc1
 mf v[244:247], v[152:155], a[208:211], v[244:247]
 trr v[152:153], v186 offset:32768
 trr v[154:155], v187 offset:32768
 mf v[244:247], v[156:159], a[212:215], v[244:247]
 trr v[156:157], v186 offset:36864
 trr v[158:159], v187 offset:36864
 mf v[244:247], v[160:163], a[216:219], v[244:247]
 trr v[160:161], v186 offset:40960
 trr v[162:163], v187 offset:40960
 mf v[244:247], v[164:167], a[220:223], v[244:247]
 trr v[164:165], v186 offset:45056
 trr v[166:167], v187 offset:45056
 swc lgkmcnt(8)
 mf v[216:219], v[136:139], a[160:163], v[216:219]
 swc vmcnt(46)
 s_barrier
 v_max_f32 v16, 0, v16
 mf v[216:219], v[140:143], a[164:167], v[216:219]
 sad m0, s36, 81920
 sad s19, s89, 128
 v_max_f32 v17, 0, v17
 v_max_f32 v18, 0, v18
 mf v[216:219], v[144:147], a[168:171], v[216:219]
 bl4 v192, s[48:51], s19 offen lds
 v_max_f32 v19, 0, v19
 vmf v48, v48, v210
 mf v[216:219], v[148:151], a[172:175], v[216:219]
 sad m0, s36, 82944
 sad s19, s89, 65664
 vmf v49, v49, v210
 mf v[220:223], v[136:139], a[224:227], v[220:223]
 trr v[136:137], v188 offset:32768
 trr v[138:139], v189 offset:32768
 mf v[220:223], v[140:143], a[228:231], v[220:223]
 trr v[140:141], v188 offset:36864
 trr v[142:143], v189 offset:36864
 mf v[220:223], v[144:147], a[232:235], v[220:223]
 trr v[144:145], v188 offset:40960
 trr v[146:147], v189 offset:40960
 mf v[220:223], v[148:151], a[236:239], v[220:223]
 trr v[148:149], v188 offset:45056
 trr v[150:151], v189 offset:45056
 swc lgkmcnt(8)
 mf v[224:227], v[152:155], a[160:163], v[224:227]
 bl4 v193, s[48:51], s19 offen lds
 vmf v50, v50, v210
 vmf v51, v51, v210
 mf v[224:227], v[156:159], a[164:167], v[224:227]
 sad m0, s36, 83968
 sad s19, s89, 131200
 vmf v16, v16, v48
 mf v[224:227], v[160:163], a[168:171], v[224:227]
 bl4 v192, s[48:51], s19 offen lds
 vmf v17, v17, v49
 vmf v18, v18, v50
 mf v[224:227], v[164:167], a[172:175], v[224:227]
 sad m0, s36, 84992
 sad s19, s89, 196736
 vmf v19, v19, v51
 mf v[228:231], v[152:155], a[224:227], v[228:231]
 trr v[152:153], v190 offset:32768
 trr v[154:155], v191 offset:32768
 mf v[228:231], v[156:159], a[228:231], v[228:231]
 trr v[156:157], v190 offset:36864
 trr v[158:159], v191 offset:36864
 mf v[228:231], v[160:163], a[232:235], v[228:231]
 trr v[160:161], v190 offset:40960
 trr v[162:163], v191 offset:40960
 mf v[228:231], v[164:167], a[236:239], v[228:231]
 trr v[164:165], v190 offset:45056
 trr v[166:167], v191 offset:45056
 swc lgkmcnt(8)
 mf v[232:235], v[136:139], a[160:163], v[232:235]
 bl4 v193, s[48:51], s19 offen lds
 cvp v200, v16, v17
 cvp v201, v18, v19
 mf v[232:235], v[140:143], a[164:167], v[232:235]
 v_max_f32 v32, 0, v32
 v_max_f32 v33, 0, v33
 v_max_f32 v34, 0, v34
 mf v[232:235], v[144:147], a[168:171], v[232:235]
 v_max_f32 v35, 0, v35
 vmf v64, v64, v210
 vmf v65, v65, v210
 mf v[232:235], v[148:151], a[172:175], v[232:235]
 vmf v66, v66, v210
 vmf v67, v67, v210
 mf v[236:239], v[136:139], a[224:227], v[236:239]
 trr v[136:137], v184 offset:49152
 trr v[138:139], v185 offset:49152
 mf v[236:239], v[140:143], a[228:231], v[236:239]
 trr v[140:141], v184 offset:53248
 trr v[142:143], v185 offset:53248
 mf v[236:239], v[144:147], a[232:235], v[236:239]
 trr v[144:145], v184 offset:57344
 trr v[146:147], v185 offset:57344
 mf v[236:239], v[148:151], a[236:239], v[236:239]
 trr v[148:149], v184 offset:61440
 trr v[150:151], v185 offset:61440
 swc lgkmcnt(8)
 mf v[240:243], v[152:155], a[160:163], v[240:243]
 vmf v32, v32, v64
 vmf v33, v33, v65
 vmf v34, v34, v66
 mf v[240:243], v[156:159], a[164:167], v[240:243]
 vmf v35, v35, v67
 cvp v202, v32, v33
 cvp v203, v34, v35
 mf v[240:243], v[160:163], a[168:171], v[240:243]
 bs4 v[200:203], v198, s[12:15], s37 offen offset:0 sc1
 v_max_f32 v20, 0, v20
 mf v[240:243], v[164:167], a[172:175], v[240:243]
 v_max_f32 v21, 0, v21
 v_max_f32 v22, 0, v22
 v_max_f32 v23, 0, v23
 mf v[244:247], v[152:155], a[224:227], v[244:247]
 trr v[152:153], v186 offset:49152
 trr v[154:155], v187 offset:49152
 mf v[244:247], v[156:159], a[228:231], v[244:247]
 trr v[156:157], v186 offset:53248
 trr v[158:159], v187 offset:53248
 mf v[244:247], v[160:163], a[232:235], v[244:247]
 trr v[160:161], v186 offset:57344
 trr v[162:163], v187 offset:57344
 mf v[244:247], v[164:167], a[236:239], v[244:247]
 trr v[164:165], v186 offset:61440
 trr v[166:167], v187 offset:61440
 swc lgkmcnt(8)
 mf v[216:219], v[136:139], a[176:179], v[216:219]
 swc vmcnt(19)
 s_barrier
 s_cmp_lg_u32 s16, 0
 s_cbranch_scc1 K1_NS21
 s_mov_b64 exec, 1
 buffer_atomic_add v5, v4, s[80:83], 0 offen offset:0 sc1
 s_mov_b64 exec, -1
K1_NS21:
 mf v[216:219], v[140:143], a[180:183], v[216:219]
 sad m0, s36, 98304
 sad s19, s90, 128
 vmf v52, v52, v211
 mf v[216:219], v[144:147], a[184:187], v[216:219]
 bl4 v192, s[48:51], s19 offen lds
 vmf v53, v53, v211
 vmf v54, v54, v211
 mf v[216:219], v[148:151], a[188:191], v[216:219]
 sad m0, s36, 99328
 sad s19, s90, 65664
 vmf v55, v55, v211
 vmf v20, v20, v52
 mf v[220:223], v[136:139], a[240:243], v[220:223]
 trr v[136:137], v188 offset:49152
 trr v[138:139], v189 offset:49152
 mf v[220:223], v[140:143], a[244:247], v[220:223]
 trr v[140:141], v188 offset:53248
 trr v[142:143], v189 offset:53248
 mf v[220:223], v[144:147], a[248:251], v[220:223]
 trr v[144:145], v188 offset:57344
 trr v[146:147], v189 offset:57344
 mf v[220:223], v[148:151], a[252:255], v[220:223]
 trr v[148:149], v188 offset:61440
 trr v[150:151], v189 offset:61440
 swc lgkmcnt(8)
 mf v[224:227], v[152:155], a[176:179], v[224:227]
 bl4 v193, s[48:51], s19 offen lds
 vmf v21, v21, v53
 vmf v22, v22, v54
 mf v[224:227], v[156:159], a[180:183], v[224:227]
 sad m0, s36, 100352
 sad s19, s90, 131200
 vmf v23, v23, v55
 mf v[224:227], v[160:163], a[184:187], v[224:227]
 bl4 v192, s[48:51], s19 offen lds
 cvp v204, v20, v21
 cvp v205, v22, v23
 mf v[224:227], v[164:167], a[188:191], v[224:227]
 sad m0, s36, 101376
 sad s19, s90, 196736
 v_max_f32 v36, 0, v36
 mf v[228:231], v[152:155], a[240:243], v[228:231]
 trr v[152:153], v190 offset:49152
 trr v[154:155], v191 offset:49152
 mf v[228:231], v[156:159], a[244:247], v[228:231]
 trr v[156:157], v190 offset:53248
 trr v[158:159], v191 offset:53248
 mf v[228:231], v[160:163], a[248:251], v[228:231]
 trr v[160:161], v190 offset:57344
 trr v[162:163], v191 offset:57344
 mf v[228:231], v[164:167], a[252:255], v[228:231]
 trr v[164:165], v190 offset:61440
 trr v[166:167], v191 offset:61440
 swc lgkmcnt(8)
 mf v[232:235], v[136:139], a[176:179], v[232:235]
 bl4 v193, s[48:51], s19 offen lds
 v_max_f32 v37, 0, v37
 v_max_f32 v38, 0, v38
 mf v[232:235], v[140:143], a[180:183], v[232:235]
 v_max_f32 v39, 0, v39
 vmf v68, v68, v211
 vmf v69, v69, v211
 mf v[232:235], v[144:147], a[184:187], v[232:235]
 vmf v70, v70, v211
 vmf v71, v71, v211
 mf v[232:235], v[148:151], a[188:191], v[232:235]
 vmf v36, v36, v68
 vmf v37, v37, v69
 vmf v38, v38, v70
 mf v[236:239], v[136:139], a[240:243], v[236:239]
 trr v[136:137], v168 offset:0
 trr v[138:139], v169 offset:0
 mf v[236:239], v[140:143], a[244:247], v[236:239]
 trr v[140:141], v168 offset:4096
 trr v[142:143], v169 offset:4096
 mf v[236:239], v[144:147], a[248:251], v[236:239]
 trr v[144:145], v168 offset:8192
 trr v[146:147], v169 offset:8192
 mf v[236:239], v[148:151], a[252:255], v[236:239]
 trr v[148:149], v168 offset:12288
 trr v[150:151], v169 offset:12288
 swc lgkmcnt(8)
 mf v[240:243], v[152:155], a[176:179], v[240:243]
 vmf v39, v39, v71
 cvp v206, v36, v37
 cvp v207, v38, v39
 mf v[240:243], v[156:159], a[180:183], v[240:243]
 bs4 v[204:207], v199, s[12:15], s37 offen offset:0 sc1
 mf v[240:243], v[160:163], a[184:187], v[240:243]
 mf v[240:243], v[164:167], a[188:191], v[240:243]
 mf v[244:247], v[152:155], a[240:243], v[244:247]
 trr v[152:153], v170 offset:0
 trr v[154:155], v171 offset:0
 mf v[244:247], v[156:159], a[244:247], v[244:247]
 trr v[156:157], v170 offset:4096
 trr v[158:159], v171 offset:4096
 mf v[244:247], v[160:163], a[248:251], v[244:247]
 trr v[160:161], v170 offset:8192
 trr v[162:163], v171 offset:8192
 mf v[244:247], v[164:167], a[252:255], v[244:247]
 trr v[164:165], v170 offset:12288
 trr v[166:167], v171 offset:12288
K1_Q:
 mf v[72:75], v[136:139], a[0:3], 0
 swc vmcnt(26)
 s_barrier
 mf v[72:75], v[140:143], a[4:7], v[72:75]
 sad m0, s36, 114688
 sad s19, s91, 128
 mf v[72:75], v[144:147], a[8:11], v[72:75]
 mf v[72:75], v[148:151], a[12:15], v[72:75]
 mf v[76:79], v[136:139], a[64:67], 0
 bl4 v192, s[48:51], s19 offen lds
 mf v[76:79], v[140:143], a[68:71], v[76:79]
 mf v[76:79], v[144:147], a[72:75], v[76:79]
 s_lshr_b32 s20, s17, 1
 mf v[76:79], v[148:151], a[76:79], v[76:79]
 sad m0, s36, 115712
 sad s19, s91, 65664
 mf v[80:83], v[136:139], a[128:131], 0
 mf v[80:83], v[140:143], a[132:135], v[80:83]
 s_lshl_b32 s20, s20, 12
 mf v[80:83], v[144:147], a[136:139], v[80:83]
 bl4 v193, s[48:51], s19 offen lds
 mf v[80:83], v[148:151], a[140:143], v[80:83]
 swc lgkmcnt(0)
 mf v[84:87], v[136:139], a[192:195], 0
 trr v[136:137], v172 offset:0
 trr v[138:139], v173 offset:0
 mf v[84:87], v[140:143], a[196:199], v[84:87]
 trr v[140:141], v172 offset:4096
 trr v[142:143], v173 offset:4096
 mf v[84:87], v[144:147], a[200:203], v[84:87]
 trr v[144:145], v172 offset:8192
 trr v[146:147], v173 offset:8192
 mf v[84:87], v[148:151], a[204:207], v[84:87]
 trr v[148:149], v172 offset:12288
 trr v[150:151], v173 offset:12288
 mf v[88:91], v[152:155], a[0:3], 0
 sad s37, s20, 35258368
 mf v[88:91], v[156:159], a[4:7], v[88:91]
 mf v[88:91], v[160:163], a[8:11], v[88:91]
 sad m0, s36, 116736
 sad s19, s91, 131200
 mf v[88:91], v[164:167], a[12:15], v[88:91]
 mf v[92:95], v[152:155], a[64:67], 0
 s_cmp_lt_u32 s17, 22
 s_cselect_b32 s37, s37, 80740352
 mf v[92:95], v[156:159], a[68:71], v[92:95]
 bl4 v192, s[48:51], s19 offen lds
 mf v[92:95], v[160:163], a[72:75], v[92:95]
 mf v[92:95], v[164:167], a[76:79], v[92:95]
 v_max_f32 v216, 0, v216
 mf v[96:99], v[152:155], a[128:131], 0
 sad m0, s36, 117760
 sad s19, s91, 196736
 mf v[96:99], v[156:159], a[132:135], v[96:99]
 mf v[96:99], v[160:163], a[136:139], v[96:99]
 v_max_f32 v217, 0, v217
 mf v[96:99], v[164:167], a[140:143], v[96:99]
 swc lgkmcnt(0)
 mf v[100:103], v[152:155], a[192:195], 0
 trr v[152:153], v174 offset:0
 trr v[154:155], v175 offset:0
 mf v[100:103], v[156:159], a[196:199], v[100:103]
 trr v[156:157], v174 offset:4096
 trr v[158:159], v175 offset:4096
 mf v[100:103], v[160:163], a[200:203], v[100:103]
 trr v[160:161], v174 offset:8192
 trr v[162:163], v175 offset:8192
 mf v[100:103], v[164:167], a[204:207], v[100:103]
 trr v[164:165], v174 offset:12288
 trr v[166:167], v175 offset:12288
 mf v[104:107], v[136:139], a[0:3], 0
 bl4 v193, s[48:51], s19 offen lds
 mf v[104:107], v[140:143], a[4:7], v[104:107]
 mf v[104:107], v[144:147], a[8:11], v[104:107]
 v_max_f32 v218, 0, v218
 mf v[104:107], v[148:151], a[12:15], v[104:107]
 mf v[108:111], v[136:139], a[64:67], 0
 v_max_f32 v219, 0, v219
 mf v[108:111], v[140:143], a[68:71], v[108:111]
 mf v[108:111], v[144:147], a[72:75], v[108:111]
 mf v[108:111], v[148:151], a[76:79], v[108:111]
 vmf v232, v232, v251
 mf v[112:115], v[136:139], a[128:131], 0
 mf v[112:115], v[140:143], a[132:135], v[112:115]
 vmf v233, v233, v251
 mf v[112:115], v[144:147], a[136:139], v[112:115]
 mf v[112:115], v[148:151], a[140:143], v[112:115]
 swc lgkmcnt(0)
 mf v[116:119], v[136:139], a[192:195], 0
 trr v[136:137], v168 offset:16384
 trr v[138:139], v169 offset:16384
 mf v[116:119], v[140:143], a[196:199], v[116:119]
 trr v[140:141], v168 offset:20480
 trr v[142:143], v169 offset:20480
 mf v[116:119], v[144:147], a[200:203], v[116:119]
 trr v[144:145], v168 offset:24576
 trr v[146:147], v169 offset:24576
 mf v[116:119], v[148:151], a[204:207], v[116:119]
 trr v[148:149], v168 offset:28672
 trr v[150:151], v169 offset:28672
 mf v[120:123], v[152:155], a[0:3], 0
 vmf v234, v234, v251
 mf v[120:123], v[156:159], a[4:7], v[120:123]
 mf v[120:123], v[160:163], a[8:11], v[120:123]
 mf v[120:123], v[164:167], a[12:15], v[120:123]
 vmf v235, v235, v251
 mf v[124:127], v[152:155], a[64:67], 0
 mf v[124:127], v[156:159], a[68:71], v[124:127]
 vmf v216, v216, v232
 mf v[124:127], v[160:163], a[72:75], v[124:127]
 mf v[124:127], v[164:167], a[76:79], v[124:127]
 mf v[128:131], v[152:155], a[128:131], 0
 vmf v217, v217, v233
 mf v[128:131], v[156:159], a[132:135], v[128:131]
 mf v[128:131], v[160:163], a[136:139], v[128:131]
 vmf v218, v218, v234
 mf v[128:131], v[164:167], a[140:143], v[128:131]
 swc lgkmcnt(0)
 mf v[132:135], v[152:155], a[192:195], 0
 trr v[152:153], v170 offset:16384
 trr v[154:155], v171 offset:16384
 mf v[132:135], v[156:159], a[196:199], v[132:135]
 trr v[156:157], v170 offset:20480
 trr v[158:159], v171 offset:20480
 mf v[132:135], v[160:163], a[200:203], v[132:135]
 trr v[160:161], v170 offset:24576
 trr v[162:163], v171 offset:24576
 mf v[132:135], v[164:167], a[204:207], v[132:135]
 trr v[164:165], v170 offset:28672
 trr v[166:167], v171 offset:28672
 mf v[72:75], v[136:139], a[16:19], v[72:75]
 swc vmcnt(24)
 s_barrier
 mf v[72:75], v[140:143], a[20:23], v[72:75]
 s_mov_b32 s11, 0x00020000
 s_lshl_b32 s20, s18, 16
 s_sub_u32 s10, 0x108000, s20
 mf v[72:75], v[144:147], a[24:27], v[72:75]
 mf v[72:75], v[148:151], a[28:31], v[72:75]
 vmf v219, v219, v235
 mf v[76:79], v[136:139], a[80:83], v[76:79]
 s_lshl_b32 s20, s17, 20
 sad s20, s20, 1015808
 sad s8, s40, s20
 s_addc_u32 s9, s41, 0
 mf v[76:79], v[140:143], a[84:87], v[76:79]
 mf v[76:79], v[144:147], a[88:91], v[76:79]
 mf v[76:79], v[148:151], a[92:95], v[76:79]
 s_mov_b32 s24, 0x4e800000
 s_mov_b32 s25, 0xff800000
 mf v[80:83], v[136:139], a[144:147], v[80:83]
 cvp v200, v216, v217
 mf v[80:83], v[140:143], a[148:151], v[80:83]
 mf v[80:83], v[144:147], a[152:155], v[80:83]
 s_lshl_b32 s20, s16, 12
 v_lshlrev_b32 v7, 4, v248
 v_add_u32 v7, s20, v7
 mf v[80:83], v[148:151], a[156:159], v[80:83]
 swc lgkmcnt(0)
 mf v[84:87], v[136:139], a[208:211], v[84:87]
 trr v[136:137], v172 offset:16384
 trr v[138:139], v173 offset:16384
 mf v[84:87], v[140:143], a[212:215], v[84:87]
 trr v[140:141], v172 offset:20480
 trr v[142:143], v173 offset:20480
 mf v[84:87], v[144:147], a[216:219], v[84:87]
 trr v[144:145], v172 offset:24576
 trr v[146:147], v173 offset:24576
 mf v[84:87], v[148:151], a[220:223], v[84:87]
 trr v[148:149], v172 offset:28672
 trr v[150:151], v173 offset:28672
 mf v[88:91], v[152:155], a[16:19], v[88:91]
 cvp v201, v218, v219
 mf v[88:91], v[156:159], a[20:23], v[88:91]
 mf v[88:91], v[160:163], a[24:27], v[88:91]
 s_and_b32 s20, s16, 1
 s_lshl_b32 s22, s20, 12
 s_lshr_b32 s20, s16, 1
 s_lshl_b32 s3, s20, 16
 sad s22, s22, s3
 s_lshl_b32 s20, s20, 15
 s_sub_u32 s21, 0x8000, s20
 mf v[88:91], v[164:167], a[28:31], v[88:91]
 v_max_f32 v224, 0, v224
 mf v[92:95], v[152:155], a[80:83], v[92:95]
 mf v[92:95], v[156:159], a[84:87], v[92:95]
 v_mov_b32 v6, 0x20000
 v_mov_b32 v1, 0
 ds_write_b32 v6, v1
 mf v[92:95], v[160:163], a[88:91], v[92:95]
 mf v[92:95], v[164:167], a[92:95], v[92:95]
 v_max_f32 v225, 0, v225
 mf v[96:99], v[152:155], a[144:147], v[96:99]
 v_and_b32 v2, 15, v248
 v_lshrrev_b32 v3, 4, v248
 v_lshlrev_b32 v3, 2, v3
 v_sub_u32 v2, v2, v3
 mf v[96:99], v[156:159], a[148:151], v[96:99]
 mf v[96:99], v[160:163], a[152:155], v[96:99]
 v_max_f32 v226, 0, v226
 mf v[96:99], v[164:167], a[156:159], v[96:99]
 swc lgkmcnt(0)
 mf v[100:103], v[152:155], a[208:211], v[100:103]
 trr v[152:153], v174 offset:16384
 trr v[154:155], v175 offset:16384
 mf v[100:103], v[156:159], a[212:215], v[100:103]
 trr v[156:157], v174 offset:20480
 trr v[158:159], v175 offset:20480
 mf v[100:103], v[160:163], a[216:219], v[100:103]
 trr v[160:161], v174 offset:24576
 trr v[162:163], v175 offset:24576
 mf v[100:103], v[164:167], a[220:223], v[100:103]
 trr v[164:165], v174 offset:28672
 trr v[166:167], v175 offset:28672
 mf v[104:107], v[136:139], a[16:19], v[104:107]
 v_cmp_le_i32 s[26:27], 0, v2
 mf v[104:107], v[140:143], a[20:23], v[104:107]
 v_max_f32 v227, 0, v227
 mf v[104:107], v[144:147], a[24:27], v[104:107]
 mf v[104:107], v[148:151], a[28:31], v[104:107]
 v_cmp_le_i32 s[28:29], 1, v2
 mf v[108:111], v[136:139], a[80:83], v[108:111]
 vmf v240, v240, v251
 mf v[108:111], v[140:143], a[84:87], v[108:111]
 mf v[108:111], v[144:147], a[88:91], v[108:111]
 v_cmp_le_i32 s[30:31], 2, v2
 mf v[108:111], v[148:151], a[92:95], v[108:111]
 vmf v241, v241, v251
 mf v[112:115], v[136:139], a[144:147], v[112:115]
 mf v[112:115], v[140:143], a[148:151], v[112:115]
 v_cmp_le_i32 s[32:33], 3, v2
 mf v[112:115], v[144:147], a[152:155], v[112:115]
 vmf v242, v242, v251
 mf v[112:115], v[148:151], a[156:159], v[112:115]
 swc lgkmcnt(0)
 mf v[116:119], v[136:139], a[208:211], v[116:119]
 trr v[136:137], v168 offset:32768
 trr v[138:139], v169 offset:32768
 mf v[116:119], v[140:143], a[212:215], v[116:119]
 trr v[140:141], v168 offset:36864
 trr v[142:143], v169 offset:36864
 mf v[116:119], v[144:147], a[216:219], v[116:119]
 trr v[144:145], v168 offset:40960
 trr v[146:147], v169 offset:40960
 mf v[116:119], v[148:151], a[220:223], v[116:119]
 trr v[148:149], v168 offset:45056
 trr v[150:151], v169 offset:45056
 mf v[120:123], v[152:155], a[16:19], v[120:123]
 mf v[120:123], v[156:159], a[20:23], v[120:123]
 vmf v243, v243, v251
 mf v[120:123], v[160:163], a[24:27], v[120:123]
 mf v[120:123], v[164:167], a[28:31], v[120:123]
 mf v[124:127], v[152:155], a[80:83], v[124:127]
 vmf v224, v224, v240
 mf v[124:127], v[156:159], a[84:87], v[124:127]
 mf v[124:127], v[160:163], a[88:91], v[124:127]
 vmf v225, v225, v241
 mf v[124:127], v[164:167], a[92:95], v[124:127]
 mf v[128:131], v[152:155], a[144:147], v[128:131]
 mf v[128:131], v[156:159], a[148:151], v[128:131]
 vmf v226, v226, v242
 mf v[128:131], v[160:163], a[152:155], v[128:131]
 mf v[128:131], v[164:167], a[156:159], v[128:131]
 swc lgkmcnt(0)
 mf v[132:135], v[152:155], a[208:211], v[132:135]
 trr v[152:153], v170 offset:32768
 trr v[154:155], v171 offset:32768
 mf v[132:135], v[156:159], a[212:215], v[132:135]
 trr v[156:157], v170 offset:36864
 trr v[158:159], v171 offset:36864
 mf v[132:135], v[160:163], a[216:219], v[132:135]
 trr v[160:161], v170 offset:40960
 trr v[162:163], v171 offset:40960
 mf v[132:135], v[164:167], a[220:223], v[132:135]
 trr v[164:165], v170 offset:45056
 trr v[166:167], v171 offset:45056
 mf v[72:75], v[136:139], a[32:35], v[72:75]
 swc vmcnt(20)
 s_barrier
 mf v[72:75], v[140:143], a[36:39], v[72:75]
 vmf v227, v227, v243
 mf v[72:75], v[144:147], a[40:43], v[72:75]
 mf v[72:75], v[148:151], a[44:47], v[72:75]
 cvp v202, v224, v225
 mf v[76:79], v[136:139], a[96:99], v[76:79]
 mf v[76:79], v[140:143], a[100:103], v[76:79]
 mf v[76:79], v[144:147], a[104:107], v[76:79]
 cvp v203, v226, v227
 mf v[76:79], v[148:151], a[108:111], v[76:79]
 mf v[80:83], v[136:139], a[160:163], v[80:83]
 bs4 v[200:203], v249, s[12:15], s37 offen offset:0 sc1
 mf v[80:83], v[140:143], a[164:167], v[80:83]
 mf v[80:83], v[144:147], a[168:171], v[80:83]
 mf v[80:83], v[148:151], a[172:175], v[80:83]
 swc lgkmcnt(0)
 v_max_f32 v220, 0, v220
 mf v[84:87], v[136:139], a[224:227], v[84:87]
 trr v[136:137], v172 offset:32768
 trr v[138:139], v173 offset:32768
 mf v[84:87], v[140:143], a[228:231], v[84:87]
 trr v[140:141], v172 offset:36864
 trr v[142:143], v173 offset:36864
 mf v[84:87], v[144:147], a[232:235], v[84:87]
 trr v[144:145], v172 offset:40960
 trr v[146:147], v173 offset:40960
 mf v[84:87], v[148:151], a[236:239], v[84:87]
 trr v[148:149], v172 offset:45056
 trr v[150:151], v173 offset:45056
 mf v[88:91], v[152:155], a[32:35], v[88:91]
 mf v[88:91], v[156:159], a[36:39], v[88:91]
 mf v[88:91], v[160:163], a[40:43], v[88:91]
 v_max_f32 v221, 0, v221
 mf v[88:91], v[164:167], a[44:47], v[88:91]
 mf v[92:95], v[152:155], a[96:99], v[92:95]
 v_max_f32 v222, 0, v222
 mf v[92:95], v[156:159], a[100:103], v[92:95]
 mf v[92:95], v[160:163], a[104:107], v[92:95]
 mf v[92:95], v[164:167], a[108:111], v[92:95]
 v_max_f32 v223, 0, v223
 mf v[96:99], v[152:155], a[160:163], v[96:99]
 mf v[96:99], v[156:159], a[164:167], v[96:99]
 vmf v236, v236, v252
 mf v[96:99], v[160:163], a[168:171], v[96:99]
 mf v[96:99], v[164:167], a[172:175], v[96:99]
 swc lgkmcnt(0)
 mf v[100:103], v[152:155], a[224:227], v[100:103]
 trr v[152:153], v174 offset:32768
 trr v[154:155], v175 offset:32768
 mf v[100:103], v[156:159], a[228:231], v[100:103]
 trr v[156:157], v174 offset:36864
 trr v[158:159], v175 offset:36864
 mf v[100:103], v[160:163], a[232:235], v[100:103]
 trr v[160:161], v174 offset:40960
 trr v[162:163], v175 offset:40960
 mf v[100:103], v[164:167], a[236:239], v[100:103]
 trr v[164:165], v174 offset:45056
 trr v[166:167], v175 offset:45056
 mf v[104:107], v[136:139], a[32:35], v[104:107]
 vmf v237, v237, v252
 mf v[104:107], v[140:143], a[36:39], v[104:107]
 mf v[104:107], v[144:147], a[40:43], v[104:107]
 mf v[104:107], v[148:151], a[44:47], v[104:107]
 vmf v238, v238, v252
 mf v[108:111], v[136:139], a[96:99], v[108:111]
 mf v[108:111], v[140:143], a[100:103], v[108:111]
 vmf v239, v239, v252
 mf v[108:111], v[144:147], a[104:107], v[108:111]
 mf v[108:111], v[148:151], a[108:111], v[108:111]
 vmf v220, v220, v236
 mf v[112:115], v[136:139], a[160:163], v[112:115]
 mf v[112:115], v[140:143], a[164:167], v[112:115]
 mf v[112:115], v[144:147], a[168:171], v[112:115]
 vmf v221, v221, v237
 mf v[112:115], v[148:151], a[172:175], v[112:115]
 swc lgkmcnt(0)
 mf v[116:119], v[136:139], a[224:227], v[116:119]
 trr v[136:137], v168 offset:49152
 trr v[138:139], v169 offset:49152
 mf v[116:119], v[140:143], a[228:231], v[116:119]
 trr v[140:141], v168 offset:53248
 trr v[142:143], v169 offset:53248
 mf v[116:119], v[144:147], a[232:235], v[116:119]
 trr v[144:145], v168 offset:57344
 trr v[146:147], v169 offset:57344
 mf v[116:119], v[148:151], a[236:239], v[116:119]
 trr v[148:149], v168 offset:61440
 trr v[150:151], v169 offset:61440
 mf v[120:123], v[152:155], a[32:35], v[120:123]
 mf v[120:123], v[156:159], a[36:39], v[120:123]
 vmf v222, v222, v238
 mf v[120:123], v[160:163], a[40:43], v[120:123]
 mf v[120:123], v[164:167], a[44:47], v[120:123]
 vmf v223, v223, v239
 mf v[124:127], v[152:155], a[96:99], v[124:127]
 mf v[124:127], v[156:159], a[100:103], v[124:127]
 mf v[124:127], v[160:163], a[104:107], v[124:127]
 cvp v204, v220, v221
 mf v[124:127], v[164:167], a[108:111], v[124:127]
 mf v[128:131], v[152:155], a[160:163], v[128:131]
 cvp v205, v222, v223
 mf v[128:131], v[156:159], a[164:167], v[128:131]
 mf v[128:131], v[160:163], a[168:171], v[128:131]
 mf v[128:131], v[164:167], a[172:175], v[128:131]
 swc lgkmcnt(0)
 v_max_f32 v228, 0, v228
 mf v[132:135], v[152:155], a[224:227], v[132:135]
 trr v[152:153], v170 offset:49152
 trr v[154:155], v171 offset:49152
 mf v[132:135], v[156:159], a[228:231], v[132:135]
 trr v[156:157], v170 offset:53248
 trr v[158:159], v171 offset:53248
 mf v[132:135], v[160:163], a[232:235], v[132:135]
 trr v[160:161], v170 offset:57344
 trr v[162:163], v171 offset:57344
 mf v[132:135], v[164:167], a[236:239], v[132:135]
 trr v[164:165], v170 offset:61440
 trr v[166:167], v171 offset:61440
 mf v[72:75], v[136:139], a[48:51], v[72:75]
 swc vmcnt(16)
 s_barrier
 mf v[72:75], v[140:143], a[52:55], v[72:75]
 mf v[72:75], v[144:147], a[56:59], v[72:75]
 mf v[72:75], v[148:151], a[60:63], v[72:75]
 v_max_f32 v229, 0, v229
 mf v[76:79], v[136:139], a[112:115], v[76:79]
 mf v[76:79], v[140:143], a[116:119], v[76:79]
 v_max_f32 v230, 0, v230
 mf v[76:79], v[144:147], a[120:123], v[76:79]
 mf v[76:79], v[148:151], a[124:127], v[76:79]
 mf v[80:83], v[136:139], a[176:179], v[80:83]
 v_max_f32 v231, 0, v231
 mf v[80:83], v[140:143], a[180:183], v[80:83]
 mf v[80:83], v[144:147], a[184:187], v[80:83]
 vmf v244, v244, v252
 mf v[80:83], v[148:151], a[188:191], v[80:83]
 swc lgkmcnt(0)
 mf v[84:87], v[136:139], a[240:243], v[84:87]
 trr v[136:137], v172 offset:49152
 trr v[138:139], v173 offset:49152
 mf v[84:87], v[140:143], a[244:247], v[84:87]
 trr v[140:141], v172 offset:53248
 trr v[142:143], v173 offset:53248
 mf v[84:87], v[144:147], a[248:251], v[84:87]
 trr v[144:145], v172 offset:57344
 trr v[146:147], v173 offset:57344
 mf v[84:87], v[148:151], a[252:255], v[84:87]
 trr v[148:149], v172 offset:61440
 trr v[150:151], v173 offset:61440
 mf v[88:91], v[152:155], a[48:51], v[88:91]
 mf v[88:91], v[156:159], a[52:55], v[88:91]
 vmf v245, v245, v252
 mf v[88:91], v[160:163], a[56:59], v[88:91]
 mf v[88:91], v[164:167], a[60:63], v[88:91]
 mf v[92:95], v[152:155], a[112:115], v[92:95]
 vmf v246, v246, v252
 mf v[92:95], v[156:159], a[116:119], v[92:95]
 mf v[92:95], v[160:163], a[120:123], v[92:95]
 vmf v247, v247, v252
 mf v[92:95], v[164:167], a[124:127], v[92:95]
 mf v[96:99], v[152:155], a[176:179], v[96:99]
 mf v[96:99], v[156:159], a[180:183], v[96:99]
 vmf v228, v228, v244
 mf v[96:99], v[160:163], a[184:187], v[96:99]
 mf v[96:99], v[164:167], a[188:191], v[96:99]
 swc lgkmcnt(0)
 mf v[100:103], v[152:155], a[240:243], v[100:103]
 trr v[152:153], v174 offset:49152
 trr v[154:155], v175 offset:49152
 mf v[100:103], v[156:159], a[244:247], v[100:103]
 trr v[156:157], v174 offset:53248
 trr v[158:159], v175 offset:53248
 mf v[100:103], v[160:163], a[248:251], v[100:103]
 trr v[160:161], v174 offset:57344
 trr v[162:163], v175 offset:57344
 mf v[100:103], v[164:167], a[252:255], v[100:103]
 trr v[164:165], v174 offset:61440
 trr v[166:167], v175 offset:61440
 mf v[104:107], v[136:139], a[48:51], v[104:107]
 vmf v229, v229, v245
 mf v[104:107], v[140:143], a[52:55], v[104:107]
 mf v[104:107], v[144:147], a[56:59], v[104:107]
 vmf v230, v230, v246
 mf v[104:107], v[148:151], a[60:63], v[104:107]
 mf v[108:111], v[136:139], a[112:115], v[108:111]
 mf v[108:111], v[140:143], a[116:119], v[108:111]
 vmf v231, v231, v247
 mf v[108:111], v[144:147], a[120:123], v[108:111]
 mf v[108:111], v[148:151], a[124:127], v[108:111]
 cvp v206, v228, v229
 mf v[112:115], v[136:139], a[176:179], v[112:115]
 mf v[112:115], v[140:143], a[180:183], v[112:115]
 cvp v207, v230, v231
 mf v[112:115], v[144:147], a[184:187], v[112:115]
 mf v[112:115], v[148:151], a[188:191], v[112:115]
 swc lgkmcnt(0)
 mf v[116:119], v[136:139], a[240:243], v[116:119]
 trr v[136:137], v176 offset:0
 trr v[138:139], v177 offset:0
 mf v[116:119], v[140:143], a[244:247], v[116:119]
 trr v[140:141], v176 offset:4096
 trr v[142:143], v177 offset:4096
 mf v[116:119], v[144:147], a[248:251], v[116:119]
 trr v[144:145], v176 offset:8192
 trr v[146:147], v177 offset:8192
 mf v[116:119], v[148:151], a[252:255], v[116:119]
 trr v[148:149], v176 offset:12288
 trr v[150:151], v177 offset:12288
 mf v[120:123], v[152:155], a[48:51], v[120:123]
 bs4 v[204:207], v250, s[12:15], s37 offen offset:0 sc1
 mf v[120:123], v[156:159], a[52:55], v[120:123]
 mf v[120:123], v[160:163], a[56:59], v[120:123]
 mf v[120:123], v[164:167], a[60:63], v[120:123]
 mf v[124:127], v[152:155], a[112:115], v[124:127]
 mf v[124:127], v[156:159], a[116:119], v[124:127]
 mf v[124:127], v[160:163], a[120:123], v[124:127]
 mf v[124:127], v[164:167], a[124:127], v[124:127]
 mf v[128:131], v[152:155], a[176:179], v[128:131]
 mf v[128:131], v[156:159], a[180:183], v[128:131]
 mf v[128:131], v[160:163], a[184:187], v[128:131]
 mf v[128:131], v[164:167], a[188:191], v[128:131]
 swc lgkmcnt(0)
 mf v[132:135], v[152:155], a[240:243], v[132:135]
 trr v[152:153], v178 offset:0
 trr v[154:155], v179 offset:0
 mf v[132:135], v[156:159], a[244:247], v[132:135]
 trr v[156:157], v178 offset:4096
 trr v[158:159], v179 offset:4096
 mf v[132:135], v[160:163], a[248:251], v[132:135]
 trr v[160:161], v178 offset:8192
 trr v[162:163], v179 offset:8192
 mf v[132:135], v[164:167], a[252:255], v[132:135]
 trr v[164:165], v178 offset:12288
 trr v[166:167], v179 offset:12288
 mf v[8:11], v[136:139], a[0:3], 0
 swc vmcnt(12)
 s_barrier
 mf v[8:11], v[140:143], a[4:7], v[8:11]
 buffer_load_dword v254, v253, s[80:83], 0 offen sc1
 mf v[8:11], v[144:147], a[8:11], v[8:11]
 mf v[8:11], v[148:151], a[12:15], v[8:11]
 mf v[12:15], v[136:139], a[64:67], 0
 s_lshl_b32 s20, s18, 1
 s_mul_i32 s38, s20, 700416
 s_sub_u32 s20, 30, s20
 s_mul_i32 s37, s20, 700416
 mf v[12:15], v[140:143], a[68:71], v[12:15]
 mf v[12:15], v[144:147], a[72:75], v[12:15]
 vmf v72, v72, v212
 mf v[12:15], v[148:151], a[76:79], v[12:15]
 s_lshl_b32 s19, s17, 14
 s_lshl_b32 s20, s16, 10
 sad s19, s19, s20
 sad s19, s19, 34603008
 sad s38, s38, s19
 sad s37, s37, s19
 mf v[16:19], v[136:139], a[128:131], 0
 vmf v73, v73, v212
 mf v[16:19], v[140:143], a[132:135], v[16:19]
 mf v[16:19], v[144:147], a[136:139], v[16:19]
 s_lshl_b32 s20, s16, 11
 s_sub_u32 s85, 703488, s20
 mf v[16:19], v[148:151], a[140:143], v[16:19]
 swc lgkmcnt(0)
 vmf v74, v74, v212
 mf v[20:23], v[136:139], a[192:195], 0
 trr v[136:137], v180 offset:0
 trr v[138:139], v181 offset:0
 mf v[20:23], v[140:143], a[196:199], v[20:23]
 trr v[140:141], v180 offset:4096
 trr v[142:143], v181 offset:4096
 mf v[20:23], v[144:147], a[200:203], v[20:23]
 trr v[144:145], v180 offset:8192
 trr v[146:147], v181 offset:8192
 mf v[20:23], v[148:151], a[204:207], v[20:23]
 trr v[148:149], v180 offset:12288
 trr v[150:151], v181 offset:12288
 mf v[24:27], v[152:155], a[0:3], 0
 mf v[24:27], v[156:159], a[4:7], v[24:27]
 vmf v75, v75, v212
 mf v[24:27], v[160:163], a[8:11], v[24:27]
 cvp v216, v72, v73
 mf v[24:27], v[164:167], a[12:15], v[24:27]
 mf v[28:31], v[152:155], a[64:67], 0
 cvp v217, v74, v75
 mf v[28:31], v[156:159], a[68:71], v[28:31]
 mf v[28:31], v[160:163], a[72:75], v[28:31]
 vmf v88, v88, v212
 mf v[28:31], v[164:167], a[76:79], v[28:31]
 vmf v89, v89, v212
 mf v[32:35], v[152:155], a[128:131], 0
 mf v[32:35], v[156:159], a[132:135], v[32:35]
 vmf v90, v90, v212
 mf v[32:35], v[160:163], a[136:139], v[32:35]
 vmf v91, v91, v212
 mf v[32:35], v[164:167], a[140:143], v[32:35]
 swc lgkmcnt(0)
 mf v[36:39], v[152:155], a[192:195], 0
 trr v[152:153], v182 offset:0
 trr v[154:155], v183 offset:0
 mf v[36:39], v[156:159], a[196:199], v[36:39]
 trr v[156:157], v182 offset:4096
 trr v[158:159], v183 offset:4096
 mf v[36:39], v[160:163], a[200:203], v[36:39]
 trr v[160:161], v182 offset:8192
 trr v[162:163], v183 offset:8192
 mf v[36:39], v[164:167], a[204:207], v[36:39]
 trr v[164:165], v182 offset:12288
 trr v[166:167], v183 offset:12288
 mf v[40:43], v[136:139], a[0:3], 0
 cvp v218, v88, v89
 mf v[40:43], v[140:143], a[4:7], v[40:43]
 mf v[40:43], v[144:147], a[8:11], v[40:43]
 cvp v219, v90, v91
 mf v[40:43], v[148:151], a[12:15], v[40:43]
 mf v[44:47], v[136:139], a[64:67], 0
 vmf v76, v76, v213
 mf v[44:47], v[140:143], a[68:71], v[44:47]
 vmf v77, v77, v213
 mf v[44:47], v[144:147], a[72:75], v[44:47]
 mf v[44:47], v[148:151], a[76:79], v[44:47]
 vmf v78, v78, v213
 mf v[48:51], v[136:139], a[128:131], 0
 vmf v79, v79, v213
 mf v[48:51], v[140:143], a[132:135], v[48:51]
 mf v[48:51], v[144:147], a[136:139], v[48:51]
 cvp v220, v76, v77
 mf v[48:51], v[148:151], a[140:143], v[48:51]
 swc lgkmcnt(0)
 mf v[52:55], v[136:139], a[192:195], 0
 trr v[136:137], v176 offset:16384
 trr v[138:139], v177 offset:16384
 mf v[52:55], v[140:143], a[196:199], v[52:55]
 trr v[140:141], v176 offset:20480
 trr v[142:143], v177 offset:20480
 mf v[52:55], v[144:147], a[200:203], v[52:55]
 trr v[144:145], v176 offset:24576
 trr v[146:147], v177 offset:24576
 mf v[52:55], v[148:151], a[204:207], v[52:55]
 trr v[148:149], v176 offset:28672
 trr v[150:151], v177 offset:28672
 mf v[56:59], v[152:155], a[0:3], 0
 cvp v221, v78, v79
 mf v[56:59], v[156:159], a[4:7], v[56:59]
 mf v[56:59], v[160:163], a[8:11], v[56:59]
 vmf v92, v92, v213
 mf v[56:59], v[164:167], a[12:15], v[56:59]
 vmf v93, v93, v213
 mf v[60:63], v[152:155], a[64:67], 0
 mf v[60:63], v[156:159], a[68:71], v[60:63]
 vmf v94, v94, v213
 mf v[60:63], v[160:163], a[72:75], v[60:63]
 vmf v95, v95, v213
 mf v[60:63], v[164:167], a[76:79], v[60:63]
 mf v[64:67], v[152:155], a[128:131], 0
 cvp v222, v92, v93
 mf v[64:67], v[156:159], a[132:135], v[64:67]
 cvp v223, v94, v95
 mf v[64:67], v[160:163], a[136:139], v[64:67]
 mf v[64:67], v[164:167], a[140:143], v[64:67]
 swc lgkmcnt(0)
 mf v[68:71], v[152:155], a[192:195], 0
 trr v[152:153], v178 offset:16384
 trr v[154:155], v179 offset:16384
 mf v[68:71], v[156:159], a[196:199], v[68:71]
 trr v[156:157], v178 offset:20480
 trr v[158:159], v179 offset:20480
 mf v[68:71], v[160:163], a[200:203], v[68:71]
 trr v[160:161], v178 offset:24576
 trr v[162:163], v179 offset:24576
 mf v[68:71], v[164:167], a[204:207], v[68:71]
 trr v[164:165], v178 offset:28672
 trr v[166:167], v179 offset:28672
 mf v[8:11], v[136:139], a[16:19], v[8:11]
 swc vmcnt(8)
 s_barrier
 mf v[8:11], v[140:143], a[20:23], v[8:11]
 swc vmcnt(0)
 v_cmp_ne_u32 vcc, 16, v254
 mf v[8:11], v[144:147], a[24:27], v[8:11]
 vmf v80, v80, v214
 mf v[8:11], v[148:151], a[28:31], v[8:11]
 vmf v81, v81, v214
 mf v[12:15], v[136:139], a[80:83], v[12:15]
 s_nop 0
 mf v[12:15], v[140:143], a[84:87], v[12:15]
 vmf v82, v82, v214
 mf v[12:15], v[144:147], a[88:91], v[12:15]
 mf v[12:15], v[148:151], a[92:95], v[12:15]
 s_cmp_eq_u64 vcc, 0
 s_cselect_b32 s86, 1, 0
 v_mov_b32 v1, s86
 s_cmp_lg_u32 s16, 0
 s_cbranch_scc1 K2_NOMB
 ds_write_b32 v6, v1
K2_NOMB:
 mf v[16:19], v[136:139], a[144:147], v[16:19]
 vmf v83, v83, v214
 mf v[16:19], v[140:143], a[148:151], v[16:19]
 cvp v224, v80, v81
 mf v[16:19], v[144:147], a[152:155], v[16:19]
 s_cmp_eq_u32 s86, 0
 s_cbranch_scc1 K2_NR_1
 s_cmp_ge_u32 s16, 2
 s_cbranch_scc1 K2_KS_2
 sad m0, s22, 0
 s_nop 0
 bl4 v7, s[8:11], s21 offen offset:0 sc1 lds
 bl4 v7, s[8:11], s21 offen offset:1024 sc1 lds
 bl4 v7, s[8:11], s21 offen offset:2048 sc1 lds
 bl4 v7, s[8:11], s21 offen offset:3072 sc1 lds
K2_KS_2:
 sad s21, s21, 16384
K2_NR_1:
 mf v[16:19], v[148:151], a[156:159], v[16:19]
 swc lgkmcnt(0)
 mf v[20:23], v[136:139], a[208:211], v[20:23]
 trr v[136:137], v180 offset:16384
 trr v[138:139], v181 offset:16384
 mf v[20:23], v[140:143], a[212:215], v[20:23]
 trr v[140:141], v180 offset:20480
 trr v[142:143], v181 offset:20480
 mf v[20:23], v[144:147], a[216:219], v[20:23]
 trr v[144:145], v180 offset:24576
 trr v[146:147], v181 offset:24576
 mf v[20:23], v[148:151], a[220:223], v[20:23]
 trr v[148:149], v180 offset:28672
 trr v[150:151], v181 offset:28672
 mf v[24:27], v[152:155], a[16:19], v[24:27]
 mf v[24:27], v[156:159], a[20:23], v[24:27]
 cvp v225, v82, v83
 mf v[24:27], v[160:163], a[24:27], v[24:27]
 s_cmp_eq_u32 s86, 0
 s_cbranch_scc1 K2_NR_3
 s_cmp_ge_u32 s16, 2
 s_cbranch_scc1 K2_KS_4
 sad m0, s22, 8192
 s_nop 0
 bl4 v7, s[8:11], s21 offen offset:0 sc1 lds
 bl4 v7, s[8:11], s21 offen offset:1024 sc1 lds
 bl4 v7, s[8:11], s21 offen offset:2048 sc1 lds
 bl4 v7, s[8:11], s21 offen offset:3072 sc1 lds
K2_KS_4:
 sad s21, s21, 16384
K2_NR_3:
 mf v[24:27], v[164:167], a[28:31], v[24:27]
 vmf v96, v96, v214
 mf v[28:31], v[152:155], a[80:83], v[28:31]
 mf v[28:31], v[156:159], a[84:87], v[28:31]
 vmf v97, v97, v214
 mf v[28:31], v[160:163], a[88:91], v[28:31]
 vmf v98, v98, v214
 mf v[28:31], v[164:167], a[92:95], v[28:31]
 mf v[32:35], v[152:155], a[144:147], v[32:35]
 vmf v99, v99, v214
 mf v[32:35], v[156:159], a[148:151], v[32:35]
 cvp v226, v96, v97
 mf v[32:35], v[160:163], a[152:155], v[32:35]
 mf v[32:35], v[164:167], a[156:159], v[32:35]
 swc lgkmcnt(0)
 mf v[36:39], v[152:155], a[208:211], v[36:39]
 trr v[152:153], v182 offset:16384
 trr v[154:155], v183 offset:16384
 mf v[36:39], v[156:159], a[212:215], v[36:39]
 trr v[156:157], v182 offset:20480
 trr v[158:159], v183 offset:20480
 mf v[36:39], v[160:163], a[216:219], v[36:39]
 trr v[160:161], v182 offset:24576
 trr v[162:163], v183 offset:24576
 mf v[36:39], v[164:167], a[220:223], v[36:39]
 trr v[164:165], v182 offset:28672
 trr v[166:167], v183 offset:28672
 mf v[40:43], v[136:139], a[16:19], v[40:43]
 cvp v227, v98, v99
 mf v[40:43], v[140:143], a[20:23], v[40:43]
 vmf v84, v84, v215
 mf v[40:43], v[144:147], a[24:27], v[40:43]
 mf v[40:43], v[148:151], a[28:31], v[40:43]
 vmf v85, v85, v215
 mf v[44:47], v[136:139], a[80:83], v[44:47]
 vmf v86, v86, v215
 mf v[44:47], v[140:143], a[84:87], v[44:47]
 mf v[44:47], v[144:147], a[88:91], v[44:47]
 vmf v87, v87, v215
 mf v[44:47], v[148:151], a[92:95], v[44:47]
 cvp v228, v84, v85
 mf v[48:51], v[136:139], a[144:147], v[48:51]
 mf v[48:51], v[140:143], a[148:151], v[48:51]
 cvp v229, v86, v87
 mf v[48:51], v[144:147], a[152:155], v[48:51]
 mf v[48:51], v[148:151], a[156:159], v[48:51]
 swc lgkmcnt(0)
 vmf v100, v100, v215
 mf v[52:55], v[136:139], a[208:211], v[52:55]
 trr v[136:137], v176 offset:32768
 trr v[138:139], v177 offset:32768
 mf v[52:55], v[140:143], a[212:215], v[52:55]
 trr v[140:141], v176 offset:36864
 trr v[142:143], v177 offset:36864
 mf v[52:55], v[144:147], a[216:219], v[52:55]
 trr v[144:145], v176 offset:40960
 trr v[146:147], v177 offset:40960
 mf v[52:55], v[148:151], a[220:223], v[52:55]
 trr v[148:149], v176 offset:45056
 trr v[150:151], v177 offset:45056
 mf v[56:59], v[152:155], a[16:19], v[56:59]
 mf v[56:59], v[156:159], a[20:23], v[56:59]
 vmf v101, v101, v215
 mf v[56:59], v[160:163], a[24:27], v[56:59]
 vmf v102, v102, v215
 mf v[56:59], v[164:167], a[28:31], v[56:59]
 mf v[60:63], v[152:155], a[80:83], v[60:63]
 vmf v103, v103, v215
 mf v[60:63], v[156:159], a[84:87], v[60:63]
 cvp v230, v100, v101
 mf v[60:63], v[160:163], a[88:91], v[60:63]
 mf v[60:63], v[164:167], a[92:95], v[60:63]
 cvp v231, v102, v103
 mf v[64:67], v[152:155], a[144:147], v[64:67]
 mf v[64:67], v[156:159], a[148:151], v[64:67]
 vmf v104, v104, v212
 mf v[64:67], v[160:163], a[152:155], v[64:67]
 vmf v105, v105, v212
 mf v[64:67], v[164:167], a[156:159], v[64:67]
 swc lgkmcnt(0)
 mf v[68:71], v[152:155], a[208:211], v[68:71]
 trr v[152:153], v178 offset:32768
 trr v[154:155], v179 offset:32768
 mf v[68:71], v[156:159], a[212:215], v[68:71]
 trr v[156:157], v178 offset:36864
 trr v[158:159], v179 offset:36864
 mf v[68:71], v[160:163], a[216:219], v[68:71]
 trr v[160:161], v178 offset:40960
 trr v[162:163], v179 offset:40960
 mf v[68:71], v[164:167], a[220:223], v[68:71]
 trr v[164:165], v178 offset:45056
 trr v[166:167], v179 offset:45056
 mf v[8:11], v[136:139], a[32:35], v[8:11]
 swc vmcnt(3)
 s_barrier
 mf v[8:11], v[140:143], a[36:39], v[8:11]
 s_cmp_eq_u32 s86, 0
 s_cbranch_scc1 K2_NR_5
 sad m0, s22, 16384
 s_nop 0
 bl4 v7, s[8:11], s21 offen offset:0 sc1 lds
 bl4 v7, s[8:11], s21 offen offset:1024 sc1 lds
 bl4 v7, s[8:11], s21 offen offset:2048 sc1 lds
 bl4 v7, s[8:11], s21 offen offset:3072 sc1 lds
 sad s21, s21, 16384
K2_NR_5:
 mf v[8:11], v[144:147], a[40:43], v[8:11]
 vmf v106, v106, v212
 mf v[8:11], v[148:151], a[44:47], v[8:11]
 mf v[12:15], v[136:139], a[96:99], v[12:15]
 s_cmp_eq_u32 s86, 0
 s_cbranch_scc1 K2_NR_6
 sad m0, s22, 24576
 s_nop 0
 bl4 v7, s[8:11], s21 offen offset:0 sc1 lds
 bl4 v7, s[8:11], s21 offen offset:1024 sc1 lds
 bl4 v7, s[8:11], s21 offen offset:2048 sc1 lds
 bl4 v7, s[8:11], s21 offen offset:3072 sc1 lds
 sad s21, s21, 16384
 s_xor_b32 s22, s22, 0x8000
K2_NR_6:
 mf v[12:15], v[140:143], a[100:103], v[12:15]
 vmf v107, v107, v212
 mf v[12:15], v[144:147], a[104:107], v[12:15]
 cvp v232, v104, v105
 mf v[12:15], v[148:151], a[108:111], v[12:15]
 mf v[16:19], v[136:139], a[160:163], v[16:19]
 cvp v233, v106, v107
 mf v[16:19], v[140:143], a[164:167], v[16:19]
 mf v[16:19], v[144:147], a[168:171], v[16:19]
 vmf v120, v120, v212
 mf v[16:19], v[148:151], a[172:175], v[16:19]
 swc lgkmcnt(0)
 mf v[20:23], v[136:139], a[224:227], v[20:23]
 trr v[136:137], v180 offset:32768
 trr v[138:139], v181 offset:32768
 mf v[20:23], v[140:143], a[228:231], v[20:23]
 trr v[140:141], v180 offset:36864
 trr v[142:143], v181 offset:36864
 mf v[20:23], v[144:147], a[232:235], v[20:23]
 trr v[144:145], v180 offset:40960
 trr v[146:147], v181 offset:40960
 mf v[20:23], v[148:151], a[236:239], v[20:23]
 trr v[148:149], v180 offset:45056
 trr v[150:151], v181 offset:45056
 mf v[24:27], v[152:155], a[32:35], v[24:27]
 vmf v121, v121, v212
 mf v[24:27], v[156:159], a[36:39], v[24:27]
 vmf v122, v122, v212
 mf v[24:27], v[160:163], a[40:43], v[24:27]
 mf v[24:27], v[164:167], a[44:47], v[24:27]
 vmf v123, v123, v212
 mf v[28:31], v[152:155], a[96:99], v[28:31]
 mf v[28:31], v[156:159], a[100:103], v[28:31]
 cvp v234, v120, v121
 mf v[28:31], v[160:163], a[104:107], v[28:31]
 cvp v235, v122, v123
 mf v[28:31], v[164:167], a[108:111], v[28:31]
 mf v[32:35], v[152:155], a[160:163], v[32:35]
 vmf v108, v108, v213
 mf v[32:35], v[156:159], a[164:167], v[32:35]
 vmf v109, v109, v213
 mf v[32:35], v[160:163], a[168:171], v[32:35]
 mf v[32:35], v[164:167], a[172:175], v[32:35]
 swc lgkmcnt(0)
 vmf v110, v110, v213
 mf v[36:39], v[152:155], a[224:227], v[36:39]
 trr v[152:153], v182 offset:32768
 trr v[154:155], v183 offset:32768
 mf v[36:39], v[156:159], a[228:231], v[36:39]
 trr v[156:157], v182 offset:36864
 trr v[158:159], v183 offset:36864
 mf v[36:39], v[160:163], a[232:235], v[36:39]
 trr v[160:161], v182 offset:40960
 trr v[162:163], v183 offset:40960
 mf v[36:39], v[164:167], a[236:239], v[36:39]
 trr v[164:165], v182 offset:45056
 trr v[166:167], v183 offset:45056
 mf v[40:43], v[136:139], a[32:35], v[40:43]
 mf v[40:43], v[140:143], a[36:39], v[40:43]
 vmf v111, v111, v213
 mf v[40:43], v[144:147], a[40:43], v[40:43]
 mf v[40:43], v[148:151], a[44:47], v[40:43]
 cvp v236, v108, v109
 mf v[44:47], v[136:139], a[96:99], v[44:47]
 cvp v237, v110, v111
 mf v[44:47], v[140:143], a[100:103], v[44:47]
 mf v[44:47], v[144:147], a[104:107], v[44:47]
 vmf v124, v124, v213
 mf v[44:47], v[148:151], a[108:111], v[44:47]
 vmf v125, v125, v213
 mf v[48:51], v[136:139], a[160:163], v[48:51]
 mf v[48:51], v[140:143], a[164:167], v[48:51]
 vmf v126, v126, v213
 mf v[48:51], v[144:147], a[168:171], v[48:51]
 vmf v127, v127, v213
 mf v[48:51], v[148:151], a[172:175], v[48:51]
 swc lgkmcnt(0)
 mf v[52:55], v[136:139], a[224:227], v[52:55]
 trr v[136:137], v176 offset:49152
 trr v[138:139], v177 offset:49152
 mf v[52:55], v[140:143], a[228:231], v[52:55]
 trr v[140:141], v176 offset:53248
 trr v[142:143], v177 offset:53248
 mf v[52:55], v[144:147], a[232:235], v[52:55]
 trr v[144:145], v176 offset:57344
 trr v[146:147], v177 offset:57344
 mf v[52:55], v[148:151], a[236:239], v[52:55]
 trr v[148:149], v176 offset:61440
 trr v[150:151], v177 offset:61440
 mf v[56:59], v[152:155], a[32:35], v[56:59]
 mf v[56:59], v[156:159], a[36:39], v[56:59]
 cvp v238, v124, v125
 mf v[56:59], v[160:163], a[40:43], v[56:59]
 cvp v239, v126, v127
 mf v[56:59], v[164:167], a[44:47], v[56:59]
 mf v[60:63], v[152:155], a[96:99], v[60:63]
 vmf v112, v112, v214
 mf v[60:63], v[156:159], a[100:103], v[60:63]
 vmf v113, v113, v214
 mf v[60:63], v[160:163], a[104:107], v[60:63]
 mf v[60:63], v[164:167], a[108:111], v[60:63]
 vmf v114, v114, v214
 mf v[64:67], v[152:155], a[160:163], v[64:67]
 vmf v115, v115, v214
 mf v[64:67], v[156:159], a[164:167], v[64:67]
 mf v[64:67], v[160:163], a[168:171], v[64:67]
 cvp v240, v112, v113
 mf v[64:67], v[164:167], a[172:175], v[64:67]
 swc lgkmcnt(0)
 mf v[68:71], v[152:155], a[224:227], v[68:71]
 trr v[152:153], v178 offset:49152
 trr v[154:155], v179 offset:49152
 mf v[68:71], v[156:159], a[228:231], v[68:71]
 trr v[156:157], v178 offset:53248
 trr v[158:159], v179 offset:53248
 mf v[68:71], v[160:163], a[232:235], v[68:71]
 trr v[160:161], v178 offset:57344
 trr v[162:163], v179 offset:57344
 mf v[68:71], v[164:167], a[236:239], v[68:71]
 trr v[164:165], v178 offset:61440
 trr v[166:167], v179 offset:61440
 mf v[8:11], v[136:139], a[48:51], v[8:11]
 s_barrier
 mf v[8:11], v[140:143], a[52:55], v[8:11]
 cvp v241, v114, v115
 mf v[8:11], v[144:147], a[56:59], v[8:11]
 vmf v128, v128, v214
 mf v[8:11], v[148:151], a[60:63], v[8:11]
 mf v[12:15], v[136:139], a[112:115], v[12:15]
 vmf v129, v129, v214
 mf v[12:15], v[140:143], a[116:119], v[12:15]
 vmf v130, v130, v214
 mf v[12:15], v[144:147], a[120:123], v[12:15]
 mf v[12:15], v[148:151], a[124:127], v[12:15]
 vmf v131, v131, v214
 mf v[16:19], v[136:139], a[176:179], v[16:19]
 mf v[16:19], v[140:143], a[180:183], v[16:19]
 cvp v242, v128, v129
 mf v[16:19], v[144:147], a[184:187], v[16:19]
 cvp v243, v130, v131
 mf v[16:19], v[148:151], a[188:191], v[16:19]
 swc lgkmcnt(0)
 mf v[20:23], v[136:139], a[240:243], v[20:23]
 trr v[136:137], v180 offset:49152
 trr v[138:139], v181 offset:49152
 mf v[20:23], v[140:143], a[244:247], v[20:23]
 trr v[140:141], v180 offset:53248
 trr v[142:143], v181 offset:53248
 mf v[20:23], v[144:147], a[248:251], v[20:23]
 trr v[144:145], v180 offset:57344
 trr v[146:147], v181 offset:57344
 mf v[20:23], v[148:151], a[252:255], v[20:23]
 trr v[148:149], v180 offset:61440
 trr v[150:151], v181 offset:61440
 mf v[24:27], v[152:155], a[48:51], v[24:27]
 vmf v116, v116, v215
 mf v[24:27], v[156:159], a[52:55], v[24:27]
 mf v[24:27], v[160:163], a[56:59], v[24:27]
 vmf v117, v117, v215
 mf v[24:27], v[164:167], a[60:63], v[24:27]
 vmf v118, v118, v215
 mf v[28:31], v[152:155], a[112:115], v[28:31]
 mf v[28:31], v[156:159], a[116:119], v[28:31]
 vmf v119, v119, v215
 mf v[28:31], v[160:163], a[120:123], v[28:31]
 mf v[28:31], v[164:167], a[124:127], v[28:31]
 cvp v244, v116, v117
 mf v[32:35], v[152:155], a[176:179], v[32:35]
 cvp v245, v118, v119
 mf v[32:35], v[156:159], a[180:183], v[32:35]
 mf v[32:35], v[160:163], a[184:187], v[32:35]
 vmf v132, v132, v215
 mf v[32:35], v[164:167], a[188:191], v[32:35]
 swc lgkmcnt(0)
 mf v[36:39], v[152:155], a[240:243], v[36:39]
 trr v[152:153], v182 offset:49152
 trr v[154:155], v183 offset:49152
 mf v[36:39], v[156:159], a[244:247], v[36:39]
 trr v[156:157], v182 offset:53248
 trr v[158:159], v183 offset:53248
 mf v[36:39], v[160:163], a[248:251], v[36:39]
 trr v[160:161], v182 offset:57344
 trr v[162:163], v183 offset:57344
 mf v[36:39], v[164:167], a[252:255], v[36:39]
 trr v[164:165], v182 offset:61440
 trr v[166:167], v183 offset:61440
 mf v[40:43], v[136:139], a[48:51], v[40:43]
 vmf v133, v133, v215
 mf v[40:43], v[140:143], a[52:55], v[40:43]
 vmf v134, v134, v215
 mf v[40:43], v[144:147], a[56:59], v[40:43]
 mf v[40:43], v[148:151], a[60:63], v[40:43]
 vmf v135, v135, v215
 mf v[44:47], v[136:139], a[112:115], v[44:47]
 mf v[44:47], v[140:143], a[116:119], v[44:47]
 cvp v246, v132, v133
 mf v[44:47], v[144:147], a[120:123], v[44:47]
 cvp v247, v134, v135
 mf v[44:47], v[148:151], a[124:127], v[44:47]
 mf v[48:51], v[136:139], a[176:179], v[48:51]
 v_mov_b32 v249, v212
 mf v[48:51], v[140:143], a[180:183], v[48:51]
 v_mov_b32 v250, v213
 mf v[48:51], v[144:147], a[184:187], v[48:51]
 mf v[48:51], v[148:151], a[188:191], v[48:51]
 swc lgkmcnt(0)
 v_mov_b32 v251, v214
 mf v[52:55], v[136:139], a[240:243], v[52:55]
 mf v[52:55], v[140:143], a[244:247], v[52:55]
 mf v[52:55], v[144:147], a[248:251], v[52:55]
 mf v[52:55], v[148:151], a[252:255], v[52:55]
 mf v[56:59], v[152:155], a[48:51], v[56:59]
 mf v[56:59], v[156:159], a[52:55], v[56:59]
 v_mov_b32 v252, v215
 mf v[56:59], v[160:163], a[56:59], v[56:59]
 mf v[56:59], v[164:167], a[60:63], v[56:59]
 mf v[60:63], v[152:155], a[112:115], v[60:63]
 mf v[60:63], v[156:159], a[116:119], v[60:63]
 mf v[60:63], v[160:163], a[120:123], v[60:63]
 mf v[60:63], v[164:167], a[124:127], v[60:63]
 mf v[64:67], v[152:155], a[176:179], v[64:67]
 mf v[64:67], v[156:159], a[180:183], v[64:67]
 mf v[64:67], v[160:163], a[184:187], v[64:67]
 mf v[64:67], v[164:167], a[188:191], v[64:67]
 swc lgkmcnt(0)
 mf v[68:71], v[152:155], a[240:243], v[68:71]
 mf v[68:71], v[156:159], a[244:247], v[68:71]
 mf v[68:71], v[160:163], a[248:251], v[68:71]
 mf v[68:71], v[164:167], a[252:255], v[68:71]
K1_FIN:
 s_cmp_eq_u32 s86, 0
 s_cbranch_scc1 K2_KLATE
K2_KOK:
 acw a0, v216
 acw a1, v217
 acw a2, v218
 acw a3, v219
 acw a16, v220
 acw a17, v221
 acw a18, v222
 acw a19, v223
 acw a32, v224
 acw a33, v225
 acw a34, v226
 acw a35, v227
 acw a48, v228
 acw a49, v229
 acw a50, v230
 acw a51, v231
 acw a4, v232
 acw a5, v233
 acw a6, v234
 acw a7, v235
 acw a20, v236
 acw a21, v237
 acw a22, v238
 acw a23, v239
 acw a36, v240
 acw a37, v241
 acw a38, v242
 acw a39, v243
 acw a52, v244
 acw a53, v245
 acw a54, v246
 acw a55, v247
 v_lshlrev_b32 v244, 4, v248
 v_add_u32 v245, 0x10000, v244
 v_mov_b32 v246, v7
 v_mov_b32 v255, s25
 v_mov_b32 v200, 0
 v_mov_b32 v201, 0
 v_mov_b32 v202, 0
 v_mov_b32 v203, 0
 v_mov_b32 v204, 0
 v_mov_b32 v205, 0
 v_mov_b32 v206, 0
 v_mov_b32 v207, 0
 v_mov_b32 v208, 0
 v_mov_b32 v209, 0
 v_mov_b32 v210, 0
 v_mov_b32 v211, 0
 v_mov_b32 v212, 0
 v_mov_b32 v213, 0
 v_mov_b32 v214, 0
 v_mov_b32 v215, 0
 v_mov_b32 v216, 0
 v_mov_b32 v217, 0
 v_mov_b32 v218, 0
 v_mov_b32 v219, 0
 v_mov_b32 v220, 0
 v_mov_b32 v221, 0
 v_mov_b32 v222, 0
 v_mov_b32 v223, 0
 v_mov_b32 v224, 0
 v_mov_b32 v225, 0
 v_mov_b32 v226, 0
 v_mov_b32 v227, 0
 v_mov_b32 v228, 0
 v_mov_b32 v229, 0
 v_mov_b32 v230, 0
 v_mov_b32 v231, 0
 v_mov_b32 v236, 0
 v_mov_b32 v237, 0
 v_mov_b32 v238, 0
 v_mov_b32 v239, 0
 v_mov_b32 v240, 0
 v_mov_b32 v241, 0
 v_mov_b32 v242, 0
 v_mov_b32 v243, 0
 s_cmp_eq_u32 s18, 0
 s_cbranch_scc1 K2_HOOK_13
K2_HB_14:
 swc vmcnt(0)
 s_barrier
 dr4 a[64:67], v244 offset:0
 dr4 a[68:71], v244 offset:1024
 dr4 a[72:75], v244 offset:2048
 dr4 a[76:79], v244 offset:3072
 dr4 a[80:83], v244 offset:4096
 dr4 a[84:87], v244 offset:5120
 dr4 a[88:91], v244 offset:6144
 dr4 a[92:95], v244 offset:7168
 dr4 a[96:99], v245 offset:16384
 dr4 a[100:103], v245 offset:17408
 dr4 a[104:107], v245 offset:18432
 dr4 a[108:111], v245 offset:19456
 dr4 a[112:115], v245 offset:20480
 dr4 a[116:119], v245 offset:21504
 dr4 a[120:123], v245 offset:22528
 dr4 a[124:127], v245 offset:23552
 vmf v8, v8, v249
 vmf v9, v9, v249
 vmf v10, v10, v249
 vmf v11, v11, v249
 cvp v176, v8, v9
 cvp v177, v10, v11
 vmf v24, v24, v249
 vmf v25, v25, v249
 vmf v26, v26, v249
 vmf v27, v27, v249
 cvp v178, v24, v25
 cvp v179, v26, v27
 acw a8, v176
 acw a9, v177
 acw a10, v178
 acw a11, v179
 vmf v12, v12, v250
 vmf v13, v13, v250
 vmf v14, v14, v250
 vmf v15, v15, v250
 cvp v180, v12, v13
 cvp v181, v14, v15
 vmf v28, v28, v250
 vmf v29, v29, v250
 swc lgkmcnt(8)
 sad m0, s22, 0
 s_nop 0
 mf v[128:131], a[64:67], a[0:3], v[200:203]
 vmf v30, v30, v250
 vmf v31, v31, v250
 cvp v182, v28, v29
 cvp v183, v30, v31
 acw a24, v180
 mf v[136:139], a[64:67], a[16:19], v[208:211]
 bl4 v246, s[8:11], s21 offen offset:0 sc1 lds
 acw a25, v181
 acw a26, v182
 acw a27, v183
 vmf v16, v16, v251
 vmf v17, v17, v251
 mf v[144:147], a[64:67], a[32:35], v[216:219]
 bl4 v246, s[8:11], s21 offen offset:1024 sc1 lds
 vmf v18, v18, v251
 vmf v19, v19, v251
 cvp v176, v16, v17
 cvp v177, v18, v19
 vmf v32, v32, v251
 mf v[152:155], a[64:67], a[48:51], v[224:227]
 dr4 a[64:67], v244 offset:8192
 bl4 v246, s[8:11], s21 offen offset:2048 sc1 lds
 vmf v33, v33, v251
 vmf v34, v34, v251
 vmf v35, v35, v251
 cvp v178, v32, v33
 cvp v179, v34, v35
 mf v[132:135], a[80:83], a[0:3], v[204:207]
 bl4 v246, s[8:11], s21 offen offset:3072 sc1 lds
 acw a40, v176
 acw a41, v177
 acw a42, v178
 acw a43, v179
 vmf v20, v20, v252
 mf v[140:143], a[80:83], a[16:19], v[212:215]
 vmf v21, v21, v252
 vmf v22, v22, v252
 vmf v23, v23, v252
 cvp v180, v20, v21
 cvp v181, v22, v23
 mf v[148:151], a[80:83], a[32:35], v[220:223]
 sad s21, s21, 16384
 vmf v36, v36, v252
 vmf v37, v37, v252
 vmf v38, v38, v252
 vmf v39, v39, v252
 cvp v182, v36, v37
 mf v[156:159], a[80:83], a[48:51], v[228:231]
 dr4 a[80:83], v244 offset:12288
 cvp v183, v38, v39
 acw a56, v180
 acw a57, v181
 acw a58, v182
 acw a59, v183
 sad m0, s22, 8192
 s_nop 0
 mf v[128:131], a[68:71], a[4:7], v[128:131]
 vmf v40, v40, v249
 vmf v41, v41, v249
 vmf v42, v42, v249
 vmf v43, v43, v249
 cvp v176, v40, v41
 mf v[136:139], a[68:71], a[20:23], v[136:139]
 bl4 v246, s[8:11], s21 offen offset:0 sc1 lds
 cvp v177, v42, v43
 vmf v56, v56, v249
 vmf v57, v57, v249
 vmf v58, v58, v249
 vmf v59, v59, v249
 mf v[144:147], a[68:71], a[36:39], v[144:147]
 bl4 v246, s[8:11], s21 offen offset:1024 sc1 lds
 cvp v178, v56, v57
 cvp v179, v58, v59
 acw a12, v176
 acw a13, v177
 acw a14, v178
 mf v[152:155], a[68:71], a[52:55], v[152:155]
 dr4 a[68:71], v244 offset:9216
 bl4 v246, s[8:11], s21 offen offset:2048 sc1 lds
 acw a15, v179
 vmf v44, v44, v250
 vmf v45, v45, v250
 vmf v46, v46, v250
 vmf v47, v47, v250
 mf v[132:135], a[84:87], a[4:7], v[132:135]
 bl4 v246, s[8:11], s21 offen offset:3072 sc1 lds
 cvp v180, v44, v45
 cvp v181, v46, v47
 vmf v60, v60, v250
 vmf v61, v61, v250
 vmf v62, v62, v250
 mf v[140:143], a[84:87], a[20:23], v[140:143]
 vmf v63, v63, v250
 cvp v182, v60, v61
 cvp v183, v62, v63
 acw a28, v180
 acw a29, v181
 mf v[148:151], a[84:87], a[36:39], v[148:151]
 sad s21, s21, 16384
 acw a30, v182
 acw a31, v183
 vmf v48, v48, v251
 vmf v49, v49, v251
 vmf v50, v50, v251
 mf v[156:159], a[84:87], a[52:55], v[156:159]
 dr4 a[84:87], v244 offset:13312
 vmf v51, v51, v251
 cvp v176, v48, v49
 cvp v177, v50, v51
 vmf v64, v64, v251
 vmf v65, v65, v251
 s_nop 1
 sad m0, s22, 16384
 s_nop 0
 mf v[128:131], a[72:75], a[8:11], v[128:131]
 vmf v66, v66, v251
 vmf v67, v67, v251
 cvp v178, v64, v65
 cvp v179, v66, v67
 acw a44, v176
 mf v[136:139], a[72:75], a[24:27], v[136:139]
 bl4 v246, s[8:11], s21 offen offset:0 sc1 lds
 acw a45, v177
 acw a46, v178
 acw a47, v179
 vmf v52, v52, v252
 vmf v53, v53, v252
 mf v[144:147], a[72:75], a[40:43], v[144:147]
 bl4 v246, s[8:11], s21 offen offset:1024 sc1 lds
 vmf v54, v54, v252
 vmf v55, v55, v252
 cvp v180, v52, v53
 cvp v181, v54, v55
 vmf v68, v68, v252
 mf v[152:155], a[72:75], a[56:59], v[152:155]
 dr4 a[72:75], v244 offset:10240
 bl4 v246, s[8:11], s21 offen offset:2048 sc1 lds
 vmf v69, v69, v252
 vmf v70, v70, v252
 vmf v71, v71, v252
 cvp v182, v68, v69
 cvp v183, v70, v71
 mf v[132:135], a[88:91], a[8:11], v[132:135]
 bl4 v246, s[8:11], s21 offen offset:3072 sc1 lds
 acw a60, v180
 acw a61, v181
 acw a62, v182
 acw a63, v183
 mf v[140:143], a[88:91], a[24:27], v[140:143]
 mf v[148:151], a[88:91], a[40:43], v[148:151]
 sad s21, s21, 16384
 mf v[156:159], a[88:91], a[56:59], v[156:159]
 dr4 a[88:91], v244 offset:14336
 s_nop 1
 sad m0, s22, 24576
 s_nop 0
 mf v[128:131], a[76:79], a[12:15], v[128:131]
 mf v[136:139], a[76:79], a[28:31], v[136:139]
 bl4 v246, s[8:11], s21 offen offset:0 sc1 lds
 mf v[144:147], a[76:79], a[44:47], v[144:147]
 bl4 v246, s[8:11], s21 offen offset:1024 sc1 lds
 mf v[152:155], a[76:79], a[60:63], v[152:155]
 dr4 a[76:79], v244 offset:11264
 bl4 v246, s[8:11], s21 offen offset:2048 sc1 lds
 mf v[132:135], a[92:95], a[12:15], v[132:135]
 bl4 v246, s[8:11], s21 offen offset:3072 sc1 lds
 mf v[140:143], a[92:95], a[28:31], v[140:143]
 mf v[148:151], a[92:95], a[44:47], v[148:151]
 sad s21, s21, 16384
 s_xor_b32 s22, s22, 0x8000
 mf v[156:159], a[92:95], a[60:63], v[156:159]
 dr4 a[92:95], v244 offset:15360
 s_nop 7
 v_max3_f32 v248, v128, v129, v130
 v_max3_f32 v248, v248, v131, v132
 v_max3_f32 v248, v248, v133, v134
 v_max_f32 v248, v248, v135
 v_mov_b32 v249, v248
 s_nop 1
 v_permlane16_swap_b32 v248, v249
 v_max_f32 v248, v248, v249
 v_mov_b32 v249, v248
 s_nop 1
 v_permlane32_swap_b32 v248, v249
 v_max_f32 v248, v248, v249
 v_ceil_f32 v248, v248
 vsf v128, v128, v248
 vsf v129, v129, v248
 vsf v130, v130, v248
 vsf v131, v131, v248
 vsf v132, v132, v248
 vsf v133, v133, v248
 vsf v134, v134, v248
 vsf v135, v135, v248
 vsf v200, v200, v248
 vsf v201, v201, v248
 vsf v202, v202, v248
 vsf v203, v203, v248
 vsf v204, v204, v248
 vsf v205, v205, v248
 vsf v206, v206, v248
 vsf v207, v207, v248
 v_max3_f32 v248, v136, v137, v138
 v_max3_f32 v248, v248, v139, v140
 v_max3_f32 v248, v248, v141, v142
 v_max_f32 v248, v248, v143
 v_mov_b32 v249, v248
 s_nop 1
 v_permlane16_swap_b32 v248, v249
 v_max_f32 v248, v248, v249
 v_mov_b32 v249, v248
 s_nop 1
 v_permlane32_swap_b32 v248, v249
 v_max_f32 v248, v248, v249
 v_ceil_f32 v248, v248
 vsf v136, v136, v248
 vsf v137, v137, v248
 vsf v138, v138, v248
 vsf v139, v139, v248
 vsf v140, v140, v248
 vsf v141, v141, v248
 vsf v142, v142, v248
 vsf v143, v143, v248
 vsf v208, v208, v248
 vsf v209, v209, v248
 vsf v210, v210, v248
 vsf v211, v211, v248
 vsf v212, v212, v248
 vsf v213, v213, v248
 vsf v214, v214, v248
 vsf v215, v215, v248
 v_max3_f32 v248, v144, v145, v146
 v_max3_f32 v248, v248, v147, v148
 v_max3_f32 v248, v248, v149, v150
 v_max_f32 v248, v248, v151
 v_mov_b32 v249, v248
 s_nop 1
 v_permlane16_swap_b32 v248, v249
 v_max_f32 v248, v248, v249
 v_mov_b32 v249, v248
 s_nop 1
 v_permlane32_swap_b32 v248, v249
 v_max_f32 v248, v248, v249
 v_ceil_f32 v248, v248
 vsf v144, v144, v248
 vsf v145, v145, v248
 vsf v146, v146, v248
 vsf v147, v147, v248
 vsf v148, v148, v248
 vsf v149, v149, v248
 vsf v150, v150, v248
 vsf v151, v151, v248
 vsf v216, v216, v248
 vsf v217, v217, v248
 vsf v218, v218, v248
 vsf v219, v219, v248
 vsf v220, v220, v248
 vsf v221, v221, v248
 vsf v222, v222, v248
 vsf v223, v223, v248
 v_max3_f32 v248, v152, v153, v154
 v_max3_f32 v248, v248, v155, v156
 v_max3_f32 v248, v248, v157, v158
 v_max_f32 v248, v248, v159
 v_mov_b32 v249, v248
 s_nop 1
 v_permlane16_swap_b32 v248, v249
 v_max_f32 v248, v248, v249
 v_mov_b32 v249, v248
 s_nop 1
 v_permlane32_swap_b32 v248, v249
 v_max_f32 v248, v248, v249
 v_ceil_f32 v248, v248
 vsf v152, v152, v248
 vsf v153, v153, v248
 vsf v154, v154, v248
 vsf v155, v155, v248
 vsf v156, v156, v248
 vsf v157, v157, v248
 vsf v158, v158, v248
 vsf v159, v159, v248
 vsf v224, v224, v248
 vsf v225, v225, v248
 vsf v226, v226, v248
 vsf v227, v227, v248
 vsf v228, v228, v248
 vsf v229, v229, v248
 vsf v230, v230, v248
 vsf v231, v231, v248
 vex v232, v128
 vex v233, v129
 vex v234, v130
 vaf v236, v232, v233
 vaf v242, v242, v238
 vex v235, v131
 cvp v176, v232, v233
 vex v232, v132
 vaf v236, v236, v234
 vaf v236, v236, v235
 vex v233, v133
 cvp v177, v234, v235
 vex v234, v134
 vaf v236, v236, v232
 vaf v236, v236, v233
 vex v235, v135
 cvp v178, v232, v233
 vex v232, v136
 vaf v236, v236, v234
 vaf v236, v236, v235
 vex v233, v137
 cvp v179, v234, v235
 vex v234, v138
 vaf v237, v232, v233
 vaf v243, v243, v239
 vex v235, v139
 cvp v180, v232, v233
 vex v232, v140
 vaf v237, v237, v234
 vaf v237, v237, v235
 vex v233, v141
 cvp v181, v234, v235
 vex v234, v142
 vaf v237, v237, v232
 vaf v237, v237, v233
 vex v235, v143
 cvp v182, v232, v233
 s_nop 0
 vaf v237, v237, v234
 vaf v237, v237, v235
 v_max_f32 v247, v236, v237
 v_cmp_lt_f32 vcc, s24, v247
 vex v232, v144
 cvp v183, v234, v235
 vex v233, v145
 s_mov_b32 s23, s18
 swc lgkmcnt(0)
 s_cmp_eq_u32 s18, 0
 s_cbranch_scc1 K2_HOOK_19
K2_HB_20:
 swc lgkmcnt(8)
 mf v[128:131], a[64:67], a[0:3], v[200:203]
 swc vmcnt(16)
 s_barrier
 vex v234, v146
 mf v[136:139], a[64:67], a[16:19], v[208:211]
 vaf v238, v232, v233
 vaf v240, v240, v236
 mf v[160:163], a[64:67], a[32:35], v[216:219]
 vex v235, v147
 mf v[168:171], a[64:67], a[48:51], v[224:227]
 dr4 a[64:67], v244 offset:16384
 cvp v192, v232, v233
 mf v[128:131], a[68:71], a[4:7], v[128:131]
 vex v232, v148
 mf v[136:139], a[68:71], a[20:23], v[136:139]
 vaf v238, v238, v234
 vaf v238, v238, v235
 mf v[160:163], a[68:71], a[36:39], v[160:163]
 vex v233, v149
 mf v[168:171], a[68:71], a[52:55], v[168:171]
 dr4 a[68:71], v244 offset:17408
 cvp v193, v234, v235
 mf v[128:131], a[72:75], a[8:11], v[128:131]
 sad m0, s22, 0
 vex v234, v150
 mf v[136:139], a[72:75], a[24:27], v[136:139]
 bl4 v246, s[8:11], s21 offen offset:0 sc1 lds
 vaf v238, v238, v232
 vaf v238, v238, v233
 mf v[160:163], a[72:75], a[40:43], v[160:163]
 vex v235, v151
 mf v[168:171], a[72:75], a[56:59], v[168:171]
 dr4 a[72:75], v244 offset:18432
 cvp v194, v232, v233
 mf v[128:131], a[76:79], a[12:15], v[128:131]
 vex v232, v152
 mf v[136:139], a[76:79], a[28:31], v[136:139]
 bl4 v246, s[8:11], s21 offen offset:1024 sc1 lds
 vaf v238, v238, v234
 vaf v238, v238, v235
 mf v[160:163], a[76:79], a[44:47], v[160:163]
 vex v233, v153
 mf v[168:171], a[76:79], a[60:63], v[168:171]
 dr4 a[76:79], v244 offset:19456
 cvp v195, v234, v235
 mf v[132:135], a[80:83], a[0:3], v[204:207]
 vex v234, v154
 mf v[140:143], a[80:83], a[16:19], v[212:215]
 bl4 v246, s[8:11], s21 offen offset:2048 sc1 lds
 vaf v239, v232, v233
 vaf v241, v241, v237
 mf v[164:167], a[80:83], a[32:35], v[220:223]
 vex v235, v155
 mf v[172:175], a[80:83], a[48:51], v[228:231]
 dr4 a[80:83], v244 offset:20480
 cvp v196, v232, v233
 mf v[132:135], a[84:87], a[4:7], v[132:135]
 vex v232, v156
 mf v[140:143], a[84:87], a[20:23], v[140:143]
 bl4 v246, s[8:11], s21 offen offset:3072 sc1 lds
 vaf v239, v239, v234
 vaf v239, v239, v235
 mf v[164:167], a[84:87], a[36:39], v[164:167]
 sad s21, s21, 16384
 vex v233, v157
 mf v[172:175], a[84:87], a[52:55], v[172:175]
 dr4 a[84:87], v244 offset:21504
 cvp v197, v234, v235
 mf v[132:135], a[88:91], a[8:11], v[132:135]
 vex v234, v158
 mf v[140:143], a[88:91], a[24:27], v[140:143]
 vaf v239, v239, v232
 vaf v239, v239, v233
 mf v[164:167], a[88:91], a[40:43], v[164:167]
 vex v235, v159
 mf v[172:175], a[88:91], a[56:59], v[172:175]
 dr4 a[88:91], v244 offset:22528
 cvp v198, v232, v233
 mf v[132:135], a[92:95], a[12:15], v[132:135]
 vaf v239, v239, v234
 vaf v239, v239, v235
 mf v[140:143], a[92:95], a[28:31], v[140:143]
 v_max_f32 v247, v238, v239
 v_cmp_lt_f32 vcc, s24, v247
 mf v[164:167], a[92:95], a[44:47], v[164:167]
 vex v232, v128
 mf v[172:175], a[92:95], a[60:63], v[172:175]
 dr4 a[92:95], v244 offset:23552
 cvp v199, v234, v235
 vex v233, v129
 s_cbranch_vccnz K2_SLOW_21
K2_BACK_22:
 swc lgkmcnt(8)
 mf v[0:3], a[96:99], v[176:179], 0
 vex v234, v130
 mf v[4:7], a[96:99], v[180:183], 0
 vaf v236, v232, v233
 vaf v242, v242, v238
 mf v[8:11], a[96:99], v[192:195], 0
 vex v235, v131
 mf v[12:15], a[96:99], v[196:199], 0
 dr4 a[96:99], v245 offset:24576
 cvp v184, v232, v233
 mf v[16:19], a[100:103], v[176:179], 0
 vex v232, v132
 mf v[20:23], a[100:103], v[180:183], 0
 vaf v236, v236, v234
 vaf v236, v236, v235
 mf v[24:27], a[100:103], v[192:195], 0
 vex v233, v133
 mf v[28:31], a[100:103], v[196:199], 0
 dr4 a[100:103], v245 offset:25600
 cvp v185, v234, v235
 mf v[32:35], a[104:107], v[176:179], 0
 vex v234, v134
 mf v[36:39], a[104:107], v[180:183], 0
 vaf v236, v236, v232
 vaf v236, v236, v233
 mf v[40:43], a[104:107], v[192:195], 0
 vex v235, v135
 mf v[44:47], a[104:107], v[196:199], 0
 dr4 a[104:107], v245 offset:26624
 cvp v186, v232, v233
 mf v[48:51], a[108:111], v[176:179], 0
 vex v232, v136
 mf v[52:55], a[108:111], v[180:183], 0
 vaf v236, v236, v234
 vaf v236, v236, v235
 mf v[56:59], a[108:111], v[192:195], 0
 vex v233, v137
 mf v[60:63], a[108:111], v[196:199], 0
 dr4 a[108:111], v245 offset:27648
 cvp v187, v234, v235
 mf v[64:67], a[112:115], v[176:179], 0
 vex v234, v138
 mf v[68:71], a[112:115], v[180:183], 0
 vaf v237, v232, v233
 vaf v243, v243, v239
 mf v[72:75], a[112:115], v[192:195], 0
 vex v235, v139
 mf v[76:79], a[112:115], v[196:199], 0
 dr4 a[112:115], v245 offset:28672
 cvp v188, v232, v233
 mf v[80:83], a[116:119], v[176:179], 0
 vex v232, v140
 mf v[84:87], a[116:119], v[180:183], 0
 vaf v237, v237, v234
 vaf v237, v237, v235
 mf v[88:91], a[116:119], v[192:195], 0
 vex v233, v141
 mf v[92:95], a[116:119], v[196:199], 0
 dr4 a[116:119], v245 offset:29696
 cvp v189, v234, v235
 mf v[96:99], a[120:123], v[176:179], 0
 vex v234, v142
 mf v[100:103], a[120:123], v[180:183], 0
 vaf v237, v237, v232
 vaf v237, v237, v233
 mf v[104:107], a[120:123], v[192:195], 0
 vex v235, v143
 mf v[108:111], a[120:123], v[196:199], 0
 dr4 a[120:123], v245 offset:30720
 cvp v190, v232, v233
 mf v[112:115], a[124:127], v[176:179], 0
 vaf v237, v237, v234
 vaf v237, v237, v235
 mf v[116:119], a[124:127], v[180:183], 0
 v_max_f32 v247, v236, v237
 v_cmp_lt_f32 vcc, s24, v247
 mf v[120:123], a[124:127], v[192:195], 0
 vex v232, v160
 mf v[124:127], a[124:127], v[196:199], 0
 dr4 a[124:127], v245 offset:31744
 cvp v191, v234, v235
 vex v233, v161
 s_cbranch_vccnz K2_SLOW_23
K2_BACK_24:
 s_cmp_eq_u32 s23, 0
 s_cbranch_scc1 K2_SPECIAL_R1
 s_branch K2_LOOPA_R1
.p2align 6
K2_LOOPA:
 swc lgkmcnt(8)
 mf v[128:131], a[64:67], a[0:3], v[200:203]
 swc vmcnt(16)
 s_barrier
 vex v234, v146
 mf v[136:139], a[64:67], a[16:19], v[208:211]
 vaf v238, v232, v233
 vaf v240, v240, v236
 mf v[160:163], a[64:67], a[32:35], v[216:219]
 vex v235, v147
 mf v[168:171], a[64:67], a[48:51], v[224:227]
 dr4 a[64:67], v244 offset:16384
 cvp v192, v232, v233
 mf v[128:131], a[68:71], a[4:7], v[128:131]
 vex v232, v148
 mf v[136:139], a[68:71], a[20:23], v[136:139]
 vaf v238, v238, v234
 vaf v238, v238, v235
 mf v[160:163], a[68:71], a[36:39], v[160:163]
 vex v233, v149
 mf v[168:171], a[68:71], a[52:55], v[168:171]
 dr4 a[68:71], v244 offset:17408
 cvp v193, v234, v235
 mf v[128:131], a[72:75], a[8:11], v[128:131]
 sad m0, s22, 0
 vex v234, v150
 mf v[136:139], a[72:75], a[24:27], v[136:139]
 bl4 v246, s[8:11], s21 offen offset:0 sc1 lds
 vaf v238, v238, v232
 vaf v238, v238, v233
 mf v[160:163], a[72:75], a[40:43], v[160:163]
 vex v235, v151
 mf v[168:171], a[72:75], a[56:59], v[168:171]
 dr4 a[72:75], v244 offset:18432
 cvp v194, v232, v233
 mf v[128:131], a[76:79], a[12:15], v[128:131]
 vex v232, v152
 mf v[136:139], a[76:79], a[28:31], v[136:139]
 bl4 v246, s[8:11], s21 offen offset:1024 sc1 lds
 vaf v238, v238, v234
 vaf v238, v238, v235
 mf v[160:163], a[76:79], a[44:47], v[160:163]
 vex v233, v153
 mf v[168:171], a[76:79], a[60:63], v[168:171]
 dr4 a[76:79], v244 offset:19456
 cvp v195, v234, v235
 mf v[132:135], a[80:83], a[0:3], v[204:207]
 vex v234, v154
 mf v[140:143], a[80:83], a[16:19], v[212:215]
 bl4 v246, s[8:11], s21 offen offset:2048 sc1 lds
 vaf v239, v232, v233
 vaf v241, v241, v237
 mf v[164:167], a[80:83], a[32:35], v[220:223]
 vex v235, v155
 mf v[172:175], a[80:83], a[48:51], v[228:231]
 dr4 a[80:83], v244 offset:20480
 cvp v196, v232, v233
 mf v[132:135], a[84:87], a[4:7], v[132:135]
 vex v232, v156
 mf v[140:143], a[84:87], a[20:23], v[140:143]
 bl4 v246, s[8:11], s21 offen offset:3072 sc1 lds
 vaf v239, v239, v234
 vaf v239, v239, v235
 mf v[164:167], a[84:87], a[36:39], v[164:167]
 sad s21, s21, 16384
 vex v233, v157
 mf v[172:175], a[84:87], a[52:55], v[172:175]
 dr4 a[84:87], v244 offset:21504
 cvp v197, v234, v235
 mf v[132:135], a[88:91], a[8:11], v[132:135]
 vex v234, v158
 mf v[140:143], a[88:91], a[24:27], v[140:143]
 vaf v239, v239, v232
 vaf v239, v239, v233
 mf v[164:167], a[88:91], a[40:43], v[164:167]
 vex v235, v159
 mf v[172:175], a[88:91], a[56:59], v[172:175]
 dr4 a[88:91], v244 offset:22528
 cvp v198, v232, v233
 mf v[132:135], a[92:95], a[12:15], v[132:135]
 vaf v239, v239, v234
 vaf v239, v239, v235
 mf v[140:143], a[92:95], a[28:31], v[140:143]
 v_max_f32 v247, v238, v239
 v_cmp_lt_f32 vcc, s24, v247
 mf v[164:167], a[92:95], a[44:47], v[164:167]
 vex v232, v128
 mf v[172:175], a[92:95], a[60:63], v[172:175]
 dr4 a[92:95], v244 offset:23552
 cvp v199, v234, v235
 vex v233, v129
 s_cbranch_vccnz K2_SLOW_25
K2_BACK_26:
 swc lgkmcnt(8)
 mf v[0:3], a[96:99], v[176:179], v[0:3]
 vex v234, v130
 mf v[4:7], a[96:99], v[180:183], v[4:7]
 vaf v236, v232, v233
 vaf v242, v242, v238
 mf v[8:11], a[96:99], v[192:195], v[8:11]
 vex v235, v131
 mf v[12:15], a[96:99], v[196:199], v[12:15]
 dr4 a[96:99], v245 offset:24576
 cvp v184, v232, v233
 mf v[16:19], a[100:103], v[176:179], v[16:19]
 vex v232, v132
 mf v[20:23], a[100:103], v[180:183], v[20:23]
 vaf v236, v236, v234
 vaf v236, v236, v235
 mf v[24:27], a[100:103], v[192:195], v[24:27]
 vex v233, v133
 mf v[28:31], a[100:103], v[196:199], v[28:31]
 dr4 a[100:103], v245 offset:25600
 cvp v185, v234, v235
 mf v[32:35], a[104:107], v[176:179], v[32:35]
 vex v234, v134
 mf v[36:39], a[104:107], v[180:183], v[36:39]
 vaf v236, v236, v232
 vaf v236, v236, v233
 mf v[40:43], a[104:107], v[192:195], v[40:43]
 vex v235, v135
 mf v[44:47], a[104:107], v[196:199], v[44:47]
 dr4 a[104:107], v245 offset:26624
 cvp v186, v232, v233
 mf v[48:51], a[108:111], v[176:179], v[48:51]
 vex v232, v136
 mf v[52:55], a[108:111], v[180:183], v[52:55]
 vaf v236, v236, v234
 vaf v236, v236, v235
 mf v[56:59], a[108:111], v[192:195], v[56:59]
 vex v233, v137
 mf v[60:63], a[108:111], v[196:199], v[60:63]
 dr4 a[108:111], v245 offset:27648
 cvp v187, v234, v235
 mf v[64:67], a[112:115], v[176:179], v[64:67]
 vex v234, v138
 mf v[68:71], a[112:115], v[180:183], v[68:71]
 vaf v237, v232, v233
 vaf v243, v243, v239
 mf v[72:75], a[112:115], v[192:195], v[72:75]
 vex v235, v139
 mf v[76:79], a[112:115], v[196:199], v[76:79]
 dr4 a[112:115], v245 offset:28672
 cvp v188, v232, v233
 mf v[80:83], a[116:119], v[176:179], v[80:83]
 vex v232, v140
 mf v[84:87], a[116:119], v[180:183], v[84:87]
 vaf v237, v237, v234
 vaf v237, v237, v235
 mf v[88:91], a[116:119], v[192:195], v[88:91]
 vex v233, v141
 mf v[92:95], a[116:119], v[196:199], v[92:95]
 dr4 a[116:119], v245 offset:29696
 cvp v189, v234, v235
 mf v[96:99], a[120:123], v[176:179], v[96:99]
 vex v234, v142
 mf v[100:103], a[120:123], v[180:183], v[100:103]
 vaf v237, v237, v232
 vaf v237, v237, v233
 mf v[104:107], a[120:123], v[192:195], v[104:107]
 vex v235, v143
 mf v[108:111], a[120:123], v[196:199], v[108:111]
 dr4 a[120:123], v245 offset:30720
 cvp v190, v232, v233
 mf v[112:115], a[124:127], v[176:179], v[112:115]
 vaf v237, v237, v234
 vaf v237, v237, v235
 mf v[116:119], a[124:127], v[180:183], v[116:119]
 v_max_f32 v247, v236, v237
 v_cmp_lt_f32 vcc, s24, v247
 mf v[120:123], a[124:127], v[192:195], v[120:123]
 vex v232, v160
 mf v[124:127], a[124:127], v[196:199], v[124:127]
 dr4 a[124:127], v245 offset:31744
 cvp v191, v234, v235
 vex v233, v161
 s_cbranch_vccnz K2_SLOW_27
K2_BACK_28:
K2_LOOPA_R1:
 swc lgkmcnt(8)
 mf v[128:131], a[64:67], a[0:3], v[200:203]
 swc vmcnt(16)
 s_barrier
 vex v234, v162
 mf v[136:139], a[64:67], a[16:19], v[208:211]
 vaf v238, v232, v233
 vaf v240, v240, v236
 mf v[144:147], a[64:67], a[32:35], v[216:219]
 vex v235, v163
 mf v[152:155], a[64:67], a[48:51], v[224:227]
 dr4 a[64:67], v244 offset:24576
 cvp v192, v232, v233
 mf v[128:131], a[68:71], a[4:7], v[128:131]
 vex v232, v164
 mf v[136:139], a[68:71], a[20:23], v[136:139]
 vaf v238, v238, v234
 vaf v238, v238, v235
 mf v[144:147], a[68:71], a[36:39], v[144:147]
 vex v233, v165
 mf v[152:155], a[68:71], a[52:55], v[152:155]
 dr4 a[68:71], v244 offset:25600
 cvp v193, v234, v235
 mf v[128:131], a[72:75], a[8:11], v[128:131]
 sad m0, s22, 8192
 vex v234, v166
 mf v[136:139], a[72:75], a[24:27], v[136:139]
 bl4 v246, s[8:11], s21 offen offset:0 sc1 lds
 vaf v238, v238, v232
 vaf v238, v238, v233
 mf v[144:147], a[72:75], a[40:43], v[144:147]
 vex v235, v167
 mf v[152:155], a[72:75], a[56:59], v[152:155]
 dr4 a[72:75], v244 offset:26624
 cvp v194, v232, v233
 mf v[128:131], a[76:79], a[12:15], v[128:131]
 vex v232, v168
 mf v[136:139], a[76:79], a[28:31], v[136:139]
 bl4 v246, s[8:11], s21 offen offset:1024 sc1 lds
 vaf v238, v238, v234
 vaf v238, v238, v235
 mf v[144:147], a[76:79], a[44:47], v[144:147]
 vex v233, v169
 mf v[152:155], a[76:79], a[60:63], v[152:155]
 dr4 a[76:79], v244 offset:27648
 cvp v195, v234, v235
 mf v[132:135], a[80:83], a[0:3], v[204:207]
 vex v234, v170
 mf v[140:143], a[80:83], a[16:19], v[212:215]
 bl4 v246, s[8:11], s21 offen offset:2048 sc1 lds
 vaf v239, v232, v233
 vaf v241, v241, v237
 mf v[148:151], a[80:83], a[32:35], v[220:223]
 vex v235, v171
 mf v[156:159], a[80:83], a[48:51], v[228:231]
 dr4 a[80:83], v244 offset:28672
 cvp v196, v232, v233
 mf v[132:135], a[84:87], a[4:7], v[132:135]
 vex v232, v172
 mf v[140:143], a[84:87], a[20:23], v[140:143]
 bl4 v246, s[8:11], s21 offen offset:3072 sc1 lds
 vaf v239, v239, v234
 vaf v239, v239, v235
 mf v[148:151], a[84:87], a[36:39], v[148:151]
 sad s21, s21, 16384
 vex v233, v173
 mf v[156:159], a[84:87], a[52:55], v[156:159]
 dr4 a[84:87], v244 offset:29696
 cvp v197, v234, v235
 mf v[132:135], a[88:91], a[8:11], v[132:135]
 vex v234, v174
 mf v[140:143], a[88:91], a[24:27], v[140:143]
 vaf v239, v239, v232
 vaf v239, v239, v233
 mf v[148:151], a[88:91], a[40:43], v[148:151]
 vex v235, v175
 mf v[156:159], a[88:91], a[56:59], v[156:159]
 dr4 a[88:91], v244 offset:30720
 cvp v198, v232, v233
 mf v[132:135], a[92:95], a[12:15], v[132:135]
 vaf v239, v239, v234
 vaf v239, v239, v235
 mf v[140:143], a[92:95], a[28:31], v[140:143]
 v_max_f32 v247, v238, v239
 v_cmp_lt_f32 vcc, s24, v247
 mf v[148:151], a[92:95], a[44:47], v[148:151]
 vex v232, v128
 mf v[156:159], a[92:95], a[60:63], v[156:159]
 dr4 a[92:95], v244 offset:31744
 cvp v199, v234, v235
 vex v233, v129
 s_cbranch_vccnz K2_SLOW_29
K2_BACK_30:
 swc lgkmcnt(8)
 mf v[0:3], a[96:99], v[184:187], v[0:3]
 v_xor_b32 v245, 0x8000, v245
 vex v234, v130
 mf v[4:7], a[96:99], v[188:191], v[4:7]
 vaf v236, v232, v233
 vaf v242, v242, v238
 mf v[8:11], a[96:99], v[192:195], v[8:11]
 vex v235, v131
 mf v[12:15], a[96:99], v[196:199], v[12:15]
 dr4 a[96:99], v245 offset:0
 cvp v176, v232, v233
 mf v[16:19], a[100:103], v[184:187], v[16:19]
 vex v232, v132
 mf v[20:23], a[100:103], v[188:191], v[20:23]
 vaf v236, v236, v234
 vaf v236, v236, v235
 mf v[24:27], a[100:103], v[192:195], v[24:27]
 vex v233, v133
 mf v[28:31], a[100:103], v[196:199], v[28:31]
 dr4 a[100:103], v245 offset:1024
 cvp v177, v234, v235
 mf v[32:35], a[104:107], v[184:187], v[32:35]
 vex v234, v134
 mf v[36:39], a[104:107], v[188:191], v[36:39]
 vaf v236, v236, v232
 vaf v236, v236, v233
 mf v[40:43], a[104:107], v[192:195], v[40:43]
 vex v235, v135
 mf v[44:47], a[104:107], v[196:199], v[44:47]
 dr4 a[104:107], v245 offset:2048
 cvp v178, v232, v233
 mf v[48:51], a[108:111], v[184:187], v[48:51]
 vex v232, v136
 mf v[52:55], a[108:111], v[188:191], v[52:55]
 vaf v236, v236, v234
 vaf v236, v236, v235
 mf v[56:59], a[108:111], v[192:195], v[56:59]
 vex v233, v137
 mf v[60:63], a[108:111], v[196:199], v[60:63]
 dr4 a[108:111], v245 offset:3072
 cvp v179, v234, v235
 mf v[64:67], a[112:115], v[184:187], v[64:67]
 vex v234, v138
 mf v[68:71], a[112:115], v[188:191], v[68:71]
 vaf v237, v232, v233
 vaf v243, v243, v239
 mf v[72:75], a[112:115], v[192:195], v[72:75]
 vex v235, v139
 mf v[76:79], a[112:115], v[196:199], v[76:79]
 dr4 a[112:115], v245 offset:4096
 cvp v180, v232, v233
 mf v[80:83], a[116:119], v[184:187], v[80:83]
 vex v232, v140
 mf v[84:87], a[116:119], v[188:191], v[84:87]
 vaf v237, v237, v234
 vaf v237, v237, v235
 mf v[88:91], a[116:119], v[192:195], v[88:91]
 vex v233, v141
 mf v[92:95], a[116:119], v[196:199], v[92:95]
 dr4 a[116:119], v245 offset:5120
 cvp v181, v234, v235
 mf v[96:99], a[120:123], v[184:187], v[96:99]
 vex v234, v142
 mf v[100:103], a[120:123], v[188:191], v[100:103]
 vaf v237, v237, v232
 vaf v237, v237, v233
 mf v[104:107], a[120:123], v[192:195], v[104:107]
 vex v235, v143
 mf v[108:111], a[120:123], v[196:199], v[108:111]
 dr4 a[120:123], v245 offset:6144
 cvp v182, v232, v233
 mf v[112:115], a[124:127], v[184:187], v[112:115]
 vaf v237, v237, v234
 vaf v237, v237, v235
 mf v[116:119], a[124:127], v[188:191], v[116:119]
 v_max_f32 v247, v236, v237
 v_cmp_lt_f32 vcc, s24, v247
 mf v[120:123], a[124:127], v[192:195], v[120:123]
 vex v232, v144
 mf v[124:127], a[124:127], v[196:199], v[124:127]
 dr4 a[124:127], v245 offset:7168
 cvp v183, v234, v235
 vex v233, v145
 s_cbranch_vccnz K2_SLOW_31
K2_BACK_32:
 swc lgkmcnt(8)
 mf v[128:131], a[64:67], a[0:3], v[200:203]
 swc vmcnt(16)
 s_barrier
 v_xor_b32 v244, 0x8000, v244
 vex v234, v146
 mf v[136:139], a[64:67], a[16:19], v[208:211]
 vaf v238, v232, v233
 vaf v240, v240, v236
 mf v[160:163], a[64:67], a[32:35], v[216:219]
 vex v235, v147
 mf v[168:171], a[64:67], a[48:51], v[224:227]
 dr4 a[64:67], v244 offset:0
 cvp v192, v232, v233
 mf v[128:131], a[68:71], a[4:7], v[128:131]
 vex v232, v148
 mf v[136:139], a[68:71], a[20:23], v[136:139]
 vaf v238, v238, v234
 vaf v238, v238, v235
 mf v[160:163], a[68:71], a[36:39], v[160:163]
 vex v233, v149
 mf v[168:171], a[68:71], a[52:55], v[168:171]
 dr4 a[68:71], v244 offset:1024
 cvp v193, v234, v235
 mf v[128:131], a[72:75], a[8:11], v[128:131]
 sad m0, s22, 16384
 vex v234, v150
 mf v[136:139], a[72:75], a[24:27], v[136:139]
 bl4 v246, s[8:11], s21 offen offset:0 sc1 lds
 vaf v238, v238, v232
 vaf v238, v238, v233
 mf v[160:163], a[72:75], a[40:43], v[160:163]
 vex v235, v151
 mf v[168:171], a[72:75], a[56:59], v[168:171]
 dr4 a[72:75], v244 offset:2048
 cvp v194, v232, v233
 mf v[128:131], a[76:79], a[12:15], v[128:131]
 vex v232, v152
 mf v[136:139], a[76:79], a[28:31], v[136:139]
 bl4 v246, s[8:11], s21 offen offset:1024 sc1 lds
 vaf v238, v238, v234
 vaf v238, v238, v235
 mf v[160:163], a[76:79], a[44:47], v[160:163]
 vex v233, v153
 mf v[168:171], a[76:79], a[60:63], v[168:171]
 dr4 a[76:79], v244 offset:3072
 cvp v195, v234, v235
 mf v[132:135], a[80:83], a[0:3], v[204:207]
 vex v234, v154
 mf v[140:143], a[80:83], a[16:19], v[212:215]
 bl4 v246, s[8:11], s21 offen offset:2048 sc1 lds
 vaf v239, v232, v233
 vaf v241, v241, v237
 mf v[164:167], a[80:83], a[32:35], v[220:223]
 vex v235, v155
 mf v[172:175], a[80:83], a[48:51], v[228:231]
 dr4 a[80:83], v244 offset:4096
 cvp v196, v232, v233
 mf v[132:135], a[84:87], a[4:7], v[132:135]
 vex v232, v156
 mf v[140:143], a[84:87], a[20:23], v[140:143]
 bl4 v246, s[8:11], s21 offen offset:3072 sc1 lds
 vaf v239, v239, v234
 vaf v239, v239, v235
 mf v[164:167], a[84:87], a[36:39], v[164:167]
 sad s21, s21, 16384
 vex v233, v157
 mf v[172:175], a[84:87], a[52:55], v[172:175]
 dr4 a[84:87], v244 offset:5120
 cvp v197, v234, v235
 mf v[132:135], a[88:91], a[8:11], v[132:135]
 vex v234, v158
 mf v[140:143], a[88:91], a[24:27], v[140:143]
 vaf v239, v239, v232
 vaf v239, v239, v233
 mf v[164:167], a[88:91], a[40:43], v[164:167]
 vex v235, v159
 mf v[172:175], a[88:91], a[56:59], v[172:175]
 dr4 a[88:91], v244 offset:6144
 cvp v198, v232, v233
 mf v[132:135], a[92:95], a[12:15], v[132:135]
 vaf v239, v239, v234
 vaf v239, v239, v235
 mf v[140:143], a[92:95], a[28:31], v[140:143]
 v_max_f32 v247, v238, v239
 v_cmp_lt_f32 vcc, s24, v247
 mf v[164:167], a[92:95], a[44:47], v[164:167]
 vex v232, v128
 mf v[172:175], a[92:95], a[60:63], v[172:175]
 dr4 a[92:95], v244 offset:7168
 cvp v199, v234, v235
 vex v233, v129
 s_cbranch_vccnz K2_SLOW_33
K2_BACK_34:
 swc lgkmcnt(8)
 mf v[0:3], a[96:99], v[176:179], v[0:3]
 vex v234, v130
 mf v[4:7], a[96:99], v[180:183], v[4:7]
 vaf v236, v232, v233
 vaf v242, v242, v238
 mf v[8:11], a[96:99], v[192:195], v[8:11]
 vex v235, v131
 mf v[12:15], a[96:99], v[196:199], v[12:15]
 dr4 a[96:99], v245 offset:8192
 cvp v184, v232, v233
 mf v[16:19], a[100:103], v[176:179], v[16:19]
 vex v232, v132
 mf v[20:23], a[100:103], v[180:183], v[20:23]
 vaf v236, v236, v234
 vaf v236, v236, v235
 mf v[24:27], a[100:103], v[192:195], v[24:27]
 vex v233, v133
 mf v[28:31], a[100:103], v[196:199], v[28:31]
 dr4 a[100:103], v245 offset:9216
 cvp v185, v234, v235
 mf v[32:35], a[104:107], v[176:179], v[32:35]
 vex v234, v134
 mf v[36:39], a[104:107], v[180:183], v[36:39]
 vaf v236, v236, v232
 vaf v236, v236, v233
 mf v[40:43], a[104:107], v[192:195], v[40:43]
 vex v235, v135
 mf v[44:47], a[104:107], v[196:199], v[44:47]
 dr4 a[104:107], v245 offset:10240
 cvp v186, v232, v233
 mf v[48:51], a[108:111], v[176:179], v[48:51]
 vex v232, v136
 mf v[52:55], a[108:111], v[180:183], v[52:55]
 vaf v236, v236, v234
 vaf v236, v236, v235
 mf v[56:59], a[108:111], v[192:195], v[56:59]
 vex v233, v137
 mf v[60:63], a[108:111], v[196:199], v[60:63]
 dr4 a[108:111], v245 offset:11264
 cvp v187, v234, v235
 mf v[64:67], a[112:115], v[176:179], v[64:67]
 vex v234, v138
 mf v[68:71], a[112:115], v[180:183], v[68:71]
 vaf v237, v232, v233
 vaf v243, v243, v239
 mf v[72:75], a[112:115], v[192:195], v[72:75]
 vex v235, v139
 mf v[76:79], a[112:115], v[196:199], v[76:79]
 dr4 a[112:115], v245 offset:12288
 cvp v188, v232, v233
 mf v[80:83], a[116:119], v[176:179], v[80:83]
 vex v232, v140
 mf v[84:87], a[116:119], v[180:183], v[84:87]
 vaf v237, v237, v234
 vaf v237, v237, v235
 mf v[88:91], a[116:119], v[192:195], v[88:91]
 vex v233, v141
 mf v[92:95], a[116:119], v[196:199], v[92:95]
 dr4 a[116:119], v245 offset:13312
 cvp v189, v234, v235
 mf v[96:99], a[120:123], v[176:179], v[96:99]
 vex v234, v142
 mf v[100:103], a[120:123], v[180:183], v[100:103]
 vaf v237, v237, v232
 vaf v237, v237, v233
 mf v[104:107], a[120:123], v[192:195], v[104:107]
 vex v235, v143
 mf v[108:111], a[120:123], v[196:199], v[108:111]
 dr4 a[120:123], v245 offset:14336
 cvp v190, v232, v233
 mf v[112:115], a[124:127], v[176:179], v[112:115]
 vaf v237, v237, v234
 vaf v237, v237, v235
 mf v[116:119], a[124:127], v[180:183], v[116:119]
 v_max_f32 v247, v236, v237
 v_cmp_lt_f32 vcc, s24, v247
 mf v[120:123], a[124:127], v[192:195], v[120:123]
 vex v232, v160
 mf v[124:127], a[124:127], v[196:199], v[124:127]
 dr4 a[124:127], v245 offset:15360
 cvp v191, v234, v235
 vex v233, v161
 s_cbranch_vccnz K2_SLOW_35
K2_BACK_36:
 s_cmp_eq_u32 s23, 1
 s_cbranch_scc1 K2_HOOK_41
K2_HB_42:
 swc lgkmcnt(8)
 mf v[128:131], a[64:67], a[0:3], v[200:203]
 swc vmcnt(16)
 s_barrier
 vex v234, v162
 mf v[136:139], a[64:67], a[16:19], v[208:211]
 vaf v238, v232, v233
 vaf v240, v240, v236
 mf v[144:147], a[64:67], a[32:35], v[216:219]
 vex v235, v163
 mf v[152:155], a[64:67], a[48:51], v[224:227]
 dr4 a[64:67], v244 offset:8192
 cvp v192, v232, v233
 mf v[128:131], a[68:71], a[4:7], v[128:131]
 vex v232, v164
 mf v[136:139], a[68:71], a[20:23], v[136:139]
 vaf v238, v238, v234
 vaf v238, v238, v235
 mf v[144:147], a[68:71], a[36:39], v[144:147]
 vex v233, v165
 mf v[152:155], a[68:71], a[52:55], v[152:155]
 dr4 a[68:71], v244 offset:9216
 cvp v193, v234, v235
 mf v[128:131], a[72:75], a[8:11], v[128:131]
 sad m0, s22, 24576
 vex v234, v166
 mf v[136:139], a[72:75], a[24:27], v[136:139]
 bl4 v246, s[8:11], s21 offen offset:0 sc1 lds
 vaf v238, v238, v232
 vaf v238, v238, v233
 mf v[144:147], a[72:75], a[40:43], v[144:147]
 vex v235, v167
 mf v[152:155], a[72:75], a[56:59], v[152:155]
 dr4 a[72:75], v244 offset:10240
 cvp v194, v232, v233
 mf v[128:131], a[76:79], a[12:15], v[128:131]
 vex v232, v168
 mf v[136:139], a[76:79], a[28:31], v[136:139]
 bl4 v246, s[8:11], s21 offen offset:1024 sc1 lds
 vaf v238, v238, v234
 vaf v238, v238, v235
 mf v[144:147], a[76:79], a[44:47], v[144:147]
 vex v233, v169
 mf v[152:155], a[76:79], a[60:63], v[152:155]
 dr4 a[76:79], v244 offset:11264
 cvp v195, v234, v235
 mf v[132:135], a[80:83], a[0:3], v[204:207]
 vex v234, v170
 mf v[140:143], a[80:83], a[16:19], v[212:215]
 bl4 v246, s[8:11], s21 offen offset:2048 sc1 lds
 vaf v239, v232, v233
 vaf v241, v241, v237
 mf v[148:151], a[80:83], a[32:35], v[220:223]
 vex v235, v171
 mf v[156:159], a[80:83], a[48:51], v[228:231]
 dr4 a[80:83], v244 offset:12288
 cvp v196, v232, v233
 mf v[132:135], a[84:87], a[4:7], v[132:135]
 vex v232, v172
 mf v[140:143], a[84:87], a[20:23], v[140:143]
 bl4 v246, s[8:11], s21 offen offset:3072 sc1 lds
 vaf v239, v239, v234
 vaf v239, v239, v235
 mf v[148:151], a[84:87], a[36:39], v[148:151]
 sad s21, s21, 16384
 s_xor_b32 s22, s22, 0x8000
 vex v233, v173
 mf v[156:159], a[84:87], a[52:55], v[156:159]
 dr4 a[84:87], v244 offset:13312
 cvp v197, v234, v235
 mf v[132:135], a[88:91], a[8:11], v[132:135]
 vex v234, v174
 mf v[140:143], a[88:91], a[24:27], v[140:143]
 vaf v239, v239, v232
 vaf v239, v239, v233
 mf v[148:151], a[88:91], a[40:43], v[148:151]
 vex v235, v175
 mf v[156:159], a[88:91], a[56:59], v[156:159]
 dr4 a[88:91], v244 offset:14336
 cvp v198, v232, v233
 mf v[132:135], a[92:95], a[12:15], v[132:135]
 vaf v239, v239, v234
 vaf v239, v239, v235
 mf v[140:143], a[92:95], a[28:31], v[140:143]
 v_max_f32 v247, v238, v239
 v_cmp_lt_f32 vcc, s24, v247
 mf v[148:151], a[92:95], a[44:47], v[148:151]
 vex v232, v128
 mf v[156:159], a[92:95], a[60:63], v[156:159]
 dr4 a[92:95], v244 offset:15360
 cvp v199, v234, v235
 vex v233, v129
 s_cbranch_vccnz K2_SLOW_43
K2_BACK_44:
 swc lgkmcnt(8)
 mf v[0:3], a[96:99], v[184:187], v[0:3]
 vex v234, v130
 mf v[4:7], a[96:99], v[188:191], v[4:7]
 vaf v236, v232, v233
 vaf v242, v242, v238
 mf v[8:11], a[96:99], v[192:195], v[8:11]
 vex v235, v131
 mf v[12:15], a[96:99], v[196:199], v[12:15]
 dr4 a[96:99], v245 offset:16384
 cvp v176, v232, v233
 mf v[16:19], a[100:103], v[184:187], v[16:19]
 vex v232, v132
 mf v[20:23], a[100:103], v[188:191], v[20:23]
 vaf v236, v236, v234
 vaf v236, v236, v235
 mf v[24:27], a[100:103], v[192:195], v[24:27]
 vex v233, v133
 mf v[28:31], a[100:103], v[196:199], v[28:31]
 dr4 a[100:103], v245 offset:17408
 cvp v177, v234, v235
 mf v[32:35], a[104:107], v[184:187], v[32:35]
 vex v234, v134
 mf v[36:39], a[104:107], v[188:191], v[36:39]
 vaf v236, v236, v232
 vaf v236, v236, v233
 mf v[40:43], a[104:107], v[192:195], v[40:43]
 vex v235, v135
 mf v[44:47], a[104:107], v[196:199], v[44:47]
 dr4 a[104:107], v245 offset:18432
 cvp v178, v232, v233
 mf v[48:51], a[108:111], v[184:187], v[48:51]
 vex v232, v136
 mf v[52:55], a[108:111], v[188:191], v[52:55]
 vaf v236, v236, v234
 vaf v236, v236, v235
 mf v[56:59], a[108:111], v[192:195], v[56:59]
 vex v233, v137
 mf v[60:63], a[108:111], v[196:199], v[60:63]
 dr4 a[108:111], v245 offset:19456
 cvp v179, v234, v235
 mf v[64:67], a[112:115], v[184:187], v[64:67]
 vex v234, v138
 mf v[68:71], a[112:115], v[188:191], v[68:71]
 vaf v237, v232, v233
 vaf v243, v243, v239
 mf v[72:75], a[112:115], v[192:195], v[72:75]
 vex v235, v139
 mf v[76:79], a[112:115], v[196:199], v[76:79]
 dr4 a[112:115], v245 offset:20480
 cvp v180, v232, v233
 mf v[80:83], a[116:119], v[184:187], v[80:83]
 vex v232, v140
 mf v[84:87], a[116:119], v[188:191], v[84:87]
 vaf v237, v237, v234
 vaf v237, v237, v235
 mf v[88:91], a[116:119], v[192:195], v[88:91]
 vex v233, v141
 mf v[92:95], a[116:119], v[196:199], v[92:95]
 dr4 a[116:119], v245 offset:21504
 cvp v181, v234, v235
 mf v[96:99], a[120:123], v[184:187], v[96:99]
 vex v234, v142
 mf v[100:103], a[120:123], v[188:191], v[100:103]
 vaf v237, v237, v232
 vaf v237, v237, v233
 mf v[104:107], a[120:123], v[192:195], v[104:107]
 vex v235, v143
 mf v[108:111], a[120:123], v[196:199], v[108:111]
 dr4 a[120:123], v245 offset:22528
 cvp v182, v232, v233
 mf v[112:115], a[124:127], v[184:187], v[112:115]
 vaf v237, v237, v234
 vaf v237, v237, v235
 mf v[116:119], a[124:127], v[188:191], v[116:119]
 v_max_f32 v247, v236, v237
 v_cmp_lt_f32 vcc, s24, v247
 mf v[120:123], a[124:127], v[192:195], v[120:123]
 vex v232, v144
 mf v[124:127], a[124:127], v[196:199], v[124:127]
 dr4 a[124:127], v245 offset:23552
 cvp v183, v234, v235
 vex v233, v145
 s_cbranch_vccnz K2_SLOW_45
K2_BACK_46:
 s_sub_u32 s23, s23, 1
 s_cmp_lg_u32 s23, 0
 s_cbranch_scc1 K2_LOOPA
K2_SPECIAL:
 s_cmp_eq_u32 s16, 2
 s_cbranch_scc1 K2_PD_47
 s_cmp_gt_u32 s16, 2
 s_cbranch_scc1 K2_PE_48
 v_mov_b32 v216, v255
 v_mov_b32 v217, v255
 v_mov_b32 v218, v255
 v_mov_b32 v219, v255
 s_branch K2_PE_48
K2_PD_47:
 v_cndmask_b32 v216, v255, v216, s[26:27]
 v_cndmask_b32 v217, v255, v217, s[28:29]
 v_cndmask_b32 v218, v255, v218, s[30:31]
 v_cndmask_b32 v219, v255, v219, s[32:33]
K2_PE_48:
 s_cmp_eq_u32 s16, 3
 s_cbranch_scc1 K2_PD_49
 s_cmp_gt_u32 s16, 3
 s_cbranch_scc1 K2_PE_50
 v_mov_b32 v220, v255
 v_mov_b32 v221, v255
 v_mov_b32 v222, v255
 v_mov_b32 v223, v255
 s_branch K2_PE_50
K2_PD_49:
 v_cndmask_b32 v220, v255, v220, s[26:27]
 v_cndmask_b32 v221, v255, v221, s[28:29]
 v_cndmask_b32 v222, v255, v222, s[30:31]
 v_cndmask_b32 v223, v255, v223, s[32:33]
K2_PE_50:
 s_nop 1
 swc lgkmcnt(8)
 mf v[128:131], a[64:67], a[0:3], v[200:203]
 swc vmcnt(16)
 s_barrier
 vex v234, v146
 mf v[136:139], a[64:67], a[16:19], v[208:211]
 vaf v238, v232, v233
 vaf v240, v240, v236
 mf v[160:163], a[64:67], a[32:35], v[216:219]
 vex v235, v147
 mf v[168:171], a[64:67], a[48:51], v[224:227]
 dr4 a[64:67], v244 offset:16384
 cvp v192, v232, v233
 mf v[128:131], a[68:71], a[4:7], v[128:131]
 vex v232, v148
 mf v[136:139], a[68:71], a[20:23], v[136:139]
 vaf v238, v238, v234
 vaf v238, v238, v235
 mf v[160:163], a[68:71], a[36:39], v[160:163]
 vex v233, v149
 mf v[168:171], a[68:71], a[52:55], v[168:171]
 dr4 a[68:71], v244 offset:17408
 cvp v193, v234, v235
 mf v[128:131], a[72:75], a[8:11], v[128:131]
 sad m0, s22, 0
 vex v234, v150
 mf v[136:139], a[72:75], a[24:27], v[136:139]
 bl4 v246, s[8:11], s21 offen offset:0 sc1 lds
 vaf v238, v238, v232
 vaf v238, v238, v233
 mf v[160:163], a[72:75], a[40:43], v[160:163]
 vex v235, v151
 mf v[168:171], a[72:75], a[56:59], v[168:171]
 dr4 a[72:75], v244 offset:18432
 cvp v194, v232, v233
 mf v[128:131], a[76:79], a[12:15], v[128:131]
 vex v232, v152
 mf v[136:139], a[76:79], a[28:31], v[136:139]
 bl4 v246, s[8:11], s21 offen offset:1024 sc1 lds
 vaf v238, v238, v234
 vaf v238, v238, v235
 mf v[160:163], a[76:79], a[44:47], v[160:163]
 vex v233, v153
 mf v[168:171], a[76:79], a[60:63], v[168:171]
 dr4 a[76:79], v244 offset:19456
 cvp v195, v234, v235
 mf v[132:135], a[80:83], a[0:3], v[204:207]
 vex v234, v154
 mf v[140:143], a[80:83], a[16:19], v[212:215]
 bl4 v246, s[8:11], s21 offen offset:2048 sc1 lds
 vaf v239, v232, v233
 vaf v241, v241, v237
 mf v[164:167], a[80:83], a[32:35], v[220:223]
 vex v235, v155
 mf v[172:175], a[80:83], a[48:51], v[228:231]
 dr4 a[80:83], v244 offset:20480
 cvp v196, v232, v233
 mf v[132:135], a[84:87], a[4:7], v[132:135]
 vex v232, v156
 mf v[140:143], a[84:87], a[20:23], v[140:143]
 bl4 v246, s[8:11], s21 offen offset:3072 sc1 lds
 vaf v239, v239, v234
 vaf v239, v239, v235
 mf v[164:167], a[84:87], a[36:39], v[164:167]
 sad s21, s21, 16384
 vex v233, v157
 mf v[172:175], a[84:87], a[52:55], v[172:175]
 dr4 a[84:87], v244 offset:21504
 cvp v197, v234, v235
 mf v[132:135], a[88:91], a[8:11], v[132:135]
 vex v234, v158
 mf v[140:143], a[88:91], a[24:27], v[140:143]
 vaf v239, v239, v232
 vaf v239, v239, v233
 mf v[164:167], a[88:91], a[40:43], v[164:167]
 vex v235, v159
 mf v[172:175], a[88:91], a[56:59], v[172:175]
 dr4 a[88:91], v244 offset:22528
 cvp v198, v232, v233
 mf v[132:135], a[92:95], a[12:15], v[132:135]
 vaf v239, v239, v234
 vaf v239, v239, v235
 mf v[140:143], a[92:95], a[28:31], v[140:143]
 v_max_f32 v247, v238, v239
 v_cmp_lt_f32 vcc, s24, v247
 mf v[164:167], a[92:95], a[44:47], v[164:167]
 vex v232, v128
 mf v[172:175], a[92:95], a[60:63], v[172:175]
 dr4 a[92:95], v244 offset:23552
 cvp v199, v234, v235
 vex v233, v129
 s_cbranch_vccnz K2_SLOW_51
K2_BACK_52:
 swc lgkmcnt(8)
 mf v[0:3], a[96:99], v[176:179], v[0:3]
 vex v234, v130
 mf v[4:7], a[96:99], v[180:183], v[4:7]
 vaf v236, v232, v233
 vaf v242, v242, v238
 mf v[8:11], a[96:99], v[192:195], v[8:11]
 vex v235, v131
 mf v[12:15], a[96:99], v[196:199], v[12:15]
 dr4 a[96:99], v245 offset:24576
 cvp v184, v232, v233
 mf v[16:19], a[100:103], v[176:179], v[16:19]
 vex v232, v132
 mf v[20:23], a[100:103], v[180:183], v[20:23]
 vaf v236, v236, v234
 vaf v236, v236, v235
 mf v[24:27], a[100:103], v[192:195], v[24:27]
 vex v233, v133
 mf v[28:31], a[100:103], v[196:199], v[28:31]
 dr4 a[100:103], v245 offset:25600
 cvp v185, v234, v235
 mf v[32:35], a[104:107], v[176:179], v[32:35]
 vex v234, v134
 mf v[36:39], a[104:107], v[180:183], v[36:39]
 vaf v236, v236, v232
 vaf v236, v236, v233
 mf v[40:43], a[104:107], v[192:195], v[40:43]
 vex v235, v135
 mf v[44:47], a[104:107], v[196:199], v[44:47]
 dr4 a[104:107], v245 offset:26624
 cvp v186, v232, v233
 mf v[48:51], a[108:111], v[176:179], v[48:51]
 vex v232, v136
 mf v[52:55], a[108:111], v[180:183], v[52:55]
 vaf v236, v236, v234
 vaf v236, v236, v235
 mf v[56:59], a[108:111], v[192:195], v[56:59]
 vex v233, v137
 mf v[60:63], a[108:111], v[196:199], v[60:63]
 dr4 a[108:111], v245 offset:27648
 cvp v187, v234, v235
 mf v[64:67], a[112:115], v[176:179], v[64:67]
 vex v234, v138
 mf v[68:71], a[112:115], v[180:183], v[68:71]
 vaf v237, v232, v233
 vaf v243, v243, v239
 mf v[72:75], a[112:115], v[192:195], v[72:75]
 vex v235, v139
 mf v[76:79], a[112:115], v[196:199], v[76:79]
 dr4 a[112:115], v245 offset:28672
 cvp v188, v232, v233
 mf v[80:83], a[116:119], v[176:179], v[80:83]
 vex v232, v140
 mf v[84:87], a[116:119], v[180:183], v[84:87]
 vaf v237, v237, v234
 vaf v237, v237, v235
 mf v[88:91], a[116:119], v[192:195], v[88:91]
 vex v233, v141
 mf v[92:95], a[116:119], v[196:199], v[92:95]
 dr4 a[116:119], v245 offset:29696
 cvp v189, v234, v235
 mf v[96:99], a[120:123], v[176:179], v[96:99]
 vex v234, v142
 mf v[100:103], a[120:123], v[180:183], v[100:103]
 vaf v237, v237, v232
 vaf v237, v237, v233
 mf v[104:107], a[120:123], v[192:195], v[104:107]
 vex v235, v143
 mf v[108:111], a[120:123], v[196:199], v[108:111]
 dr4 a[120:123], v245 offset:30720
 cvp v190, v232, v233
 mf v[112:115], a[124:127], v[176:179], v[112:115]
 vaf v237, v237, v234
 vaf v237, v237, v235
 mf v[116:119], a[124:127], v[180:183], v[116:119]
 v_max_f32 v247, v236, v237
 v_cmp_lt_f32 vcc, s24, v247
 mf v[120:123], a[124:127], v[192:195], v[120:123]
 vex v232, v160
 mf v[124:127], a[124:127], v[196:199], v[124:127]
 dr4 a[124:127], v245 offset:31744
 cvp v191, v234, v235
 vex v233, v161
 s_cbranch_vccnz K2_SLOW_53
K2_BACK_54:
K2_SPECIAL_R1:
 s_cmp_eq_u32 s16, 3
 s_cbranch_scc1 K2_PD_55
 s_cmp_lt_u32 s16, 3
 s_cbranch_scc1 K2_PE_56
 v_mov_b32 v224, v255
 v_mov_b32 v225, v255
 v_mov_b32 v226, v255
 v_mov_b32 v227, v255
 s_branch K2_PE_56
K2_PD_55:
 v_cndmask_b32 v224, v255, v224, s[26:27]
 v_cndmask_b32 v225, v255, v225, s[28:29]
 v_cndmask_b32 v226, v255, v226, s[30:31]
 v_cndmask_b32 v227, v255, v227, s[32:33]
K2_PE_56:
 s_cmp_eq_u32 s16, 2
 s_cbranch_scc1 K2_PD_57
 s_cmp_lt_u32 s16, 2
 s_cbranch_scc1 K2_PE_58
 v_mov_b32 v228, v255
 v_mov_b32 v229, v255
 v_mov_b32 v230, v255
 v_mov_b32 v231, v255
 s_branch K2_PE_58
K2_PD_57:
 v_cndmask_b32 v228, v255, v228, s[26:27]
 v_cndmask_b32 v229, v255, v229, s[28:29]
 v_cndmask_b32 v230, v255, v230, s[30:31]
 v_cndmask_b32 v231, v255, v231, s[32:33]
K2_PE_58:
 s_nop 1
 swc lgkmcnt(8)
 mf v[128:131], a[64:67], a[0:3], v[200:203]
 swc vmcnt(16)
 s_barrier
 vex v234, v162
 vaf v238, v232, v233
 mf v[136:139], a[64:67], a[16:19], v[208:211]
 vex v235, v163
 cvp v192, v232, v233
 mf v[152:155], a[64:67], a[48:51], v[224:227]
 dr4 a[64:67], v244 offset:24576
 vaf v240, v240, v236
 vaf v241, v241, v237
 mf v[128:131], a[68:71], a[4:7], v[128:131]
 vex v232, v164
 vaf v238, v238, v234
 mf v[136:139], a[68:71], a[20:23], v[136:139]
 vaf v238, v238, v235
 mf v[152:155], a[68:71], a[52:55], v[152:155]
 dr4 a[68:71], v244 offset:25600
 vex v233, v165
 cvp v193, v234, v235
 mf v[128:131], a[72:75], a[8:11], v[128:131]
 sad m0, s22, 8192
 vex v234, v166
 vaf v238, v238, v232
 mf v[136:139], a[72:75], a[24:27], v[136:139]
 bl4 v246, s[8:11], s21 offen offset:0 sc1 lds
 vaf v238, v238, v233
 vex v235, v167
 mf v[152:155], a[72:75], a[56:59], v[152:155]
 dr4 a[72:75], v244 offset:26624
 cvp v194, v232, v233
 vex v232, v168
 mf v[128:131], a[76:79], a[12:15], v[128:131]
 vaf v238, v238, v234
 mf v[136:139], a[76:79], a[28:31], v[136:139]
 bl4 v246, s[8:11], s21 offen offset:1024 sc1 lds
 vaf v238, v238, v235
 vex v233, v169
 mf v[152:155], a[76:79], a[60:63], v[152:155]
 dr4 a[76:79], v244 offset:27648
 cvp v195, v234, v235
 vex v234, v170
 mf v[132:135], a[80:83], a[0:3], v[204:207]
 vaf v239, v232, v233
 vex v235, v171
 mf v[140:143], a[80:83], a[16:19], v[212:215]
 bl4 v246, s[8:11], s21 offen offset:2048 sc1 lds
 cvp v196, v232, v233
 vex v232, v172
 mf v[156:159], a[80:83], a[48:51], v[228:231]
 dr4 a[80:83], v244 offset:28672
 vaf v239, v239, v234
 mf v[132:135], a[84:87], a[4:7], v[132:135]
 vaf v239, v239, v235
 vex v233, v173
 mf v[140:143], a[84:87], a[20:23], v[140:143]
 bl4 v246, s[8:11], s21 offen offset:3072 sc1 lds
 sad s21, s21, 16384
 cvp v197, v234, v235
 vex v234, v174
 mf v[156:159], a[84:87], a[52:55], v[156:159]
 dr4 a[84:87], v244 offset:29696
 vaf v239, v239, v232
 vaf v239, v239, v233
 mf v[132:135], a[88:91], a[8:11], v[132:135]
 vex v235, v175
 cvp v198, v232, v233
 mf v[140:143], a[88:91], a[24:27], v[140:143]
 s_nop 0
 mf v[156:159], a[88:91], a[56:59], v[156:159]
 dr4 a[88:91], v244 offset:30720
 vaf v239, v239, v234
 vaf v239, v239, v235
 mf v[132:135], a[92:95], a[12:15], v[132:135]
 v_max_f32 v247, v238, v239
 v_cmp_lt_f32 vcc, s24, v247
 mf v[140:143], a[92:95], a[28:31], v[140:143]
 cvp v199, v234, v235
 vex v232, v128
 mf v[156:159], a[92:95], a[60:63], v[156:159]
 dr4 a[92:95], v244 offset:31744
 vex v233, v129
 s_cbranch_vccnz K2_SLOW_59
K2_BACK_60:
 swc lgkmcnt(8)
 mf v[0:3], a[96:99], v[184:187], v[0:3]
 v_xor_b32 v245, 0x8000, v245
 vex v234, v130
 mf v[4:7], a[96:99], v[188:191], v[4:7]
 vaf v236, v232, v233
 vaf v242, v242, v238
 mf v[8:11], a[96:99], v[192:195], v[8:11]
 vex v235, v131
 mf v[12:15], a[96:99], v[196:199], v[12:15]
 dr4 a[96:99], v245 offset:0
 cvp v176, v232, v233
 mf v[16:19], a[100:103], v[184:187], v[16:19]
 vex v232, v132
 mf v[20:23], a[100:103], v[188:191], v[20:23]
 vaf v236, v236, v234
 vaf v236, v236, v235
 mf v[24:27], a[100:103], v[192:195], v[24:27]
 vex v233, v133
 mf v[28:31], a[100:103], v[196:199], v[28:31]
 dr4 a[100:103], v245 offset:1024
 cvp v177, v234, v235
 mf v[32:35], a[104:107], v[184:187], v[32:35]
 vex v234, v134
 mf v[36:39], a[104:107], v[188:191], v[36:39]
 vaf v236, v236, v232
 vaf v236, v236, v233
 mf v[40:43], a[104:107], v[192:195], v[40:43]
 vex v235, v135
 mf v[44:47], a[104:107], v[196:199], v[44:47]
 dr4 a[104:107], v245 offset:2048
 cvp v178, v232, v233
 mf v[48:51], a[108:111], v[184:187], v[48:51]
 vex v232, v136
 mf v[52:55], a[108:111], v[188:191], v[52:55]
 vaf v236, v236, v234
 vaf v236, v236, v235
 mf v[56:59], a[108:111], v[192:195], v[56:59]
 vex v233, v137
 mf v[60:63], a[108:111], v[196:199], v[60:63]
 dr4 a[108:111], v245 offset:3072
 cvp v179, v234, v235
 mf v[64:67], a[112:115], v[184:187], v[64:67]
 vex v234, v138
 mf v[68:71], a[112:115], v[188:191], v[68:71]
 vaf v237, v232, v233
 vaf v243, v243, v239
 mf v[72:75], a[112:115], v[192:195], v[72:75]
 vex v235, v139
 mf v[76:79], a[112:115], v[196:199], v[76:79]
 dr4 a[112:115], v245 offset:4096
 cvp v180, v232, v233
 mf v[80:83], a[116:119], v[184:187], v[80:83]
 vex v232, v140
 mf v[84:87], a[116:119], v[188:191], v[84:87]
 vaf v237, v237, v234
 vaf v237, v237, v235
 mf v[88:91], a[116:119], v[192:195], v[88:91]
 vex v233, v141
 mf v[92:95], a[116:119], v[196:199], v[92:95]
 dr4 a[116:119], v245 offset:5120
 cvp v181, v234, v235
 mf v[96:99], a[120:123], v[184:187], v[96:99]
 vex v234, v142
 mf v[100:103], a[120:123], v[188:191], v[100:103]
 vaf v237, v237, v232
 vaf v237, v237, v233
 mf v[104:107], a[120:123], v[192:195], v[104:107]
 vex v235, v143
 mf v[108:111], a[120:123], v[196:199], v[108:111]
 dr4 a[120:123], v245 offset:6144
 cvp v182, v232, v233
 mf v[112:115], a[124:127], v[184:187], v[112:115]
 vaf v237, v237, v234
 vaf v237, v237, v235
 mf v[116:119], a[124:127], v[188:191], v[116:119]
 v_max_f32 v247, v236, v237
 v_cmp_lt_f32 vcc, s24, v247
 mf v[120:123], a[124:127], v[192:195], v[120:123]
 vex v232, v152
 mf v[124:127], a[124:127], v[196:199], v[124:127]
 dr4 a[124:127], v245 offset:7168
 cvp v183, v234, v235
 vex v233, v153
 s_cbranch_vccnz K2_SLOW_61
K2_BACK_62:
 s_cmp_eq_u32 s16, 1
 s_cbranch_scc1 K2_PD_63
 s_cmp_lt_u32 s16, 1
 s_cbranch_scc1 K2_PE_64
 v_mov_b32 v224, v255
 v_mov_b32 v225, v255
 v_mov_b32 v226, v255
 v_mov_b32 v227, v255
 s_branch K2_PE_64
K2_PD_63:
 v_cndmask_b32 v224, v255, v224, s[26:27]
 v_cndmask_b32 v225, v255, v225, s[28:29]
 v_cndmask_b32 v226, v255, v226, s[30:31]
 v_cndmask_b32 v227, v255, v227, s[32:33]
K2_PE_64:
 s_cmp_eq_u32 s16, 0
 s_cbranch_scc1 K2_PD_65
 s_cmp_lt_u32 s16, 0
 s_cbranch_scc1 K2_PE_66
 v_mov_b32 v228, v255
 v_mov_b32 v229, v255
 v_mov_b32 v230, v255
 v_mov_b32 v231, v255
 s_branch K2_PE_66
K2_PD_65:
 v_cndmask_b32 v228, v255, v228, s[26:27]
 v_cndmask_b32 v229, v255, v229, s[28:29]
 v_cndmask_b32 v230, v255, v230, s[30:31]
 v_cndmask_b32 v231, v255, v231, s[32:33]
K2_PE_66:
 s_nop 1
 swc lgkmcnt(8)
 mf v[128:131], a[64:67], a[0:3], v[200:203]
 swc vmcnt(16)
 s_barrier
 v_xor_b32 v244, 0x8000, v244
 vex v234, v154
 mf v[136:139], a[64:67], a[16:19], v[208:211]
 vaf v239, v232, v233
 mf v[168:171], a[64:67], a[48:51], v[224:227]
 dr4 a[64:67], v244 offset:0
 vex v235, v155
 mf v[128:131], a[68:71], a[4:7], v[128:131]
 cvp v196, v232, v233
 mf v[136:139], a[68:71], a[20:23], v[136:139]
 vaf v240, v240, v236
 mf v[168:171], a[68:71], a[52:55], v[168:171]
 dr4 a[68:71], v244 offset:1024
 vaf v241, v241, v237
 mf v[128:131], a[72:75], a[8:11], v[128:131]
 sad m0, s22, 16384
 vex v232, v156
 mf v[136:139], a[72:75], a[24:27], v[136:139]
 bl4 v246, s[8:11], s21 offen offset:0 sc1 lds
 vaf v239, v239, v234
 mf v[168:171], a[72:75], a[56:59], v[168:171]
 dr4 a[72:75], v244 offset:2048
 vaf v239, v239, v235
 mf v[128:131], a[76:79], a[12:15], v[128:131]
 vex v233, v157
 mf v[136:139], a[76:79], a[28:31], v[136:139]
 bl4 v246, s[8:11], s21 offen offset:1024 sc1 lds
 cvp v197, v234, v235
 mf v[168:171], a[76:79], a[60:63], v[168:171]
 dr4 a[76:79], v244 offset:3072
 vex v234, v158
 mf v[132:135], a[80:83], a[0:3], v[204:207]
 vaf v239, v239, v232
 mf v[140:143], a[80:83], a[16:19], v[212:215]
 bl4 v246, s[8:11], s21 offen offset:2048 sc1 lds
 vaf v239, v239, v233
 mf v[172:175], a[80:83], a[48:51], v[228:231]
 dr4 a[80:83], v244 offset:4096
 vex v235, v159
 mf v[132:135], a[84:87], a[4:7], v[132:135]
 cvp v198, v232, v233
 mf v[140:143], a[84:87], a[20:23], v[140:143]
 bl4 v246, s[8:11], s21 offen offset:3072 sc1 lds
 sad s21, s21, 16384
 s_nop 0
 mf v[172:175], a[84:87], a[52:55], v[172:175]
 dr4 a[84:87], v244 offset:5120
 vaf v239, v239, v234
 mf v[132:135], a[88:91], a[8:11], v[132:135]
 vaf v239, v239, v235
 mf v[140:143], a[88:91], a[24:27], v[140:143]
 v_cmp_lt_f32 vcc, s24, v239
 mf v[172:175], a[88:91], a[56:59], v[172:175]
 dr4 a[88:91], v244 offset:6144
 cvp v199, v234, v235
 mf v[132:135], a[92:95], a[12:15], v[132:135]
 vex v232, v128
 mf v[140:143], a[92:95], a[28:31], v[140:143]
 vex v233, v129
 mf v[172:175], a[92:95], a[60:63], v[172:175]
 dr4 a[92:95], v244 offset:7168
 s_cbranch_vccnz K2_SLOW_67
K2_BACK_68:
 swc lgkmcnt(8)
 mf v[0:3], a[96:99], v[176:179], v[0:3]
 vex v234, v130
 vaf v236, v232, v233
 mf v[4:7], a[96:99], v[180:183], v[4:7]
 vex v235, v131
 cvp v184, v232, v233
 mf v[12:15], a[96:99], v[196:199], v[12:15]
 dr4 a[96:99], v245 offset:8192
 vaf v243, v243, v239
 vex v232, v132
 mf v[16:19], a[100:103], v[176:179], v[16:19]
 vaf v236, v236, v234
 mf v[20:23], a[100:103], v[180:183], v[20:23]
 vaf v236, v236, v235
 vex v233, v133
 mf v[28:31], a[100:103], v[196:199], v[28:31]
 dr4 a[100:103], v245 offset:9216
 cvp v185, v234, v235
 vex v234, v134
 mf v[32:35], a[104:107], v[176:179], v[32:35]
 vaf v236, v236, v232
 vaf v236, v236, v233
 mf v[36:39], a[104:107], v[180:183], v[36:39]
 vex v235, v135
 mf v[44:47], a[104:107], v[196:199], v[44:47]
 dr4 a[104:107], v245 offset:10240
 cvp v186, v232, v233
 vex v232, v136
 mf v[48:51], a[108:111], v[176:179], v[48:51]
 vaf v236, v236, v234
 vaf v236, v236, v235
 mf v[52:55], a[108:111], v[180:183], v[52:55]
 vex v233, v137
 cvp v187, v234, v235
 mf v[60:63], a[108:111], v[196:199], v[60:63]
 dr4 a[108:111], v245 offset:11264
 vex v234, v138
 mf v[64:67], a[112:115], v[176:179], v[64:67]
 vaf v237, v232, v233
 vex v235, v139
 mf v[68:71], a[112:115], v[180:183], v[68:71]
 cvp v188, v232, v233
 vex v232, v140
 mf v[76:79], a[112:115], v[196:199], v[76:79]
 dr4 a[112:115], v245 offset:12288
 vaf v237, v237, v234
 vaf v237, v237, v235
 mf v[80:83], a[116:119], v[176:179], v[80:83]
 vex v233, v141
 mf v[84:87], a[116:119], v[180:183], v[84:87]
 cvp v189, v234, v235
 vex v234, v142
 mf v[92:95], a[116:119], v[196:199], v[92:95]
 dr4 a[116:119], v245 offset:13312
 vaf v237, v237, v232
 vaf v237, v237, v233
 mf v[96:99], a[120:123], v[176:179], v[96:99]
 vex v235, v143
 cvp v190, v232, v233
 mf v[100:103], a[120:123], v[180:183], v[100:103]
 s_nop 0
 mf v[108:111], a[120:123], v[196:199], v[108:111]
 dr4 a[120:123], v245 offset:14336
 vaf v237, v237, v234
 vaf v237, v237, v235
 mf v[112:115], a[124:127], v[176:179], v[112:115]
 v_max_f32 v247, v236, v237
 v_cmp_lt_f32 vcc, s24, v247
 mf v[116:119], a[124:127], v[180:183], v[116:119]
 cvp v191, v234, v235
 vex v232, v168
 mf v[124:127], a[124:127], v[196:199], v[124:127]
 dr4 a[124:127], v245 offset:15360
 vex v233, v169
 s_cbranch_vccnz K2_SLOW_69
K2_BACK_70:
 s_cmp_lt_u32 s16, 2
 s_cselect_b32 s48, s42, s44
 s_cselect_b32 s49, s43, s45
 s_mov_b32 s19, 1409024
 s_cselect_b32 s50, 4194304, s19
 s_mul_i32 s19, s2, 5504
 s_mul_i32 s20, s2, 16384
 s_cselect_b32 s19, s20, s19
 s_and_b32 s20, s16, 1
 s_lshl_b32 s20, s20, 13
 sad s19, s19, s20
 v_and_b32 v254, 0x3ff, v244
 v_lshlrev_b32 v254, 3, v254
 buffer_load_dword v254, v254, s[48:51], s19 offen
 v_and_b32 v253, 0x3ff, v244
 s_getpc_b64 s[88:89]
CT4:
 sad s88, s88, (K3_START-CT4)&0xffffffff
 s_addc_u32 s89, s89, ((K3_START-CT4)>>32)&0xffffffff
 s_lshr_b32 s90, s2, 3
 s_lshl_b32 s90, s90, 2
 sad s90, s90, s16
 s_mul_i32 s90, s90, ((K2_END-K3_START+16383)/16384)*128
 v_lshlrev_b32 v253, 3, v253
 v_min_u32 v253, ((K2_END-K3_START+16383)/16384)*128-128, v253
 v_add_u32 v253, s90, v253
 v_min_u32 v253, K2_END-K3_START-4, v253
 global_load_dword v253, v253, s[88:89]
 v_mov_b32 v216, v200
 v_mov_b32 v217, v201
 v_mov_b32 v218, v202
 v_mov_b32 v219, v203
 v_mov_b32 v220, v204
 v_mov_b32 v221, v205
 v_mov_b32 v222, v206
 v_mov_b32 v223, v207
 v_mov_b32 v224, v208
 v_mov_b32 v225, v209
 v_mov_b32 v226, v210
 v_mov_b32 v227, v211
 v_mov_b32 v228, v212
 v_mov_b32 v229, v213
 v_mov_b32 v230, v214
 v_mov_b32 v231, v215
 s_cmp_eq_u32 s18, 7
 s_cbranch_scc1 K2_HOOK_79
K2_HB_80:
 s_nop 1
 swc lgkmcnt(8)
 mf v[128:131], a[64:67], a[0:3], v[200:203]
 swc vmcnt(16)
 s_barrier
 vex v234, v170
 mf v[136:139], a[64:67], a[16:19], v[208:211]
 dr4 a[64:67], v244 offset:8192
 vaf v239, v232, v233
 mf v[128:131], a[68:71], a[4:7], v[128:131]
 vex v235, v171
 mf v[136:139], a[68:71], a[20:23], v[136:139]
 dr4 a[68:71], v244 offset:9216
 mf v[128:131], a[72:75], a[8:11], v[128:131]
 cvp v196, v232, v233
 mf v[136:139], a[72:75], a[24:27], v[136:139]
 dr4 a[72:75], v244 offset:10240
 vaf v240, v240, v236
 mf v[128:131], a[76:79], a[12:15], v[128:131]
 vaf v241, v241, v237
 mf v[136:139], a[76:79], a[28:31], v[136:139]
 dr4 a[76:79], v244 offset:11264
 mf v[132:135], a[80:83], a[0:3], v[204:207]
 sad m0, s22, 24576
 vex v232, v172
 mf v[140:143], a[80:83], a[16:19], v[212:215]
 dr4 a[80:83], v244 offset:12288
 bl4 v246, s[8:11], s21 offen offset:0 sc1 lds
 vaf v239, v239, v234
 mf v[132:135], a[84:87], a[4:7], v[132:135]
 mf v[140:143], a[84:87], a[20:23], v[140:143]
 dr4 a[84:87], v244 offset:13312
 vaf v239, v239, v235
 mf v[132:135], a[88:91], a[8:11], v[132:135]
 vex v233, v173
 mf v[140:143], a[88:91], a[24:27], v[140:143]
 dr4 a[88:91], v244 offset:14336
 bl4 v246, s[8:11], s21 offen offset:1024 sc1 lds
 cvp v197, v234, v235
 mf v[132:135], a[92:95], a[12:15], v[132:135]
 mf v[140:143], a[92:95], a[28:31], v[140:143]
 dr4 a[92:95], v244 offset:15360
 vex v234, v174
 swc lgkmcnt(4)
 mf v[144:147], a[64:67], a[0:3], v[216:219]
 vaf v239, v239, v232
 mf v[152:155], a[64:67], a[16:19], v[224:227]
 dr4 a[64:67], v244 offset:16384
 bl4 v246, s[8:11], s21 offen offset:2048 sc1 lds
 mf v[144:147], a[68:71], a[4:7], v[144:147]
 vaf v239, v239, v233
 mf v[152:155], a[68:71], a[20:23], v[152:155]
 dr4 a[68:71], v244 offset:17408
 vex v235, v175
 mf v[144:147], a[72:75], a[8:11], v[144:147]
 cvp v198, v232, v233
 mf v[152:155], a[72:75], a[24:27], v[152:155]
 dr4 a[72:75], v244 offset:18432
 bl4 v246, s[8:11], s21 offen offset:3072 sc1 lds
 mf v[144:147], a[76:79], a[12:15], v[144:147]
 sad s21, s21, 16384
 s_xor_b32 s22, s22, 0x8000
 s_nop 0
 mf v[152:155], a[76:79], a[28:31], v[152:155]
 dr4 a[76:79], v244 offset:19456
 vaf v239, v239, v234
 swc lgkmcnt(4)
 mf v[148:151], a[80:83], a[0:3], v[220:223]
 mf v[156:159], a[80:83], a[16:19], v[228:231]
 dr4 a[80:83], v244 offset:20480
 vaf v239, v239, v235
 mf v[148:151], a[84:87], a[4:7], v[148:151]
 v_cmp_lt_f32 vcc, s24, v239
 mf v[156:159], a[84:87], a[20:23], v[156:159]
 dr4 a[84:87], v244 offset:21504
 cvp v199, v234, v235
 mf v[148:151], a[88:91], a[8:11], v[148:151]
 mf v[156:159], a[88:91], a[24:27], v[156:159]
 dr4 a[88:91], v244 offset:22528
 vex v232, v128
 mf v[148:151], a[92:95], a[12:15], v[148:151]
 vex v233, v129
 mf v[156:159], a[92:95], a[28:31], v[156:159]
 dr4 a[92:95], v244 offset:23552
 s_cbranch_vccnz K2_SLOW_81
K2_BACK_82:
 swc lgkmcnt(8)
 mf v[0:3], a[96:99], v[184:187], v[0:3]
 vex v234, v130
 vaf v236, v232, v233
 mf v[4:7], a[96:99], v[188:191], v[4:7]
 vex v235, v131
 cvp v176, v232, v233
 mf v[12:15], a[96:99], v[196:199], v[12:15]
 dr4 a[96:99], v245 offset:16384
 vaf v243, v243, v239
 vex v232, v132
 mf v[16:19], a[100:103], v[184:187], v[16:19]
 vaf v236, v236, v234
 mf v[20:23], a[100:103], v[188:191], v[20:23]
 vaf v236, v236, v235
 vex v233, v133
 mf v[28:31], a[100:103], v[196:199], v[28:31]
 dr4 a[100:103], v245 offset:17408
 cvp v177, v234, v235
 vex v234, v134
 mf v[32:35], a[104:107], v[184:187], v[32:35]
 vaf v236, v236, v232
 vaf v236, v236, v233
 mf v[36:39], a[104:107], v[188:191], v[36:39]
 vex v235, v135
 mf v[44:47], a[104:107], v[196:199], v[44:47]
 dr4 a[104:107], v245 offset:18432
 cvp v178, v232, v233
 vex v232, v136
 mf v[48:51], a[108:111], v[184:187], v[48:51]
 vaf v236, v236, v234
 vaf v236, v236, v235
 mf v[52:55], a[108:111], v[188:191], v[52:55]
 vex v233, v137
 cvp v179, v234, v235
 mf v[60:63], a[108:111], v[196:199], v[60:63]
 dr4 a[108:111], v245 offset:19456
 vex v234, v138
 mf v[64:67], a[112:115], v[184:187], v[64:67]
 vaf v237, v232, v233
 vex v235, v139
 mf v[68:71], a[112:115], v[188:191], v[68:71]
 cvp v180, v232, v233
 vex v232, v140
 mf v[76:79], a[112:115], v[196:199], v[76:79]
 dr4 a[112:115], v245 offset:20480
 vaf v237, v237, v234
 vaf v237, v237, v235
 mf v[80:83], a[116:119], v[184:187], v[80:83]
 vex v233, v141
 mf v[84:87], a[116:119], v[188:191], v[84:87]
 cvp v181, v234, v235
 vex v234, v142
 mf v[92:95], a[116:119], v[196:199], v[92:95]
 dr4 a[116:119], v245 offset:21504
 vaf v237, v237, v232
 vaf v237, v237, v233
 mf v[96:99], a[120:123], v[184:187], v[96:99]
 vex v235, v143
 cvp v182, v232, v233
 mf v[100:103], a[120:123], v[188:191], v[100:103]
 s_nop 0
 mf v[108:111], a[120:123], v[196:199], v[108:111]
 dr4 a[120:123], v245 offset:22528
 vaf v237, v237, v234
 vaf v237, v237, v235
 mf v[112:115], a[124:127], v[184:187], v[112:115]
 v_max_f32 v247, v236, v237
 v_cmp_lt_f32 vcc, s24, v247
 mf v[116:119], a[124:127], v[188:191], v[116:119]
 cvp v183, v234, v235
 vex v232, v144
 mf v[124:127], a[124:127], v[196:199], v[124:127]
 dr4 a[124:127], v245 offset:23552
 vex v233, v145
 s_cbranch_vccnz K2_SLOW_83
K2_BACK_84:
 v_and_b32 v249, 0x3ff, v244
 v_mov_b32 v248, v242
 s_nop 1
 v_permlane16_swap_b32 v242, v248
 vaf v242, v242, v248
 v_mov_b32 v248, v242
 s_nop 1
 v_permlane32_swap_b32 v242, v248
 vaf v242, v242, v248
 v_rcp_f32 v242, v242
 v_mov_b32 v248, v243
 s_nop 1
 v_permlane16_swap_b32 v243, v248
 vaf v243, v243, v248
 v_mov_b32 v248, v243
 s_nop 1
 v_permlane32_swap_b32 v243, v248
 vaf v243, v243, v248
 v_rcp_f32 v243, v243
 vmf v8, v8, v242
 vmf v9, v9, v242
 vmf v10, v10, v242
 vmf v11, v11, v242
 vmf v24, v24, v242
 vmf v25, v25, v242
 vmf v26, v26, v242
 vmf v27, v27, v242
 cvp v8, v8, v9
 cvp v9, v10, v11
 cvp v10, v24, v25
 cvp v11, v26, v27
 sad s19, s38, 0
 bs4 v[8:11], v249, s[12:15], s19 offen offset:0 sc1
 vmf v40, v40, v242
 vmf v41, v41, v242
 vmf v42, v42, v242
 vmf v43, v43, v242
 vmf v56, v56, v242
 vmf v57, v57, v242
 vmf v58, v58, v242
 vmf v59, v59, v242
 cvp v40, v40, v41
 cvp v41, v42, v43
 cvp v42, v56, v57
 cvp v43, v58, v59
 sad s19, s38, 4096
 bs4 v[40:43], v249, s[12:15], s19 offen offset:0 sc1
 vmf v72, v72, v242
 vmf v73, v73, v242
 vmf v74, v74, v242
 vmf v75, v75, v242
 vmf v88, v88, v242
 vmf v89, v89, v242
 vmf v90, v90, v242
 vmf v91, v91, v242
 cvp v72, v72, v73
 cvp v73, v74, v75
 cvp v74, v88, v89
 cvp v75, v90, v91
 sad s19, s38, 8192
 bs4 v[72:75], v249, s[12:15], s19 offen offset:0 sc1
 vmf v104, v104, v242
 vmf v105, v105, v242
 vmf v106, v106, v242
 vmf v107, v107, v242
 vmf v120, v120, v242
 vmf v121, v121, v242
 vmf v122, v122, v242
 vmf v123, v123, v242
 cvp v104, v104, v105
 cvp v105, v106, v107
 cvp v106, v120, v121
 cvp v107, v122, v123
 sad s19, s38, 12288
 bs4 v[104:107], v249, s[12:15], s19 offen offset:0 sc1
 vmf v12, v12, v243
 vmf v13, v13, v243
 vmf v14, v14, v243
 vmf v15, v15, v243
 vmf v28, v28, v243
 vmf v29, v29, v243
 vmf v30, v30, v243
 vmf v31, v31, v243
 cvp v12, v12, v13
 cvp v13, v14, v15
 cvp v14, v28, v29
 cvp v15, v30, v31
 sad s19, s38, 0
 sad s19, s19, s85
 bs4 v[12:15], v249, s[12:15], s19 offen offset:0 sc1
 vmf v44, v44, v243
 vmf v45, v45, v243
 vmf v46, v46, v243
 vmf v47, v47, v243
 vmf v60, v60, v243
 vmf v61, v61, v243
 vmf v62, v62, v243
 vmf v63, v63, v243
 cvp v44, v44, v45
 cvp v45, v46, v47
 cvp v46, v60, v61
 cvp v47, v62, v63
 sad s19, s38, 4096
 sad s19, s19, s85
 bs4 v[44:47], v249, s[12:15], s19 offen offset:0 sc1
 vmf v76, v76, v243
 vmf v77, v77, v243
 vmf v78, v78, v243
 vmf v79, v79, v243
 vmf v92, v92, v243
 vmf v93, v93, v243
 vmf v94, v94, v243
 vmf v95, v95, v243
 cvp v76, v76, v77
 cvp v77, v78, v79
 cvp v78, v92, v93
 cvp v79, v94, v95
 sad s19, s38, 8192
 sad s19, s19, s85
 bs4 v[76:79], v249, s[12:15], s19 offen offset:0 sc1
 vmf v108, v108, v243
 vmf v109, v109, v243
 vmf v110, v110, v243
 vmf v111, v111, v243
 vmf v124, v124, v243
 vmf v125, v125, v243
 vmf v126, v126, v243
 vmf v127, v127, v243
 cvp v108, v108, v109
 cvp v109, v110, v111
 cvp v110, v124, v125
 cvp v111, v126, v127
 sad s19, s38, 12288
 sad s19, s19, s85
 bs4 v[108:111], v249, s[12:15], s19 offen offset:0 sc1
 s_cmp_eq_u32 s16, 0
 s_cselect_b32 s87, 2, 0x40000000
 s_lshl_b32 s19, s18, 1
 s_sub_u32 s23, 14, s19
 s_cmp_eq_u32 s23, 0
 s_cbranch_scc1 K2_TAIL
.p2align 6
K2_LOOPB:
 swc lgkmcnt(8)
 mf v[128:131], a[64:67], a[0:3], v[200:203]
 swc vmcnt(12)
 s_barrier
 vex v234, v146
 mf v[136:139], a[64:67], a[16:19], v[208:211]
 dr4 a[64:67], v244 offset:24576
 vaf v238, v232, v233
 vaf v240, v240, v236
 mf v[128:131], a[68:71], a[4:7], v[128:131]
 vex v235, v147
 mf v[136:139], a[68:71], a[20:23], v[136:139]
 dr4 a[68:71], v244 offset:25600
 cvp v192, v232, v233
 mf v[128:131], a[72:75], a[8:11], v[128:131]
 vex v232, v148
 mf v[136:139], a[72:75], a[24:27], v[136:139]
 dr4 a[72:75], v244 offset:26624
 vaf v238, v238, v234
 vaf v238, v238, v235
 mf v[128:131], a[76:79], a[12:15], v[128:131]
 vex v233, v149
 mf v[136:139], a[76:79], a[28:31], v[136:139]
 dr4 a[76:79], v244 offset:27648
 cvp v193, v234, v235
 mf v[132:135], a[80:83], a[0:3], v[204:207]
 sad m0, s22, 0
 vex v234, v150
 mf v[140:143], a[80:83], a[16:19], v[212:215]
 dr4 a[80:83], v244 offset:28672
 bl4 v246, s[8:11], s21 offen offset:0 sc1 lds
 vaf v238, v238, v232
 vaf v238, v238, v233
 mf v[132:135], a[84:87], a[4:7], v[132:135]
 vex v235, v151
 mf v[140:143], a[84:87], a[20:23], v[140:143]
 dr4 a[84:87], v244 offset:29696
 cvp v194, v232, v233
 mf v[132:135], a[88:91], a[8:11], v[132:135]
 vex v232, v152
 mf v[140:143], a[88:91], a[24:27], v[140:143]
 dr4 a[88:91], v244 offset:30720
 bl4 v246, s[8:11], s21 offen offset:1024 sc1 lds
 vaf v238, v238, v234
 vaf v238, v238, v235
 mf v[132:135], a[92:95], a[12:15], v[132:135]
 vex v233, v153
 mf v[140:143], a[92:95], a[28:31], v[140:143]
 dr4 a[92:95], v244 offset:31744
 cvp v195, v234, v235
 swc lgkmcnt(4)
 mf v[160:163], a[64:67], a[0:3], v[216:219]
 v_xor_b32 v244, 0x8000, v244
 vex v234, v154
 mf v[168:171], a[64:67], a[16:19], v[224:227]
 dr4 a[64:67], v244 offset:0
 bl4 v246, s[8:11], s21 offen offset:2048 sc1 lds
 vaf v239, v232, v233
 vaf v241, v241, v237
 mf v[160:163], a[68:71], a[4:7], v[160:163]
 vex v235, v155
 mf v[168:171], a[68:71], a[20:23], v[168:171]
 dr4 a[68:71], v244 offset:1024
 cvp v196, v232, v233
 mf v[160:163], a[72:75], a[8:11], v[160:163]
 vex v232, v156
 mf v[168:171], a[72:75], a[24:27], v[168:171]
 dr4 a[72:75], v244 offset:2048
 bl4 v246, s[8:11], s21 offen offset:3072 sc1 lds
 vaf v239, v239, v234
 vaf v239, v239, v235
 mf v[160:163], a[76:79], a[12:15], v[160:163]
 sad s21, s21, 16384
 vex v233, v157
 mf v[168:171], a[76:79], a[28:31], v[168:171]
 dr4 a[76:79], v244 offset:3072
 cvp v197, v234, v235
 swc lgkmcnt(4)
 mf v[164:167], a[80:83], a[0:3], v[220:223]
 vex v234, v158
 mf v[172:175], a[80:83], a[16:19], v[228:231]
 dr4 a[80:83], v244 offset:4096
 vaf v239, v239, v232
 vaf v239, v239, v233
 mf v[164:167], a[84:87], a[4:7], v[164:167]
 vex v235, v159
 mf v[172:175], a[84:87], a[20:23], v[172:175]
 dr4 a[84:87], v244 offset:5120
 cvp v198, v232, v233
 mf v[164:167], a[88:91], a[8:11], v[164:167]
 vaf v239, v239, v234
 vaf v239, v239, v235
 mf v[172:175], a[88:91], a[24:27], v[172:175]
 dr4 a[88:91], v244 offset:6144
 v_max_f32 v247, v238, v239
 v_cmp_lt_f32 vcc, s24, v247
 mf v[164:167], a[92:95], a[12:15], v[164:167]
 vex v232, v128
 mf v[172:175], a[92:95], a[28:31], v[172:175]
 dr4 a[92:95], v244 offset:7168
 cvp v199, v234, v235
 vex v233, v129
 s_cbranch_vccnz K2_SLOW_85
K2_BACK_86:
 swc lgkmcnt(8)
 mf v[0:3], a[96:99], v[176:179], v[0:3]
 vex v234, v130
 mf v[4:7], a[96:99], v[180:183], v[4:7]
 dr4 a[96:99], v245 offset:24576
 vaf v236, v232, v233
 vaf v240, v240, v238
 mf v[16:19], a[100:103], v[176:179], v[16:19]
 vex v235, v131
 mf v[20:23], a[100:103], v[180:183], v[20:23]
 dr4 a[100:103], v245 offset:25600
 cvp v184, v232, v233
 mf v[32:35], a[104:107], v[176:179], v[32:35]
 vex v232, v132
 mf v[36:39], a[104:107], v[180:183], v[36:39]
 dr4 a[104:107], v245 offset:26624
 vaf v236, v236, v234
 vaf v236, v236, v235
 mf v[48:51], a[108:111], v[176:179], v[48:51]
 vex v233, v133
 mf v[52:55], a[108:111], v[180:183], v[52:55]
 dr4 a[108:111], v245 offset:27648
 cvp v185, v234, v235
 mf v[64:67], a[112:115], v[176:179], v[64:67]
 sad m0, s22, 8192
 vex v234, v134
 mf v[68:71], a[112:115], v[180:183], v[68:71]
 dr4 a[112:115], v245 offset:28672
 bl4 v246, s[8:11], s21 offen offset:0 sc1 lds
 vaf v236, v236, v232
 vaf v236, v236, v233
 mf v[80:83], a[116:119], v[176:179], v[80:83]
 vex v235, v135
 mf v[84:87], a[116:119], v[180:183], v[84:87]
 dr4 a[116:119], v245 offset:29696
 cvp v186, v232, v233
 mf v[96:99], a[120:123], v[176:179], v[96:99]
 vex v232, v136
 mf v[100:103], a[120:123], v[180:183], v[100:103]
 dr4 a[120:123], v245 offset:30720
 bl4 v246, s[8:11], s21 offen offset:1024 sc1 lds
 vaf v236, v236, v234
 vaf v236, v236, v235
 mf v[112:115], a[124:127], v[176:179], v[112:115]
 vex v233, v137
 mf v[116:119], a[124:127], v[180:183], v[116:119]
 dr4 a[124:127], v245 offset:31744
 cvp v187, v234, v235
 swc lgkmcnt(4)
 mf v[0:3], a[96:99], v[192:195], v[0:3]
 v_xor_b32 v245, 0x8000, v245
 vex v234, v138
 mf v[4:7], a[96:99], v[196:199], v[4:7]
 dr4 a[96:99], v245 offset:0
 bl4 v246, s[8:11], s21 offen offset:2048 sc1 lds
 vaf v237, v232, v233
 vaf v241, v241, v239
 mf v[16:19], a[100:103], v[192:195], v[16:19]
 vex v235, v139
 mf v[20:23], a[100:103], v[196:199], v[20:23]
 dr4 a[100:103], v245 offset:1024
 cvp v188, v232, v233
 mf v[32:35], a[104:107], v[192:195], v[32:35]
 vex v232, v140
 mf v[36:39], a[104:107], v[196:199], v[36:39]
 dr4 a[104:107], v245 offset:2048
 bl4 v246, s[8:11], s21 offen offset:3072 sc1 lds
 vaf v237, v237, v234
 vaf v237, v237, v235
 mf v[48:51], a[108:111], v[192:195], v[48:51]
 sad s21, s21, 16384
 vex v233, v141
 mf v[52:55], a[108:111], v[196:199], v[52:55]
 dr4 a[108:111], v245 offset:3072
 cvp v189, v234, v235
 swc lgkmcnt(4)
 mf v[64:67], a[112:115], v[192:195], v[64:67]
 vex v234, v142
 mf v[68:71], a[112:115], v[196:199], v[68:71]
 dr4 a[112:115], v245 offset:4096
 vaf v237, v237, v232
 vaf v237, v237, v233
 mf v[80:83], a[116:119], v[192:195], v[80:83]
 vex v235, v143
 mf v[84:87], a[116:119], v[196:199], v[84:87]
 dr4 a[116:119], v245 offset:5120
 cvp v190, v232, v233
 mf v[96:99], a[120:123], v[192:195], v[96:99]
 vaf v237, v237, v234
 vaf v237, v237, v235
 mf v[100:103], a[120:123], v[196:199], v[100:103]
 dr4 a[120:123], v245 offset:6144
 v_max_f32 v247, v236, v237
 v_cmp_lt_f32 vcc, s24, v247
 mf v[112:115], a[124:127], v[192:195], v[112:115]
 vex v232, v160
 mf v[116:119], a[124:127], v[196:199], v[116:119]
 dr4 a[124:127], v245 offset:7168
 cvp v191, v234, v235
 vex v233, v161
 s_cbranch_vccnz K2_SLOW_87
K2_BACK_88:
 s_cmp_eq_u32 s23, 1
 s_cbranch_scc1 K2_HOOK_97
K2_HB_98:
 swc lgkmcnt(8)
 mf v[128:131], a[64:67], a[0:3], v[200:203]
 swc vmcnt(12)
 s_barrier
 vex v234, v162
 mf v[136:139], a[64:67], a[16:19], v[208:211]
 dr4 a[64:67], v244 offset:8192
 vaf v238, v232, v233
 vaf v240, v240, v236
 mf v[128:131], a[68:71], a[4:7], v[128:131]
 vex v235, v163
 mf v[136:139], a[68:71], a[20:23], v[136:139]
 dr4 a[68:71], v244 offset:9216
 cvp v192, v232, v233
 mf v[128:131], a[72:75], a[8:11], v[128:131]
 vex v232, v164
 mf v[136:139], a[72:75], a[24:27], v[136:139]
 dr4 a[72:75], v244 offset:10240
 vaf v238, v238, v234
 vaf v238, v238, v235
 mf v[128:131], a[76:79], a[12:15], v[128:131]
 vex v233, v165
 mf v[136:139], a[76:79], a[28:31], v[136:139]
 dr4 a[76:79], v244 offset:11264
 cvp v193, v234, v235
 mf v[132:135], a[80:83], a[0:3], v[204:207]
 sad m0, s22, 16384
 vex v234, v166
 mf v[140:143], a[80:83], a[16:19], v[212:215]
 dr4 a[80:83], v244 offset:12288
 bl4 v246, s[8:11], s21 offen offset:0 sc1 lds
 vaf v238, v238, v232
 vaf v238, v238, v233
 mf v[132:135], a[84:87], a[4:7], v[132:135]
 vex v235, v167
 mf v[140:143], a[84:87], a[20:23], v[140:143]
 dr4 a[84:87], v244 offset:13312
 cvp v194, v232, v233
 mf v[132:135], a[88:91], a[8:11], v[132:135]
 vex v232, v168
 mf v[140:143], a[88:91], a[24:27], v[140:143]
 dr4 a[88:91], v244 offset:14336
 bl4 v246, s[8:11], s21 offen offset:1024 sc1 lds
 vaf v238, v238, v234
 vaf v238, v238, v235
 mf v[132:135], a[92:95], a[12:15], v[132:135]
 vex v233, v169
 mf v[140:143], a[92:95], a[28:31], v[140:143]
 dr4 a[92:95], v244 offset:15360
 cvp v195, v234, v235
 swc lgkmcnt(4)
 mf v[144:147], a[64:67], a[0:3], v[216:219]
 vex v234, v170
 mf v[152:155], a[64:67], a[16:19], v[224:227]
 dr4 a[64:67], v244 offset:16384
 bl4 v246, s[8:11], s21 offen offset:2048 sc1 lds
 vaf v239, v232, v233
 vaf v241, v241, v237
 mf v[144:147], a[68:71], a[4:7], v[144:147]
 vex v235, v171
 mf v[152:155], a[68:71], a[20:23], v[152:155]
 dr4 a[68:71], v244 offset:17408
 cvp v196, v232, v233
 mf v[144:147], a[72:75], a[8:11], v[144:147]
 vex v232, v172
 mf v[152:155], a[72:75], a[24:27], v[152:155]
 dr4 a[72:75], v244 offset:18432
 bl4 v246, s[8:11], s21 offen offset:3072 sc1 lds
 vaf v239, v239, v234
 vaf v239, v239, v235
 mf v[144:147], a[76:79], a[12:15], v[144:147]
 sad s21, s21, 16384
 vex v233, v173
 mf v[152:155], a[76:79], a[28:31], v[152:155]
 dr4 a[76:79], v244 offset:19456
 cvp v197, v234, v235
 swc lgkmcnt(4)
 mf v[148:151], a[80:83], a[0:3], v[220:223]
 vex v234, v174
 mf v[156:159], a[80:83], a[16:19], v[228:231]
 dr4 a[80:83], v244 offset:20480
 vaf v239, v239, v232
 vaf v239, v239, v233
 mf v[148:151], a[84:87], a[4:7], v[148:151]
 vex v235, v175
 mf v[156:159], a[84:87], a[20:23], v[156:159]
 dr4 a[84:87], v244 offset:21504
 cvp v198, v232, v233
 mf v[148:151], a[88:91], a[8:11], v[148:151]
 vaf v239, v239, v234
 vaf v239, v239, v235
 mf v[156:159], a[88:91], a[24:27], v[156:159]
 dr4 a[88:91], v244 offset:22528
 v_max_f32 v247, v238, v239
 v_cmp_lt_f32 vcc, s24, v247
 mf v[148:151], a[92:95], a[12:15], v[148:151]
 vex v232, v128
 mf v[156:159], a[92:95], a[28:31], v[156:159]
 dr4 a[92:95], v244 offset:23552
 cvp v199, v234, v235
 vex v233, v129
 s_cbranch_vccnz K2_SLOW_99
K2_BACK_100:
 swc lgkmcnt(8)
 mf v[0:3], a[96:99], v[184:187], v[0:3]
 vex v234, v130
 mf v[4:7], a[96:99], v[188:191], v[4:7]
 dr4 a[96:99], v245 offset:8192
 vaf v236, v232, v233
 vaf v240, v240, v238
 mf v[16:19], a[100:103], v[184:187], v[16:19]
 vex v235, v131
 mf v[20:23], a[100:103], v[188:191], v[20:23]
 dr4 a[100:103], v245 offset:9216
 cvp v176, v232, v233
 mf v[32:35], a[104:107], v[184:187], v[32:35]
 vex v232, v132
 mf v[36:39], a[104:107], v[188:191], v[36:39]
 dr4 a[104:107], v245 offset:10240
 vaf v236, v236, v234
 vaf v236, v236, v235
 mf v[48:51], a[108:111], v[184:187], v[48:51]
 vex v233, v133
 mf v[52:55], a[108:111], v[188:191], v[52:55]
 dr4 a[108:111], v245 offset:11264
 cvp v177, v234, v235
 mf v[64:67], a[112:115], v[184:187], v[64:67]
 sad m0, s22, 24576
 vex v234, v134
 mf v[68:71], a[112:115], v[188:191], v[68:71]
 dr4 a[112:115], v245 offset:12288
 bl4 v246, s[8:11], s21 offen offset:0 sc1 lds
 vaf v236, v236, v232
 vaf v236, v236, v233
 mf v[80:83], a[116:119], v[184:187], v[80:83]
 vex v235, v135
 mf v[84:87], a[116:119], v[188:191], v[84:87]
 dr4 a[116:119], v245 offset:13312
 cvp v178, v232, v233
 mf v[96:99], a[120:123], v[184:187], v[96:99]
 vex v232, v136
 mf v[100:103], a[120:123], v[188:191], v[100:103]
 dr4 a[120:123], v245 offset:14336
 bl4 v246, s[8:11], s21 offen offset:1024 sc1 lds
 vaf v236, v236, v234
 vaf v236, v236, v235
 mf v[112:115], a[124:127], v[184:187], v[112:115]
 vex v233, v137
 mf v[116:119], a[124:127], v[188:191], v[116:119]
 dr4 a[124:127], v245 offset:15360
 cvp v179, v234, v235
 swc lgkmcnt(4)
 mf v[0:3], a[96:99], v[192:195], v[0:3]
 vex v234, v138
 mf v[4:7], a[96:99], v[196:199], v[4:7]
 dr4 a[96:99], v245 offset:16384
 bl4 v246, s[8:11], s21 offen offset:2048 sc1 lds
 vaf v237, v232, v233
 vaf v241, v241, v239
 mf v[16:19], a[100:103], v[192:195], v[16:19]
 vex v235, v139
 mf v[20:23], a[100:103], v[196:199], v[20:23]
 dr4 a[100:103], v245 offset:17408
 cvp v180, v232, v233
 mf v[32:35], a[104:107], v[192:195], v[32:35]
 vex v232, v140
 mf v[36:39], a[104:107], v[196:199], v[36:39]
 dr4 a[104:107], v245 offset:18432
 bl4 v246, s[8:11], s21 offen offset:3072 sc1 lds
 vaf v237, v237, v234
 vaf v237, v237, v235
 mf v[48:51], a[108:111], v[192:195], v[48:51]
 sad s21, s21, 16384
 s_xor_b32 s22, s22, 0x8000
 vex v233, v141
 mf v[52:55], a[108:111], v[196:199], v[52:55]
 dr4 a[108:111], v245 offset:19456
 cvp v181, v234, v235
 swc lgkmcnt(4)
 mf v[64:67], a[112:115], v[192:195], v[64:67]
 vex v234, v142
 mf v[68:71], a[112:115], v[196:199], v[68:71]
 dr4 a[112:115], v245 offset:20480
 vaf v237, v237, v232
 vaf v237, v237, v233
 mf v[80:83], a[116:119], v[192:195], v[80:83]
 vex v235, v143
 mf v[84:87], a[116:119], v[196:199], v[84:87]
 dr4 a[116:119], v245 offset:21504
 cvp v182, v232, v233
 mf v[96:99], a[120:123], v[192:195], v[96:99]
 vaf v237, v237, v234
 vaf v237, v237, v235
 mf v[100:103], a[120:123], v[196:199], v[100:103]
 dr4 a[120:123], v245 offset:22528
 v_max_f32 v247, v236, v237
 v_cmp_lt_f32 vcc, s24, v247
 mf v[112:115], a[124:127], v[192:195], v[112:115]
 vex v232, v144
 mf v[116:119], a[124:127], v[196:199], v[116:119]
 dr4 a[124:127], v245 offset:23552
 cvp v183, v234, v235
 vex v233, v145
 s_cbranch_vccnz K2_SLOW_101
K2_BACK_102:
 s_sub_u32 s87, s87, 1
 s_cmp_eq_u32 s87, 0
 s_cbranch_scc1 K2_HOOK_103
K2_HB_104:
 s_sub_u32 s23, s23, 1
 s_cmp_lg_u32 s23, 0
 s_cbranch_scc1 K2_LOOPB
K2_TAIL:
 s_cmp_eq_u32 s16, 3
 s_cbranch_scc1 K2_PD_105
 s_cmp_lt_u32 s16, 3
 s_cbranch_scc1 K2_PE_106
 v_mov_b32 v208, v255
 v_mov_b32 v209, v255
 v_mov_b32 v210, v255
 v_mov_b32 v211, v255
 s_branch K2_PE_106
K2_PD_105:
 v_cndmask_b32 v208, v255, v208, s[26:27]
 v_cndmask_b32 v209, v255, v209, s[28:29]
 v_cndmask_b32 v210, v255, v210, s[30:31]
 v_cndmask_b32 v211, v255, v211, s[32:33]
K2_PE_106:
 s_cmp_eq_u32 s16, 2
 s_cbranch_scc1 K2_PD_107
 s_cmp_lt_u32 s16, 2
 s_cbranch_scc1 K2_PE_108
 v_mov_b32 v212, v255
 v_mov_b32 v213, v255
 v_mov_b32 v214, v255
 v_mov_b32 v215, v255
 s_branch K2_PE_108
K2_PD_107:
 v_cndmask_b32 v212, v255, v212, s[26:27]
 v_cndmask_b32 v213, v255, v213, s[28:29]
 v_cndmask_b32 v214, v255, v214, s[30:31]
 v_cndmask_b32 v215, v255, v215, s[32:33]
K2_PE_108:
 s_nop 1
 s_cmp_eq_u32 s16, 1
 s_cbranch_scc1 K2_PD_109
 s_cmp_lt_u32 s16, 1
 s_cbranch_scc1 K2_PE_110
 v_mov_b32 v224, v255
 v_mov_b32 v225, v255
 v_mov_b32 v226, v255
 v_mov_b32 v227, v255
 s_branch K2_PE_110
K2_PD_109:
 v_cndmask_b32 v224, v255, v224, s[26:27]
 v_cndmask_b32 v225, v255, v225, s[28:29]
 v_cndmask_b32 v226, v255, v226, s[30:31]
 v_cndmask_b32 v227, v255, v227, s[32:33]
K2_PE_110:
 s_cmp_eq_u32 s16, 0
 s_cbranch_scc1 K2_PD_111
 s_cmp_lt_u32 s16, 0
 s_cbranch_scc1 K2_PE_112
 v_mov_b32 v228, v255
 v_mov_b32 v229, v255
 v_mov_b32 v230, v255
 v_mov_b32 v231, v255
 s_branch K2_PE_112
K2_PD_111:
 v_cndmask_b32 v228, v255, v228, s[26:27]
 v_cndmask_b32 v229, v255, v229, s[28:29]
 v_cndmask_b32 v230, v255, v230, s[30:31]
 v_cndmask_b32 v231, v255, v231, s[32:33]
K2_PE_112:
 s_nop 1
 swc vmcnt(12)
 s_barrier
 swc lgkmcnt(8)
 mf v[136:139], a[64:67], a[16:19], v[208:211]
 dr4 a[64:67], v244 offset:24576
 vex v234, v146
 vaf v238, v232, v233
 vex v235, v147
 mf v[136:139], a[68:71], a[20:23], v[136:139]
 dr4 a[68:71], v244 offset:25600
 cvp v192, v232, v233
 vaf v240, v240, v236
 vaf v241, v241, v237
 mf v[136:139], a[72:75], a[24:27], v[136:139]
 dr4 a[72:75], v244 offset:26624
 vex v232, v148
 vaf v238, v238, v234
 vaf v238, v238, v235
 mf v[136:139], a[76:79], a[28:31], v[136:139]
 dr4 a[76:79], v244 offset:27648
 vex v233, v149
 cvp v193, v234, v235
 mf v[140:143], a[80:83], a[16:19], v[212:215]
 dr4 a[80:83], v244 offset:28672
 vex v234, v150
 vaf v238, v238, v232
 vaf v238, v238, v233
 mf v[140:143], a[84:87], a[20:23], v[140:143]
 dr4 a[84:87], v244 offset:29696
 vex v235, v151
 cvp v194, v232, v233
 vex v232, v152
 mf v[140:143], a[88:91], a[24:27], v[140:143]
 dr4 a[88:91], v244 offset:30720
 vaf v238, v238, v234
 vaf v238, v238, v235
 mf v[140:143], a[92:95], a[28:31], v[140:143]
 dr4 a[92:95], v244 offset:31744
 vex v233, v153
 cvp v195, v234, v235
 vex v234, v154
 swc lgkmcnt(4)
 mf v[168:171], a[64:67], a[16:19], v[224:227]
 vaf v239, v232, v233
 vex v235, v155
 cvp v196, v232, v233
 mf v[168:171], a[68:71], a[20:23], v[168:171]
 vex v232, v156
 vaf v239, v239, v234
 mf v[168:171], a[72:75], a[24:27], v[168:171]
 vaf v239, v239, v235
 vex v233, v157
 cvp v197, v234, v235
 mf v[168:171], a[76:79], a[28:31], v[168:171]
 vex v234, v158
 vaf v239, v239, v232
 vaf v239, v239, v233
 swc lgkmcnt(0)
 mf v[172:175], a[80:83], a[16:19], v[228:231]
 vex v235, v159
 cvp v198, v232, v233
 mf v[172:175], a[84:87], a[20:23], v[172:175]
 s_nop 0
 vaf v239, v239, v234
 vaf v239, v239, v235
 mf v[172:175], a[88:91], a[24:27], v[172:175]
 v_max_f32 v247, v238, v239
 v_cmp_lt_f32 vcc, s24, v247
 cvp v199, v234, v235
 mf v[172:175], a[92:95], a[28:31], v[172:175]
 vex v232, v136
 vex v233, v137
 s_cbranch_vccnz K2_SLOW_113
K2_BACK_114:
 swc lgkmcnt(8)
 mf v[0:3], a[96:99], v[176:179], v[0:3]
 vex v234, v138
 mf v[4:7], a[96:99], v[180:183], v[4:7]
 dr4 a[96:99], v245 offset:24576
 vaf v237, v232, v233
 mf v[16:19], a[100:103], v[176:179], v[16:19]
 vex v235, v139
 mf v[20:23], a[100:103], v[180:183], v[20:23]
 dr4 a[100:103], v245 offset:25600
 mf v[32:35], a[104:107], v[176:179], v[32:35]
 cvp v188, v232, v233
 mf v[36:39], a[104:107], v[180:183], v[36:39]
 dr4 a[104:107], v245 offset:26624
 vaf v240, v240, v238
 mf v[48:51], a[108:111], v[176:179], v[48:51]
 vaf v241, v241, v239
 mf v[52:55], a[108:111], v[180:183], v[52:55]
 dr4 a[108:111], v245 offset:27648
 mf v[64:67], a[112:115], v[176:179], v[64:67]
 vex v232, v140
 mf v[68:71], a[112:115], v[180:183], v[68:71]
 dr4 a[112:115], v245 offset:28672
 vaf v237, v237, v234
 mf v[80:83], a[116:119], v[176:179], v[80:83]
 mf v[84:87], a[116:119], v[180:183], v[84:87]
 dr4 a[116:119], v245 offset:29696
 vaf v237, v237, v235
 mf v[96:99], a[120:123], v[176:179], v[96:99]
 vex v233, v141
 mf v[100:103], a[120:123], v[180:183], v[100:103]
 dr4 a[120:123], v245 offset:30720
 cvp v189, v234, v235
 mf v[112:115], a[124:127], v[176:179], v[112:115]
 mf v[116:119], a[124:127], v[180:183], v[116:119]
 dr4 a[124:127], v245 offset:31744
 vex v234, v142
 swc lgkmcnt(4)
 mf v[0:3], a[96:99], v[192:195], v[0:3]
 v_xor_b32 v245, 0x8000, v245
 vaf v237, v237, v232
 mf v[4:7], a[96:99], v[196:199], v[4:7]
 dr4 a[96:99], v245 offset:0
 mf v[16:19], a[100:103], v[192:195], v[16:19]
 vaf v237, v237, v233
 mf v[20:23], a[100:103], v[196:199], v[20:23]
 dr4 a[100:103], v245 offset:1024
 vex v235, v143
 mf v[32:35], a[104:107], v[192:195], v[32:35]
 cvp v190, v232, v233
 mf v[36:39], a[104:107], v[196:199], v[36:39]
 dr4 a[104:107], v245 offset:2048
 mf v[48:51], a[108:111], v[192:195], v[48:51]
 s_nop 0
 mf v[52:55], a[108:111], v[196:199], v[52:55]
 dr4 a[108:111], v245 offset:3072
 vaf v237, v237, v234
 swc lgkmcnt(4)
 mf v[64:67], a[112:115], v[192:195], v[64:67]
 mf v[68:71], a[112:115], v[196:199], v[68:71]
 dr4 a[112:115], v245 offset:4096
 vaf v237, v237, v235
 mf v[80:83], a[116:119], v[192:195], v[80:83]
 v_cmp_lt_f32 vcc, s24, v237
 mf v[84:87], a[116:119], v[196:199], v[84:87]
 dr4 a[116:119], v245 offset:5120
 cvp v191, v234, v235
 mf v[96:99], a[120:123], v[192:195], v[96:99]
 mf v[100:103], a[120:123], v[196:199], v[100:103]
 dr4 a[120:123], v245 offset:6144
 vex v232, v168
 mf v[112:115], a[124:127], v[192:195], v[112:115]
 vex v233, v169
 mf v[116:119], a[124:127], v[196:199], v[116:119]
 dr4 a[124:127], v245 offset:7168
 s_cbranch_vccnz K2_SLOW_115
K2_BACK_116:
 swc vmcnt(0)
 s_barrier
 vex v234, v170
 vaf v239, v232, v233
 vex v235, v171
 cvp v196, v232, v233
 vaf v241, v241, v237
 vex v232, v172
 vaf v239, v239, v234
 vaf v239, v239, v235
 vex v233, v173
 cvp v197, v234, v235
 vex v234, v174
 vaf v239, v239, v232
 vaf v239, v239, v233
 vex v235, v175
 cvp v198, v232, v233
 s_nop 0
 vaf v239, v239, v234
 vaf v239, v239, v235
 v_cmp_lt_f32 vcc, s24, v239
 cvp v199, v234, v235
 s_cbranch_vccnz K2_SLOW_117
K2_BACK_118:
 s_sub_u32 s87, s87, 1
 s_cmp_ge_u32 s87, 2
 s_cbranch_scc1 K2_NOLO
 s_mov_b32 s39, 61865984
 s_lshl_b32 s19, s18, 7
 v_mov_b32 v252, s19
 v_mov_b32 v253, 1
 s_mov_b64 exec, 1
 buffer_atomic_add v253, v252, s[12:15], s39 offen sc1
 s_mov_b64 exec, -1
K2_NOLO:
 swc lgkmcnt(0)
 mf v[4:7], a[96:99], v[188:191], v[4:7]
 dr4 a[96:99], v245 offset:8192
 vaf v241, v241, v239
 mf v[20:23], a[100:103], v[188:191], v[20:23]
 dr4 a[100:103], v245 offset:9216
 mf v[36:39], a[104:107], v[188:191], v[36:39]
 dr4 a[104:107], v245 offset:10240
 mf v[52:55], a[108:111], v[188:191], v[52:55]
 dr4 a[108:111], v245 offset:11264
 mf v[68:71], a[112:115], v[188:191], v[68:71]
 dr4 a[112:115], v245 offset:12288
 mf v[84:87], a[116:119], v[188:191], v[84:87]
 dr4 a[116:119], v245 offset:13312
 mf v[100:103], a[120:123], v[188:191], v[100:103]
 dr4 a[120:123], v245 offset:14336
 mf v[116:119], a[124:127], v[188:191], v[116:119]
 dr4 a[124:127], v245 offset:15360
 swc lgkmcnt(4)
 mf v[4:7], a[96:99], v[196:199], v[4:7]
 mf v[20:23], a[100:103], v[196:199], v[20:23]
 mf v[36:39], a[104:107], v[196:199], v[36:39]
 mf v[52:55], a[108:111], v[196:199], v[52:55]
 swc lgkmcnt(0)
 mf v[68:71], a[112:115], v[196:199], v[68:71]
 mf v[84:87], a[116:119], v[196:199], v[84:87]
 mf v[100:103], a[120:123], v[196:199], v[100:103]
 mf v[116:119], a[124:127], v[196:199], v[116:119]
 v_and_b32 v244, 0x3ff, v244
 v_mov_b32 v248, v240
 s_nop 1
 v_permlane16_swap_b32 v240, v248
 vaf v240, v240, v248
 v_mov_b32 v248, v240
 s_nop 1
 v_permlane32_swap_b32 v240, v248
 vaf v240, v240, v248
 v_rcp_f32 v240, v240
 v_mov_b32 v248, v241
 s_nop 1
 v_permlane16_swap_b32 v241, v248
 vaf v241, v241, v248
 v_mov_b32 v248, v241
 s_nop 1
 v_permlane32_swap_b32 v241, v248
 vaf v241, v241, v248
 v_rcp_f32 v241, v241
 vmf v0, v0, v240
 vmf v1, v1, v240
 vmf v2, v2, v240
 vmf v3, v3, v240
 vmf v16, v16, v240
 vmf v17, v17, v240
 vmf v18, v18, v240
 vmf v19, v19, v240
 cvp v128, v0, v1
 cvp v129, v2, v3
 cvp v130, v16, v17
 cvp v131, v18, v19
 sad s19, s37, 0
 bs4 v[128:131], v244, s[12:15], s19 offen offset:0 sc1
 vmf v32, v32, v240
 vmf v33, v33, v240
 vmf v34, v34, v240
 vmf v35, v35, v240
 vmf v48, v48, v240
 vmf v49, v49, v240
 vmf v50, v50, v240
 vmf v51, v51, v240
 cvp v132, v32, v33
 cvp v133, v34, v35
 cvp v134, v48, v49
 cvp v135, v50, v51
 sad s19, s37, 4096
 bs4 v[132:135], v244, s[12:15], s19 offen offset:0 sc1
 vmf v64, v64, v240
 vmf v65, v65, v240
 vmf v66, v66, v240
 vmf v67, v67, v240
 vmf v80, v80, v240
 vmf v81, v81, v240
 vmf v82, v82, v240
 vmf v83, v83, v240
 cvp v136, v64, v65
 cvp v137, v66, v67
 cvp v138, v80, v81
 cvp v139, v82, v83
 sad s19, s37, 8192
 bs4 v[136:139], v244, s[12:15], s19 offen offset:0 sc1
 vmf v96, v96, v240
 vmf v97, v97, v240
 vmf v98, v98, v240
 vmf v99, v99, v240
 vmf v112, v112, v240
 vmf v113, v113, v240
 vmf v114, v114, v240
 vmf v115, v115, v240
 cvp v140, v96, v97
 cvp v141, v98, v99
 cvp v142, v112, v113
 cvp v143, v114, v115
 sad s19, s37, 12288
 bs4 v[140:143], v244, s[12:15], s19 offen offset:0 sc1
 vmf v4, v4, v241
 vmf v5, v5, v241
 vmf v6, v6, v241
 vmf v7, v7, v241
 vmf v20, v20, v241
 vmf v21, v21, v241
 vmf v22, v22, v241
 vmf v23, v23, v241
 cvp v128, v4, v5
 cvp v129, v6, v7
 cvp v130, v20, v21
 cvp v131, v22, v23
 sad s19, s37, 0
 sad s19, s19, s85
 bs4 v[128:131], v244, s[12:15], s19 offen offset:0 sc1
 vmf v36, v36, v241
 vmf v37, v37, v241
 vmf v38, v38, v241
 vmf v39, v39, v241
 vmf v52, v52, v241
 vmf v53, v53, v241
 vmf v54, v54, v241
 vmf v55, v55, v241
 cvp v132, v36, v37
 cvp v133, v38, v39
 cvp v134, v52, v53
 cvp v135, v54, v55
 sad s19, s37, 4096
 sad s19, s19, s85
 bs4 v[132:135], v244, s[12:15], s19 offen offset:0 sc1
 vmf v68, v68, v241
 vmf v69, v69, v241
 vmf v70, v70, v241
 vmf v71, v71, v241
 vmf v84, v84, v241
 vmf v85, v85, v241
 vmf v86, v86, v241
 vmf v87, v87, v241
 cvp v136, v68, v69
 cvp v137, v70, v71
 cvp v138, v84, v85
 cvp v139, v86, v87
 sad s19, s37, 8192
 sad s19, s19, s85
 bs4 v[136:139], v244, s[12:15], s19 offen offset:0 sc1
 vmf v100, v100, v241
 vmf v101, v101, v241
 vmf v102, v102, v241
 vmf v103, v103, v241
 vmf v116, v116, v241
 vmf v117, v117, v241
 vmf v118, v118, v241
 vmf v119, v119, v241
 cvp v140, v100, v101
 cvp v141, v102, v103
 cvp v142, v116, v117
 cvp v143, v118, v119
 sad s19, s37, 12288
 sad s19, s19, s85
 bs4 v[140:143], v244, s[12:15], s19 offen offset:0 sc1
K3_START:
 s_load_dwordx2 s[28:29], s[0:1], 0
 s_load_dwordx2 s[30:31], s[0:1], 80
 s_and_b32 s35, s2, 7
 s_lshr_b32 s20, s2, 3
 s_and_b32 s21, s20, 7
 s_lshr_b32 s22, s2, 6
 s_mul_i32 s19, s35, 21
 s_min_u32 s20, s35, 2
 sad s19, s19, s20
 s_cmp_eq_u32 s35, 7
 s_cselect_b32 s19, 150, s19
 s_cmp_lt_u32 s35, 2
 s_cselect_b32 s32, 0, 4096
 s_cmp_eq_u32 s35, 6
 s_cselect_b32 s32, 0, s32
 s_sub_u32 s20, s19, 128
 s_cmp_ge_u32 s35, 6
 s_cselect_b32 s20, s20, s19
 s_cselect_b32 s8, s44, s42
 s_cselect_b32 s9, s45, s43
 s_mov_b32 s33, 0
 s_mov_b32 s11, 0x00020000
 sad s27, s20, 22
 s_lshl_b32 s27, s27, 15
 s_lshl_b32 s10, s32, 3
 s_sub_u32 s10, s27, s10
 s_lshl_b32 s27, s21, 1
 s_lshr_b32 s24, s16, 1
 sad s27, s27, s24
 s_mul_i32 s24, s27, 700416
 s_lshl_b32 s19, s19, 12
 sad s24, s24, s19
 s_and_b32 s27, s16, 1
 s_lshl_b32 s27, s27, 11
 sad s24, s24, s27
 sad s24, s24, 34603008
 s_lshl_b32 s23, s20, 15
 s_lshl_b32 s27, s16, 13
 sad s23, s23, s27
 s_lshl_b32 s27, s22, 8
 sad s23, s23, s27
 s_lshl_b32 s25, s16, 11
 v_lshrrev_b32 v245, 4, v244
 v_lshrrev_b32 v247, 4, v245
 v_and_b32 v248, 15, v245
 v_lshlrev_b32 v249, 1, v247
 v_xor_b32 v248, v248, v249
 v_lshlrev_b32 v247, 10, v247
 v_lshl_add_u32 v240, v248, 4, v247
 v_xor_b32 v247, 128, v240
 v_add_u32 v241, 3072, v247
 s_mov_b32 s39, 61865984
 s_lshl_b32 s19, s21, 7
 v_mov_b32 v250, s19
 buffer_load_dword v246, v250, s[12:15], s39 offen sc1
 s_barrier
 sad m0, s25, 0
 sad s20, s23, 0
 bl4 v240, s[8:11], s20 offen lds
 bl4 v241, s[8:11], s20 offen offset:1024 lds
 sad m0, s25, 8192
 sad s20, s23, 32768
 bl4 v240, s[8:11], s20 offen lds
 bl4 v241, s[8:11], s20 offen offset:1024 lds
 sad m0, s25, 16384
 sad s20, s23, 65536
 bl4 v240, s[8:11], s20 offen lds
 bl4 v241, s[8:11], s20 offen offset:1024 lds
 sad m0, s25, 24576
 sad s20, s23, 98304
 bl4 v240, s[8:11], s20 offen lds
 bl4 v241, s[8:11], s20 offen offset:1024 lds
 v_lshrrev_b32 v247, 2, v245
 v_and_b32 v248, 7, v247
 v_lshlrev_b32 v247, 8, v247
 v_and_b32 v249, 3, v245
 v_lshl_add_u32 v247, v249, 3, v247
 v_xor_b32 v249, 0, v248
 v_lshl_add_u32 v224, v249, 5, v247
 v_add_u32 v232, 0x10000, v224
 v_xor_b32 v249, 1, v248
 v_lshl_add_u32 v225, v249, 5, v247
 v_add_u32 v233, 0x10000, v225
 v_xor_b32 v249, 2, v248
 v_lshl_add_u32 v226, v249, 5, v247
 v_add_u32 v234, 0x10000, v226
 v_xor_b32 v249, 3, v248
 v_lshl_add_u32 v227, v249, 5, v247
 v_add_u32 v235, 0x10000, v227
 v_xor_b32 v249, 4, v248
 v_lshl_add_u32 v228, v249, 5, v247
 v_add_u32 v236, 0x10000, v228
 v_xor_b32 v249, 5, v248
 v_lshl_add_u32 v229, v249, 5, v247
 v_add_u32 v237, 0x10000, v229
 v_xor_b32 v249, 6, v248
 v_lshl_add_u32 v230, v249, 5, v247
 v_add_u32 v238, 0x10000, v230
 v_xor_b32 v249, 7, v248
 v_lshl_add_u32 v231, v249, 5, v247
 v_add_u32 v239, 0x10000, v231
 swc vmcnt(8)
 v_cmp_ne_u32 vcc, 32, v246
 s_cbranch_vccnz K3_LSPIN
K3_LSPIN_B:
 sad s19, s24, 0
 bl4 v[160:163], v244, s[12:15], s19 offen offset:0 sc1
 bl4 v[164:167], v244, s[12:15], s19 offen offset:1024 sc1
 sad s19, s24, 4096
 bl4 v[168:171], v244, s[12:15], s19 offen offset:0 sc1
 bl4 v[172:175], v244, s[12:15], s19 offen offset:1024 sc1
 sad s19, s24, 8192
 bl4 v[176:179], v244, s[12:15], s19 offen offset:0 sc1
 bl4 v[180:183], v244, s[12:15], s19 offen offset:1024 sc1
 sad s19, s24, 12288
 bl4 v[184:187], v244, s[12:15], s19 offen offset:0 sc1
 bl4 v[188:191], v244, s[12:15], s19 offen offset:1024 sc1
 sad s19, s24, 16384
 bl4 v[192:195], v244, s[12:15], s19 offen offset:0 sc1
 bl4 v[196:199], v244, s[12:15], s19 offen offset:1024 sc1
 sad s19, s24, 20480
 bl4 v[200:203], v244, s[12:15], s19 offen offset:0 sc1
 bl4 v[204:207], v244, s[12:15], s19 offen offset:1024 sc1
 sad s19, s24, 24576
 bl4 v[208:211], v244, s[12:15], s19 offen offset:0 sc1
 bl4 v[212:215], v244, s[12:15], s19 offen offset:1024 sc1
 s_lshl_b32 s19, s18, 7
 s_sub_u32 s19, 1920, s19
 v_mov_b32 v247, s19
 v_mov_b32 v249, 1
 v_add_u32 v250, 1024, v250
 swc vmcnt(20) lgkmcnt(0)
 s_barrier
 s_cmp_lg_u32 s16, 0
 s_cbranch_scc1 K3_NOSIG
 s_mov_b64 exec, 1
 buffer_atomic_add v249, v247, s[12:15], s39 offen sc1
 s_mov_b64 exec, -1
K3_NOSIG:
 trr v[128:129], v224 offset:0
 trr v[130:131], v224 offset:4096
 trr v[132:133], v225 offset:0
 trr v[134:135], v225 offset:4096
 trr v[136:137], v226 offset:0
 trr v[138:139], v226 offset:4096
 trr v[140:141], v227 offset:0
 trr v[142:143], v227 offset:4096
 trr v[144:145], v228 offset:0
 trr v[146:147], v228 offset:4096
 trr v[148:149], v229 offset:0
 trr v[150:151], v229 offset:4096
 trr v[152:153], v230 offset:0
 trr v[154:155], v230 offset:4096
 trr v[156:157], v231 offset:0
 trr v[158:159], v231 offset:4096
 sad m0, s25, 32768
 sad s20, s23, 131072
 bl4 v240, s[8:11], s20 offen lds
 bl4 v241, s[8:11], s20 offen offset:1024 lds
 sad m0, s25, 40960
 sad s20, s23, 163840
 bl4 v240, s[8:11], s20 offen lds
 bl4 v241, s[8:11], s20 offen offset:1024 lds
 sad m0, s25, 49152
 sad s20, s23, 196608
 bl4 v240, s[8:11], s20 offen lds
 bl4 v241, s[8:11], s20 offen offset:1024 lds
 sad m0, s25, 57344
 sad s20, s23, 229376
 bl4 v240, s[8:11], s20 offen lds
 bl4 v241, s[8:11], s20 offen offset:1024 lds
 sad m0, s25, 65536
 sad s20, s23, 262144
 bl4 v240, s[8:11], s20 offen lds
 bl4 v241, s[8:11], s20 offen offset:1024 lds
 sad m0, s25, 73728
 sad s20, s23, 294912
 bl4 v240, s[8:11], s20 offen lds
 bl4 v241, s[8:11], s20 offen offset:1024 lds
 sad m0, s25, 81920
 sad s20, s23, 327680
 bl4 v240, s[8:11], s20 offen lds
 bl4 v241, s[8:11], s20 offen offset:1024 lds
 s_mov_b32 s40, s28
 s_mov_b32 s41, s29
 s_mov_b32 s42, 0x200000
 s_mov_b32 s43, 0x00020000
 s_mov_b32 s44, s30
 s_mov_b32 s45, s31
 s_mov_b32 s46, 0x200000
 s_mov_b32 s47, 0x00020000
 s_lshl_b32 s19, s21, 17
 s_lshl_b32 s20, s35, 14
 sad s19, s19, s20
 s_lshl_b32 s20, s22, 8
 sad s19, s19, s20
 s_lshl_b32 s20, s16, 6
 sad s19, s19, s20
 v_and_b32 v247, 15, v245
 v_lshrrev_b32 v248, 4, v245
 v_lshlrev_b32 v247, 10, v247
 v_lshl_add_u32 v247, v248, 3, v247
 v_add_u32 v253, s19, v247
 s_mov_b32 s27, 0x100000
 buffer_load_dwordx2 a[0:1], v253, s[40:43], 0 offen offset:0
 buffer_load_dwordx2 a[2:3], v253, s[40:43], 0 offen offset:32
 buffer_load_dwordx2 a[4:5], v253, s[40:43], s27 offen offset:0
 buffer_load_dwordx2 a[6:7], v253, s[40:43], s27 offen offset:32
 s_lshl_b32 s34, s21, 2
 sad s34, s34, s22
 s_lshl_b32 s19, s34, 7
 sad s19, s19, 2048
 v_mov_b32 v251, s19
 v_add_u32 v252, 4096, v251
 s_lshl_b32 s34, s34, 18
 sad s34, s34, 62914560
 s_lshl_b32 s19, s35, 15
 s_lshl_b32 s20, s16, 13
 sad s26, s34, s19
 sad s26, s26, s20
 swc vmcnt(30) lgkmcnt(8)
 mf v[0:3], v[128:131], v[160:163], 0
 swc vmcnt(34)
 s_barrier
 mf v[4:7], v[128:131], v[164:167], 0
 trr v[128:129], v224 offset:8192
 trr v[130:131], v224 offset:12288
 mf v[8:11], v[132:135], v[160:163], 0
 sad m0, s25, 90112
 sad s20, s23, 360448
 mf v[12:15], v[132:135], v[164:167], 0
 trr v[132:133], v225 offset:8192
 trr v[134:135], v225 offset:12288
 mf v[16:19], v[136:139], v[160:163], 0
 bl4 v240, s[8:11], s20 offen lds
 mf v[20:23], v[136:139], v[164:167], 0
 trr v[136:137], v226 offset:8192
 trr v[138:139], v226 offset:12288
 mf v[24:27], v[140:143], v[160:163], 0
 swc lgkmcnt(6)
 mf v[28:31], v[140:143], v[164:167], 0
 trr v[140:141], v227 offset:8192
 trr v[142:143], v227 offset:12288
 mf v[32:35], v[144:147], v[160:163], 0
 bl4 v241, s[8:11], s20 offen offset:1024 lds
 mf v[36:39], v[144:147], v[164:167], 0
 trr v[144:145], v228 offset:8192
 trr v[146:147], v228 offset:12288
 mf v[40:43], v[148:151], v[160:163], 0
 sad s19, s24, 28672
 mf v[44:47], v[148:151], v[164:167], 0
 trr v[148:149], v229 offset:8192
 trr v[150:151], v229 offset:12288
 mf v[48:51], v[152:155], v[160:163], 0
 bl4 v[216:219], v244, s[12:15], s19 offen offset:0 sc1
 mf v[52:55], v[152:155], v[164:167], 0
 trr v[152:153], v230 offset:8192
 trr v[154:155], v230 offset:12288
 mf v[56:59], v[156:159], v[160:163], 0
 bl4 v[220:223], v244, s[12:15], s19 offen offset:1024 sc1
 mf v[60:63], v[156:159], v[164:167], 0
 trr v[156:157], v231 offset:8192
 trr v[158:159], v231 offset:12288
 swc vmcnt(32) lgkmcnt(8)
 mf v[0:3], v[128:131], v[168:171], v[0:3]
 mf v[4:7], v[128:131], v[172:175], v[4:7]
 trr v[128:129], v224 offset:16384
 trr v[130:131], v224 offset:20480
 mf v[8:11], v[132:135], v[168:171], v[8:11]
 sad m0, s25, 98304
 sad s20, s23, 393216
 mf v[12:15], v[132:135], v[172:175], v[12:15]
 trr v[132:133], v225 offset:16384
 trr v[134:135], v225 offset:20480
 mf v[16:19], v[136:139], v[168:171], v[16:19]
 bl4 v240, s[8:11], s20 offen lds
 mf v[20:23], v[136:139], v[172:175], v[20:23]
 trr v[136:137], v226 offset:16384
 trr v[138:139], v226 offset:20480
 mf v[24:27], v[140:143], v[168:171], v[24:27]
 swc lgkmcnt(6)
 mf v[28:31], v[140:143], v[172:175], v[28:31]
 trr v[140:141], v227 offset:16384
 trr v[142:143], v227 offset:20480
 mf v[32:35], v[144:147], v[168:171], v[32:35]
 bl4 v241, s[8:11], s20 offen offset:1024 lds
 mf v[36:39], v[144:147], v[172:175], v[36:39]
 trr v[144:145], v228 offset:16384
 trr v[146:147], v228 offset:20480
 mf v[40:43], v[148:151], v[168:171], v[40:43]
 sad s19, s24, 32768
 mf v[44:47], v[148:151], v[172:175], v[44:47]
 trr v[148:149], v229 offset:16384
 trr v[150:151], v229 offset:20480
 mf v[48:51], v[152:155], v[168:171], v[48:51]
 bl4 v[160:163], v244, s[12:15], s19 offen offset:0 sc1
 mf v[52:55], v[152:155], v[172:175], v[52:55]
 trr v[152:153], v230 offset:16384
 trr v[154:155], v230 offset:20480
 mf v[56:59], v[156:159], v[168:171], v[56:59]
 bl4 v[164:167], v244, s[12:15], s19 offen offset:1024 sc1
 mf v[60:63], v[156:159], v[172:175], v[60:63]
 trr v[156:157], v231 offset:16384
 trr v[158:159], v231 offset:20480
 swc vmcnt(34) lgkmcnt(8)
 mf v[0:3], v[128:131], v[176:179], v[0:3]
 swc vmcnt(24)
 s_barrier
 mf v[4:7], v[128:131], v[180:183], v[4:7]
 trr v[128:129], v224 offset:24576
 trr v[130:131], v224 offset:28672
 mf v[8:11], v[132:135], v[176:179], v[8:11]
 sad m0, s25, 106496
 sad s20, s23, 425984
 mf v[12:15], v[132:135], v[180:183], v[12:15]
 trr v[132:133], v225 offset:24576
 trr v[134:135], v225 offset:28672
 mf v[16:19], v[136:139], v[176:179], v[16:19]
 bl4 v240, s[8:11], s20 offen lds
 mf v[20:23], v[136:139], v[180:183], v[20:23]
 trr v[136:137], v226 offset:24576
 trr v[138:139], v226 offset:28672
 mf v[24:27], v[140:143], v[176:179], v[24:27]
 swc lgkmcnt(6)
 mf v[28:31], v[140:143], v[180:183], v[28:31]
 trr v[140:141], v227 offset:24576
 trr v[142:143], v227 offset:28672
 mf v[32:35], v[144:147], v[176:179], v[32:35]
 bl4 v241, s[8:11], s20 offen offset:1024 lds
 mf v[36:39], v[144:147], v[180:183], v[36:39]
 trr v[144:145], v228 offset:24576
 trr v[146:147], v228 offset:28672
 mf v[40:43], v[148:151], v[176:179], v[40:43]
 sad s19, s24, 36864
 mf v[44:47], v[148:151], v[180:183], v[44:47]
 trr v[148:149], v229 offset:24576
 trr v[150:151], v229 offset:28672
 mf v[48:51], v[152:155], v[176:179], v[48:51]
 bl4 v[168:171], v244, s[12:15], s19 offen offset:0 sc1
 mf v[52:55], v[152:155], v[180:183], v[52:55]
 trr v[152:153], v230 offset:24576
 trr v[154:155], v230 offset:28672
 mf v[56:59], v[156:159], v[176:179], v[56:59]
 bl4 v[172:175], v244, s[12:15], s19 offen offset:1024 sc1
 mf v[60:63], v[156:159], v[180:183], v[60:63]
 trr v[156:157], v231 offset:24576
 trr v[158:159], v231 offset:28672
 swc vmcnt(36) lgkmcnt(8)
 mf v[0:3], v[128:131], v[184:187], v[0:3]
 mf v[4:7], v[128:131], v[188:191], v[4:7]
 trr v[128:129], v224 offset:32768
 trr v[130:131], v224 offset:36864
 mf v[8:11], v[132:135], v[184:187], v[8:11]
 sad m0, s25, 114688
 sad s20, s23, 458752
 mf v[12:15], v[132:135], v[188:191], v[12:15]
 trr v[132:133], v225 offset:32768
 trr v[134:135], v225 offset:36864
 mf v[16:19], v[136:139], v[184:187], v[16:19]
 bl4 v240, s[8:11], s20 offen lds
 mf v[20:23], v[136:139], v[188:191], v[20:23]
 trr v[136:137], v226 offset:32768
 trr v[138:139], v226 offset:36864
 mf v[24:27], v[140:143], v[184:187], v[24:27]
 swc lgkmcnt(6)
 mf v[28:31], v[140:143], v[188:191], v[28:31]
 trr v[140:141], v227 offset:32768
 trr v[142:143], v227 offset:36864
 mf v[32:35], v[144:147], v[184:187], v[32:35]
 bl4 v241, s[8:11], s20 offen offset:1024 lds
 mf v[36:39], v[144:147], v[188:191], v[36:39]
 trr v[144:145], v228 offset:32768
 trr v[146:147], v228 offset:36864
 mf v[40:43], v[148:151], v[184:187], v[40:43]
 sad s19, s24, 40960
 mf v[44:47], v[148:151], v[188:191], v[44:47]
 trr v[148:149], v229 offset:32768
 trr v[150:151], v229 offset:36864
 mf v[48:51], v[152:155], v[184:187], v[48:51]
 bl4 v[176:179], v244, s[12:15], s19 offen offset:0 sc1
 mf v[52:55], v[152:155], v[188:191], v[52:55]
 trr v[152:153], v230 offset:32768
 trr v[154:155], v230 offset:36864
 mf v[56:59], v[156:159], v[184:187], v[56:59]
 bl4 v[180:183], v244, s[12:15], s19 offen offset:1024 sc1
 mf v[60:63], v[156:159], v[188:191], v[60:63]
 trr v[156:157], v231 offset:32768
 trr v[158:159], v231 offset:36864
 swc vmcnt(38) lgkmcnt(8)
 mf v[0:3], v[128:131], v[192:195], v[0:3]
 swc vmcnt(28)
 s_barrier
 mf v[4:7], v[128:131], v[196:199], v[4:7]
 trr v[128:129], v224 offset:40960
 trr v[130:131], v224 offset:45056
 mf v[8:11], v[132:135], v[192:195], v[8:11]
 sad m0, s25, 122880
 sad s20, s23, 491520
 mf v[12:15], v[132:135], v[196:199], v[12:15]
 trr v[132:133], v225 offset:40960
 trr v[134:135], v225 offset:45056
 mf v[16:19], v[136:139], v[192:195], v[16:19]
 bl4 v240, s[8:11], s20 offen lds
 mf v[20:23], v[136:139], v[196:199], v[20:23]
 trr v[136:137], v226 offset:40960
 trr v[138:139], v226 offset:45056
 mf v[24:27], v[140:143], v[192:195], v[24:27]
 swc lgkmcnt(6)
 mf v[28:31], v[140:143], v[196:199], v[28:31]
 trr v[140:141], v227 offset:40960
 trr v[142:143], v227 offset:45056
 mf v[32:35], v[144:147], v[192:195], v[32:35]
 bl4 v241, s[8:11], s20 offen offset:1024 lds
 mf v[36:39], v[144:147], v[196:199], v[36:39]
 trr v[144:145], v228 offset:40960
 trr v[146:147], v228 offset:45056
 mf v[40:43], v[148:151], v[192:195], v[40:43]
 sad s19, s24, 45056
 mf v[44:47], v[148:151], v[196:199], v[44:47]
 trr v[148:149], v229 offset:40960
 trr v[150:151], v229 offset:45056
 mf v[48:51], v[152:155], v[192:195], v[48:51]
 bl4 v[184:187], v244, s[12:15], s19 offen offset:0 sc1
 mf v[52:55], v[152:155], v[196:199], v[52:55]
 trr v[152:153], v230 offset:40960
 trr v[154:155], v230 offset:45056
 mf v[56:59], v[156:159], v[192:195], v[56:59]
 bl4 v[188:191], v244, s[12:15], s19 offen offset:1024 sc1
 mf v[60:63], v[156:159], v[196:199], v[60:63]
 trr v[156:157], v231 offset:40960
 trr v[158:159], v231 offset:45056
 swc vmcnt(40) lgkmcnt(8)
 mf v[0:3], v[128:131], v[200:203], v[0:3]
 mf v[4:7], v[128:131], v[204:207], v[4:7]
 trr v[128:129], v224 offset:49152
 trr v[130:131], v224 offset:53248
 mf v[8:11], v[132:135], v[200:203], v[8:11]
 sad m0, s25, 0
 sad s20, s23, 524288
 mf v[12:15], v[132:135], v[204:207], v[12:15]
 trr v[132:133], v225 offset:49152
 trr v[134:135], v225 offset:53248
 mf v[16:19], v[136:139], v[200:203], v[16:19]
 bl4 v240, s[8:11], s20 offen lds
 mf v[20:23], v[136:139], v[204:207], v[20:23]
 trr v[136:137], v226 offset:49152
 trr v[138:139], v226 offset:53248
 mf v[24:27], v[140:143], v[200:203], v[24:27]
 swc lgkmcnt(6)
 mf v[28:31], v[140:143], v[204:207], v[28:31]
 trr v[140:141], v227 offset:49152
 trr v[142:143], v227 offset:53248
 mf v[32:35], v[144:147], v[200:203], v[32:35]
 bl4 v241, s[8:11], s20 offen offset:1024 lds
 mf v[36:39], v[144:147], v[204:207], v[36:39]
 trr v[144:145], v228 offset:49152
 trr v[146:147], v228 offset:53248
 mf v[40:43], v[148:151], v[200:203], v[40:43]
 sad s19, s24, 49152
 mf v[44:47], v[148:151], v[204:207], v[44:47]
 trr v[148:149], v229 offset:49152
 trr v[150:151], v229 offset:53248
 mf v[48:51], v[152:155], v[200:203], v[48:51]
 bl4 v[192:195], v244, s[12:15], s19 offen offset:0 sc1
 mf v[52:55], v[152:155], v[204:207], v[52:55]
 trr v[152:153], v230 offset:49152
 trr v[154:155], v230 offset:53248
 mf v[56:59], v[156:159], v[200:203], v[56:59]
 bl4 v[196:199], v244, s[12:15], s19 offen offset:1024 sc1
 mf v[60:63], v[156:159], v[204:207], v[60:63]
 trr v[156:157], v231 offset:49152
 trr v[158:159], v231 offset:53248
 swc vmcnt(42) lgkmcnt(8)
 mf v[0:3], v[128:131], v[208:211], v[0:3]
 swc vmcnt(32)
 s_barrier
 mf v[4:7], v[128:131], v[212:215], v[4:7]
 trr v[128:129], v224 offset:57344
 trr v[130:131], v224 offset:61440
 mf v[8:11], v[132:135], v[208:211], v[8:11]
 sad m0, s25, 8192
 sad s20, s23, 557056
 mf v[12:15], v[132:135], v[212:215], v[12:15]
 trr v[132:133], v225 offset:57344
 trr v[134:135], v225 offset:61440
 mf v[16:19], v[136:139], v[208:211], v[16:19]
 bl4 v240, s[8:11], s20 offen lds
 mf v[20:23], v[136:139], v[212:215], v[20:23]
 trr v[136:137], v226 offset:57344
 trr v[138:139], v226 offset:61440
 mf v[24:27], v[140:143], v[208:211], v[24:27]
 swc lgkmcnt(6)
 mf v[28:31], v[140:143], v[212:215], v[28:31]
 trr v[140:141], v227 offset:57344
 trr v[142:143], v227 offset:61440
 mf v[32:35], v[144:147], v[208:211], v[32:35]
 bl4 v241, s[8:11], s20 offen offset:1024 lds
 mf v[36:39], v[144:147], v[212:215], v[36:39]
 trr v[144:145], v228 offset:57344
 trr v[146:147], v228 offset:61440
 mf v[40:43], v[148:151], v[208:211], v[40:43]
 sad s19, s24, 53248
 mf v[44:47], v[148:151], v[212:215], v[44:47]
 trr v[148:149], v229 offset:57344
 trr v[150:151], v229 offset:61440
 mf v[48:51], v[152:155], v[208:211], v[48:51]
 bl4 v[200:203], v244, s[12:15], s19 offen offset:0 sc1
 mf v[52:55], v[152:155], v[212:215], v[52:55]
 trr v[152:153], v230 offset:57344
 trr v[154:155], v230 offset:61440
 mf v[56:59], v[156:159], v[208:211], v[56:59]
 bl4 v[204:207], v244, s[12:15], s19 offen offset:1024 sc1
 mf v[60:63], v[156:159], v[212:215], v[60:63]
 trr v[156:157], v231 offset:57344
 trr v[158:159], v231 offset:61440
 swc vmcnt(24) lgkmcnt(8)
 mf v[0:3], v[128:131], v[216:219], v[0:3]
 mf v[4:7], v[128:131], v[220:223], v[4:7]
 trr v[128:129], v232 offset:0
 trr v[130:131], v232 offset:4096
 mf v[8:11], v[132:135], v[216:219], v[8:11]
 sad m0, s25, 16384
 sad s20, s23, 589824
 mf v[12:15], v[132:135], v[220:223], v[12:15]
 trr v[132:133], v233 offset:0
 trr v[134:135], v233 offset:4096
 mf v[16:19], v[136:139], v[216:219], v[16:19]
 bl4 v240, s[8:11], s20 offen lds
 mf v[20:23], v[136:139], v[220:223], v[20:23]
 trr v[136:137], v234 offset:0
 trr v[138:139], v234 offset:4096
 mf v[24:27], v[140:143], v[216:219], v[24:27]
 swc lgkmcnt(6)
 mf v[28:31], v[140:143], v[220:223], v[28:31]
 trr v[140:141], v235 offset:0
 trr v[142:143], v235 offset:4096
 mf v[32:35], v[144:147], v[216:219], v[32:35]
 bl4 v241, s[8:11], s20 offen offset:1024 lds
 mf v[36:39], v[144:147], v[220:223], v[36:39]
 trr v[144:145], v236 offset:0
 trr v[146:147], v236 offset:4096
 mf v[40:43], v[148:151], v[216:219], v[40:43]
 sad s19, s24, 57344
 mf v[44:47], v[148:151], v[220:223], v[44:47]
 trr v[148:149], v237 offset:0
 trr v[150:151], v237 offset:4096
 mf v[48:51], v[152:155], v[216:219], v[48:51]
 bl4 v[208:211], v244, s[12:15], s19 offen offset:0 sc1
 mf v[52:55], v[152:155], v[220:223], v[52:55]
 trr v[152:153], v238 offset:0
 trr v[154:155], v238 offset:4096
 mf v[56:59], v[156:159], v[216:219], v[56:59]
 bl4 v[212:215], v244, s[12:15], s19 offen offset:1024 sc1
 mf v[60:63], v[156:159], v[220:223], v[60:63]
 trr v[156:157], v239 offset:0
 trr v[158:159], v239 offset:4096
 swc vmcnt(24) lgkmcnt(8)
 mf v[0:3], v[128:131], v[160:163], v[0:3]
 swc vmcnt(36)
 s_barrier
 mf v[4:7], v[128:131], v[164:167], v[4:7]
 trr v[128:129], v232 offset:8192
 trr v[130:131], v232 offset:12288
 mf v[8:11], v[132:135], v[160:163], v[8:11]
 sad m0, s25, 24576
 sad s20, s23, 622592
 mf v[12:15], v[132:135], v[164:167], v[12:15]
 trr v[132:133], v233 offset:8192
 trr v[134:135], v233 offset:12288
 mf v[16:19], v[136:139], v[160:163], v[16:19]
 bl4 v240, s[8:11], s20 offen lds
 mf v[20:23], v[136:139], v[164:167], v[20:23]
 trr v[136:137], v234 offset:8192
 trr v[138:139], v234 offset:12288
 mf v[24:27], v[140:143], v[160:163], v[24:27]
 swc lgkmcnt(6)
 mf v[28:31], v[140:143], v[164:167], v[28:31]
 trr v[140:141], v235 offset:8192
 trr v[142:143], v235 offset:12288
 mf v[32:35], v[144:147], v[160:163], v[32:35]
 bl4 v241, s[8:11], s20 offen offset:1024 lds
 mf v[36:39], v[144:147], v[164:167], v[36:39]
 trr v[144:145], v236 offset:8192
 trr v[146:147], v236 offset:12288
 mf v[40:43], v[148:151], v[160:163], v[40:43]
 sad s19, s24, 61440
 mf v[44:47], v[148:151], v[164:167], v[44:47]
 trr v[148:149], v237 offset:8192
 trr v[150:151], v237 offset:12288
 mf v[48:51], v[152:155], v[160:163], v[48:51]
 bl4 v[216:219], v244, s[12:15], s19 offen offset:0 sc1
 mf v[52:55], v[152:155], v[164:167], v[52:55]
 trr v[152:153], v238 offset:8192
 trr v[154:155], v238 offset:12288
 mf v[56:59], v[156:159], v[160:163], v[56:59]
 bl4 v[220:223], v244, s[12:15], s19 offen offset:1024 sc1
 mf v[60:63], v[156:159], v[164:167], v[60:63]
 trr v[156:157], v239 offset:8192
 trr v[158:159], v239 offset:12288
 swc vmcnt(24) lgkmcnt(8)
 mf v[0:3], v[128:131], v[168:171], v[0:3]
 mf v[4:7], v[128:131], v[172:175], v[4:7]
 trr v[128:129], v232 offset:16384
 trr v[130:131], v232 offset:20480
 mf v[8:11], v[132:135], v[168:171], v[8:11]
 sad m0, s25, 32768
 sad s20, s23, 655360
 mf v[12:15], v[132:135], v[172:175], v[12:15]
 trr v[132:133], v233 offset:16384
 trr v[134:135], v233 offset:20480
 mf v[16:19], v[136:139], v[168:171], v[16:19]
 bl4 v240, s[8:11], s20 offen lds
 mf v[20:23], v[136:139], v[172:175], v[20:23]
 trr v[136:137], v234 offset:16384
 trr v[138:139], v234 offset:20480
 mf v[24:27], v[140:143], v[168:171], v[24:27]
 swc lgkmcnt(6)
 mf v[28:31], v[140:143], v[172:175], v[28:31]
 trr v[140:141], v235 offset:16384
 trr v[142:143], v235 offset:20480
 mf v[32:35], v[144:147], v[168:171], v[32:35]
 bl4 v241, s[8:11], s20 offen offset:1024 lds
 mf v[36:39], v[144:147], v[172:175], v[36:39]
 trr v[144:145], v236 offset:16384
 trr v[146:147], v236 offset:20480
 mf v[40:43], v[148:151], v[168:171], v[40:43]
 sad s19, s24, 65536
 mf v[44:47], v[148:151], v[172:175], v[44:47]
 trr v[148:149], v237 offset:16384
 trr v[150:151], v237 offset:20480
 mf v[48:51], v[152:155], v[168:171], v[48:51]
 bl4 v[160:163], v244, s[12:15], s19 offen offset:0 sc1
 mf v[52:55], v[152:155], v[172:175], v[52:55]
 trr v[152:153], v238 offset:16384
 trr v[154:155], v238 offset:20480
 mf v[56:59], v[156:159], v[168:171], v[56:59]
 bl4 v[164:167], v244, s[12:15], s19 offen offset:1024 sc1
 mf v[60:63], v[156:159], v[172:175], v[60:63]
 trr v[156:157], v239 offset:16384
 trr v[158:159], v239 offset:20480
 swc vmcnt(24) lgkmcnt(8)
 mf v[0:3], v[128:131], v[176:179], v[0:3]
 swc vmcnt(34)
 s_barrier
 mf v[4:7], v[128:131], v[180:183], v[4:7]
 trr v[128:129], v232 offset:24576
 trr v[130:131], v232 offset:28672
 mf v[8:11], v[132:135], v[176:179], v[8:11]
 sad m0, s25, 40960
 sad s20, s23, 688128
 mf v[12:15], v[132:135], v[180:183], v[12:15]
 trr v[132:133], v233 offset:24576
 trr v[134:135], v233 offset:28672
 mf v[16:19], v[136:139], v[176:179], v[16:19]
 bl4 v240, s[8:11], s20 offen lds
 mf v[20:23], v[136:139], v[180:183], v[20:23]
 trr v[136:137], v234 offset:24576
 trr v[138:139], v234 offset:28672
 mf v[24:27], v[140:143], v[176:179], v[24:27]
 swc lgkmcnt(6)
 mf v[28:31], v[140:143], v[180:183], v[28:31]
 trr v[140:141], v235 offset:24576
 trr v[142:143], v235 offset:28672
 mf v[32:35], v[144:147], v[176:179], v[32:35]
 bl4 v241, s[8:11], s20 offen offset:1024 lds
 mf v[36:39], v[144:147], v[180:183], v[36:39]
 trr v[144:145], v236 offset:24576
 trr v[146:147], v236 offset:28672
 mf v[40:43], v[148:151], v[176:179], v[40:43]
 sad s19, s24, 69632
 mf v[44:47], v[148:151], v[180:183], v[44:47]
 trr v[148:149], v237 offset:24576
 trr v[150:151], v237 offset:28672
 mf v[48:51], v[152:155], v[176:179], v[48:51]
 bl4 v[168:171], v244, s[12:15], s19 offen offset:0 sc1
 mf v[52:55], v[152:155], v[180:183], v[52:55]
 trr v[152:153], v238 offset:24576
 trr v[154:155], v238 offset:28672
 mf v[56:59], v[156:159], v[176:179], v[56:59]
 bl4 v[172:175], v244, s[12:15], s19 offen offset:1024 sc1
 mf v[60:63], v[156:159], v[180:183], v[60:63]
 trr v[156:157], v239 offset:24576
 trr v[158:159], v239 offset:28672
 swc vmcnt(24) lgkmcnt(8)
 mf v[0:3], v[128:131], v[184:187], v[0:3]
 mf v[4:7], v[128:131], v[188:191], v[4:7]
 trr v[128:129], v232 offset:32768
 trr v[130:131], v232 offset:36864
 mf v[8:11], v[132:135], v[184:187], v[8:11]
 sad m0, s25, 49152
 sad s20, s23, 0
 mf v[12:15], v[132:135], v[188:191], v[12:15]
 trr v[132:133], v233 offset:32768
 trr v[134:135], v233 offset:36864
 mf v[16:19], v[136:139], v[184:187], v[16:19]
 bl4 v240, s[8:11], s20 offen lds
 mf v[20:23], v[136:139], v[188:191], v[20:23]
 trr v[136:137], v234 offset:32768
 trr v[138:139], v234 offset:36864
 mf v[24:27], v[140:143], v[184:187], v[24:27]
 swc lgkmcnt(6)
 mf v[28:31], v[140:143], v[188:191], v[28:31]
 trr v[140:141], v235 offset:32768
 trr v[142:143], v235 offset:36864
 mf v[32:35], v[144:147], v[184:187], v[32:35]
 bl4 v241, s[8:11], s20 offen offset:1024 lds
 mf v[36:39], v[144:147], v[188:191], v[36:39]
 trr v[144:145], v236 offset:32768
 trr v[146:147], v236 offset:36864
 mf v[40:43], v[148:151], v[184:187], v[40:43]
 sad s19, s24, 73728
 mf v[44:47], v[148:151], v[188:191], v[44:47]
 trr v[148:149], v237 offset:32768
 trr v[150:151], v237 offset:36864
 mf v[48:51], v[152:155], v[184:187], v[48:51]
 bl4 v[176:179], v244, s[12:15], s19 offen offset:0 sc1
 mf v[52:55], v[152:155], v[188:191], v[52:55]
 trr v[152:153], v238 offset:32768
 trr v[154:155], v238 offset:36864
 mf v[56:59], v[156:159], v[184:187], v[56:59]
 bl4 v[180:183], v244, s[12:15], s19 offen offset:1024 sc1
 mf v[60:63], v[156:159], v[188:191], v[60:63]
 trr v[156:157], v239 offset:32768
 trr v[158:159], v239 offset:36864
 swc vmcnt(24) lgkmcnt(8)
 mf v[0:3], v[128:131], v[192:195], v[0:3]
 swc vmcnt(34)
 s_barrier
 mf v[4:7], v[128:131], v[196:199], v[4:7]
 trr v[128:129], v232 offset:40960
 trr v[130:131], v232 offset:45056
 mf v[8:11], v[132:135], v[192:195], v[8:11]
 sad m0, s25, 57344
 sad s20, s23, 32768
 mf v[12:15], v[132:135], v[196:199], v[12:15]
 trr v[132:133], v233 offset:40960
 trr v[134:135], v233 offset:45056
 mf v[16:19], v[136:139], v[192:195], v[16:19]
 bl4 v240, s[8:11], s20 offen lds
 mf v[20:23], v[136:139], v[196:199], v[20:23]
 trr v[136:137], v234 offset:40960
 trr v[138:139], v234 offset:45056
 mf v[24:27], v[140:143], v[192:195], v[24:27]
 swc lgkmcnt(6)
 mf v[28:31], v[140:143], v[196:199], v[28:31]
 trr v[140:141], v235 offset:40960
 trr v[142:143], v235 offset:45056
 mf v[32:35], v[144:147], v[192:195], v[32:35]
 bl4 v241, s[8:11], s20 offen offset:1024 lds
 mf v[36:39], v[144:147], v[196:199], v[36:39]
 trr v[144:145], v236 offset:40960
 trr v[146:147], v236 offset:45056
 mf v[40:43], v[148:151], v[192:195], v[40:43]
 sad s19, s24, 77824
 mf v[44:47], v[148:151], v[196:199], v[44:47]
 trr v[148:149], v237 offset:40960
 trr v[150:151], v237 offset:45056
 mf v[48:51], v[152:155], v[192:195], v[48:51]
 bl4 v[184:187], v244, s[12:15], s19 offen offset:0 sc1
 mf v[52:55], v[152:155], v[196:199], v[52:55]
 trr v[152:153], v238 offset:40960
 trr v[154:155], v238 offset:45056
 mf v[56:59], v[156:159], v[192:195], v[56:59]
 bl4 v[188:191], v244, s[12:15], s19 offen offset:1024 sc1
 mf v[60:63], v[156:159], v[196:199], v[60:63]
 trr v[156:157], v239 offset:40960
 trr v[158:159], v239 offset:45056
 swc vmcnt(24) lgkmcnt(8)
 mf v[0:3], v[128:131], v[200:203], v[0:3]
 mf v[4:7], v[128:131], v[204:207], v[4:7]
 trr v[128:129], v232 offset:49152
 trr v[130:131], v232 offset:53248
 mf v[8:11], v[132:135], v[200:203], v[8:11]
 sad m0, s25, 65536
 sad s20, s23, 65536
 mf v[12:15], v[132:135], v[204:207], v[12:15]
 trr v[132:133], v233 offset:49152
 trr v[134:135], v233 offset:53248
 mf v[16:19], v[136:139], v[200:203], v[16:19]
 bl4 v240, s[8:11], s20 offen lds
 mf v[20:23], v[136:139], v[204:207], v[20:23]
 trr v[136:137], v234 offset:49152
 trr v[138:139], v234 offset:53248
 mf v[24:27], v[140:143], v[200:203], v[24:27]
 swc lgkmcnt(6)
 mf v[28:31], v[140:143], v[204:207], v[28:31]
 trr v[140:141], v235 offset:49152
 trr v[142:143], v235 offset:53248
 mf v[32:35], v[144:147], v[200:203], v[32:35]
 bl4 v241, s[8:11], s20 offen offset:1024 lds
 mf v[36:39], v[144:147], v[204:207], v[36:39]
 trr v[144:145], v236 offset:49152
 trr v[146:147], v236 offset:53248
 mf v[40:43], v[148:151], v[200:203], v[40:43]
 sad s19, s24, 81920
 mf v[44:47], v[148:151], v[204:207], v[44:47]
 trr v[148:149], v237 offset:49152
 trr v[150:151], v237 offset:53248
 mf v[48:51], v[152:155], v[200:203], v[48:51]
 bl4 v[192:195], v244, s[12:15], s19 offen offset:0 sc1
 mf v[52:55], v[152:155], v[204:207], v[52:55]
 trr v[152:153], v238 offset:49152
 trr v[154:155], v238 offset:53248
 mf v[56:59], v[156:159], v[200:203], v[56:59]
 bl4 v[196:199], v244, s[12:15], s19 offen offset:1024 sc1
 mf v[60:63], v[156:159], v[204:207], v[60:63]
 trr v[156:157], v239 offset:49152
 trr v[158:159], v239 offset:53248
 swc vmcnt(24) lgkmcnt(8)
 mf v[0:3], v[128:131], v[208:211], v[0:3]
 swc vmcnt(34)
 s_barrier
 mf v[4:7], v[128:131], v[212:215], v[4:7]
 trr v[128:129], v232 offset:57344
 trr v[130:131], v232 offset:61440
 mf v[8:11], v[132:135], v[208:211], v[8:11]
 sad m0, s25, 73728
 sad s20, s23, 98304
 mf v[12:15], v[132:135], v[212:215], v[12:15]
 trr v[132:133], v233 offset:57344
 trr v[134:135], v233 offset:61440
 mf v[16:19], v[136:139], v[208:211], v[16:19]
 bl4 v240, s[8:11], s20 offen lds
 mf v[20:23], v[136:139], v[212:215], v[20:23]
 trr v[136:137], v234 offset:57344
 trr v[138:139], v234 offset:61440
 mf v[24:27], v[140:143], v[208:211], v[24:27]
 swc lgkmcnt(6)
 mf v[28:31], v[140:143], v[212:215], v[28:31]
 trr v[140:141], v235 offset:57344
 trr v[142:143], v235 offset:61440
 mf v[32:35], v[144:147], v[208:211], v[32:35]
 bl4 v241, s[8:11], s20 offen offset:1024 lds
 mf v[36:39], v[144:147], v[212:215], v[36:39]
 trr v[144:145], v236 offset:57344
 trr v[146:147], v236 offset:61440
 mf v[40:43], v[148:151], v[208:211], v[40:43]
 sad s19, s24, 86016
 s_sub_u32 s19, s19, s32
 mf v[44:47], v[148:151], v[212:215], v[44:47]
 trr v[148:149], v237 offset:57344
 trr v[150:151], v237 offset:61440
 mf v[48:51], v[152:155], v[208:211], v[48:51]
 bl4 v[200:203], v244, s[12:15], s19 offen offset:0 sc1
 mf v[52:55], v[152:155], v[212:215], v[52:55]
 trr v[152:153], v238 offset:57344
 trr v[154:155], v238 offset:61440
 mf v[56:59], v[156:159], v[208:211], v[56:59]
 bl4 v[204:207], v244, s[12:15], s19 offen offset:1024 sc1
 mf v[60:63], v[156:159], v[212:215], v[60:63]
 trr v[156:157], v239 offset:57344
 trr v[158:159], v239 offset:61440
 swc vmcnt(24) lgkmcnt(8)
 mf v[0:3], v[128:131], v[216:219], v[0:3]
 mf v[4:7], v[128:131], v[220:223], v[4:7]
 trr v[128:129], v224 offset:0
 trr v[130:131], v224 offset:4096
 mf v[8:11], v[132:135], v[216:219], v[8:11]
 sad m0, s25, 81920
 sad s20, s23, 131072
 mf v[12:15], v[132:135], v[220:223], v[12:15]
 trr v[132:133], v225 offset:0
 trr v[134:135], v225 offset:4096
 mf v[16:19], v[136:139], v[216:219], v[16:19]
 bl4 v240, s[8:11], s20 offen lds
 mf v[20:23], v[136:139], v[220:223], v[20:23]
 trr v[136:137], v226 offset:0
 trr v[138:139], v226 offset:4096
 mf v[24:27], v[140:143], v[216:219], v[24:27]
 swc lgkmcnt(6)
 mf v[28:31], v[140:143], v[220:223], v[28:31]
 trr v[140:141], v227 offset:0
 trr v[142:143], v227 offset:4096
 mf v[32:35], v[144:147], v[216:219], v[32:35]
 bl4 v241, s[8:11], s20 offen offset:1024 lds
 mf v[36:39], v[144:147], v[220:223], v[36:39]
 trr v[144:145], v228 offset:0
 trr v[146:147], v228 offset:4096
 mf v[40:43], v[148:151], v[216:219], v[40:43]
 buffer_load_dword v246, v250, s[12:15], s39 offen sc1
 mf v[44:47], v[148:151], v[220:223], v[44:47]
 trr v[148:149], v229 offset:0
 trr v[150:151], v229 offset:4096
 mf v[48:51], v[152:155], v[216:219], v[48:51]
 mf v[52:55], v[152:155], v[220:223], v[52:55]
 trr v[152:153], v230 offset:0
 trr v[154:155], v230 offset:4096
 mf v[56:59], v[156:159], v[216:219], v[56:59]
 mf v[60:63], v[156:159], v[220:223], v[60:63]
 trr v[156:157], v231 offset:0
 trr v[158:159], v231 offset:4096
 swc vmcnt(23) lgkmcnt(8)
 mf v[0:3], v[128:131], v[160:163], v[0:3]
 swc vmcnt(33)
 s_barrier
 mf v[4:7], v[128:131], v[164:167], v[4:7]
 trr v[128:129], v224 offset:8192
 trr v[130:131], v224 offset:12288
 mf v[8:11], v[132:135], v[160:163], v[8:11]
 sad m0, s25, 90112
 sad s20, s23, 163840
 mf v[12:15], v[132:135], v[164:167], v[12:15]
 trr v[132:133], v225 offset:8192
 trr v[134:135], v225 offset:12288
 mf v[16:19], v[136:139], v[160:163], v[16:19]
 bl4 v240, s[8:11], s20 offen lds
 mf v[20:23], v[136:139], v[164:167], v[20:23]
 trr v[136:137], v226 offset:8192
 trr v[138:139], v226 offset:12288
 mf v[24:27], v[140:143], v[160:163], v[24:27]
 swc lgkmcnt(6)
 mf v[28:31], v[140:143], v[164:167], v[28:31]
 trr v[140:141], v227 offset:8192
 trr v[142:143], v227 offset:12288
 mf v[32:35], v[144:147], v[160:163], v[32:35]
 bl4 v241, s[8:11], s20 offen offset:1024 lds
 mf v[36:39], v[144:147], v[164:167], v[36:39]
 trr v[144:145], v228 offset:8192
 trr v[146:147], v228 offset:12288
 mf v[40:43], v[148:151], v[160:163], v[40:43]
 mf v[44:47], v[148:151], v[164:167], v[44:47]
 trr v[148:149], v229 offset:8192
 trr v[150:151], v229 offset:12288
 mf v[48:51], v[152:155], v[160:163], v[48:51]
 mf v[52:55], v[152:155], v[164:167], v[52:55]
 trr v[152:153], v230 offset:8192
 trr v[154:155], v230 offset:12288
 mf v[56:59], v[156:159], v[160:163], v[56:59]
 mf v[60:63], v[156:159], v[164:167], v[60:63]
 trr v[156:157], v231 offset:8192
 trr v[158:159], v231 offset:12288
 swc vmcnt(21) lgkmcnt(8)
 mf v[0:3], v[128:131], v[168:171], v[0:3]
 mf v[4:7], v[128:131], v[172:175], v[4:7]
 trr v[128:129], v224 offset:16384
 trr v[130:131], v224 offset:20480
 mf v[8:11], v[132:135], v[168:171], v[8:11]
 sad m0, s25, 98304
 sad s20, s23, 196608
 mf v[12:15], v[132:135], v[172:175], v[12:15]
 trr v[132:133], v225 offset:16384
 trr v[134:135], v225 offset:20480
 mf v[16:19], v[136:139], v[168:171], v[16:19]
 bl4 v240, s[8:11], s20 offen lds
 mf v[20:23], v[136:139], v[172:175], v[20:23]
 trr v[136:137], v226 offset:16384
 trr v[138:139], v226 offset:20480
 mf v[24:27], v[140:143], v[168:171], v[24:27]
 swc lgkmcnt(6)
 mf v[28:31], v[140:143], v[172:175], v[28:31]
 trr v[140:141], v227 offset:16384
 trr v[142:143], v227 offset:20480
 mf v[32:35], v[144:147], v[168:171], v[32:35]
 bl4 v241, s[8:11], s20 offen offset:1024 lds
 mf v[36:39], v[144:147], v[172:175], v[36:39]
 trr v[144:145], v228 offset:16384
 trr v[146:147], v228 offset:20480
 mf v[40:43], v[148:151], v[168:171], v[40:43]
 swc vmcnt(4)
 v_cmp_ne_u32 vcc, 32, v246
 mf v[44:47], v[148:151], v[172:175], v[44:47]
 trr v[148:149], v229 offset:16384
 trr v[150:151], v229 offset:20480
 mf v[48:51], v[152:155], v[168:171], v[48:51]
 s_cmp_eq_u64 vcc, 0
 s_cselect_b32 s33, 1, s33
 mf v[52:55], v[152:155], v[172:175], v[52:55]
 trr v[152:153], v230 offset:16384
 trr v[154:155], v230 offset:20480
 mf v[56:59], v[156:159], v[168:171], v[56:59]
 mf v[60:63], v[156:159], v[172:175], v[60:63]
 trr v[156:157], v231 offset:16384
 trr v[158:159], v231 offset:20480
 swc vmcnt(19) lgkmcnt(8)
 mf v[0:3], v[128:131], v[176:179], v[0:3]
 swc vmcnt(29)
 s_barrier
 mf v[4:7], v[128:131], v[180:183], v[4:7]
 trr v[128:129], v224 offset:24576
 trr v[130:131], v224 offset:28672
 mf v[8:11], v[132:135], v[176:179], v[8:11]
 sad m0, s25, 106496
 sad s20, s23, 229376
 mf v[12:15], v[132:135], v[180:183], v[12:15]
 trr v[132:133], v225 offset:24576
 trr v[134:135], v225 offset:28672
 mf v[16:19], v[136:139], v[176:179], v[16:19]
 bl4 v240, s[8:11], s20 offen lds
 mf v[20:23], v[136:139], v[180:183], v[20:23]
 trr v[136:137], v226 offset:24576
 trr v[138:139], v226 offset:28672
 mf v[24:27], v[140:143], v[176:179], v[24:27]
 swc lgkmcnt(6)
 mf v[28:31], v[140:143], v[180:183], v[28:31]
 trr v[140:141], v227 offset:24576
 trr v[142:143], v227 offset:28672
 mf v[32:35], v[144:147], v[176:179], v[32:35]
 bl4 v241, s[8:11], s20 offen offset:1024 lds
 mf v[36:39], v[144:147], v[180:183], v[36:39]
 trr v[144:145], v228 offset:24576
 trr v[146:147], v228 offset:28672
 mf v[40:43], v[148:151], v[176:179], v[40:43]
 s_cmp_eq_u32 s33, 0
 s_cbranch_scc1 K2_NB_119
 sad s19, s24, 11206656
 bl4 v[208:211], v244, s[12:15], s19 offen offset:0 sc1
 bl4 v[212:215], v244, s[12:15], s19 offen offset:1024 sc1
K2_NB_119:
 mf v[44:47], v[148:151], v[180:183], v[44:47]
 trr v[148:149], v229 offset:24576
 trr v[150:151], v229 offset:28672
 mf v[48:51], v[152:155], v[176:179], v[48:51]
 mf v[52:55], v[152:155], v[180:183], v[52:55]
 trr v[152:153], v230 offset:24576
 trr v[154:155], v230 offset:28672
 mf v[56:59], v[156:159], v[176:179], v[56:59]
 mf v[60:63], v[156:159], v[180:183], v[60:63]
 trr v[156:157], v231 offset:24576
 trr v[158:159], v231 offset:28672
 swc vmcnt(17) lgkmcnt(8)
 mf v[0:3], v[128:131], v[184:187], v[0:3]
 mf v[4:7], v[128:131], v[188:191], v[4:7]
 trr v[128:129], v224 offset:32768
 trr v[130:131], v224 offset:36864
 mf v[8:11], v[132:135], v[184:187], v[8:11]
 sad m0, s25, 114688
 sad s20, s23, 262144
 mf v[12:15], v[132:135], v[188:191], v[12:15]
 trr v[132:133], v225 offset:32768
 trr v[134:135], v225 offset:36864
 mf v[16:19], v[136:139], v[184:187], v[16:19]
 bl4 v240, s[8:11], s20 offen lds
 mf v[20:23], v[136:139], v[188:191], v[20:23]
 trr v[136:137], v226 offset:32768
 trr v[138:139], v226 offset:36864
 mf v[24:27], v[140:143], v[184:187], v[24:27]
 swc lgkmcnt(6)
 mf v[28:31], v[140:143], v[188:191], v[28:31]
 trr v[140:141], v227 offset:32768
 trr v[142:143], v227 offset:36864
 mf v[32:35], v[144:147], v[184:187], v[32:35]
 bl4 v241, s[8:11], s20 offen offset:1024 lds
 mf v[36:39], v[144:147], v[188:191], v[36:39]
 trr v[144:145], v228 offset:32768
 trr v[146:147], v228 offset:36864
 mf v[40:43], v[148:151], v[184:187], v[40:43]
 s_cmp_eq_u32 s33, 0
 s_cbranch_scc1 K2_NB_120
 sad s19, s24, 11210752
 bl4 v[216:219], v244, s[12:15], s19 offen offset:0 sc1
 bl4 v[220:223], v244, s[12:15], s19 offen offset:1024 sc1
K2_NB_120:
 mf v[44:47], v[148:151], v[188:191], v[44:47]
 trr v[148:149], v229 offset:32768
 trr v[150:151], v229 offset:36864
 mf v[48:51], v[152:155], v[184:187], v[48:51]
 mf v[52:55], v[152:155], v[188:191], v[52:55]
 trr v[152:153], v230 offset:32768
 trr v[154:155], v230 offset:36864
 mf v[56:59], v[156:159], v[184:187], v[56:59]
 mf v[60:63], v[156:159], v[188:191], v[60:63]
 trr v[156:157], v231 offset:32768
 trr v[158:159], v231 offset:36864
 swc vmcnt(15) lgkmcnt(8)
 mf v[0:3], v[128:131], v[192:195], v[0:3]
 swc vmcnt(25)
 s_barrier
 mf v[4:7], v[128:131], v[196:199], v[4:7]
 trr v[128:129], v224 offset:40960
 trr v[130:131], v224 offset:45056
 mf v[8:11], v[132:135], v[192:195], v[8:11]
 sad m0, s25, 122880
 sad s20, s23, 294912
 mf v[12:15], v[132:135], v[196:199], v[12:15]
 trr v[132:133], v225 offset:40960
 trr v[134:135], v225 offset:45056
 mf v[16:19], v[136:139], v[192:195], v[16:19]
 bl4 v240, s[8:11], s20 offen lds
 mf v[20:23], v[136:139], v[196:199], v[20:23]
 trr v[136:137], v226 offset:40960
 trr v[138:139], v226 offset:45056
 mf v[24:27], v[140:143], v[192:195], v[24:27]
 swc lgkmcnt(6)
 mf v[28:31], v[140:143], v[196:199], v[28:31]
 trr v[140:141], v227 offset:40960
 trr v[142:143], v227 offset:45056
 mf v[32:35], v[144:147], v[192:195], v[32:35]
 bl4 v241, s[8:11], s20 offen offset:1024 lds
 mf v[36:39], v[144:147], v[196:199], v[36:39]
 trr v[144:145], v228 offset:40960
 trr v[146:147], v228 offset:45056
 mf v[40:43], v[148:151], v[192:195], v[40:43]
 s_cmp_eq_u32 s33, 0
 s_cbranch_scc1 K2_NB_121
 sad s19, s24, 11214848
 bl4 v[160:163], v244, s[12:15], s19 offen offset:0 sc1
 bl4 v[164:167], v244, s[12:15], s19 offen offset:1024 sc1
K2_NB_121:
 mf v[44:47], v[148:151], v[196:199], v[44:47]
 trr v[148:149], v229 offset:40960
 trr v[150:151], v229 offset:45056
 mf v[48:51], v[152:155], v[192:195], v[48:51]
 mf v[52:55], v[152:155], v[196:199], v[52:55]
 trr v[152:153], v230 offset:40960
 trr v[154:155], v230 offset:45056
 mf v[56:59], v[156:159], v[192:195], v[56:59]
 mf v[60:63], v[156:159], v[196:199], v[60:63]
 trr v[156:157], v231 offset:40960
 trr v[158:159], v231 offset:45056
 swc vmcnt(13) lgkmcnt(8)
 mf v[0:3], v[128:131], v[200:203], v[0:3]
 mf v[4:7], v[128:131], v[204:207], v[4:7]
 trr v[128:129], v224 offset:49152
 trr v[130:131], v224 offset:53248
 mf v[8:11], v[132:135], v[200:203], v[8:11]
 sad m0, s25, 0
 sad s20, s23, 327680
 mf v[12:15], v[132:135], v[204:207], v[12:15]
 trr v[132:133], v225 offset:49152
 trr v[134:135], v225 offset:53248
 mf v[16:19], v[136:139], v[200:203], v[16:19]
 bl4 v240, s[8:11], s20 offen lds
 mf v[20:23], v[136:139], v[204:207], v[20:23]
 trr v[136:137], v226 offset:49152
 trr v[138:139], v226 offset:53248
 mf v[24:27], v[140:143], v[200:203], v[24:27]
 swc lgkmcnt(6)
 mf v[28:31], v[140:143], v[204:207], v[28:31]
 trr v[140:141], v227 offset:49152
 trr v[142:143], v227 offset:53248
 mf v[32:35], v[144:147], v[200:203], v[32:35]
 bl4 v241, s[8:11], s20 offen offset:1024 lds
 mf v[36:39], v[144:147], v[204:207], v[36:39]
 trr v[144:145], v228 offset:49152
 trr v[146:147], v228 offset:53248
 mf v[40:43], v[148:151], v[200:203], v[40:43]
 s_cmp_eq_u32 s33, 0
 s_cbranch_scc1 K2_NB_122
 sad s19, s24, 11218944
 bl4 v[168:171], v244, s[12:15], s19 offen offset:0 sc1
 bl4 v[172:175], v244, s[12:15], s19 offen offset:1024 sc1
K2_NB_122:
 mf v[44:47], v[148:151], v[204:207], v[44:47]
 trr v[148:149], v229 offset:49152
 trr v[150:151], v229 offset:53248
 mf v[48:51], v[152:155], v[200:203], v[48:51]
 mf v[52:55], v[152:155], v[204:207], v[52:55]
 trr v[152:153], v230 offset:49152
 trr v[154:155], v230 offset:53248
 mf v[56:59], v[156:159], v[200:203], v[56:59]
 mf v[60:63], v[156:159], v[204:207], v[60:63]
 trr v[156:157], v231 offset:49152
 trr v[158:159], v231 offset:53248
 s_cmp_eq_u32 s33, 0
 s_cbranch_scc1 K3_HSPIN_F
K3_HOK:
 swc vmcnt(6) lgkmcnt(8)
 mf v[64:67], v[128:131], v[208:211], 0
 swc vmcnt(29)
 s_barrier
 mf v[68:71], v[128:131], v[212:215], 0
 trr v[128:129], v224 offset:57344
 trr v[130:131], v224 offset:61440
 mf v[72:75], v[132:135], v[208:211], 0
 sad m0, s25, 8192
 sad s20, s23, 360448
 mf v[76:79], v[132:135], v[212:215], 0
 trr v[132:133], v225 offset:57344
 trr v[134:135], v225 offset:61440
 mf v[80:83], v[136:139], v[208:211], 0
 bl4 v240, s[8:11], s20 offen lds
 mf v[84:87], v[136:139], v[212:215], 0
 trr v[136:137], v226 offset:57344
 trr v[138:139], v226 offset:61440
 mf v[88:91], v[140:143], v[208:211], 0
 swc lgkmcnt(6)
 mf v[92:95], v[140:143], v[212:215], 0
 trr v[140:141], v227 offset:57344
 trr v[142:143], v227 offset:61440
 mf v[96:99], v[144:147], v[208:211], 0
 bl4 v241, s[8:11], s20 offen offset:1024 lds
 mf v[100:103], v[144:147], v[212:215], 0
 trr v[144:145], v228 offset:57344
 trr v[146:147], v228 offset:61440
 mf v[104:107], v[148:151], v[208:211], 0
 sad s19, s24, 11223040
 mf v[108:111], v[148:151], v[212:215], 0
 trr v[148:149], v229 offset:57344
 trr v[150:151], v229 offset:61440
 mf v[112:115], v[152:155], v[208:211], 0
 bl4 v[176:179], v244, s[12:15], s19 offen offset:0 sc1
 mf v[116:119], v[152:155], v[212:215], 0
 trr v[152:153], v230 offset:57344
 trr v[154:155], v230 offset:61440
 mf v[120:123], v[156:159], v[208:211], 0
 bl4 v[180:183], v244, s[12:15], s19 offen offset:1024 sc1
 sad s19, s24, 11227136
 bl4 v[184:187], v244, s[12:15], s19 offen offset:0 sc1
 bl4 v[188:191], v244, s[12:15], s19 offen offset:1024 sc1
 mf v[124:127], v[156:159], v[212:215], 0
 trr v[156:157], v231 offset:57344
 trr v[158:159], v231 offset:61440
 swc vmcnt(10) lgkmcnt(8)
 mf v[64:67], v[128:131], v[216:219], v[64:67]
 mf v[68:71], v[128:131], v[220:223], v[68:71]
 trr v[128:129], v232 offset:0
 trr v[130:131], v232 offset:4096
 mf v[72:75], v[132:135], v[216:219], v[72:75]
 sad m0, s25, 16384
 sad s20, s23, 393216
 cvp v0, v0, v1
 cvp v1, v2, v3
 mf v[76:79], v[132:135], v[220:223], v[76:79]
 trr v[132:133], v233 offset:0
 trr v[134:135], v233 offset:4096
 mf v[80:83], v[136:139], v[216:219], v[80:83]
 bl4 v240, s[8:11], s20 offen lds
 cvp v2, v8, v9
 cvp v3, v10, v11
 mf v[84:87], v[136:139], v[220:223], v[84:87]
 trr v[136:137], v234 offset:0
 trr v[138:139], v234 offset:4096
 mf v[88:91], v[140:143], v[216:219], v[88:91]
 swc lgkmcnt(6)
 mf v[92:95], v[140:143], v[220:223], v[92:95]
 trr v[140:141], v235 offset:0
 trr v[142:143], v235 offset:4096
 mf v[96:99], v[144:147], v[216:219], v[96:99]
 bl4 v241, s[8:11], s20 offen offset:1024 lds
 sad s36, s26, 0
 bs4 v[0:3], v244, s[12:15], s36 offen offset:0 sc1
 mf v[100:103], v[144:147], v[220:223], v[100:103]
 trr v[144:145], v236 offset:0
 trr v[146:147], v236 offset:4096
 mf v[104:107], v[148:151], v[216:219], v[104:107]
 sad s19, s24, 11231232
 cvp v4, v4, v5
 cvp v5, v6, v7
 mf v[108:111], v[148:151], v[220:223], v[108:111]
 trr v[148:149], v237 offset:0
 trr v[150:151], v237 offset:4096
 mf v[112:115], v[152:155], v[216:219], v[112:115]
 bl4 v[192:195], v244, s[12:15], s19 offen offset:0 sc1
 cvp v6, v12, v13
 cvp v7, v14, v15
 mf v[116:119], v[152:155], v[220:223], v[116:119]
 trr v[152:153], v238 offset:0
 trr v[154:155], v238 offset:4096
 mf v[120:123], v[156:159], v[216:219], v[120:123]
 bl4 v[196:199], v244, s[12:15], s19 offen offset:1024 sc1
 sad s19, s24, 11235328
 bl4 v[200:203], v244, s[12:15], s19 offen offset:0 sc1
 bl4 v[204:207], v244, s[12:15], s19 offen offset:1024 sc1
 bs4 v[4:7], v244, s[12:15], s36 offen offset:1024 sc1
 cvp v16, v16, v17
 mf v[124:127], v[156:159], v[220:223], v[124:127]
 trr v[156:157], v239 offset:0
 trr v[158:159], v239 offset:4096
 swc vmcnt(16) lgkmcnt(8)
 mf v[64:67], v[128:131], v[160:163], v[64:67]
 swc vmcnt(35)
 s_barrier
 mf v[68:71], v[128:131], v[164:167], v[68:71]
 trr v[128:129], v232 offset:8192
 trr v[130:131], v232 offset:12288
 mf v[72:75], v[132:135], v[160:163], v[72:75]
 sad m0, s25, 24576
 sad s20, s23, 425984
 cvp v17, v18, v19
 cvp v18, v24, v25
 mf v[76:79], v[132:135], v[164:167], v[76:79]
 trr v[132:133], v233 offset:8192
 trr v[134:135], v233 offset:12288
 mf v[80:83], v[136:139], v[160:163], v[80:83]
 bl4 v240, s[8:11], s20 offen lds
 cvp v19, v26, v27
 bs4 v[16:19], v244, s[12:15], s36 offen offset:2048 sc1
 mf v[84:87], v[136:139], v[164:167], v[84:87]
 trr v[136:137], v234 offset:8192
 trr v[138:139], v234 offset:12288
 mf v[88:91], v[140:143], v[160:163], v[88:91]
 swc lgkmcnt(6)
 mf v[92:95], v[140:143], v[164:167], v[92:95]
 trr v[140:141], v235 offset:8192
 trr v[142:143], v235 offset:12288
 mf v[96:99], v[144:147], v[160:163], v[96:99]
 bl4 v241, s[8:11], s20 offen offset:1024 lds
 cvp v20, v20, v21
 cvp v21, v22, v23
 mf v[100:103], v[144:147], v[164:167], v[100:103]
 trr v[144:145], v236 offset:8192
 trr v[146:147], v236 offset:12288
 mf v[104:107], v[148:151], v[160:163], v[104:107]
 sad s19, s24, 11239424
 cvp v22, v28, v29
 cvp v23, v30, v31
 mf v[108:111], v[148:151], v[164:167], v[108:111]
 trr v[148:149], v237 offset:8192
 trr v[150:151], v237 offset:12288
 mf v[112:115], v[152:155], v[160:163], v[112:115]
 bl4 v[208:211], v244, s[12:15], s19 offen offset:0 sc1
 bs4 v[20:23], v244, s[12:15], s36 offen offset:3072 sc1
 cvp v32, v32, v33
 mf v[116:119], v[152:155], v[164:167], v[116:119]
 trr v[152:153], v238 offset:8192
 trr v[154:155], v238 offset:12288
 mf v[120:123], v[156:159], v[160:163], v[120:123]
 bl4 v[212:215], v244, s[12:15], s19 offen offset:1024 sc1
 sad s19, s24, 11243520
 bl4 v[216:219], v244, s[12:15], s19 offen offset:0 sc1
 bl4 v[220:223], v244, s[12:15], s19 offen offset:1024 sc1
 cvp v33, v34, v35
 cvp v34, v40, v41
 mf v[124:127], v[156:159], v[164:167], v[124:127]
 trr v[156:157], v239 offset:8192
 trr v[158:159], v239 offset:12288
 swc vmcnt(22) lgkmcnt(8)
 mf v[64:67], v[128:131], v[168:171], v[64:67]
 mf v[68:71], v[128:131], v[172:175], v[68:71]
 trr v[128:129], v232 offset:16384
 trr v[130:131], v232 offset:20480
 mf v[72:75], v[132:135], v[168:171], v[72:75]
 sad m0, s25, 32768
 sad s20, s23, 458752
 cvp v35, v42, v43
 sad s36, s26, 4096
 mf v[76:79], v[132:135], v[172:175], v[76:79]
 trr v[132:133], v233 offset:16384
 trr v[134:135], v233 offset:20480
 mf v[80:83], v[136:139], v[168:171], v[80:83]
 bl4 v240, s[8:11], s20 offen lds
 bs4 v[32:35], v244, s[12:15], s36 offen offset:0 sc1
 cvp v36, v36, v37
 mf v[84:87], v[136:139], v[172:175], v[84:87]
 trr v[136:137], v234 offset:16384
 trr v[138:139], v234 offset:20480
 mf v[88:91], v[140:143], v[168:171], v[88:91]
 swc lgkmcnt(6)
 mf v[92:95], v[140:143], v[172:175], v[92:95]
 trr v[140:141], v235 offset:16384
 trr v[142:143], v235 offset:20480
 mf v[96:99], v[144:147], v[168:171], v[96:99]
 bl4 v241, s[8:11], s20 offen offset:1024 lds
 cvp v37, v38, v39
 cvp v38, v44, v45
 mf v[100:103], v[144:147], v[172:175], v[100:103]
 trr v[144:145], v236 offset:16384
 trr v[146:147], v236 offset:20480
 mf v[104:107], v[148:151], v[168:171], v[104:107]
 sad s19, s24, 11247616
 cvp v39, v46, v47
 bs4 v[36:39], v244, s[12:15], s36 offen offset:1024 sc1
 mf v[108:111], v[148:151], v[172:175], v[108:111]
 trr v[148:149], v237 offset:16384
 trr v[150:151], v237 offset:20480
 mf v[112:115], v[152:155], v[168:171], v[112:115]
 bl4 v[160:163], v244, s[12:15], s19 offen offset:0 sc1
 cvp v48, v48, v49
 cvp v49, v50, v51
 mf v[116:119], v[152:155], v[172:175], v[116:119]
 trr v[152:153], v238 offset:16384
 trr v[154:155], v238 offset:20480
 mf v[120:123], v[156:159], v[168:171], v[120:123]
 bl4 v[164:167], v244, s[12:15], s19 offen offset:1024 sc1
 cvp v50, v56, v57
 cvp v51, v58, v59
 mf v[124:127], v[156:159], v[172:175], v[124:127]
 trr v[156:157], v239 offset:16384
 trr v[158:159], v239 offset:20480
 swc vmcnt(24) lgkmcnt(8)
 mf v[64:67], v[128:131], v[176:179], v[64:67]
 swc vmcnt(44)
 s_barrier
 mf v[68:71], v[128:131], v[180:183], v[68:71]
 trr v[128:129], v232 offset:24576
 trr v[130:131], v232 offset:28672
 mf v[72:75], v[132:135], v[176:179], v[72:75]
 sad m0, s25, 40960
 sad s20, s23, 491520
 bs4 v[48:51], v244, s[12:15], s36 offen offset:2048 sc1
 cvp v52, v52, v53
 mf v[76:79], v[132:135], v[180:183], v[76:79]
 trr v[132:133], v233 offset:24576
 trr v[134:135], v233 offset:28672
 mf v[80:83], v[136:139], v[176:179], v[80:83]
 bl4 v240, s[8:11], s20 offen lds
 cvp v53, v54, v55
 cvp v54, v60, v61
 mf v[84:87], v[136:139], v[180:183], v[84:87]
 trr v[136:137], v234 offset:24576
 trr v[138:139], v234 offset:28672
 mf v[88:91], v[140:143], v[176:179], v[88:91]
 swc lgkmcnt(6)
 mf v[92:95], v[140:143], v[180:183], v[92:95]
 trr v[140:141], v235 offset:24576
 trr v[142:143], v235 offset:28672
 mf v[96:99], v[144:147], v[176:179], v[96:99]
 bl4 v241, s[8:11], s20 offen offset:1024 lds
 cvp v55, v62, v63
 bs4 v[52:55], v244, s[12:15], s36 offen offset:3072 sc1
 mf v[100:103], v[144:147], v[180:183], v[100:103]
 trr v[144:145], v236 offset:24576
 trr v[146:147], v236 offset:28672
 mf v[104:107], v[148:151], v[176:179], v[104:107]
 sad s19, s24, 11251712
 mf v[108:111], v[148:151], v[180:183], v[108:111]
 trr v[148:149], v237 offset:24576
 trr v[150:151], v237 offset:28672
 mf v[112:115], v[152:155], v[176:179], v[112:115]
 bl4 v[168:171], v244, s[12:15], s19 offen offset:0 sc1
 mf v[116:119], v[152:155], v[180:183], v[116:119]
 trr v[152:153], v238 offset:24576
 trr v[154:155], v238 offset:28672
 mf v[120:123], v[156:159], v[176:179], v[120:123]
 bl4 v[172:175], v244, s[12:15], s19 offen offset:1024 sc1
 mf v[124:127], v[156:159], v[180:183], v[124:127]
 trr v[156:157], v239 offset:24576
 trr v[158:159], v239 offset:28672
 swc vmcnt(28) lgkmcnt(8)
 mf v[64:67], v[128:131], v[184:187], v[64:67]
 mf v[68:71], v[128:131], v[188:191], v[68:71]
 trr v[128:129], v232 offset:32768
 trr v[130:131], v232 offset:36864
 mf v[72:75], v[132:135], v[184:187], v[72:75]
 sad m0, s25, 49152
 sad s20, s23, 524288
 mf v[76:79], v[132:135], v[188:191], v[76:79]
 trr v[132:133], v233 offset:32768
 trr v[134:135], v233 offset:36864
 mf v[80:83], v[136:139], v[184:187], v[80:83]
 bl4 v240, s[8:11], s20 offen lds
 mf v[84:87], v[136:139], v[188:191], v[84:87]
 trr v[136:137], v234 offset:32768
 trr v[138:139], v234 offset:36864
 mf v[88:91], v[140:143], v[184:187], v[88:91]
 swc lgkmcnt(6)
 mf v[92:95], v[140:143], v[188:191], v[92:95]
 trr v[140:141], v235 offset:32768
 trr v[142:143], v235 offset:36864
 mf v[96:99], v[144:147], v[184:187], v[96:99]
 bl4 v241, s[8:11], s20 offen offset:1024 lds
 mf v[100:103], v[144:147], v[188:191], v[100:103]
 trr v[144:145], v236 offset:32768
 trr v[146:147], v236 offset:36864
 mf v[104:107], v[148:151], v[184:187], v[104:107]
 sad s19, s24, 11255808
 mf v[108:111], v[148:151], v[188:191], v[108:111]
 trr v[148:149], v237 offset:32768
 trr v[150:151], v237 offset:36864
 mf v[112:115], v[152:155], v[184:187], v[112:115]
 bl4 v[176:179], v244, s[12:15], s19 offen offset:0 sc1
 mf v[116:119], v[152:155], v[188:191], v[116:119]
 trr v[152:153], v238 offset:32768
 trr v[154:155], v238 offset:36864
 mf v[120:123], v[156:159], v[184:187], v[120:123]
 bl4 v[180:183], v244, s[12:15], s19 offen offset:1024 sc1
 mf v[124:127], v[156:159], v[188:191], v[124:127]
 trr v[156:157], v239 offset:32768
 trr v[158:159], v239 offset:36864
 swc vmcnt(28) lgkmcnt(8)
 mf v[64:67], v[128:131], v[192:195], v[64:67]
 swc vmcnt(50)
 s_barrier
 mf v[68:71], v[128:131], v[196:199], v[68:71]
 trr v[128:129], v232 offset:40960
 trr v[130:131], v232 offset:45056
 mf v[72:75], v[132:135], v[192:195], v[72:75]
 sad m0, s25, 57344
 sad s20, s23, 557056
 mf v[76:79], v[132:135], v[196:199], v[76:79]
 trr v[132:133], v233 offset:40960
 trr v[134:135], v233 offset:45056
 mf v[80:83], v[136:139], v[192:195], v[80:83]
 bl4 v240, s[8:11], s20 offen lds
 mf v[84:87], v[136:139], v[196:199], v[84:87]
 trr v[136:137], v234 offset:40960
 trr v[138:139], v234 offset:45056
 mf v[88:91], v[140:143], v[192:195], v[88:91]
 swc lgkmcnt(6)
 mf v[92:95], v[140:143], v[196:199], v[92:95]
 trr v[140:141], v235 offset:40960
 trr v[142:143], v235 offset:45056
 mf v[96:99], v[144:147], v[192:195], v[96:99]
 bl4 v241, s[8:11], s20 offen offset:1024 lds
 mf v[100:103], v[144:147], v[196:199], v[100:103]
 trr v[144:145], v236 offset:40960
 trr v[146:147], v236 offset:45056
 mf v[104:107], v[148:151], v[192:195], v[104:107]
 sad s19, s24, 11259904
 mf v[108:111], v[148:151], v[196:199], v[108:111]
 trr v[148:149], v237 offset:40960
 trr v[150:151], v237 offset:45056
 mf v[112:115], v[152:155], v[192:195], v[112:115]
 bl4 v[184:187], v244, s[12:15], s19 offen offset:0 sc1
 mf v[116:119], v[152:155], v[196:199], v[116:119]
 trr v[152:153], v238 offset:40960
 trr v[154:155], v238 offset:45056
 mf v[120:123], v[156:159], v[192:195], v[120:123]
 bl4 v[188:191], v244, s[12:15], s19 offen offset:1024 sc1
 mf v[124:127], v[156:159], v[196:199], v[124:127]
 trr v[156:157], v239 offset:40960
 trr v[158:159], v239 offset:45056
 swc vmcnt(30) lgkmcnt(8)
 mf v[64:67], v[128:131], v[200:203], v[64:67]
 mf v[68:71], v[128:131], v[204:207], v[68:71]
 trr v[128:129], v232 offset:49152
 trr v[130:131], v232 offset:53248
 mf v[72:75], v[132:135], v[200:203], v[72:75]
 sad m0, s25, 65536
 sad s20, s23, 589824
 mf v[76:79], v[132:135], v[204:207], v[76:79]
 trr v[132:133], v233 offset:49152
 trr v[134:135], v233 offset:53248
 mf v[80:83], v[136:139], v[200:203], v[80:83]
 bl4 v240, s[8:11], s20 offen lds
 mf v[84:87], v[136:139], v[204:207], v[84:87]
 trr v[136:137], v234 offset:49152
 trr v[138:139], v234 offset:53248
 mf v[88:91], v[140:143], v[200:203], v[88:91]
 swc lgkmcnt(6)
 mf v[92:95], v[140:143], v[204:207], v[92:95]
 trr v[140:141], v235 offset:49152
 trr v[142:143], v235 offset:53248
 mf v[96:99], v[144:147], v[200:203], v[96:99]
 bl4 v241, s[8:11], s20 offen offset:1024 lds
 mf v[100:103], v[144:147], v[204:207], v[100:103]
 trr v[144:145], v236 offset:49152
 trr v[146:147], v236 offset:53248
 mf v[104:107], v[148:151], v[200:203], v[104:107]
 sad s19, s24, 11264000
 mf v[108:111], v[148:151], v[204:207], v[108:111]
 trr v[148:149], v237 offset:49152
 trr v[150:151], v237 offset:53248
 mf v[112:115], v[152:155], v[200:203], v[112:115]
 bl4 v[192:195], v244, s[12:15], s19 offen offset:0 sc1
 mf v[116:119], v[152:155], v[204:207], v[116:119]
 trr v[152:153], v238 offset:49152
 trr v[154:155], v238 offset:53248
 mf v[120:123], v[156:159], v[200:203], v[120:123]
 bl4 v[196:199], v244, s[12:15], s19 offen offset:1024 sc1
 mf v[124:127], v[156:159], v[204:207], v[124:127]
 trr v[156:157], v239 offset:49152
 trr v[158:159], v239 offset:53248
 swc vmcnt(28) lgkmcnt(8)
 mf v[64:67], v[128:131], v[208:211], v[64:67]
 swc vmcnt(12)
 s_barrier
 s_cmp_lg_u32 s16, 0
 s_cbranch_scc1 K3_NOSA
 s_mov_b64 exec, 1
 buffer_atomic_add v249, v251, s[12:15], s39 offen sc1
 s_mov_b64 exec, -1
K3_NOSA:
 mf v[68:71], v[128:131], v[212:215], v[68:71]
 trr v[128:129], v232 offset:57344
 trr v[130:131], v232 offset:61440
 mf v[72:75], v[132:135], v[208:211], v[72:75]
 sad m0, s25, 73728
 sad s20, s23, 622592
 mf v[76:79], v[132:135], v[212:215], v[76:79]
 trr v[132:133], v233 offset:57344
 trr v[134:135], v233 offset:61440
 mf v[80:83], v[136:139], v[208:211], v[80:83]
 bl4 v240, s[8:11], s20 offen lds
 mf v[84:87], v[136:139], v[212:215], v[84:87]
 trr v[136:137], v234 offset:57344
 trr v[138:139], v234 offset:61440
 mf v[88:91], v[140:143], v[208:211], v[88:91]
 swc lgkmcnt(6)
 mf v[92:95], v[140:143], v[212:215], v[92:95]
 trr v[140:141], v235 offset:57344
 trr v[142:143], v235 offset:61440
 mf v[96:99], v[144:147], v[208:211], v[96:99]
 bl4 v241, s[8:11], s20 offen offset:1024 lds
 mf v[100:103], v[144:147], v[212:215], v[100:103]
 trr v[144:145], v236 offset:57344
 trr v[146:147], v236 offset:61440
 mf v[104:107], v[148:151], v[208:211], v[104:107]
 sad s19, s24, 11268096
 mf v[108:111], v[148:151], v[212:215], v[108:111]
 trr v[148:149], v237 offset:57344
 trr v[150:151], v237 offset:61440
 mf v[112:115], v[152:155], v[208:211], v[112:115]
 bl4 v[200:203], v244, s[12:15], s19 offen offset:0 sc1
 mf v[116:119], v[152:155], v[212:215], v[116:119]
 trr v[152:153], v238 offset:57344
 trr v[154:155], v238 offset:61440
 mf v[120:123], v[156:159], v[208:211], v[120:123]
 bl4 v[204:207], v244, s[12:15], s19 offen offset:1024 sc1
 mf v[124:127], v[156:159], v[212:215], v[124:127]
 trr v[156:157], v239 offset:57344
 trr v[158:159], v239 offset:61440
 swc vmcnt(30) lgkmcnt(8)
 mf v[64:67], v[128:131], v[216:219], v[64:67]
 mf v[68:71], v[128:131], v[220:223], v[68:71]
 trr v[128:129], v224 offset:0
 trr v[130:131], v224 offset:4096
 mf v[72:75], v[132:135], v[216:219], v[72:75]
 sad m0, s25, 81920
 sad s20, s23, 655360
 mf v[76:79], v[132:135], v[220:223], v[76:79]
 trr v[132:133], v225 offset:0
 trr v[134:135], v225 offset:4096
 mf v[80:83], v[136:139], v[216:219], v[80:83]
 bl4 v240, s[8:11], s20 offen lds
 mf v[84:87], v[136:139], v[220:223], v[84:87]
 trr v[136:137], v226 offset:0
 trr v[138:139], v226 offset:4096
 mf v[88:91], v[140:143], v[216:219], v[88:91]
 swc lgkmcnt(6)
 mf v[92:95], v[140:143], v[220:223], v[92:95]
 trr v[140:141], v227 offset:0
 trr v[142:143], v227 offset:4096
 mf v[96:99], v[144:147], v[216:219], v[96:99]
 bl4 v241, s[8:11], s20 offen offset:1024 lds
 mf v[100:103], v[144:147], v[220:223], v[100:103]
 trr v[144:145], v228 offset:0
 trr v[146:147], v228 offset:4096
 mf v[104:107], v[148:151], v[216:219], v[104:107]
 sad s19, s24, 11272192
 mf v[108:111], v[148:151], v[220:223], v[108:111]
 trr v[148:149], v229 offset:0
 trr v[150:151], v229 offset:4096
 mf v[112:115], v[152:155], v[216:219], v[112:115]
 bl4 v[208:211], v244, s[12:15], s19 offen offset:0 sc1
 mf v[116:119], v[152:155], v[220:223], v[116:119]
 trr v[152:153], v230 offset:0
 trr v[154:155], v230 offset:4096
 mf v[120:123], v[156:159], v[216:219], v[120:123]
 bl4 v[212:215], v244, s[12:15], s19 offen offset:1024 sc1
 mf v[124:127], v[156:159], v[220:223], v[124:127]
 trr v[156:157], v231 offset:0
 trr v[158:159], v231 offset:4096
 swc vmcnt(28) lgkmcnt(8)
 mf v[64:67], v[128:131], v[160:163], v[64:67]
 swc vmcnt(46)
 s_barrier
 mf v[68:71], v[128:131], v[164:167], v[68:71]
 trr v[128:129], v224 offset:8192
 trr v[130:131], v224 offset:12288
 mf v[72:75], v[132:135], v[160:163], v[72:75]
 sad m0, s25, 90112
 sad s20, s23, 688128
 mf v[76:79], v[132:135], v[164:167], v[76:79]
 trr v[132:133], v225 offset:8192
 trr v[134:135], v225 offset:12288
 mf v[80:83], v[136:139], v[160:163], v[80:83]
 bl4 v240, s[8:11], s20 offen lds
 mf v[84:87], v[136:139], v[164:167], v[84:87]
 trr v[136:137], v226 offset:8192
 trr v[138:139], v226 offset:12288
 mf v[88:91], v[140:143], v[160:163], v[88:91]
 swc lgkmcnt(6)
 mf v[92:95], v[140:143], v[164:167], v[92:95]
 trr v[140:141], v227 offset:8192
 trr v[142:143], v227 offset:12288
 mf v[96:99], v[144:147], v[160:163], v[96:99]
 bl4 v241, s[8:11], s20 offen offset:1024 lds
 mf v[100:103], v[144:147], v[164:167], v[100:103]
 trr v[144:145], v228 offset:8192
 trr v[146:147], v228 offset:12288
 mf v[104:107], v[148:151], v[160:163], v[104:107]
 sad s19, s24, 11276288
 mf v[108:111], v[148:151], v[164:167], v[108:111]
 trr v[148:149], v229 offset:8192
 trr v[150:151], v229 offset:12288
 mf v[112:115], v[152:155], v[160:163], v[112:115]
 bl4 v[216:219], v244, s[12:15], s19 offen offset:0 sc1
 mf v[116:119], v[152:155], v[164:167], v[116:119]
 trr v[152:153], v230 offset:8192
 trr v[154:155], v230 offset:12288
 mf v[120:123], v[156:159], v[160:163], v[120:123]
 bl4 v[220:223], v244, s[12:15], s19 offen offset:1024 sc1
 mf v[124:127], v[156:159], v[164:167], v[124:127]
 trr v[156:157], v231 offset:8192
 trr v[158:159], v231 offset:12288
 swc vmcnt(26) lgkmcnt(8)
 mf v[64:67], v[128:131], v[168:171], v[64:67]
 mf v[68:71], v[128:131], v[172:175], v[68:71]
 trr v[128:129], v224 offset:16384
 trr v[130:131], v224 offset:20480
 mf v[72:75], v[132:135], v[168:171], v[72:75]
 sad s19, s24, 11280384
 mf v[76:79], v[132:135], v[172:175], v[76:79]
 trr v[132:133], v225 offset:16384
 trr v[134:135], v225 offset:20480
 mf v[80:83], v[136:139], v[168:171], v[80:83]
 bl4 v[160:163], v244, s[12:15], s19 offen offset:0 sc1
 mf v[84:87], v[136:139], v[172:175], v[84:87]
 trr v[136:137], v226 offset:16384
 trr v[138:139], v226 offset:20480
 mf v[88:91], v[140:143], v[168:171], v[88:91]
 swc lgkmcnt(6)
 mf v[92:95], v[140:143], v[172:175], v[92:95]
 trr v[140:141], v227 offset:16384
 trr v[142:143], v227 offset:20480
 mf v[96:99], v[144:147], v[168:171], v[96:99]
 bl4 v[164:167], v244, s[12:15], s19 offen offset:1024 sc1
 mf v[100:103], v[144:147], v[172:175], v[100:103]
 trr v[144:145], v228 offset:16384
 trr v[146:147], v228 offset:20480
 mf v[104:107], v[148:151], v[168:171], v[104:107]
 mf v[108:111], v[148:151], v[172:175], v[108:111]
 trr v[148:149], v229 offset:16384
 trr v[150:151], v229 offset:20480
 mf v[112:115], v[152:155], v[168:171], v[112:115]
 mf v[116:119], v[152:155], v[172:175], v[116:119]
 trr v[152:153], v230 offset:16384
 trr v[154:155], v230 offset:20480
 mf v[120:123], v[156:159], v[168:171], v[120:123]
 mf v[124:127], v[156:159], v[172:175], v[124:127]
 trr v[156:157], v231 offset:16384
 trr v[158:159], v231 offset:20480
 swc vmcnt(22) lgkmcnt(8)
 mf v[64:67], v[128:131], v[176:179], v[64:67]
 swc vmcnt(36)
 s_barrier
 mf v[68:71], v[128:131], v[180:183], v[68:71]
 trr v[128:129], v224 offset:24576
 trr v[130:131], v224 offset:28672
 mf v[72:75], v[132:135], v[176:179], v[72:75]
 sad s19, s24, 11284480
 mf v[76:79], v[132:135], v[180:183], v[76:79]
 trr v[132:133], v225 offset:24576
 trr v[134:135], v225 offset:28672
 mf v[80:83], v[136:139], v[176:179], v[80:83]
 bl4 v[168:171], v244, s[12:15], s19 offen offset:0 sc1
 mf v[84:87], v[136:139], v[180:183], v[84:87]
 trr v[136:137], v226 offset:24576
 trr v[138:139], v226 offset:28672
 mf v[88:91], v[140:143], v[176:179], v[88:91]
 swc lgkmcnt(6)
 mf v[92:95], v[140:143], v[180:183], v[92:95]
 trr v[140:141], v227 offset:24576
 trr v[142:143], v227 offset:28672
 mf v[96:99], v[144:147], v[176:179], v[96:99]
 bl4 v[172:175], v244, s[12:15], s19 offen offset:1024 sc1
 mf v[100:103], v[144:147], v[180:183], v[100:103]
 trr v[144:145], v228 offset:24576
 trr v[146:147], v228 offset:28672
 mf v[104:107], v[148:151], v[176:179], v[104:107]
 mf v[108:111], v[148:151], v[180:183], v[108:111]
 trr v[148:149], v229 offset:24576
 trr v[150:151], v229 offset:28672
 mf v[112:115], v[152:155], v[176:179], v[112:115]
 mf v[116:119], v[152:155], v[180:183], v[116:119]
 trr v[152:153], v230 offset:24576
 trr v[154:155], v230 offset:28672
 mf v[120:123], v[156:159], v[176:179], v[120:123]
 mf v[124:127], v[156:159], v[180:183], v[124:127]
 trr v[156:157], v231 offset:24576
 trr v[158:159], v231 offset:28672
 swc vmcnt(20) lgkmcnt(8)
 mf v[64:67], v[128:131], v[184:187], v[64:67]
 mf v[68:71], v[128:131], v[188:191], v[68:71]
 trr v[128:129], v224 offset:32768
 trr v[130:131], v224 offset:36864
 mf v[72:75], v[132:135], v[184:187], v[72:75]
 sad s19, s24, 11288576
 mf v[76:79], v[132:135], v[188:191], v[76:79]
 trr v[132:133], v225 offset:32768
 trr v[134:135], v225 offset:36864
 mf v[80:83], v[136:139], v[184:187], v[80:83]
 bl4 v[176:179], v244, s[12:15], s19 offen offset:0 sc1
 mf v[84:87], v[136:139], v[188:191], v[84:87]
 trr v[136:137], v226 offset:32768
 trr v[138:139], v226 offset:36864
 mf v[88:91], v[140:143], v[184:187], v[88:91]
 swc lgkmcnt(6)
 mf v[92:95], v[140:143], v[188:191], v[92:95]
 trr v[140:141], v227 offset:32768
 trr v[142:143], v227 offset:36864
 mf v[96:99], v[144:147], v[184:187], v[96:99]
 bl4 v[180:183], v244, s[12:15], s19 offen offset:1024 sc1
 mf v[100:103], v[144:147], v[188:191], v[100:103]
 trr v[144:145], v228 offset:32768
 trr v[146:147], v228 offset:36864
 mf v[104:107], v[148:151], v[184:187], v[104:107]
 mf v[108:111], v[148:151], v[188:191], v[108:111]
 trr v[148:149], v229 offset:32768
 trr v[150:151], v229 offset:36864
 mf v[112:115], v[152:155], v[184:187], v[112:115]
 mf v[116:119], v[152:155], v[188:191], v[116:119]
 trr v[152:153], v230 offset:32768
 trr v[154:155], v230 offset:36864
 mf v[120:123], v[156:159], v[184:187], v[120:123]
 mf v[124:127], v[156:159], v[188:191], v[124:127]
 trr v[156:157], v231 offset:32768
 trr v[158:159], v231 offset:36864
 swc vmcnt(18) lgkmcnt(8)
 mf v[64:67], v[128:131], v[192:195], v[64:67]
 swc vmcnt(28)
 s_barrier
 mf v[68:71], v[128:131], v[196:199], v[68:71]
 trr v[128:129], v224 offset:40960
 trr v[130:131], v224 offset:45056
 mf v[72:75], v[132:135], v[192:195], v[72:75]
 sad s19, s24, 11292672
 s_sub_u32 s19, s19, s32
 mf v[76:79], v[132:135], v[196:199], v[76:79]
 trr v[132:133], v225 offset:40960
 trr v[134:135], v225 offset:45056
 mf v[80:83], v[136:139], v[192:195], v[80:83]
 bl4 v[184:187], v244, s[12:15], s19 offen offset:0 sc1
 mf v[84:87], v[136:139], v[196:199], v[84:87]
 trr v[136:137], v226 offset:40960
 trr v[138:139], v226 offset:45056
 mf v[88:91], v[140:143], v[192:195], v[88:91]
 swc lgkmcnt(6)
 mf v[92:95], v[140:143], v[196:199], v[92:95]
 trr v[140:141], v227 offset:40960
 trr v[142:143], v227 offset:45056
 mf v[96:99], v[144:147], v[192:195], v[96:99]
 bl4 v[188:191], v244, s[12:15], s19 offen offset:1024 sc1
 mf v[100:103], v[144:147], v[196:199], v[100:103]
 trr v[144:145], v228 offset:40960
 trr v[146:147], v228 offset:45056
 mf v[104:107], v[148:151], v[192:195], v[104:107]
 mf v[108:111], v[148:151], v[196:199], v[108:111]
 trr v[148:149], v229 offset:40960
 trr v[150:151], v229 offset:45056
 mf v[112:115], v[152:155], v[192:195], v[112:115]
 mf v[116:119], v[152:155], v[196:199], v[116:119]
 trr v[152:153], v230 offset:40960
 trr v[154:155], v230 offset:45056
 mf v[120:123], v[156:159], v[192:195], v[120:123]
 mf v[124:127], v[156:159], v[196:199], v[124:127]
 trr v[156:157], v231 offset:40960
 trr v[158:159], v231 offset:45056
 swc vmcnt(16) lgkmcnt(8)
 mf v[64:67], v[128:131], v[200:203], v[64:67]
 mf v[68:71], v[128:131], v[204:207], v[68:71]
 trr v[128:129], v224 offset:49152
 trr v[130:131], v224 offset:53248
 mf v[72:75], v[132:135], v[200:203], v[72:75]
 mf v[76:79], v[132:135], v[204:207], v[76:79]
 trr v[132:133], v225 offset:49152
 trr v[134:135], v225 offset:53248
 mf v[80:83], v[136:139], v[200:203], v[80:83]
 mf v[84:87], v[136:139], v[204:207], v[84:87]
 trr v[136:137], v226 offset:49152
 trr v[138:139], v226 offset:53248
 mf v[88:91], v[140:143], v[200:203], v[88:91]
 swc lgkmcnt(6)
 mf v[92:95], v[140:143], v[204:207], v[92:95]
 trr v[140:141], v227 offset:49152
 trr v[142:143], v227 offset:53248
 mf v[96:99], v[144:147], v[200:203], v[96:99]
 mf v[100:103], v[144:147], v[204:207], v[100:103]
 trr v[144:145], v228 offset:49152
 trr v[146:147], v228 offset:53248
 mf v[104:107], v[148:151], v[200:203], v[104:107]
 mf v[108:111], v[148:151], v[204:207], v[108:111]
 trr v[148:149], v229 offset:49152
 trr v[150:151], v229 offset:53248
 mf v[112:115], v[152:155], v[200:203], v[112:115]
 mf v[116:119], v[152:155], v[204:207], v[116:119]
 trr v[152:153], v230 offset:49152
 trr v[154:155], v230 offset:53248
 mf v[120:123], v[156:159], v[200:203], v[120:123]
 mf v[124:127], v[156:159], v[204:207], v[124:127]
 trr v[156:157], v231 offset:49152
 trr v[158:159], v231 offset:53248
 swc vmcnt(12) lgkmcnt(8)
 mf v[64:67], v[128:131], v[208:211], v[64:67]
 swc vmcnt(22)
 s_barrier
 mf v[68:71], v[128:131], v[212:215], v[68:71]
 trr v[128:129], v224 offset:57344
 trr v[130:131], v224 offset:61440
 mf v[72:75], v[132:135], v[208:211], v[72:75]
 mf v[76:79], v[132:135], v[212:215], v[76:79]
 trr v[132:133], v225 offset:57344
 trr v[134:135], v225 offset:61440
 mf v[80:83], v[136:139], v[208:211], v[80:83]
 mf v[84:87], v[136:139], v[212:215], v[84:87]
 trr v[136:137], v226 offset:57344
 trr v[138:139], v226 offset:61440
 mf v[88:91], v[140:143], v[208:211], v[88:91]
 swc lgkmcnt(6)
 mf v[92:95], v[140:143], v[212:215], v[92:95]
 trr v[140:141], v227 offset:57344
 trr v[142:143], v227 offset:61440
 mf v[96:99], v[144:147], v[208:211], v[96:99]
 mf v[100:103], v[144:147], v[212:215], v[100:103]
 trr v[144:145], v228 offset:57344
 trr v[146:147], v228 offset:61440
 mf v[104:107], v[148:151], v[208:211], v[104:107]
 mf v[108:111], v[148:151], v[212:215], v[108:111]
 trr v[148:149], v229 offset:57344
 trr v[150:151], v229 offset:61440
 mf v[112:115], v[152:155], v[208:211], v[112:115]
 mf v[116:119], v[152:155], v[212:215], v[116:119]
 trr v[152:153], v230 offset:57344
 trr v[154:155], v230 offset:61440
 mf v[120:123], v[156:159], v[208:211], v[120:123]
 mf v[124:127], v[156:159], v[212:215], v[124:127]
 trr v[156:157], v231 offset:57344
 trr v[158:159], v231 offset:61440
 swc vmcnt(8) lgkmcnt(8)
 mf v[64:67], v[128:131], v[216:219], v[64:67]
 mf v[68:71], v[128:131], v[220:223], v[68:71]
 trr v[128:129], v232 offset:0
 trr v[130:131], v232 offset:4096
 mf v[72:75], v[132:135], v[216:219], v[72:75]
 mf v[76:79], v[132:135], v[220:223], v[76:79]
 trr v[132:133], v233 offset:0
 trr v[134:135], v233 offset:4096
 mf v[80:83], v[136:139], v[216:219], v[80:83]
 mf v[84:87], v[136:139], v[220:223], v[84:87]
 trr v[136:137], v234 offset:0
 trr v[138:139], v234 offset:4096
 mf v[88:91], v[140:143], v[216:219], v[88:91]
 swc lgkmcnt(6)
 mf v[92:95], v[140:143], v[220:223], v[92:95]
 trr v[140:141], v235 offset:0
 trr v[142:143], v235 offset:4096
 mf v[96:99], v[144:147], v[216:219], v[96:99]
 mf v[100:103], v[144:147], v[220:223], v[100:103]
 trr v[144:145], v236 offset:0
 trr v[146:147], v236 offset:4096
 mf v[104:107], v[148:151], v[216:219], v[104:107]
 mf v[108:111], v[148:151], v[220:223], v[108:111]
 trr v[148:149], v237 offset:0
 trr v[150:151], v237 offset:4096
 mf v[112:115], v[152:155], v[216:219], v[112:115]
 mf v[116:119], v[152:155], v[220:223], v[116:119]
 trr v[152:153], v238 offset:0
 trr v[154:155], v238 offset:4096
 mf v[120:123], v[156:159], v[216:219], v[120:123]
 mf v[124:127], v[156:159], v[220:223], v[124:127]
 trr v[156:157], v239 offset:0
 trr v[158:159], v239 offset:4096
 swc vmcnt(6) lgkmcnt(8)
 mf v[64:67], v[128:131], v[160:163], v[64:67]
 swc vmcnt(14)
 s_barrier
 mf v[68:71], v[128:131], v[164:167], v[68:71]
 trr v[128:129], v232 offset:8192
 trr v[130:131], v232 offset:12288
 mf v[72:75], v[132:135], v[160:163], v[72:75]
 mf v[76:79], v[132:135], v[164:167], v[76:79]
 trr v[132:133], v233 offset:8192
 trr v[134:135], v233 offset:12288
 mf v[80:83], v[136:139], v[160:163], v[80:83]
 mf v[84:87], v[136:139], v[164:167], v[84:87]
 trr v[136:137], v234 offset:8192
 trr v[138:139], v234 offset:12288
 mf v[88:91], v[140:143], v[160:163], v[88:91]
 swc lgkmcnt(6)
 mf v[92:95], v[140:143], v[164:167], v[92:95]
 trr v[140:141], v235 offset:8192
 trr v[142:143], v235 offset:12288
 mf v[96:99], v[144:147], v[160:163], v[96:99]
 mf v[100:103], v[144:147], v[164:167], v[100:103]
 trr v[144:145], v236 offset:8192
 trr v[146:147], v236 offset:12288
 mf v[104:107], v[148:151], v[160:163], v[104:107]
 mf v[108:111], v[148:151], v[164:167], v[108:111]
 trr v[148:149], v237 offset:8192
 trr v[150:151], v237 offset:12288
 mf v[112:115], v[152:155], v[160:163], v[112:115]
 mf v[116:119], v[152:155], v[164:167], v[116:119]
 trr v[152:153], v238 offset:8192
 trr v[154:155], v238 offset:12288
 mf v[120:123], v[156:159], v[160:163], v[120:123]
 mf v[124:127], v[156:159], v[164:167], v[124:127]
 trr v[156:157], v239 offset:8192
 trr v[158:159], v239 offset:12288
 swc vmcnt(4) lgkmcnt(8)
 mf v[64:67], v[128:131], v[168:171], v[64:67]
 mf v[68:71], v[128:131], v[172:175], v[68:71]
 trr v[128:129], v232 offset:16384
 trr v[130:131], v232 offset:20480
 mf v[72:75], v[132:135], v[168:171], v[72:75]
 mf v[76:79], v[132:135], v[172:175], v[76:79]
 trr v[132:133], v233 offset:16384
 trr v[134:135], v233 offset:20480
 mf v[80:83], v[136:139], v[168:171], v[80:83]
 mf v[84:87], v[136:139], v[172:175], v[84:87]
 trr v[136:137], v234 offset:16384
 trr v[138:139], v234 offset:20480
 mf v[88:91], v[140:143], v[168:171], v[88:91]
 swc lgkmcnt(6)
 mf v[92:95], v[140:143], v[172:175], v[92:95]
 trr v[140:141], v235 offset:16384
 trr v[142:143], v235 offset:20480
 mf v[96:99], v[144:147], v[168:171], v[96:99]
 mf v[100:103], v[144:147], v[172:175], v[100:103]
 trr v[144:145], v236 offset:16384
 trr v[146:147], v236 offset:20480
 mf v[104:107], v[148:151], v[168:171], v[104:107]
 mf v[108:111], v[148:151], v[172:175], v[108:111]
 trr v[148:149], v237 offset:16384
 trr v[150:151], v237 offset:20480
 mf v[112:115], v[152:155], v[168:171], v[112:115]
 mf v[116:119], v[152:155], v[172:175], v[116:119]
 trr v[152:153], v238 offset:16384
 trr v[154:155], v238 offset:20480
 mf v[120:123], v[156:159], v[168:171], v[120:123]
 mf v[124:127], v[156:159], v[172:175], v[124:127]
 trr v[156:157], v239 offset:16384
 trr v[158:159], v239 offset:20480
 swc vmcnt(2) lgkmcnt(8)
 mf v[64:67], v[128:131], v[176:179], v[64:67]
 swc vmcnt(10)
 s_barrier
 mf v[68:71], v[128:131], v[180:183], v[68:71]
 trr v[128:129], v232 offset:24576
 trr v[130:131], v232 offset:28672
 mf v[72:75], v[132:135], v[176:179], v[72:75]
 mf v[76:79], v[132:135], v[180:183], v[76:79]
 trr v[132:133], v233 offset:24576
 trr v[134:135], v233 offset:28672
 mf v[80:83], v[136:139], v[176:179], v[80:83]
 mf v[84:87], v[136:139], v[180:183], v[84:87]
 trr v[136:137], v234 offset:24576
 trr v[138:139], v234 offset:28672
 mf v[88:91], v[140:143], v[176:179], v[88:91]
 swc lgkmcnt(6)
 mf v[92:95], v[140:143], v[180:183], v[92:95]
 trr v[140:141], v235 offset:24576
 trr v[142:143], v235 offset:28672
 mf v[96:99], v[144:147], v[176:179], v[96:99]
 mf v[100:103], v[144:147], v[180:183], v[100:103]
 trr v[144:145], v236 offset:24576
 trr v[146:147], v236 offset:28672
 mf v[104:107], v[148:151], v[176:179], v[104:107]
 mf v[108:111], v[148:151], v[180:183], v[108:111]
 trr v[148:149], v237 offset:24576
 trr v[150:151], v237 offset:28672
 mf v[112:115], v[152:155], v[176:179], v[112:115]
 mf v[116:119], v[152:155], v[180:183], v[116:119]
 trr v[152:153], v238 offset:24576
 trr v[154:155], v238 offset:28672
 mf v[120:123], v[156:159], v[176:179], v[120:123]
 mf v[124:127], v[156:159], v[180:183], v[124:127]
 trr v[156:157], v239 offset:24576
 trr v[158:159], v239 offset:28672
 swc vmcnt(0) lgkmcnt(8)
 mf v[64:67], v[128:131], v[184:187], v[64:67]
 mf v[68:71], v[128:131], v[188:191], v[68:71]
 mf v[72:75], v[132:135], v[184:187], v[72:75]
 mf v[76:79], v[132:135], v[188:191], v[76:79]
 mf v[80:83], v[136:139], v[184:187], v[80:83]
 mf v[84:87], v[136:139], v[188:191], v[84:87]
 mf v[88:91], v[140:143], v[184:187], v[88:91]
 swc lgkmcnt(6)
 mf v[92:95], v[140:143], v[188:191], v[92:95]
 mf v[96:99], v[144:147], v[184:187], v[96:99]
 mf v[100:103], v[144:147], v[188:191], v[100:103]
 mf v[104:107], v[148:151], v[184:187], v[104:107]
 mf v[108:111], v[148:151], v[188:191], v[108:111]
 mf v[112:115], v[152:155], v[184:187], v[112:115]
 mf v[116:119], v[152:155], v[188:191], v[116:119]
 mf v[120:123], v[156:159], v[184:187], v[120:123]
 mf v[124:127], v[156:159], v[188:191], v[124:127]
 buffer_load_dword v246, v251, s[12:15], s39 offen sc1
 s_nop 4
 cvp v64, v64, v65
 cvp v65, v66, v67
 cvp v66, v72, v73
 cvp v67, v74, v75
 sad s36, s26, 8388608
 bs4 v[64:67], v244, s[12:15], s36 offen offset:0 sc1
 cvp v68, v68, v69
 cvp v69, v70, v71
 cvp v70, v76, v77
 cvp v71, v78, v79
 bs4 v[68:71], v244, s[12:15], s36 offen offset:1024 sc1
 cvp v80, v80, v81
 cvp v81, v82, v83
 cvp v82, v88, v89
 cvp v83, v90, v91
 bs4 v[80:83], v244, s[12:15], s36 offen offset:2048 sc1
 cvp v84, v84, v85
 cvp v85, v86, v87
 cvp v86, v92, v93
 cvp v87, v94, v95
 bs4 v[84:87], v244, s[12:15], s36 offen offset:3072 sc1
 cvp v96, v96, v97
 cvp v97, v98, v99
 cvp v98, v104, v105
 cvp v99, v106, v107
 sad s36, s26, 8392704
 bs4 v[96:99], v244, s[12:15], s36 offen offset:0 sc1
 cvp v100, v100, v101
 cvp v101, v102, v103
 cvp v102, v108, v109
 cvp v103, v110, v111
 bs4 v[100:103], v244, s[12:15], s36 offen offset:1024 sc1
 cvp v112, v112, v113
 cvp v113, v114, v115
 cvp v114, v120, v121
 cvp v115, v122, v123
 bs4 v[112:115], v244, s[12:15], s36 offen offset:2048 sc1
 cvp v116, v116, v117
 cvp v117, v118, v119
 cvp v118, v124, v125
 cvp v119, v126, v127
 bs4 v[116:119], v244, s[12:15], s36 offen offset:3072 sc1
 swc vmcnt(8)
 v_cmp_ne_u32 vcc, 8, v246
 s_cbranch_vccnz K4_LSPIN
K4_LSPIN_B:
 s_lshr_b32 s19, s35, 1
 s_lshl_b32 s19, s19, 13
 s_and_b32 s20, s35, 1
 s_lshl_b32 s20, s20, 10
 sad s19, s19, s20
 s_lshl_b32 s20, s16, 11
 sad s19, s19, s20
 sad s19, s19, s34
 sad s20, s19, 196608
 bl4 v[152:155], v244, s[12:15], s20 offen sc1
 sad s20, s19, 229376
 bl4 v[156:159], v244, s[12:15], s20 offen sc1
 sad s20, s19, 0
 bl4 v[128:131], v244, s[12:15], s20 offen sc1
 sad s20, s19, 32768
 bl4 v[132:135], v244, s[12:15], s20 offen sc1
 sad s20, s19, 65536
 bl4 v[136:139], v244, s[12:15], s20 offen sc1
 sad s20, s19, 98304
 bl4 v[140:143], v244, s[12:15], s20 offen sc1
 sad s20, s19, 131072
 bl4 v[144:147], v244, s[12:15], s20 offen sc1
 sad s20, s19, 163840
 bl4 v[148:151], v244, s[12:15], s20 offen sc1
 swc vmcnt(8)
 s_barrier
 s_cmp_lg_u32 s16, 0
 s_cbranch_scc1 K4_NOSIG
 s_mov_b64 exec, 1
 buffer_atomic_add v249, v252, s[12:15], s39 offen sc1
 s_mov_b64 exec, -1
K4_NOSIG:
 v_accvgpr_read_b32 v192, a0
 v_accvgpr_read_b32 v193, a1
 v_accvgpr_read_b32 v194, a2
 v_accvgpr_read_b32 v195, a3
 v_lshlrev_b32 v184, 16, v192
 v_and_b32 v185, 0xffff0000, v192
 v_lshlrev_b32 v186, 16, v193
 v_and_b32 v187, 0xffff0000, v193
 v_lshlrev_b32 v188, 16, v194
 v_and_b32 v189, 0xffff0000, v194
 v_lshlrev_b32 v190, 16, v195
 v_and_b32 v191, 0xffff0000, v195
 swc vmcnt(6)
 v_lshlrev_b32 v160, 16, v152
 v_and_b32 v161, 0xffff0000, v152
 v_lshlrev_b32 v162, 16, v153
 v_and_b32 v163, 0xffff0000, v153
 v_lshlrev_b32 v164, 16, v154
 v_and_b32 v165, 0xffff0000, v154
 v_lshlrev_b32 v166, 16, v155
 v_and_b32 v167, 0xffff0000, v155
 v_lshlrev_b32 v168, 16, v156
 v_and_b32 v169, 0xffff0000, v156
 v_lshlrev_b32 v170, 16, v157
 v_and_b32 v171, 0xffff0000, v157
 v_lshlrev_b32 v172, 16, v158
 v_and_b32 v173, 0xffff0000, v158
 v_lshlrev_b32 v174, 16, v159
 v_and_b32 v175, 0xffff0000, v159
 vaf v160, v160, v168
 vaf v161, v161, v169
 vaf v162, v162, v170
 vaf v163, v163, v171
 vaf v164, v164, v172
 vaf v165, v165, v173
 vaf v166, v166, v174
 vaf v167, v167, v175
 vmf v176, 0xbfb8aa3b, v160
 vmf v177, 0xbfb8aa3b, v161
 vmf v178, 0xbfb8aa3b, v162
 vmf v179, 0xbfb8aa3b, v163
 vmf v180, 0xbfb8aa3b, v164
 vmf v181, 0xbfb8aa3b, v165
 vmf v182, 0xbfb8aa3b, v166
 vmf v183, 0xbfb8aa3b, v167
 vex v176, v176
 vex v177, v177
 vex v178, v178
 vex v179, v179
 vex v180, v180
 vex v181, v181
 vex v182, v182
 vex v183, v183
 vaf v176, 1.0, v176
 vaf v177, 1.0, v177
 vaf v178, 1.0, v178
 vaf v179, 1.0, v179
 vaf v180, 1.0, v180
 vaf v181, 1.0, v181
 vaf v182, 1.0, v182
 vaf v183, 1.0, v183
 v_rcp_f32 v176, v176
 v_rcp_f32 v177, v177
 v_rcp_f32 v178, v178
 v_rcp_f32 v179, v179
 v_rcp_f32 v180, v180
 v_rcp_f32 v181, v181
 v_rcp_f32 v182, v182
 v_rcp_f32 v183, v183
 vmf v176, v176, v160
 vmf v177, v177, v161
 vmf v178, v178, v162
 vmf v179, v179, v163
 vmf v180, v180, v164
 vmf v181, v181, v165
 vmf v182, v182, v166
 vmf v183, v183, v167
 swc vmcnt(0)
 v_lshlrev_b32 v192, 16, v128
 v_and_b32 v193, 0xffff0000, v128
 v_lshlrev_b32 v194, 16, v129
 v_and_b32 v195, 0xffff0000, v129
 v_lshlrev_b32 v196, 16, v130
 v_and_b32 v197, 0xffff0000, v130
 v_lshlrev_b32 v198, 16, v131
 v_and_b32 v199, 0xffff0000, v131
 v_lshlrev_b32 v160, 16, v132
 v_and_b32 v161, 0xffff0000, v132
 v_lshlrev_b32 v162, 16, v133
 v_and_b32 v163, 0xffff0000, v133
 v_lshlrev_b32 v164, 16, v134
 v_and_b32 v165, 0xffff0000, v134
 v_lshlrev_b32 v166, 16, v135
 v_and_b32 v167, 0xffff0000, v135
 vaf v192, v192, v160
 vaf v193, v193, v161
 vaf v194, v194, v162
 vaf v195, v195, v163
 vaf v196, v196, v164
 vaf v197, v197, v165
 vaf v198, v198, v166
 vaf v199, v199, v167
 v_lshlrev_b32 v160, 16, v136
 v_and_b32 v161, 0xffff0000, v136
 v_lshlrev_b32 v162, 16, v137
 v_and_b32 v163, 0xffff0000, v137
 v_lshlrev_b32 v164, 16, v138
 v_and_b32 v165, 0xffff0000, v138
 v_lshlrev_b32 v166, 16, v139
 v_and_b32 v167, 0xffff0000, v139
 vaf v192, v192, v160
 vaf v193, v193, v161
 vaf v194, v194, v162
 vaf v195, v195, v163
 vaf v196, v196, v164
 vaf v197, v197, v165
 vaf v198, v198, v166
 vaf v199, v199, v167
 v_lshlrev_b32 v160, 16, v140
 v_and_b32 v161, 0xffff0000, v140
 v_lshlrev_b32 v162, 16, v141
 v_and_b32 v163, 0xffff0000, v141
 v_lshlrev_b32 v164, 16, v142
 v_and_b32 v165, 0xffff0000, v142
 v_lshlrev_b32 v166, 16, v143
 v_and_b32 v167, 0xffff0000, v143
 vaf v192, v192, v160
 vaf v193, v193, v161
 vaf v194, v194, v162
 vaf v195, v195, v163
 vaf v196, v196, v164
 vaf v197, v197, v165
 vaf v198, v198, v166
 vaf v199, v199, v167
 v_lshlrev_b32 v160, 16, v144
 v_and_b32 v161, 0xffff0000, v144
 v_lshlrev_b32 v162, 16, v145
 v_and_b32 v163, 0xffff0000, v145
 v_lshlrev_b32 v164, 16, v146
 v_and_b32 v165, 0xffff0000, v146
 v_lshlrev_b32 v166, 16, v147
 v_and_b32 v167, 0xffff0000, v147
 vaf v192, v192, v160
 vaf v193, v193, v161
 vaf v194, v194, v162
 vaf v195, v195, v163
 vaf v196, v196, v164
 vaf v197, v197, v165
 vaf v198, v198, v166
 vaf v199, v199, v167
 v_lshlrev_b32 v160, 16, v148
 v_and_b32 v161, 0xffff0000, v148
 v_lshlrev_b32 v162, 16, v149
 v_and_b32 v163, 0xffff0000, v149
 v_lshlrev_b32 v164, 16, v150
 v_and_b32 v165, 0xffff0000, v150
 v_lshlrev_b32 v166, 16, v151
 v_and_b32 v167, 0xffff0000, v151
 vaf v192, v192, v160
 vaf v193, v193, v161
 vaf v194, v194, v162
 vaf v195, v195, v163
 vaf v196, v196, v164
 vaf v197, v197, v165
 vaf v198, v198, v166
 vaf v199, v199, v167
 v_fmac_f32 v184, v192, v176
 v_fmac_f32 v185, v193, v177
 v_fmac_f32 v186, v194, v178
 v_fmac_f32 v187, v195, v179
 v_fmac_f32 v188, v196, v180
 v_fmac_f32 v189, v197, v181
 v_fmac_f32 v190, v198, v182
 v_fmac_f32 v191, v199, v183
 cvp v160, v184, v185
 cvp v161, v186, v187
 cvp v162, v188, v189
 cvp v163, v190, v191
 buffer_store_dwordx2 v[160:161], v253, s[44:47], 0 offen offset:0
 buffer_store_dwordx2 v[162:163], v253, s[44:47], 0 offen offset:32
 s_cmp_lg_u32 s16, 0
 s_cbranch_scc0 K4_TSPIN_F
K4_TSPIN_B:
 s_barrier
 s_lshr_b32 s19, s35, 1
 s_lshl_b32 s19, s19, 13
 s_and_b32 s20, s35, 1
 s_lshl_b32 s20, s20, 10
 sad s19, s19, s20
 s_lshl_b32 s20, s16, 11
 sad s19, s19, s20
 sad s19, s19, s34
 sad s20, s19, 8585216
 bl4 v[152:155], v244, s[12:15], s20 offen sc1
 sad s20, s19, 8617984
 bl4 v[156:159], v244, s[12:15], s20 offen sc1
 sad s20, s19, 8388608
 bl4 v[128:131], v244, s[12:15], s20 offen sc1
 sad s20, s19, 8421376
 bl4 v[132:135], v244, s[12:15], s20 offen sc1
 sad s20, s19, 8454144
 bl4 v[136:139], v244, s[12:15], s20 offen sc1
 sad s20, s19, 8486912
 bl4 v[140:143], v244, s[12:15], s20 offen sc1
 sad s20, s19, 8519680
 bl4 v[144:147], v244, s[12:15], s20 offen sc1
 sad s20, s19, 8552448
 bl4 v[148:151], v244, s[12:15], s20 offen sc1
 v_accvgpr_read_b32 v192, a4
 v_accvgpr_read_b32 v193, a5
 v_accvgpr_read_b32 v194, a6
 v_accvgpr_read_b32 v195, a7
 v_lshlrev_b32 v184, 16, v192
 v_and_b32 v185, 0xffff0000, v192
 v_lshlrev_b32 v186, 16, v193
 v_and_b32 v187, 0xffff0000, v193
 v_lshlrev_b32 v188, 16, v194
 v_and_b32 v189, 0xffff0000, v194
 v_lshlrev_b32 v190, 16, v195
 v_and_b32 v191, 0xffff0000, v195
 swc vmcnt(6)
 v_lshlrev_b32 v160, 16, v152
 v_and_b32 v161, 0xffff0000, v152
 v_lshlrev_b32 v162, 16, v153
 v_and_b32 v163, 0xffff0000, v153
 v_lshlrev_b32 v164, 16, v154
 v_and_b32 v165, 0xffff0000, v154
 v_lshlrev_b32 v166, 16, v155
 v_and_b32 v167, 0xffff0000, v155
 v_lshlrev_b32 v168, 16, v156
 v_and_b32 v169, 0xffff0000, v156
 v_lshlrev_b32 v170, 16, v157
 v_and_b32 v171, 0xffff0000, v157
 v_lshlrev_b32 v172, 16, v158
 v_and_b32 v173, 0xffff0000, v158
 v_lshlrev_b32 v174, 16, v159
 v_and_b32 v175, 0xffff0000, v159
 vaf v160, v160, v168
 vaf v161, v161, v169
 vaf v162, v162, v170
 vaf v163, v163, v171
 vaf v164, v164, v172
 vaf v165, v165, v173
 vaf v166, v166, v174
 vaf v167, v167, v175
 vmf v176, 0xbfb8aa3b, v160
 vmf v177, 0xbfb8aa3b, v161
 vmf v178, 0xbfb8aa3b, v162
 vmf v179, 0xbfb8aa3b, v163
 vmf v180, 0xbfb8aa3b, v164
 vmf v181, 0xbfb8aa3b, v165
 vmf v182, 0xbfb8aa3b, v166
 vmf v183, 0xbfb8aa3b, v167
 vex v176, v176
 vex v177, v177
 vex v178, v178
 vex v179, v179
 vex v180, v180
 vex v181, v181
 vex v182, v182
 vex v183, v183
 vaf v176, 1.0, v176
 vaf v177, 1.0, v177
 vaf v178, 1.0, v178
 vaf v179, 1.0, v179
 vaf v180, 1.0, v180
 vaf v181, 1.0, v181
 vaf v182, 1.0, v182
 vaf v183, 1.0, v183
 v_rcp_f32 v176, v176
 v_rcp_f32 v177, v177
 v_rcp_f32 v178, v178
 v_rcp_f32 v179, v179
 v_rcp_f32 v180, v180
 v_rcp_f32 v181, v181
 v_rcp_f32 v182, v182
 v_rcp_f32 v183, v183
 vmf v176, v176, v160
 vmf v177, v177, v161
 vmf v178, v178, v162
 vmf v179, v179, v163
 vmf v180, v180, v164
 vmf v181, v181, v165
 vmf v182, v182, v166
 vmf v183, v183, v167
 swc vmcnt(0)
 v_lshlrev_b32 v192, 16, v128
 v_and_b32 v193, 0xffff0000, v128
 v_lshlrev_b32 v194, 16, v129
 v_and_b32 v195, 0xffff0000, v129
 v_lshlrev_b32 v196, 16, v130
 v_and_b32 v197, 0xffff0000, v130
 v_lshlrev_b32 v198, 16, v131
 v_and_b32 v199, 0xffff0000, v131
 v_lshlrev_b32 v160, 16, v132
 v_and_b32 v161, 0xffff0000, v132
 v_lshlrev_b32 v162, 16, v133
 v_and_b32 v163, 0xffff0000, v133
 v_lshlrev_b32 v164, 16, v134
 v_and_b32 v165, 0xffff0000, v134
 v_lshlrev_b32 v166, 16, v135
 v_and_b32 v167, 0xffff0000, v135
 vaf v192, v192, v160
 vaf v193, v193, v161
 vaf v194, v194, v162
 vaf v195, v195, v163
 vaf v196, v196, v164
 vaf v197, v197, v165
 vaf v198, v198, v166
 vaf v199, v199, v167
 v_lshlrev_b32 v160, 16, v136
 v_and_b32 v161, 0xffff0000, v136
 v_lshlrev_b32 v162, 16, v137
 v_and_b32 v163, 0xffff0000, v137
 v_lshlrev_b32 v164, 16, v138
 v_and_b32 v165, 0xffff0000, v138
 v_lshlrev_b32 v166, 16, v139
 v_and_b32 v167, 0xffff0000, v139
 vaf v192, v192, v160
 vaf v193, v193, v161
 vaf v194, v194, v162
 vaf v195, v195, v163
 vaf v196, v196, v164
 vaf v197, v197, v165
 vaf v198, v198, v166
 vaf v199, v199, v167
 v_lshlrev_b32 v160, 16, v140
 v_and_b32 v161, 0xffff0000, v140
 v_lshlrev_b32 v162, 16, v141
 v_and_b32 v163, 0xffff0000, v141
 v_lshlrev_b32 v164, 16, v142
 v_and_b32 v165, 0xffff0000, v142
 v_lshlrev_b32 v166, 16, v143
 v_and_b32 v167, 0xffff0000, v143
 vaf v192, v192, v160
 vaf v193, v193, v161
 vaf v194, v194, v162
 vaf v195, v195, v163
 vaf v196, v196, v164
 vaf v197, v197, v165
 vaf v198, v198, v166
 vaf v199, v199, v167
 v_lshlrev_b32 v160, 16, v144
 v_and_b32 v161, 0xffff0000, v144
 v_lshlrev_b32 v162, 16, v145
 v_and_b32 v163, 0xffff0000, v145
 v_lshlrev_b32 v164, 16, v146
 v_and_b32 v165, 0xffff0000, v146
 v_lshlrev_b32 v166, 16, v147
 v_and_b32 v167, 0xffff0000, v147
 vaf v192, v192, v160
 vaf v193, v193, v161
 vaf v194, v194, v162
 vaf v195, v195, v163
 vaf v196, v196, v164
 vaf v197, v197, v165
 vaf v198, v198, v166
 vaf v199, v199, v167
 v_lshlrev_b32 v160, 16, v148
 v_and_b32 v161, 0xffff0000, v148
 v_lshlrev_b32 v162, 16, v149
 v_and_b32 v163, 0xffff0000, v149
 v_lshlrev_b32 v164, 16, v150
 v_and_b32 v165, 0xffff0000, v150
 v_lshlrev_b32 v166, 16, v151
 v_and_b32 v167, 0xffff0000, v151
 vaf v192, v192, v160
 vaf v193, v193, v161
 vaf v194, v194, v162
 vaf v195, v195, v163
 vaf v196, v196, v164
 vaf v197, v197, v165
 vaf v198, v198, v166
 vaf v199, v199, v167
 v_fmac_f32 v184, v192, v176
 v_fmac_f32 v185, v193, v177
 v_fmac_f32 v186, v194, v178
 v_fmac_f32 v187, v195, v179
 v_fmac_f32 v188, v196, v180
 v_fmac_f32 v189, v197, v181
 v_fmac_f32 v190, v198, v182
 v_fmac_f32 v191, v199, v183
 cvp v160, v184, v185
 cvp v161, v186, v187
 cvp v162, v188, v189
 cvp v163, v190, v191
 buffer_store_dwordx2 v[160:161], v253, s[44:47], s27 offen offset:0
 buffer_store_dwordx2 v[162:163], v253, s[44:47], s27 offen offset:32
K2_END:
 s_endpgm
K1_XSK_F:
 s_mov_b32 s20, 0
 s_branch K1_XSK_N
K1_XSK:
 s_mov_b32 s20, 0
K1_XSK_L:
 s_sleep 8
K1_XSK_N:
 buffer_load_dword v254, v253, s[80:83], 0 offen offset:128 sc1
 swc vmcnt(0)
 v_cmp_ne_u32 vcc, 16, v254
 sad s20, s20, 1
 s_cmp_ge_u32 s20, 0x8000
 s_cbranch_scc1 K1_XSK_B
 s_cbranch_vccnz K1_XSK_L
 s_branch K1_XSK_B
K1_XSV_F:
 s_mov_b32 s20, 0
 s_branch K1_XSV_N
K1_XSV:
 s_mov_b32 s20, 0
K1_XSV_L:
 s_sleep 8
K1_XSV_N:
 buffer_load_dword v254, v253, s[80:83], 0 offen offset:128 sc1
 swc vmcnt(0)
 v_cmp_ne_u32 vcc, 16, v254
 sad s20, s20, 1
 s_cmp_ge_u32 s20, 0x8000
 s_cbranch_scc1 K1_XSV_B
 s_cbranch_vccnz K1_XSV_L
 s_branch K1_XSV_B
K2_KLATE:
 s_cmp_eq_u32 s16, 0
 s_cbranch_scc1 K2_KSPIN_F
 s_mov_b32 s20, 0
K2_KL:
 ds_read_b32 v254, v6
 swc lgkmcnt(0)
 v_cmp_ne_u32 vcc, 1, v254
 sad s20, s20, 1
 s_cmp_ge_u32 s20, 0x100000
 s_cbranch_scc1 K2_KGO
 s_sleep 1
 s_cbranch_vccnz K2_KL
 s_branch K2_KGO
K2_KSPIN_F:
 s_mov_b32 s20, 0
 s_branch K2_KSPIN_N
K2_KSPIN:
 s_mov_b32 s20, 0
K2_KSPIN_L:
 s_sleep 8
K2_KSPIN_N:
 buffer_load_dword v254, v253, s[80:83], 0 offen offset:0 sc1
 swc vmcnt(0)
 v_cmp_ne_u32 vcc, 16, v254
 sad s20, s20, 1
 s_cmp_ge_u32 s20, 0x8000
 s_cbranch_scc1 K2_KSPIN_B
 s_cbranch_vccnz K2_KSPIN_L
 s_branch K2_KSPIN_B
K2_KSPIN_B:
 v_mov_b32 v1, 1
 ds_write_b32 v6, v1
K2_KGO:
 s_cmp_ge_u32 s16, 2
 s_cbranch_scc1 K2_KS_7
 sad m0, s22, 0
 s_nop 0
 bl4 v7, s[8:11], s21 offen offset:0 sc1 lds
 bl4 v7, s[8:11], s21 offen offset:1024 sc1 lds
 bl4 v7, s[8:11], s21 offen offset:2048 sc1 lds
 bl4 v7, s[8:11], s21 offen offset:3072 sc1 lds
K2_KS_7:
 sad s21, s21, 16384
 s_cmp_ge_u32 s16, 2
 s_cbranch_scc1 K2_KS_8
 sad m0, s22, 8192
 s_nop 0
 bl4 v7, s[8:11], s21 offen offset:0 sc1 lds
 bl4 v7, s[8:11], s21 offen offset:1024 sc1 lds
 bl4 v7, s[8:11], s21 offen offset:2048 sc1 lds
 bl4 v7, s[8:11], s21 offen offset:3072 sc1 lds
K2_KS_8:
 sad s21, s21, 16384
 sad m0, s22, 16384
 s_nop 0
 bl4 v7, s[8:11], s21 offen offset:0 sc1 lds
 bl4 v7, s[8:11], s21 offen offset:1024 sc1 lds
 bl4 v7, s[8:11], s21 offen offset:2048 sc1 lds
 bl4 v7, s[8:11], s21 offen offset:3072 sc1 lds
 sad s21, s21, 16384
 sad m0, s22, 24576
 s_nop 0
 bl4 v7, s[8:11], s21 offen offset:0 sc1 lds
 bl4 v7, s[8:11], s21 offen offset:1024 sc1 lds
 bl4 v7, s[8:11], s21 offen offset:2048 sc1 lds
 bl4 v7, s[8:11], s21 offen offset:3072 sc1 lds
 sad s21, s21, 16384
 s_xor_b32 s22, s22, 0x8000
 s_branch K2_KOK
K2_HOOK_13:
 s_cmp_eq_u32 s16, 0
 s_cbranch_scc1 K2_PD_9
 s_cmp_gt_u32 s16, 0
 s_cbranch_scc1 K2_PE_10
 v_mov_b32 v216, v255
 v_mov_b32 v217, v255
 v_mov_b32 v218, v255
 v_mov_b32 v219, v255
 s_branch K2_PE_10
K2_PD_9:
 v_cndmask_b32 v216, v255, v216, s[26:27]
 v_cndmask_b32 v217, v255, v217, s[28:29]
 v_cndmask_b32 v218, v255, v218, s[30:31]
 v_cndmask_b32 v219, v255, v219, s[32:33]
K2_PE_10:
 s_cmp_eq_u32 s16, 1
 s_cbranch_scc1 K2_PD_11
 s_cmp_gt_u32 s16, 1
 s_cbranch_scc1 K2_PE_12
 v_mov_b32 v220, v255
 v_mov_b32 v221, v255
 v_mov_b32 v222, v255
 v_mov_b32 v223, v255
 s_branch K2_PE_12
K2_PD_11:
 v_cndmask_b32 v220, v255, v220, s[26:27]
 v_cndmask_b32 v221, v255, v221, s[28:29]
 v_cndmask_b32 v222, v255, v222, s[30:31]
 v_cndmask_b32 v223, v255, v223, s[32:33]
K2_PE_12:
 s_nop 1
 s_branch K2_HB_14
K2_HOOK_19:
 s_cmp_eq_u32 s16, 2
 s_cbranch_scc1 K2_PD_15
 s_cmp_gt_u32 s16, 2
 s_cbranch_scc1 K2_PE_16
 v_mov_b32 v216, v255
 v_mov_b32 v217, v255
 v_mov_b32 v218, v255
 v_mov_b32 v219, v255
 s_branch K2_PE_16
K2_PD_15:
 v_cndmask_b32 v216, v255, v216, s[26:27]
 v_cndmask_b32 v217, v255, v217, s[28:29]
 v_cndmask_b32 v218, v255, v218, s[30:31]
 v_cndmask_b32 v219, v255, v219, s[32:33]
K2_PE_16:
 s_cmp_eq_u32 s16, 3
 s_cbranch_scc1 K2_PD_17
 s_cmp_gt_u32 s16, 3
 s_cbranch_scc1 K2_PE_18
 v_mov_b32 v220, v255
 v_mov_b32 v221, v255
 v_mov_b32 v222, v255
 v_mov_b32 v223, v255
 s_branch K2_PE_18
K2_PD_17:
 v_cndmask_b32 v220, v255, v220, s[26:27]
 v_cndmask_b32 v221, v255, v221, s[28:29]
 v_cndmask_b32 v222, v255, v222, s[30:31]
 v_cndmask_b32 v223, v255, v223, s[32:33]
K2_PE_18:
 s_nop 1
 s_branch K2_HB_20
K2_SLOW_21:
 s_nop 7
 v_max3_f32 v248, v144, v145, v146
 v_max3_f32 v248, v248, v147, v148
 v_max3_f32 v248, v248, v149, v150
 v_max_f32 v248, v248, v151
 v_mov_b32 v249, v248
 s_nop 1
 v_permlane16_swap_b32 v248, v249
 v_max_f32 v248, v248, v249
 v_mov_b32 v249, v248
 s_nop 1
 v_permlane32_swap_b32 v248, v249
 v_max_f32 v248, v248, v249
 v_ceil_f32 v248, v248
 v_max_f32 v248, 0, v248
 vex v250, -v248
 vsf v144, v144, v248
 vsf v145, v145, v248
 vsf v146, v146, v248
 vsf v147, v147, v248
 vsf v148, v148, v248
 vsf v149, v149, v248
 vsf v150, v150, v248
 vsf v151, v151, v248
 vsf v160, v160, v248
 vsf v161, v161, v248
 vsf v162, v162, v248
 vsf v163, v163, v248
 vsf v164, v164, v248
 vsf v165, v165, v248
 vsf v166, v166, v248
 vsf v167, v167, v248
 vsf v216, v216, v248
 vsf v217, v217, v248
 vsf v218, v218, v248
 vsf v219, v219, v248
 vsf v220, v220, v248
 vsf v221, v221, v248
 vsf v222, v222, v248
 vsf v223, v223, v248
 vmf v8, v8, v250
 vmf v9, v9, v250
 vmf v10, v10, v250
 vmf v11, v11, v250
 vmf v24, v24, v250
 vmf v25, v25, v250
 vmf v26, v26, v250
 vmf v27, v27, v250
 vmf v40, v40, v250
 vmf v41, v41, v250
 vmf v42, v42, v250
 vmf v43, v43, v250
 vmf v56, v56, v250
 vmf v57, v57, v250
 vmf v58, v58, v250
 vmf v59, v59, v250
 vmf v72, v72, v250
 vmf v73, v73, v250
 vmf v74, v74, v250
 vmf v75, v75, v250
 vmf v88, v88, v250
 vmf v89, v89, v250
 vmf v90, v90, v250
 vmf v91, v91, v250
 vmf v104, v104, v250
 vmf v105, v105, v250
 vmf v106, v106, v250
 vmf v107, v107, v250
 vmf v120, v120, v250
 vmf v121, v121, v250
 vmf v122, v122, v250
 vmf v123, v123, v250
 vmf v242, v242, v250
 vex v232, v144
 vex v233, v145
 s_nop 0
 vaf v238, v232, v233
 cvp v192, v232, v233
 vex v232, v146
 vex v233, v147
 s_nop 0
 vaf v238, v238, v232
 vaf v238, v238, v233
 cvp v193, v232, v233
 vex v232, v148
 vex v233, v149
 s_nop 0
 vaf v238, v238, v232
 vaf v238, v238, v233
 cvp v194, v232, v233
 vex v232, v150
 vex v233, v151
 s_nop 0
 vaf v238, v238, v232
 vaf v238, v238, v233
 cvp v195, v232, v233
 v_max3_f32 v248, v152, v153, v154
 v_max3_f32 v248, v248, v155, v156
 v_max3_f32 v248, v248, v157, v158
 v_max_f32 v248, v248, v159
 v_mov_b32 v249, v248
 s_nop 1
 v_permlane16_swap_b32 v248, v249
 v_max_f32 v248, v248, v249
 v_mov_b32 v249, v248
 s_nop 1
 v_permlane32_swap_b32 v248, v249
 v_max_f32 v248, v248, v249
 v_ceil_f32 v248, v248
 v_max_f32 v248, 0, v248
 vex v250, -v248
 vsf v152, v152, v248
 vsf v153, v153, v248
 vsf v154, v154, v248
 vsf v155, v155, v248
 vsf v156, v156, v248
 vsf v157, v157, v248
 vsf v158, v158, v248
 vsf v159, v159, v248
 vsf v168, v168, v248
 vsf v169, v169, v248
 vsf v170, v170, v248
 vsf v171, v171, v248
 vsf v172, v172, v248
 vsf v173, v173, v248
 vsf v174, v174, v248
 vsf v175, v175, v248
 vsf v224, v224, v248
 vsf v225, v225, v248
 vsf v226, v226, v248
 vsf v227, v227, v248
 vsf v228, v228, v248
 vsf v229, v229, v248
 vsf v230, v230, v248
 vsf v231, v231, v248
 vmf v12, v12, v250
 vmf v13, v13, v250
 vmf v14, v14, v250
 vmf v15, v15, v250
 vmf v28, v28, v250
 vmf v29, v29, v250
 vmf v30, v30, v250
 vmf v31, v31, v250
 vmf v44, v44, v250
 vmf v45, v45, v250
 vmf v46, v46, v250
 vmf v47, v47, v250
 vmf v60, v60, v250
 vmf v61, v61, v250
 vmf v62, v62, v250
 vmf v63, v63, v250
 vmf v76, v76, v250
 vmf v77, v77, v250
 vmf v78, v78, v250
 vmf v79, v79, v250
 vmf v92, v92, v250
 vmf v93, v93, v250
 vmf v94, v94, v250
 vmf v95, v95, v250
 vmf v108, v108, v250
 vmf v109, v109, v250
 vmf v110, v110, v250
 vmf v111, v111, v250
 vmf v124, v124, v250
 vmf v125, v125, v250
 vmf v126, v126, v250
 vmf v127, v127, v250
 vmf v243, v243, v250
 vex v232, v152
 vex v233, v153
 s_nop 0
 vaf v239, v232, v233
 cvp v196, v232, v233
 vex v232, v154
 vex v233, v155
 s_nop 0
 vaf v239, v239, v232
 vaf v239, v239, v233
 cvp v197, v232, v233
 vex v232, v156
 vex v233, v157
 s_nop 0
 vaf v239, v239, v232
 vaf v239, v239, v233
 cvp v198, v232, v233
 vex v232, v158
 vex v233, v159
 s_nop 0
 vaf v239, v239, v232
 vaf v239, v239, v233
 cvp v199, v232, v233
 vex v232, v128
 vex v233, v129
 s_nop 1
 s_branch K2_BACK_22
K2_SLOW_23:
 s_nop 7
 v_max3_f32 v248, v128, v129, v130
 v_max3_f32 v248, v248, v131, v132
 v_max3_f32 v248, v248, v133, v134
 v_max_f32 v248, v248, v135
 v_mov_b32 v249, v248
 s_nop 1
 v_permlane16_swap_b32 v248, v249
 v_max_f32 v248, v248, v249
 v_mov_b32 v249, v248
 s_nop 1
 v_permlane32_swap_b32 v248, v249
 v_max_f32 v248, v248, v249
 v_ceil_f32 v248, v248
 v_max_f32 v248, 0, v248
 vex v250, -v248
 vsf v128, v128, v248
 vsf v129, v129, v248
 vsf v130, v130, v248
 vsf v131, v131, v248
 vsf v132, v132, v248
 vsf v133, v133, v248
 vsf v134, v134, v248
 vsf v135, v135, v248
 vsf v200, v200, v248
 vsf v201, v201, v248
 vsf v202, v202, v248
 vsf v203, v203, v248
 vsf v204, v204, v248
 vsf v205, v205, v248
 vsf v206, v206, v248
 vsf v207, v207, v248
 vmf v0, v0, v250
 vmf v1, v1, v250
 vmf v2, v2, v250
 vmf v3, v3, v250
 vmf v16, v16, v250
 vmf v17, v17, v250
 vmf v18, v18, v250
 vmf v19, v19, v250
 vmf v32, v32, v250
 vmf v33, v33, v250
 vmf v34, v34, v250
 vmf v35, v35, v250
 vmf v48, v48, v250
 vmf v49, v49, v250
 vmf v50, v50, v250
 vmf v51, v51, v250
 vmf v64, v64, v250
 vmf v65, v65, v250
 vmf v66, v66, v250
 vmf v67, v67, v250
 vmf v80, v80, v250
 vmf v81, v81, v250
 vmf v82, v82, v250
 vmf v83, v83, v250
 vmf v96, v96, v250
 vmf v97, v97, v250
 vmf v98, v98, v250
 vmf v99, v99, v250
 vmf v112, v112, v250
 vmf v113, v113, v250
 vmf v114, v114, v250
 vmf v115, v115, v250
 vmf v240, v240, v250
 vex v232, v128
 vex v233, v129
 s_nop 0
 vaf v236, v232, v233
 cvp v184, v232, v233
 vex v232, v130
 vex v233, v131
 s_nop 0
 vaf v236, v236, v232
 vaf v236, v236, v233
 cvp v185, v232, v233
 vex v232, v132
 vex v233, v133
 s_nop 0
 vaf v236, v236, v232
 vaf v236, v236, v233
 cvp v186, v232, v233
 vex v232, v134
 vex v233, v135
 s_nop 0
 vaf v236, v236, v232
 vaf v236, v236, v233
 cvp v187, v232, v233
 v_max3_f32 v248, v136, v137, v138
 v_max3_f32 v248, v248, v139, v140
 v_max3_f32 v248, v248, v141, v142
 v_max_f32 v248, v248, v143
 v_mov_b32 v249, v248
 s_nop 1
 v_permlane16_swap_b32 v248, v249
 v_max_f32 v248, v248, v249
 v_mov_b32 v249, v248
 s_nop 1
 v_permlane32_swap_b32 v248, v249
 v_max_f32 v248, v248, v249
 v_ceil_f32 v248, v248
 v_max_f32 v248, 0, v248
 vex v250, -v248
 vsf v136, v136, v248
 vsf v137, v137, v248
 vsf v138, v138, v248
 vsf v139, v139, v248
 vsf v140, v140, v248
 vsf v141, v141, v248
 vsf v142, v142, v248
 vsf v143, v143, v248
 vsf v208, v208, v248
 vsf v209, v209, v248
 vsf v210, v210, v248
 vsf v211, v211, v248
 vsf v212, v212, v248
 vsf v213, v213, v248
 vsf v214, v214, v248
 vsf v215, v215, v248
 vmf v4, v4, v250
 vmf v5, v5, v250
 vmf v6, v6, v250
 vmf v7, v7, v250
 vmf v20, v20, v250
 vmf v21, v21, v250
 vmf v22, v22, v250
 vmf v23, v23, v250
 vmf v36, v36, v250
 vmf v37, v37, v250
 vmf v38, v38, v250
 vmf v39, v39, v250
 vmf v52, v52, v250
 vmf v53, v53, v250
 vmf v54, v54, v250
 vmf v55, v55, v250
 vmf v68, v68, v250
 vmf v69, v69, v250
 vmf v70, v70, v250
 vmf v71, v71, v250
 vmf v84, v84, v250
 vmf v85, v85, v250
 vmf v86, v86, v250
 vmf v87, v87, v250
 vmf v100, v100, v250
 vmf v101, v101, v250
 vmf v102, v102, v250
 vmf v103, v103, v250
 vmf v116, v116, v250
 vmf v117, v117, v250
 vmf v118, v118, v250
 vmf v119, v119, v250
 vmf v241, v241, v250
 vex v232, v136
 vex v233, v137
 s_nop 0
 vaf v237, v232, v233
 cvp v188, v232, v233
 vex v232, v138
 vex v233, v139
 s_nop 0
 vaf v237, v237, v232
 vaf v237, v237, v233
 cvp v189, v232, v233
 vex v232, v140
 vex v233, v141
 s_nop 0
 vaf v237, v237, v232
 vaf v237, v237, v233
 cvp v190, v232, v233
 vex v232, v142
 vex v233, v143
 s_nop 0
 vaf v237, v237, v232
 vaf v237, v237, v233
 cvp v191, v232, v233
 vex v232, v160
 vex v233, v161
 s_nop 1
 s_branch K2_BACK_24
K2_SLOW_25:
 s_nop 7
 v_max3_f32 v248, v144, v145, v146
 v_max3_f32 v248, v248, v147, v148
 v_max3_f32 v248, v248, v149, v150
 v_max_f32 v248, v248, v151
 v_mov_b32 v249, v248
 s_nop 1
 v_permlane16_swap_b32 v248, v249
 v_max_f32 v248, v248, v249
 v_mov_b32 v249, v248
 s_nop 1
 v_permlane32_swap_b32 v248, v249
 v_max_f32 v248, v248, v249
 v_ceil_f32 v248, v248
 v_max_f32 v248, 0, v248
 vex v250, -v248
 vsf v144, v144, v248
 vsf v145, v145, v248
 vsf v146, v146, v248
 vsf v147, v147, v248
 vsf v148, v148, v248
 vsf v149, v149, v248
 vsf v150, v150, v248
 vsf v151, v151, v248
 vsf v160, v160, v248
 vsf v161, v161, v248
 vsf v162, v162, v248
 vsf v163, v163, v248
 vsf v164, v164, v248
 vsf v165, v165, v248
 vsf v166, v166, v248
 vsf v167, v167, v248
 vsf v216, v216, v248
 vsf v217, v217, v248
 vsf v218, v218, v248
 vsf v219, v219, v248
 vsf v220, v220, v248
 vsf v221, v221, v248
 vsf v222, v222, v248
 vsf v223, v223, v248
 vmf v8, v8, v250
 vmf v9, v9, v250
 vmf v10, v10, v250
 vmf v11, v11, v250
 vmf v24, v24, v250
 vmf v25, v25, v250
 vmf v26, v26, v250
 vmf v27, v27, v250
 vmf v40, v40, v250
 vmf v41, v41, v250
 vmf v42, v42, v250
 vmf v43, v43, v250
 vmf v56, v56, v250
 vmf v57, v57, v250
 vmf v58, v58, v250
 vmf v59, v59, v250
 vmf v72, v72, v250
 vmf v73, v73, v250
 vmf v74, v74, v250
 vmf v75, v75, v250
 vmf v88, v88, v250
 vmf v89, v89, v250
 vmf v90, v90, v250
 vmf v91, v91, v250
 vmf v104, v104, v250
 vmf v105, v105, v250
 vmf v106, v106, v250
 vmf v107, v107, v250
 vmf v120, v120, v250
 vmf v121, v121, v250
 vmf v122, v122, v250
 vmf v123, v123, v250
 vmf v242, v242, v250
 vex v232, v144
 vex v233, v145
 s_nop 0
 vaf v238, v232, v233
 cvp v192, v232, v233
 vex v232, v146
 vex v233, v147
 s_nop 0
 vaf v238, v238, v232
 vaf v238, v238, v233
 cvp v193, v232, v233
 vex v232, v148
 vex v233, v149
 s_nop 0
 vaf v238, v238, v232
 vaf v238, v238, v233
 cvp v194, v232, v233
 vex v232, v150
 vex v233, v151
 s_nop 0
 vaf v238, v238, v232
 vaf v238, v238, v233
 cvp v195, v232, v233
 v_max3_f32 v248, v152, v153, v154
 v_max3_f32 v248, v248, v155, v156
 v_max3_f32 v248, v248, v157, v158
 v_max_f32 v248, v248, v159
 v_mov_b32 v249, v248
 s_nop 1
 v_permlane16_swap_b32 v248, v249
 v_max_f32 v248, v248, v249
 v_mov_b32 v249, v248
 s_nop 1
 v_permlane32_swap_b32 v248, v249
 v_max_f32 v248, v248, v249
 v_ceil_f32 v248, v248
 v_max_f32 v248, 0, v248
 vex v250, -v248
 vsf v152, v152, v248
 vsf v153, v153, v248
 vsf v154, v154, v248
 vsf v155, v155, v248
 vsf v156, v156, v248
 vsf v157, v157, v248
 vsf v158, v158, v248
 vsf v159, v159, v248
 vsf v168, v168, v248
 vsf v169, v169, v248
 vsf v170, v170, v248
 vsf v171, v171, v248
 vsf v172, v172, v248
 vsf v173, v173, v248
 vsf v174, v174, v248
 vsf v175, v175, v248
 vsf v224, v224, v248
 vsf v225, v225, v248
 vsf v226, v226, v248
 vsf v227, v227, v248
 vsf v228, v228, v248
 vsf v229, v229, v248
 vsf v230, v230, v248
 vsf v231, v231, v248
 vmf v12, v12, v250
 vmf v13, v13, v250
 vmf v14, v14, v250
 vmf v15, v15, v250
 vmf v28, v28, v250
 vmf v29, v29, v250
 vmf v30, v30, v250
 vmf v31, v31, v250
 vmf v44, v44, v250
 vmf v45, v45, v250
 vmf v46, v46, v250
 vmf v47, v47, v250
 vmf v60, v60, v250
 vmf v61, v61, v250
 vmf v62, v62, v250
 vmf v63, v63, v250
 vmf v76, v76, v250
 vmf v77, v77, v250
 vmf v78, v78, v250
 vmf v79, v79, v250
 vmf v92, v92, v250
 vmf v93, v93, v250
 vmf v94, v94, v250
 vmf v95, v95, v250
 vmf v108, v108, v250
 vmf v109, v109, v250
 vmf v110, v110, v250
 vmf v111, v111, v250
 vmf v124, v124, v250
 vmf v125, v125, v250
 vmf v126, v126, v250
 vmf v127, v127, v250
 vmf v243, v243, v250
 vex v232, v152
 vex v233, v153
 s_nop 0
 vaf v239, v232, v233
 cvp v196, v232, v233
 vex v232, v154
 vex v233, v155
 s_nop 0
 vaf v239, v239, v232
 vaf v239, v239, v233
 cvp v197, v232, v233
 vex v232, v156
 vex v233, v157
 s_nop 0
 vaf v239, v239, v232
 vaf v239, v239, v233
 cvp v198, v232, v233
 vex v232, v158
 vex v233, v159
 s_nop 0
 vaf v239, v239, v232
 vaf v239, v239, v233
 cvp v199, v232, v233
 vex v232, v128
 vex v233, v129
 s_nop 1
 s_branch K2_BACK_26
K2_SLOW_27:
 s_nop 7
 v_max3_f32 v248, v128, v129, v130
 v_max3_f32 v248, v248, v131, v132
 v_max3_f32 v248, v248, v133, v134
 v_max_f32 v248, v248, v135
 v_mov_b32 v249, v248
 s_nop 1
 v_permlane16_swap_b32 v248, v249
 v_max_f32 v248, v248, v249
 v_mov_b32 v249, v248
 s_nop 1
 v_permlane32_swap_b32 v248, v249
 v_max_f32 v248, v248, v249
 v_ceil_f32 v248, v248
 v_max_f32 v248, 0, v248
 vex v250, -v248
 vsf v128, v128, v248
 vsf v129, v129, v248
 vsf v130, v130, v248
 vsf v131, v131, v248
 vsf v132, v132, v248
 vsf v133, v133, v248
 vsf v134, v134, v248
 vsf v135, v135, v248
 vsf v200, v200, v248
 vsf v201, v201, v248
 vsf v202, v202, v248
 vsf v203, v203, v248
 vsf v204, v204, v248
 vsf v205, v205, v248
 vsf v206, v206, v248
 vsf v207, v207, v248
 vmf v0, v0, v250
 vmf v1, v1, v250
 vmf v2, v2, v250
 vmf v3, v3, v250
 vmf v16, v16, v250
 vmf v17, v17, v250
 vmf v18, v18, v250
 vmf v19, v19, v250
 vmf v32, v32, v250
 vmf v33, v33, v250
 vmf v34, v34, v250
 vmf v35, v35, v250
 vmf v48, v48, v250
 vmf v49, v49, v250
 vmf v50, v50, v250
 vmf v51, v51, v250
 vmf v64, v64, v250
 vmf v65, v65, v250
 vmf v66, v66, v250
 vmf v67, v67, v250
 vmf v80, v80, v250
 vmf v81, v81, v250
 vmf v82, v82, v250
 vmf v83, v83, v250
 vmf v96, v96, v250
 vmf v97, v97, v250
 vmf v98, v98, v250
 vmf v99, v99, v250
 vmf v112, v112, v250
 vmf v113, v113, v250
 vmf v114, v114, v250
 vmf v115, v115, v250
 vmf v240, v240, v250
 vex v232, v128
 vex v233, v129
 s_nop 0
 vaf v236, v232, v233
 cvp v184, v232, v233
 vex v232, v130
 vex v233, v131
 s_nop 0
 vaf v236, v236, v232
 vaf v236, v236, v233
 cvp v185, v232, v233
 vex v232, v132
 vex v233, v133
 s_nop 0
 vaf v236, v236, v232
 vaf v236, v236, v233
 cvp v186, v232, v233
 vex v232, v134
 vex v233, v135
 s_nop 0
 vaf v236, v236, v232
 vaf v236, v236, v233
 cvp v187, v232, v233
 v_max3_f32 v248, v136, v137, v138
 v_max3_f32 v248, v248, v139, v140
 v_max3_f32 v248, v248, v141, v142
 v_max_f32 v248, v248, v143
 v_mov_b32 v249, v248
 s_nop 1
 v_permlane16_swap_b32 v248, v249
 v_max_f32 v248, v248, v249
 v_mov_b32 v249, v248
 s_nop 1
 v_permlane32_swap_b32 v248, v249
 v_max_f32 v248, v248, v249
 v_ceil_f32 v248, v248
 v_max_f32 v248, 0, v248
 vex v250, -v248
 vsf v136, v136, v248
 vsf v137, v137, v248
 vsf v138, v138, v248
 vsf v139, v139, v248
 vsf v140, v140, v248
 vsf v141, v141, v248
 vsf v142, v142, v248
 vsf v143, v143, v248
 vsf v208, v208, v248
 vsf v209, v209, v248
 vsf v210, v210, v248
 vsf v211, v211, v248
 vsf v212, v212, v248
 vsf v213, v213, v248
 vsf v214, v214, v248
 vsf v215, v215, v248
 vmf v4, v4, v250
 vmf v5, v5, v250
 vmf v6, v6, v250
 vmf v7, v7, v250
 vmf v20, v20, v250
 vmf v21, v21, v250
 vmf v22, v22, v250
 vmf v23, v23, v250
 vmf v36, v36, v250
 vmf v37, v37, v250
 vmf v38, v38, v250
 vmf v39, v39, v250
 vmf v52, v52, v250
 vmf v53, v53, v250
 vmf v54, v54, v250
 vmf v55, v55, v250
 vmf v68, v68, v250
 vmf v69, v69, v250
 vmf v70, v70, v250
 vmf v71, v71, v250
 vmf v84, v84, v250
 vmf v85, v85, v250
 vmf v86, v86, v250
 vmf v87, v87, v250
 vmf v100, v100, v250
 vmf v101, v101, v250
 vmf v102, v102, v250
 vmf v103, v103, v250
 vmf v116, v116, v250
 vmf v117, v117, v250
 vmf v118, v118, v250
 vmf v119, v119, v250
 vmf v241, v241, v250
 vex v232, v136
 vex v233, v137
 s_nop 0
 vaf v237, v232, v233
 cvp v188, v232, v233
 vex v232, v138
 vex v233, v139
 s_nop 0
 vaf v237, v237, v232
 vaf v237, v237, v233
 cvp v189, v232, v233
 vex v232, v140
 vex v233, v141
 s_nop 0
 vaf v237, v237, v232
 vaf v237, v237, v233
 cvp v190, v232, v233
 vex v232, v142
 vex v233, v143
 s_nop 0
 vaf v237, v237, v232
 vaf v237, v237, v233
 cvp v191, v232, v233
 vex v232, v160
 vex v233, v161
 s_nop 1
 s_branch K2_BACK_28
K2_SLOW_29:
 s_nop 7
 v_max3_f32 v248, v160, v161, v162
 v_max3_f32 v248, v248, v163, v164
 v_max3_f32 v248, v248, v165, v166
 v_max_f32 v248, v248, v167
 v_mov_b32 v249, v248
 s_nop 1
 v_permlane16_swap_b32 v248, v249
 v_max_f32 v248, v248, v249
 v_mov_b32 v249, v248
 s_nop 1
 v_permlane32_swap_b32 v248, v249
 v_max_f32 v248, v248, v249
 v_ceil_f32 v248, v248
 v_max_f32 v248, 0, v248
 vex v250, -v248
 vsf v160, v160, v248
 vsf v161, v161, v248
 vsf v162, v162, v248
 vsf v163, v163, v248
 vsf v164, v164, v248
 vsf v165, v165, v248
 vsf v166, v166, v248
 vsf v167, v167, v248
 vsf v144, v144, v248
 vsf v145, v145, v248
 vsf v146, v146, v248
 vsf v147, v147, v248
 vsf v148, v148, v248
 vsf v149, v149, v248
 vsf v150, v150, v248
 vsf v151, v151, v248
 vsf v216, v216, v248
 vsf v217, v217, v248
 vsf v218, v218, v248
 vsf v219, v219, v248
 vsf v220, v220, v248
 vsf v221, v221, v248
 vsf v222, v222, v248
 vsf v223, v223, v248
 vmf v8, v8, v250
 vmf v9, v9, v250
 vmf v10, v10, v250
 vmf v11, v11, v250
 vmf v24, v24, v250
 vmf v25, v25, v250
 vmf v26, v26, v250
 vmf v27, v27, v250
 vmf v40, v40, v250
 vmf v41, v41, v250
 vmf v42, v42, v250
 vmf v43, v43, v250
 vmf v56, v56, v250
 vmf v57, v57, v250
 vmf v58, v58, v250
 vmf v59, v59, v250
 vmf v72, v72, v250
 vmf v73, v73, v250
 vmf v74, v74, v250
 vmf v75, v75, v250
 vmf v88, v88, v250
 vmf v89, v89, v250
 vmf v90, v90, v250
 vmf v91, v91, v250
 vmf v104, v104, v250
 vmf v105, v105, v250
 vmf v106, v106, v250
 vmf v107, v107, v250
 vmf v120, v120, v250
 vmf v121, v121, v250
 vmf v122, v122, v250
 vmf v123, v123, v250
 vmf v242, v242, v250
 vex v232, v160
 vex v233, v161
 s_nop 0
 vaf v238, v232, v233
 cvp v192, v232, v233
 vex v232, v162
 vex v233, v163
 s_nop 0
 vaf v238, v238, v232
 vaf v238, v238, v233
 cvp v193, v232, v233
 vex v232, v164
 vex v233, v165
 s_nop 0
 vaf v238, v238, v232
 vaf v238, v238, v233
 cvp v194, v232, v233
 vex v232, v166
 vex v233, v167
 s_nop 0
 vaf v238, v238, v232
 vaf v238, v238, v233
 cvp v195, v232, v233
 v_max3_f32 v248, v168, v169, v170
 v_max3_f32 v248, v248, v171, v172
 v_max3_f32 v248, v248, v173, v174
 v_max_f32 v248, v248, v175
 v_mov_b32 v249, v248
 s_nop 1
 v_permlane16_swap_b32 v248, v249
 v_max_f32 v248, v248, v249
 v_mov_b32 v249, v248
 s_nop 1
 v_permlane32_swap_b32 v248, v249
 v_max_f32 v248, v248, v249
 v_ceil_f32 v248, v248
 v_max_f32 v248, 0, v248
 vex v250, -v248
 vsf v168, v168, v248
 vsf v169, v169, v248
 vsf v170, v170, v248
 vsf v171, v171, v248
 vsf v172, v172, v248
 vsf v173, v173, v248
 vsf v174, v174, v248
 vsf v175, v175, v248
 vsf v152, v152, v248
 vsf v153, v153, v248
 vsf v154, v154, v248
 vsf v155, v155, v248
 vsf v156, v156, v248
 vsf v157, v157, v248
 vsf v158, v158, v248
 vsf v159, v159, v248
 vsf v224, v224, v248
 vsf v225, v225, v248
 vsf v226, v226, v248
 vsf v227, v227, v248
 vsf v228, v228, v248
 vsf v229, v229, v248
 vsf v230, v230, v248
 vsf v231, v231, v248
 vmf v12, v12, v250
 vmf v13, v13, v250
 vmf v14, v14, v250
 vmf v15, v15, v250
 vmf v28, v28, v250
 vmf v29, v29, v250
 vmf v30, v30, v250
 vmf v31, v31, v250
 vmf v44, v44, v250
 vmf v45, v45, v250
 vmf v46, v46, v250
 vmf v47, v47, v250
 vmf v60, v60, v250
 vmf v61, v61, v250
 vmf v62, v62, v250
 vmf v63, v63, v250
 vmf v76, v76, v250
 vmf v77, v77, v250
 vmf v78, v78, v250
 vmf v79, v79, v250
 vmf v92, v92, v250
 vmf v93, v93, v250
 vmf v94, v94, v250
 vmf v95, v95, v250
 vmf v108, v108, v250
 vmf v109, v109, v250
 vmf v110, v110, v250
 vmf v111, v111, v250
 vmf v124, v124, v250
 vmf v125, v125, v250
 vmf v126, v126, v250
 vmf v127, v127, v250
 vmf v243, v243, v250
 vex v232, v168
 vex v233, v169
 s_nop 0
 vaf v239, v232, v233
 cvp v196, v232, v233
 vex v232, v170
 vex v233, v171
 s_nop 0
 vaf v239, v239, v232
 vaf v239, v239, v233
 cvp v197, v232, v233
 vex v232, v172
 vex v233, v173
 s_nop 0
 vaf v239, v239, v232
 vaf v239, v239, v233
 cvp v198, v232, v233
 vex v232, v174
 vex v233, v175
 s_nop 0
 vaf v239, v239, v232
 vaf v239, v239, v233
 cvp v199, v232, v233
 vex v232, v128
 vex v233, v129
 s_nop 1
 s_branch K2_BACK_30
K2_SLOW_31:
 s_nop 7
 v_max3_f32 v248, v128, v129, v130
 v_max3_f32 v248, v248, v131, v132
 v_max3_f32 v248, v248, v133, v134
 v_max_f32 v248, v248, v135
 v_mov_b32 v249, v248
 s_nop 1
 v_permlane16_swap_b32 v248, v249
 v_max_f32 v248, v248, v249
 v_mov_b32 v249, v248
 s_nop 1
 v_permlane32_swap_b32 v248, v249
 v_max_f32 v248, v248, v249
 v_ceil_f32 v248, v248
 v_max_f32 v248, 0, v248
 vex v250, -v248
 vsf v128, v128, v248
 vsf v129, v129, v248
 vsf v130, v130, v248
 vsf v131, v131, v248
 vsf v132, v132, v248
 vsf v133, v133, v248
 vsf v134, v134, v248
 vsf v135, v135, v248
 vsf v200, v200, v248
 vsf v201, v201, v248
 vsf v202, v202, v248
 vsf v203, v203, v248
 vsf v204, v204, v248
 vsf v205, v205, v248
 vsf v206, v206, v248
 vsf v207, v207, v248
 vmf v0, v0, v250
 vmf v1, v1, v250
 vmf v2, v2, v250
 vmf v3, v3, v250
 vmf v16, v16, v250
 vmf v17, v17, v250
 vmf v18, v18, v250
 vmf v19, v19, v250
 vmf v32, v32, v250
 vmf v33, v33, v250
 vmf v34, v34, v250
 vmf v35, v35, v250
 vmf v48, v48, v250
 vmf v49, v49, v250
 vmf v50, v50, v250
 vmf v51, v51, v250
 vmf v64, v64, v250
 vmf v65, v65, v250
 vmf v66, v66, v250
 vmf v67, v67, v250
 vmf v80, v80, v250
 vmf v81, v81, v250
 vmf v82, v82, v250
 vmf v83, v83, v250
 vmf v96, v96, v250
 vmf v97, v97, v250
 vmf v98, v98, v250
 vmf v99, v99, v250
 vmf v112, v112, v250
 vmf v113, v113, v250
 vmf v114, v114, v250
 vmf v115, v115, v250
 vmf v240, v240, v250
 vex v232, v128
 vex v233, v129
 s_nop 0
 vaf v236, v232, v233
 cvp v176, v232, v233
 vex v232, v130
 vex v233, v131
 s_nop 0
 vaf v236, v236, v232
 vaf v236, v236, v233
 cvp v177, v232, v233
 vex v232, v132
 vex v233, v133
 s_nop 0
 vaf v236, v236, v232
 vaf v236, v236, v233
 cvp v178, v232, v233
 vex v232, v134
 vex v233, v135
 s_nop 0
 vaf v236, v236, v232
 vaf v236, v236, v233
 cvp v179, v232, v233
 v_max3_f32 v248, v136, v137, v138
 v_max3_f32 v248, v248, v139, v140
 v_max3_f32 v248, v248, v141, v142
 v_max_f32 v248, v248, v143
 v_mov_b32 v249, v248
 s_nop 1
 v_permlane16_swap_b32 v248, v249
 v_max_f32 v248, v248, v249
 v_mov_b32 v249, v248
 s_nop 1
 v_permlane32_swap_b32 v248, v249
 v_max_f32 v248, v248, v249
 v_ceil_f32 v248, v248
 v_max_f32 v248, 0, v248
 vex v250, -v248
 vsf v136, v136, v248
 vsf v137, v137, v248
 vsf v138, v138, v248
 vsf v139, v139, v248
 vsf v140, v140, v248
 vsf v141, v141, v248
 vsf v142, v142, v248
 vsf v143, v143, v248
 vsf v208, v208, v248
 vsf v209, v209, v248
 vsf v210, v210, v248
 vsf v211, v211, v248
 vsf v212, v212, v248
 vsf v213, v213, v248
 vsf v214, v214, v248
 vsf v215, v215, v248
 vmf v4, v4, v250
 vmf v5, v5, v250
 vmf v6, v6, v250
 vmf v7, v7, v250
 vmf v20, v20, v250
 vmf v21, v21, v250
 vmf v22, v22, v250
 vmf v23, v23, v250
 vmf v36, v36, v250
 vmf v37, v37, v250
 vmf v38, v38, v250
 vmf v39, v39, v250
 vmf v52, v52, v250
 vmf v53, v53, v250
 vmf v54, v54, v250
 vmf v55, v55, v250
 vmf v68, v68, v250
 vmf v69, v69, v250
 vmf v70, v70, v250
 vmf v71, v71, v250
 vmf v84, v84, v250
 vmf v85, v85, v250
 vmf v86, v86, v250
 vmf v87, v87, v250
 vmf v100, v100, v250
 vmf v101, v101, v250
 vmf v102, v102, v250
 vmf v103, v103, v250
 vmf v116, v116, v250
 vmf v117, v117, v250
 vmf v118, v118, v250
 vmf v119, v119, v250
 vmf v241, v241, v250
 vex v232, v136
 vex v233, v137
 s_nop 0
 vaf v237, v232, v233
 cvp v180, v232, v233
 vex v232, v138
 vex v233, v139
 s_nop 0
 vaf v237, v237, v232
 vaf v237, v237, v233
 cvp v181, v232, v233
 vex v232, v140
 vex v233, v141
 s_nop 0
 vaf v237, v237, v232
 vaf v237, v237, v233
 cvp v182, v232, v233
 vex v232, v142
 vex v233, v143
 s_nop 0
 vaf v237, v237, v232
 vaf v237, v237, v233
 cvp v183, v232, v233
 vex v232, v144
 vex v233, v145
 s_nop 1
 s_branch K2_BACK_32
K2_SLOW_33:
 s_nop 7
 v_max3_f32 v248, v144, v145, v146
 v_max3_f32 v248, v248, v147, v148
 v_max3_f32 v248, v248, v149, v150
 v_max_f32 v248, v248, v151
 v_mov_b32 v249, v248
 s_nop 1
 v_permlane16_swap_b32 v248, v249
 v_max_f32 v248, v248, v249
 v_mov_b32 v249, v248
 s_nop 1
 v_permlane32_swap_b32 v248, v249
 v_max_f32 v248, v248, v249
 v_ceil_f32 v248, v248
 v_max_f32 v248, 0, v248
 vex v250, -v248
 vsf v144, v144, v248
 vsf v145, v145, v248
 vsf v146, v146, v248
 vsf v147, v147, v248
 vsf v148, v148, v248
 vsf v149, v149, v248
 vsf v150, v150, v248
 vsf v151, v151, v248
 vsf v160, v160, v248
 vsf v161, v161, v248
 vsf v162, v162, v248
 vsf v163, v163, v248
 vsf v164, v164, v248
 vsf v165, v165, v248
 vsf v166, v166, v248
 vsf v167, v167, v248
 vsf v216, v216, v248
 vsf v217, v217, v248
 vsf v218, v218, v248
 vsf v219, v219, v248
 vsf v220, v220, v248
 vsf v221, v221, v248
 vsf v222, v222, v248
 vsf v223, v223, v248
 vmf v8, v8, v250
 vmf v9, v9, v250
 vmf v10, v10, v250
 vmf v11, v11, v250
 vmf v24, v24, v250
 vmf v25, v25, v250
 vmf v26, v26, v250
 vmf v27, v27, v250
 vmf v40, v40, v250
 vmf v41, v41, v250
 vmf v42, v42, v250
 vmf v43, v43, v250
 vmf v56, v56, v250
 vmf v57, v57, v250
 vmf v58, v58, v250
 vmf v59, v59, v250
 vmf v72, v72, v250
 vmf v73, v73, v250
 vmf v74, v74, v250
 vmf v75, v75, v250
 vmf v88, v88, v250
 vmf v89, v89, v250
 vmf v90, v90, v250
 vmf v91, v91, v250
 vmf v104, v104, v250
 vmf v105, v105, v250
 vmf v106, v106, v250
 vmf v107, v107, v250
 vmf v120, v120, v250
 vmf v121, v121, v250
 vmf v122, v122, v250
 vmf v123, v123, v250
 vmf v242, v242, v250
 vex v232, v144
 vex v233, v145
 s_nop 0
 vaf v238, v232, v233
 cvp v192, v232, v233
 vex v232, v146
 vex v233, v147
 s_nop 0
 vaf v238, v238, v232
 vaf v238, v238, v233
 cvp v193, v232, v233
 vex v232, v148
 vex v233, v149
 s_nop 0
 vaf v238, v238, v232
 vaf v238, v238, v233
 cvp v194, v232, v233
 vex v232, v150
 vex v233, v151
 s_nop 0
 vaf v238, v238, v232
 vaf v238, v238, v233
 cvp v195, v232, v233
 v_max3_f32 v248, v152, v153, v154
 v_max3_f32 v248, v248, v155, v156
 v_max3_f32 v248, v248, v157, v158
 v_max_f32 v248, v248, v159
 v_mov_b32 v249, v248
 s_nop 1
 v_permlane16_swap_b32 v248, v249
 v_max_f32 v248, v248, v249
 v_mov_b32 v249, v248
 s_nop 1
 v_permlane32_swap_b32 v248, v249
 v_max_f32 v248, v248, v249
 v_ceil_f32 v248, v248
 v_max_f32 v248, 0, v248
 vex v250, -v248
 vsf v152, v152, v248
 vsf v153, v153, v248
 vsf v154, v154, v248
 vsf v155, v155, v248
 vsf v156, v156, v248
 vsf v157, v157, v248
 vsf v158, v158, v248
 vsf v159, v159, v248
 vsf v168, v168, v248
 vsf v169, v169, v248
 vsf v170, v170, v248
 vsf v171, v171, v248
 vsf v172, v172, v248
 vsf v173, v173, v248
 vsf v174, v174, v248
 vsf v175, v175, v248
 vsf v224, v224, v248
 vsf v225, v225, v248
 vsf v226, v226, v248
 vsf v227, v227, v248
 vsf v228, v228, v248
 vsf v229, v229, v248
 vsf v230, v230, v248
 vsf v231, v231, v248
 vmf v12, v12, v250
 vmf v13, v13, v250
 vmf v14, v14, v250
 vmf v15, v15, v250
 vmf v28, v28, v250
 vmf v29, v29, v250
 vmf v30, v30, v250
 vmf v31, v31, v250
 vmf v44, v44, v250
 vmf v45, v45, v250
 vmf v46, v46, v250
 vmf v47, v47, v250
 vmf v60, v60, v250
 vmf v61, v61, v250
 vmf v62, v62, v250
 vmf v63, v63, v250
 vmf v76, v76, v250
 vmf v77, v77, v250
 vmf v78, v78, v250
 vmf v79, v79, v250
 vmf v92, v92, v250
 vmf v93, v93, v250
 vmf v94, v94, v250
 vmf v95, v95, v250
 vmf v108, v108, v250
 vmf v109, v109, v250
 vmf v110, v110, v250
 vmf v111, v111, v250
 vmf v124, v124, v250
 vmf v125, v125, v250
 vmf v126, v126, v250
 vmf v127, v127, v250
 vmf v243, v243, v250
 vex v232, v152
 vex v233, v153
 s_nop 0
 vaf v239, v232, v233
 cvp v196, v232, v233
 vex v232, v154
 vex v233, v155
 s_nop 0
 vaf v239, v239, v232
 vaf v239, v239, v233
 cvp v197, v232, v233
 vex v232, v156
 vex v233, v157
 s_nop 0
 vaf v239, v239, v232
 vaf v239, v239, v233
 cvp v198, v232, v233
 vex v232, v158
 vex v233, v159
 s_nop 0
 vaf v239, v239, v232
 vaf v239, v239, v233
 cvp v199, v232, v233
 vex v232, v128
 vex v233, v129
 s_nop 1
 s_branch K2_BACK_34
K2_SLOW_35:
 s_nop 7
 v_max3_f32 v248, v128, v129, v130
 v_max3_f32 v248, v248, v131, v132
 v_max3_f32 v248, v248, v133, v134
 v_max_f32 v248, v248, v135
 v_mov_b32 v249, v248
 s_nop 1
 v_permlane16_swap_b32 v248, v249
 v_max_f32 v248, v248, v249
 v_mov_b32 v249, v248
 s_nop 1
 v_permlane32_swap_b32 v248, v249
 v_max_f32 v248, v248, v249
 v_ceil_f32 v248, v248
 v_max_f32 v248, 0, v248
 vex v250, -v248
 vsf v128, v128, v248
 vsf v129, v129, v248
 vsf v130, v130, v248
 vsf v131, v131, v248
 vsf v132, v132, v248
 vsf v133, v133, v248
 vsf v134, v134, v248
 vsf v135, v135, v248
 vsf v200, v200, v248
 vsf v201, v201, v248
 vsf v202, v202, v248
 vsf v203, v203, v248
 vsf v204, v204, v248
 vsf v205, v205, v248
 vsf v206, v206, v248
 vsf v207, v207, v248
 vmf v0, v0, v250
 vmf v1, v1, v250
 vmf v2, v2, v250
 vmf v3, v3, v250
 vmf v16, v16, v250
 vmf v17, v17, v250
 vmf v18, v18, v250
 vmf v19, v19, v250
 vmf v32, v32, v250
 vmf v33, v33, v250
 vmf v34, v34, v250
 vmf v35, v35, v250
 vmf v48, v48, v250
 vmf v49, v49, v250
 vmf v50, v50, v250
 vmf v51, v51, v250
 vmf v64, v64, v250
 vmf v65, v65, v250
 vmf v66, v66, v250
 vmf v67, v67, v250
 vmf v80, v80, v250
 vmf v81, v81, v250
 vmf v82, v82, v250
 vmf v83, v83, v250
 vmf v96, v96, v250
 vmf v97, v97, v250
 vmf v98, v98, v250
 vmf v99, v99, v250
 vmf v112, v112, v250
 vmf v113, v113, v250
 vmf v114, v114, v250
 vmf v115, v115, v250
 vmf v240, v240, v250
 vex v232, v128
 vex v233, v129
 s_nop 0
 vaf v236, v232, v233
 cvp v184, v232, v233
 vex v232, v130
 vex v233, v131
 s_nop 0
 vaf v236, v236, v232
 vaf v236, v236, v233
 cvp v185, v232, v233
 vex v232, v132
 vex v233, v133
 s_nop 0
 vaf v236, v236, v232
 vaf v236, v236, v233
 cvp v186, v232, v233
 vex v232, v134
 vex v233, v135
 s_nop 0
 vaf v236, v236, v232
 vaf v236, v236, v233
 cvp v187, v232, v233
 v_max3_f32 v248, v136, v137, v138
 v_max3_f32 v248, v248, v139, v140
 v_max3_f32 v248, v248, v141, v142
 v_max_f32 v248, v248, v143
 v_mov_b32 v249, v248
 s_nop 1
 v_permlane16_swap_b32 v248, v249
 v_max_f32 v248, v248, v249
 v_mov_b32 v249, v248
 s_nop 1
 v_permlane32_swap_b32 v248, v249
 v_max_f32 v248, v248, v249
 v_ceil_f32 v248, v248
 v_max_f32 v248, 0, v248
 vex v250, -v248
 vsf v136, v136, v248
 vsf v137, v137, v248
 vsf v138, v138, v248
 vsf v139, v139, v248
 vsf v140, v140, v248
 vsf v141, v141, v248
 vsf v142, v142, v248
 vsf v143, v143, v248
 vsf v208, v208, v248
 vsf v209, v209, v248
 vsf v210, v210, v248
 vsf v211, v211, v248
 vsf v212, v212, v248
 vsf v213, v213, v248
 vsf v214, v214, v248
 vsf v215, v215, v248
 vmf v4, v4, v250
 vmf v5, v5, v250
 vmf v6, v6, v250
 vmf v7, v7, v250
 vmf v20, v20, v250
 vmf v21, v21, v250
 vmf v22, v22, v250
 vmf v23, v23, v250
 vmf v36, v36, v250
 vmf v37, v37, v250
 vmf v38, v38, v250
 vmf v39, v39, v250
 vmf v52, v52, v250
 vmf v53, v53, v250
 vmf v54, v54, v250
 vmf v55, v55, v250
 vmf v68, v68, v250
 vmf v69, v69, v250
 vmf v70, v70, v250
 vmf v71, v71, v250
 vmf v84, v84, v250
 vmf v85, v85, v250
 vmf v86, v86, v250
 vmf v87, v87, v250
 vmf v100, v100, v250
 vmf v101, v101, v250
 vmf v102, v102, v250
 vmf v103, v103, v250
 vmf v116, v116, v250
 vmf v117, v117, v250
 vmf v118, v118, v250
 vmf v119, v119, v250
 vmf v241, v241, v250
 vex v232, v136
 vex v233, v137
 s_nop 0
 vaf v237, v232, v233
 cvp v188, v232, v233
 vex v232, v138
 vex v233, v139
 s_nop 0
 vaf v237, v237, v232
 vaf v237, v237, v233
 cvp v189, v232, v233
 vex v232, v140
 vex v233, v141
 s_nop 0
 vaf v237, v237, v232
 vaf v237, v237, v233
 cvp v190, v232, v233
 vex v232, v142
 vex v233, v143
 s_nop 0
 vaf v237, v237, v232
 vaf v237, v237, v233
 cvp v191, v232, v233
 vex v232, v160
 vex v233, v161
 s_nop 1
 s_branch K2_BACK_36
K2_HOOK_41:
 s_cmp_eq_u32 s16, 0
 s_cbranch_scc1 K2_PD_37
 s_cmp_gt_u32 s16, 0
 s_cbranch_scc1 K2_PE_38
 v_mov_b32 v216, v255
 v_mov_b32 v217, v255
 v_mov_b32 v218, v255
 v_mov_b32 v219, v255
 s_branch K2_PE_38
K2_PD_37:
 v_cndmask_b32 v216, v255, v216, s[26:27]
 v_cndmask_b32 v217, v255, v217, s[28:29]
 v_cndmask_b32 v218, v255, v218, s[30:31]
 v_cndmask_b32 v219, v255, v219, s[32:33]
K2_PE_38:
 s_cmp_eq_u32 s16, 1
 s_cbranch_scc1 K2_PD_39
 s_cmp_gt_u32 s16, 1
 s_cbranch_scc1 K2_PE_40
 v_mov_b32 v220, v255
 v_mov_b32 v221, v255
 v_mov_b32 v222, v255
 v_mov_b32 v223, v255
 s_branch K2_PE_40
K2_PD_39:
 v_cndmask_b32 v220, v255, v220, s[26:27]
 v_cndmask_b32 v221, v255, v221, s[28:29]
 v_cndmask_b32 v222, v255, v222, s[30:31]
 v_cndmask_b32 v223, v255, v223, s[32:33]
K2_PE_40:
 s_nop 1
 s_branch K2_HB_42
K2_SLOW_43:
 s_nop 7
 v_max3_f32 v248, v160, v161, v162
 v_max3_f32 v248, v248, v163, v164
 v_max3_f32 v248, v248, v165, v166
 v_max_f32 v248, v248, v167
 v_mov_b32 v249, v248
 s_nop 1
 v_permlane16_swap_b32 v248, v249
 v_max_f32 v248, v248, v249
 v_mov_b32 v249, v248
 s_nop 1
 v_permlane32_swap_b32 v248, v249
 v_max_f32 v248, v248, v249
 v_ceil_f32 v248, v248
 v_max_f32 v248, 0, v248
 vex v250, -v248
 vsf v160, v160, v248
 vsf v161, v161, v248
 vsf v162, v162, v248
 vsf v163, v163, v248
 vsf v164, v164, v248
 vsf v165, v165, v248
 vsf v166, v166, v248
 vsf v167, v167, v248
 vsf v144, v144, v248
 vsf v145, v145, v248
 vsf v146, v146, v248
 vsf v147, v147, v248
 vsf v148, v148, v248
 vsf v149, v149, v248
 vsf v150, v150, v248
 vsf v151, v151, v248
 vsf v216, v216, v248
 vsf v217, v217, v248
 vsf v218, v218, v248
 vsf v219, v219, v248
 vsf v220, v220, v248
 vsf v221, v221, v248
 vsf v222, v222, v248
 vsf v223, v223, v248
 vmf v8, v8, v250
 vmf v9, v9, v250
 vmf v10, v10, v250
 vmf v11, v11, v250
 vmf v24, v24, v250
 vmf v25, v25, v250
 vmf v26, v26, v250
 vmf v27, v27, v250
 vmf v40, v40, v250
 vmf v41, v41, v250
 vmf v42, v42, v250
 vmf v43, v43, v250
 vmf v56, v56, v250
 vmf v57, v57, v250
 vmf v58, v58, v250
 vmf v59, v59, v250
 vmf v72, v72, v250
 vmf v73, v73, v250
 vmf v74, v74, v250
 vmf v75, v75, v250
 vmf v88, v88, v250
 vmf v89, v89, v250
 vmf v90, v90, v250
 vmf v91, v91, v250
 vmf v104, v104, v250
 vmf v105, v105, v250
 vmf v106, v106, v250
 vmf v107, v107, v250
 vmf v120, v120, v250
 vmf v121, v121, v250
 vmf v122, v122, v250
 vmf v123, v123, v250
 vmf v242, v242, v250
 vex v232, v160
 vex v233, v161
 s_nop 0
 vaf v238, v232, v233
 cvp v192, v232, v233
 vex v232, v162
 vex v233, v163
 s_nop 0
 vaf v238, v238, v232
 vaf v238, v238, v233
 cvp v193, v232, v233
 vex v232, v164
 vex v233, v165
 s_nop 0
 vaf v238, v238, v232
 vaf v238, v238, v233
 cvp v194, v232, v233
 vex v232, v166
 vex v233, v167
 s_nop 0
 vaf v238, v238, v232
 vaf v238, v238, v233
 cvp v195, v232, v233
 v_max3_f32 v248, v168, v169, v170
 v_max3_f32 v248, v248, v171, v172
 v_max3_f32 v248, v248, v173, v174
 v_max_f32 v248, v248, v175
 v_mov_b32 v249, v248
 s_nop 1
 v_permlane16_swap_b32 v248, v249
 v_max_f32 v248, v248, v249
 v_mov_b32 v249, v248
 s_nop 1
 v_permlane32_swap_b32 v248, v249
 v_max_f32 v248, v248, v249
 v_ceil_f32 v248, v248
 v_max_f32 v248, 0, v248
 vex v250, -v248
 vsf v168, v168, v248
 vsf v169, v169, v248
 vsf v170, v170, v248
 vsf v171, v171, v248
 vsf v172, v172, v248
 vsf v173, v173, v248
 vsf v174, v174, v248
 vsf v175, v175, v248
 vsf v152, v152, v248
 vsf v153, v153, v248
 vsf v154, v154, v248
 vsf v155, v155, v248
 vsf v156, v156, v248
 vsf v157, v157, v248
 vsf v158, v158, v248
 vsf v159, v159, v248
 vsf v224, v224, v248
 vsf v225, v225, v248
 vsf v226, v226, v248
 vsf v227, v227, v248
 vsf v228, v228, v248
 vsf v229, v229, v248
 vsf v230, v230, v248
 vsf v231, v231, v248
 vmf v12, v12, v250
 vmf v13, v13, v250
 vmf v14, v14, v250
 vmf v15, v15, v250
 vmf v28, v28, v250
 vmf v29, v29, v250
 vmf v30, v30, v250
 vmf v31, v31, v250
 vmf v44, v44, v250
 vmf v45, v45, v250
 vmf v46, v46, v250
 vmf v47, v47, v250
 vmf v60, v60, v250
 vmf v61, v61, v250
 vmf v62, v62, v250
 vmf v63, v63, v250
 vmf v76, v76, v250
 vmf v77, v77, v250
 vmf v78, v78, v250
 vmf v79, v79, v250
 vmf v92, v92, v250
 vmf v93, v93, v250
 vmf v94, v94, v250
 vmf v95, v95, v250
 vmf v108, v108, v250
 vmf v109, v109, v250
 vmf v110, v110, v250
 vmf v111, v111, v250
 vmf v124, v124, v250
 vmf v125, v125, v250
 vmf v126, v126, v250
 vmf v127, v127, v250
 vmf v243, v243, v250
 vex v232, v168
 vex v233, v169
 s_nop 0
 vaf v239, v232, v233
 cvp v196, v232, v233
 vex v232, v170
 vex v233, v171
 s_nop 0
 vaf v239, v239, v232
 vaf v239, v239, v233
 cvp v197, v232, v233
 vex v232, v172
 vex v233, v173
 s_nop 0
 vaf v239, v239, v232
 vaf v239, v239, v233
 cvp v198, v232, v233
 vex v232, v174
 vex v233, v175
 s_nop 0
 vaf v239, v239, v232
 vaf v239, v239, v233
 cvp v199, v232, v233
 vex v232, v128
 vex v233, v129
 s_nop 1
 s_branch K2_BACK_44
K2_SLOW_45:
 s_nop 7
 v_max3_f32 v248, v128, v129, v130
 v_max3_f32 v248, v248, v131, v132
 v_max3_f32 v248, v248, v133, v134
 v_max_f32 v248, v248, v135
 v_mov_b32 v249, v248
 s_nop 1
 v_permlane16_swap_b32 v248, v249
 v_max_f32 v248, v248, v249
 v_mov_b32 v249, v248
 s_nop 1
 v_permlane32_swap_b32 v248, v249
 v_max_f32 v248, v248, v249
 v_ceil_f32 v248, v248
 v_max_f32 v248, 0, v248
 vex v250, -v248
 vsf v128, v128, v248
 vsf v129, v129, v248
 vsf v130, v130, v248
 vsf v131, v131, v248
 vsf v132, v132, v248
 vsf v133, v133, v248
 vsf v134, v134, v248
 vsf v135, v135, v248
 vsf v200, v200, v248
 vsf v201, v201, v248
 vsf v202, v202, v248
 vsf v203, v203, v248
 vsf v204, v204, v248
 vsf v205, v205, v248
 vsf v206, v206, v248
 vsf v207, v207, v248
 vmf v0, v0, v250
 vmf v1, v1, v250
 vmf v2, v2, v250
 vmf v3, v3, v250
 vmf v16, v16, v250
 vmf v17, v17, v250
 vmf v18, v18, v250
 vmf v19, v19, v250
 vmf v32, v32, v250
 vmf v33, v33, v250
 vmf v34, v34, v250
 vmf v35, v35, v250
 vmf v48, v48, v250
 vmf v49, v49, v250
 vmf v50, v50, v250
 vmf v51, v51, v250
 vmf v64, v64, v250
 vmf v65, v65, v250
 vmf v66, v66, v250
 vmf v67, v67, v250
 vmf v80, v80, v250
 vmf v81, v81, v250
 vmf v82, v82, v250
 vmf v83, v83, v250
 vmf v96, v96, v250
 vmf v97, v97, v250
 vmf v98, v98, v250
 vmf v99, v99, v250
 vmf v112, v112, v250
 vmf v113, v113, v250
 vmf v114, v114, v250
 vmf v115, v115, v250
 vmf v240, v240, v250
 vex v232, v128
 vex v233, v129
 s_nop 0
 vaf v236, v232, v233
 cvp v176, v232, v233
 vex v232, v130
 vex v233, v131
 s_nop 0
 vaf v236, v236, v232
 vaf v236, v236, v233
 cvp v177, v232, v233
 vex v232, v132
 vex v233, v133
 s_nop 0
 vaf v236, v236, v232
 vaf v236, v236, v233
 cvp v178, v232, v233
 vex v232, v134
 vex v233, v135
 s_nop 0
 vaf v236, v236, v232
 vaf v236, v236, v233
 cvp v179, v232, v233
 v_max3_f32 v248, v136, v137, v138
 v_max3_f32 v248, v248, v139, v140
 v_max3_f32 v248, v248, v141, v142
 v_max_f32 v248, v248, v143
 v_mov_b32 v249, v248
 s_nop 1
 v_permlane16_swap_b32 v248, v249
 v_max_f32 v248, v248, v249
 v_mov_b32 v249, v248
 s_nop 1
 v_permlane32_swap_b32 v248, v249
 v_max_f32 v248, v248, v249
 v_ceil_f32 v248, v248
 v_max_f32 v248, 0, v248
 vex v250, -v248
 vsf v136, v136, v248
 vsf v137, v137, v248
 vsf v138, v138, v248
 vsf v139, v139, v248
 vsf v140, v140, v248
 vsf v141, v141, v248
 vsf v142, v142, v248
 vsf v143, v143, v248
 vsf v208, v208, v248
 vsf v209, v209, v248
 vsf v210, v210, v248
 vsf v211, v211, v248
 vsf v212, v212, v248
 vsf v213, v213, v248
 vsf v214, v214, v248
 vsf v215, v215, v248
 vmf v4, v4, v250
 vmf v5, v5, v250
 vmf v6, v6, v250
 vmf v7, v7, v250
 vmf v20, v20, v250
 vmf v21, v21, v250
 vmf v22, v22, v250
 vmf v23, v23, v250
 vmf v36, v36, v250
 vmf v37, v37, v250
 vmf v38, v38, v250
 vmf v39, v39, v250
 vmf v52, v52, v250
 vmf v53, v53, v250
 vmf v54, v54, v250
 vmf v55, v55, v250
 vmf v68, v68, v250
 vmf v69, v69, v250
 vmf v70, v70, v250
 vmf v71, v71, v250
 vmf v84, v84, v250
 vmf v85, v85, v250
 vmf v86, v86, v250
 vmf v87, v87, v250
 vmf v100, v100, v250
 vmf v101, v101, v250
 vmf v102, v102, v250
 vmf v103, v103, v250
 vmf v116, v116, v250
 vmf v117, v117, v250
 vmf v118, v118, v250
 vmf v119, v119, v250
 vmf v241, v241, v250
 vex v232, v136
 vex v233, v137
 s_nop 0
 vaf v237, v232, v233
 cvp v180, v232, v233
 vex v232, v138
 vex v233, v139
 s_nop 0
 vaf v237, v237, v232
 vaf v237, v237, v233
 cvp v181, v232, v233
 vex v232, v140
 vex v233, v141
 s_nop 0
 vaf v237, v237, v232
 vaf v237, v237, v233
 cvp v182, v232, v233
 vex v232, v142
 vex v233, v143
 s_nop 0
 vaf v237, v237, v232
 vaf v237, v237, v233
 cvp v183, v232, v233
 vex v232, v144
 vex v233, v145
 s_nop 1
 s_branch K2_BACK_46
K2_SLOW_51:
 s_nop 7
 v_max3_f32 v248, v144, v145, v146
 v_max3_f32 v248, v248, v147, v148
 v_max3_f32 v248, v248, v149, v150
 v_max_f32 v248, v248, v151
 v_mov_b32 v249, v248
 s_nop 1
 v_permlane16_swap_b32 v248, v249
 v_max_f32 v248, v248, v249
 v_mov_b32 v249, v248
 s_nop 1
 v_permlane32_swap_b32 v248, v249
 v_max_f32 v248, v248, v249
 v_ceil_f32 v248, v248
 v_max_f32 v248, 0, v248
 vex v250, -v248
 vsf v144, v144, v248
 vsf v145, v145, v248
 vsf v146, v146, v248
 vsf v147, v147, v248
 vsf v148, v148, v248
 vsf v149, v149, v248
 vsf v150, v150, v248
 vsf v151, v151, v248
 vsf v160, v160, v248
 vsf v161, v161, v248
 vsf v162, v162, v248
 vsf v163, v163, v248
 vsf v164, v164, v248
 vsf v165, v165, v248
 vsf v166, v166, v248
 vsf v167, v167, v248
 vsf v216, v216, v248
 vsf v217, v217, v248
 vsf v218, v218, v248
 vsf v219, v219, v248
 vsf v220, v220, v248
 vsf v221, v221, v248
 vsf v222, v222, v248
 vsf v223, v223, v248
 vmf v8, v8, v250
 vmf v9, v9, v250
 vmf v10, v10, v250
 vmf v11, v11, v250
 vmf v24, v24, v250
 vmf v25, v25, v250
 vmf v26, v26, v250
 vmf v27, v27, v250
 vmf v40, v40, v250
 vmf v41, v41, v250
 vmf v42, v42, v250
 vmf v43, v43, v250
 vmf v56, v56, v250
 vmf v57, v57, v250
 vmf v58, v58, v250
 vmf v59, v59, v250
 vmf v72, v72, v250
 vmf v73, v73, v250
 vmf v74, v74, v250
 vmf v75, v75, v250
 vmf v88, v88, v250
 vmf v89, v89, v250
 vmf v90, v90, v250
 vmf v91, v91, v250
 vmf v104, v104, v250
 vmf v105, v105, v250
 vmf v106, v106, v250
 vmf v107, v107, v250
 vmf v120, v120, v250
 vmf v121, v121, v250
 vmf v122, v122, v250
 vmf v123, v123, v250
 vmf v242, v242, v250
 vex v232, v144
 vex v233, v145
 s_nop 0
 vaf v238, v232, v233
 cvp v192, v232, v233
 vex v232, v146
 vex v233, v147
 s_nop 0
 vaf v238, v238, v232
 vaf v238, v238, v233
 cvp v193, v232, v233
 vex v232, v148
 vex v233, v149
 s_nop 0
 vaf v238, v238, v232
 vaf v238, v238, v233
 cvp v194, v232, v233
 vex v232, v150
 vex v233, v151
 s_nop 0
 vaf v238, v238, v232
 vaf v238, v238, v233
 cvp v195, v232, v233
 v_max3_f32 v248, v152, v153, v154
 v_max3_f32 v248, v248, v155, v156
 v_max3_f32 v248, v248, v157, v158
 v_max_f32 v248, v248, v159
 v_mov_b32 v249, v248
 s_nop 1
 v_permlane16_swap_b32 v248, v249
 v_max_f32 v248, v248, v249
 v_mov_b32 v249, v248
 s_nop 1
 v_permlane32_swap_b32 v248, v249
 v_max_f32 v248, v248, v249
 v_ceil_f32 v248, v248
 v_max_f32 v248, 0, v248
 vex v250, -v248
 vsf v152, v152, v248
 vsf v153, v153, v248
 vsf v154, v154, v248
 vsf v155, v155, v248
 vsf v156, v156, v248
 vsf v157, v157, v248
 vsf v158, v158, v248
 vsf v159, v159, v248
 vsf v168, v168, v248
 vsf v169, v169, v248
 vsf v170, v170, v248
 vsf v171, v171, v248
 vsf v172, v172, v248
 vsf v173, v173, v248
 vsf v174, v174, v248
 vsf v175, v175, v248
 vsf v224, v224, v248
 vsf v225, v225, v248
 vsf v226, v226, v248
 vsf v227, v227, v248
 vsf v228, v228, v248
 vsf v229, v229, v248
 vsf v230, v230, v248
 vsf v231, v231, v248
 vmf v12, v12, v250
 vmf v13, v13, v250
 vmf v14, v14, v250
 vmf v15, v15, v250
 vmf v28, v28, v250
 vmf v29, v29, v250
 vmf v30, v30, v250
 vmf v31, v31, v250
 vmf v44, v44, v250
 vmf v45, v45, v250
 vmf v46, v46, v250
 vmf v47, v47, v250
 vmf v60, v60, v250
 vmf v61, v61, v250
 vmf v62, v62, v250
 vmf v63, v63, v250
 vmf v76, v76, v250
 vmf v77, v77, v250
 vmf v78, v78, v250
 vmf v79, v79, v250
 vmf v92, v92, v250
 vmf v93, v93, v250
 vmf v94, v94, v250
 vmf v95, v95, v250
 vmf v108, v108, v250
 vmf v109, v109, v250
 vmf v110, v110, v250
 vmf v111, v111, v250
 vmf v124, v124, v250
 vmf v125, v125, v250
 vmf v126, v126, v250
 vmf v127, v127, v250
 vmf v243, v243, v250
 vex v232, v152
 vex v233, v153
 s_nop 0
 vaf v239, v232, v233
 cvp v196, v232, v233
 vex v232, v154
 vex v233, v155
 s_nop 0
 vaf v239, v239, v232
 vaf v239, v239, v233
 cvp v197, v232, v233
 vex v232, v156
 vex v233, v157
 s_nop 0
 vaf v239, v239, v232
 vaf v239, v239, v233
 cvp v198, v232, v233
 vex v232, v158
 vex v233, v159
 s_nop 0
 vaf v239, v239, v232
 vaf v239, v239, v233
 cvp v199, v232, v233
 vex v232, v128
 vex v233, v129
 s_nop 1
 s_branch K2_BACK_52
K2_SLOW_53:
 s_nop 7
 v_max3_f32 v248, v128, v129, v130
 v_max3_f32 v248, v248, v131, v132
 v_max3_f32 v248, v248, v133, v134
 v_max_f32 v248, v248, v135
 v_mov_b32 v249, v248
 s_nop 1
 v_permlane16_swap_b32 v248, v249
 v_max_f32 v248, v248, v249
 v_mov_b32 v249, v248
 s_nop 1
 v_permlane32_swap_b32 v248, v249
 v_max_f32 v248, v248, v249
 v_ceil_f32 v248, v248
 v_max_f32 v248, 0, v248
 vex v250, -v248
 vsf v128, v128, v248
 vsf v129, v129, v248
 vsf v130, v130, v248
 vsf v131, v131, v248
 vsf v132, v132, v248
 vsf v133, v133, v248
 vsf v134, v134, v248
 vsf v135, v135, v248
 vsf v200, v200, v248
 vsf v201, v201, v248
 vsf v202, v202, v248
 vsf v203, v203, v248
 vsf v204, v204, v248
 vsf v205, v205, v248
 vsf v206, v206, v248
 vsf v207, v207, v248
 vmf v0, v0, v250
 vmf v1, v1, v250
 vmf v2, v2, v250
 vmf v3, v3, v250
 vmf v16, v16, v250
 vmf v17, v17, v250
 vmf v18, v18, v250
 vmf v19, v19, v250
 vmf v32, v32, v250
 vmf v33, v33, v250
 vmf v34, v34, v250
 vmf v35, v35, v250
 vmf v48, v48, v250
 vmf v49, v49, v250
 vmf v50, v50, v250
 vmf v51, v51, v250
 vmf v64, v64, v250
 vmf v65, v65, v250
 vmf v66, v66, v250
 vmf v67, v67, v250
 vmf v80, v80, v250
 vmf v81, v81, v250
 vmf v82, v82, v250
 vmf v83, v83, v250
 vmf v96, v96, v250
 vmf v97, v97, v250
 vmf v98, v98, v250
 vmf v99, v99, v250
 vmf v112, v112, v250
 vmf v113, v113, v250
 vmf v114, v114, v250
 vmf v115, v115, v250
 vmf v240, v240, v250
 vex v232, v128
 vex v233, v129
 s_nop 0
 vaf v236, v232, v233
 cvp v184, v232, v233
 vex v232, v130
 vex v233, v131
 s_nop 0
 vaf v236, v236, v232
 vaf v236, v236, v233
 cvp v185, v232, v233
 vex v232, v132
 vex v233, v133
 s_nop 0
 vaf v236, v236, v232
 vaf v236, v236, v233
 cvp v186, v232, v233
 vex v232, v134
 vex v233, v135
 s_nop 0
 vaf v236, v236, v232
 vaf v236, v236, v233
 cvp v187, v232, v233
 v_max3_f32 v248, v136, v137, v138
 v_max3_f32 v248, v248, v139, v140
 v_max3_f32 v248, v248, v141, v142
 v_max_f32 v248, v248, v143
 v_mov_b32 v249, v248
 s_nop 1
 v_permlane16_swap_b32 v248, v249
 v_max_f32 v248, v248, v249
 v_mov_b32 v249, v248
 s_nop 1
 v_permlane32_swap_b32 v248, v249
 v_max_f32 v248, v248, v249
 v_ceil_f32 v248, v248
 v_max_f32 v248, 0, v248
 vex v250, -v248
 vsf v136, v136, v248
 vsf v137, v137, v248
 vsf v138, v138, v248
 vsf v139, v139, v248
 vsf v140, v140, v248
 vsf v141, v141, v248
 vsf v142, v142, v248
 vsf v143, v143, v248
 vsf v208, v208, v248
 vsf v209, v209, v248
 vsf v210, v210, v248
 vsf v211, v211, v248
 vsf v212, v212, v248
 vsf v213, v213, v248
 vsf v214, v214, v248
 vsf v215, v215, v248
 vmf v4, v4, v250
 vmf v5, v5, v250
 vmf v6, v6, v250
 vmf v7, v7, v250
 vmf v20, v20, v250
 vmf v21, v21, v250
 vmf v22, v22, v250
 vmf v23, v23, v250
 vmf v36, v36, v250
 vmf v37, v37, v250
 vmf v38, v38, v250
 vmf v39, v39, v250
 vmf v52, v52, v250
 vmf v53, v53, v250
 vmf v54, v54, v250
 vmf v55, v55, v250
 vmf v68, v68, v250
 vmf v69, v69, v250
 vmf v70, v70, v250
 vmf v71, v71, v250
 vmf v84, v84, v250
 vmf v85, v85, v250
 vmf v86, v86, v250
 vmf v87, v87, v250
 vmf v100, v100, v250
 vmf v101, v101, v250
 vmf v102, v102, v250
 vmf v103, v103, v250
 vmf v116, v116, v250
 vmf v117, v117, v250
 vmf v118, v118, v250
 vmf v119, v119, v250
 vmf v241, v241, v250
 vex v232, v136
 vex v233, v137
 s_nop 0
 vaf v237, v232, v233
 cvp v188, v232, v233
 vex v232, v138
 vex v233, v139
 s_nop 0
 vaf v237, v237, v232
 vaf v237, v237, v233
 cvp v189, v232, v233
 vex v232, v140
 vex v233, v141
 s_nop 0
 vaf v237, v237, v232
 vaf v237, v237, v233
 cvp v190, v232, v233
 vex v232, v142
 vex v233, v143
 s_nop 0
 vaf v237, v237, v232
 vaf v237, v237, v233
 cvp v191, v232, v233
 vex v232, v160
 vex v233, v161
 s_nop 1
 s_branch K2_BACK_54
K2_SLOW_59:
 s_nop 7
 v_max3_f32 v248, v160, v161, v162
 v_max3_f32 v248, v248, v163, v164
 v_max3_f32 v248, v248, v165, v166
 v_max_f32 v248, v248, v167
 v_mov_b32 v249, v248
 s_nop 1
 v_permlane16_swap_b32 v248, v249
 v_max_f32 v248, v248, v249
 v_mov_b32 v249, v248
 s_nop 1
 v_permlane32_swap_b32 v248, v249
 v_max_f32 v248, v248, v249
 v_ceil_f32 v248, v248
 v_max_f32 v248, 0, v248
 vex v250, -v248
 vsf v160, v160, v248
 vsf v161, v161, v248
 vsf v162, v162, v248
 vsf v163, v163, v248
 vsf v164, v164, v248
 vsf v165, v165, v248
 vsf v166, v166, v248
 vsf v167, v167, v248
 vsf v144, v144, v248
 vsf v145, v145, v248
 vsf v146, v146, v248
 vsf v147, v147, v248
 vsf v148, v148, v248
 vsf v149, v149, v248
 vsf v150, v150, v248
 vsf v151, v151, v248
 vsf v216, v216, v248
 vsf v217, v217, v248
 vsf v218, v218, v248
 vsf v219, v219, v248
 vsf v220, v220, v248
 vsf v221, v221, v248
 vsf v222, v222, v248
 vsf v223, v223, v248
 vmf v8, v8, v250
 vmf v9, v9, v250
 vmf v10, v10, v250
 vmf v11, v11, v250
 vmf v24, v24, v250
 vmf v25, v25, v250
 vmf v26, v26, v250
 vmf v27, v27, v250
 vmf v40, v40, v250
 vmf v41, v41, v250
 vmf v42, v42, v250
 vmf v43, v43, v250
 vmf v56, v56, v250
 vmf v57, v57, v250
 vmf v58, v58, v250
 vmf v59, v59, v250
 vmf v72, v72, v250
 vmf v73, v73, v250
 vmf v74, v74, v250
 vmf v75, v75, v250
 vmf v88, v88, v250
 vmf v89, v89, v250
 vmf v90, v90, v250
 vmf v91, v91, v250
 vmf v104, v104, v250
 vmf v105, v105, v250
 vmf v106, v106, v250
 vmf v107, v107, v250
 vmf v120, v120, v250
 vmf v121, v121, v250
 vmf v122, v122, v250
 vmf v123, v123, v250
 vmf v242, v242, v250
 vex v232, v160
 vex v233, v161
 s_nop 0
 vaf v238, v232, v233
 cvp v192, v232, v233
 vex v232, v162
 vex v233, v163
 s_nop 0
 vaf v238, v238, v232
 vaf v238, v238, v233
 cvp v193, v232, v233
 vex v232, v164
 vex v233, v165
 s_nop 0
 vaf v238, v238, v232
 vaf v238, v238, v233
 cvp v194, v232, v233
 vex v232, v166
 vex v233, v167
 s_nop 0
 vaf v238, v238, v232
 vaf v238, v238, v233
 cvp v195, v232, v233
 v_max3_f32 v248, v168, v169, v170
 v_max3_f32 v248, v248, v171, v172
 v_max3_f32 v248, v248, v173, v174
 v_max_f32 v248, v248, v175
 v_mov_b32 v249, v248
 s_nop 1
 v_permlane16_swap_b32 v248, v249
 v_max_f32 v248, v248, v249
 v_mov_b32 v249, v248
 s_nop 1
 v_permlane32_swap_b32 v248, v249
 v_max_f32 v248, v248, v249
 v_ceil_f32 v248, v248
 v_max_f32 v248, 0, v248
 vex v250, -v248
 vsf v168, v168, v248
 vsf v169, v169, v248
 vsf v170, v170, v248
 vsf v171, v171, v248
 vsf v172, v172, v248
 vsf v173, v173, v248
 vsf v174, v174, v248
 vsf v175, v175, v248
 vsf v152, v152, v248
 vsf v153, v153, v248
 vsf v154, v154, v248
 vsf v155, v155, v248
 vsf v156, v156, v248
 vsf v157, v157, v248
 vsf v158, v158, v248
 vsf v159, v159, v248
 vsf v224, v224, v248
 vsf v225, v225, v248
 vsf v226, v226, v248
 vsf v227, v227, v248
 vsf v228, v228, v248
 vsf v229, v229, v248
 vsf v230, v230, v248
 vsf v231, v231, v248
 vmf v12, v12, v250
 vmf v13, v13, v250
 vmf v14, v14, v250
 vmf v15, v15, v250
 vmf v28, v28, v250
 vmf v29, v29, v250
 vmf v30, v30, v250
 vmf v31, v31, v250
 vmf v44, v44, v250
 vmf v45, v45, v250
 vmf v46, v46, v250
 vmf v47, v47, v250
 vmf v60, v60, v250
 vmf v61, v61, v250
 vmf v62, v62, v250
 vmf v63, v63, v250
 vmf v76, v76, v250
 vmf v77, v77, v250
 vmf v78, v78, v250
 vmf v79, v79, v250
 vmf v92, v92, v250
 vmf v93, v93, v250
 vmf v94, v94, v250
 vmf v95, v95, v250
 vmf v108, v108, v250
 vmf v109, v109, v250
 vmf v110, v110, v250
 vmf v111, v111, v250
 vmf v124, v124, v250
 vmf v125, v125, v250
 vmf v126, v126, v250
 vmf v127, v127, v250
 vmf v243, v243, v250
 vex v232, v168
 vex v233, v169
 s_nop 0
 vaf v239, v232, v233
 cvp v196, v232, v233
 vex v232, v170
 vex v233, v171
 s_nop 0
 vaf v239, v239, v232
 vaf v239, v239, v233
 cvp v197, v232, v233
 vex v232, v172
 vex v233, v173
 s_nop 0
 vaf v239, v239, v232
 vaf v239, v239, v233
 cvp v198, v232, v233
 vex v232, v174
 vex v233, v175
 s_nop 0
 vaf v239, v239, v232
 vaf v239, v239, v233
 cvp v199, v232, v233
 vex v232, v128
 vex v233, v129
 s_nop 1
 s_branch K2_BACK_60
K2_SLOW_61:
 s_nop 7
 v_max3_f32 v248, v128, v129, v130
 v_max3_f32 v248, v248, v131, v132
 v_max3_f32 v248, v248, v133, v134
 v_max_f32 v248, v248, v135
 v_mov_b32 v249, v248
 s_nop 1
 v_permlane16_swap_b32 v248, v249
 v_max_f32 v248, v248, v249
 v_mov_b32 v249, v248
 s_nop 1
 v_permlane32_swap_b32 v248, v249
 v_max_f32 v248, v248, v249
 v_ceil_f32 v248, v248
 v_max_f32 v248, 0, v248
 vex v250, -v248
 vsf v128, v128, v248
 vsf v129, v129, v248
 vsf v130, v130, v248
 vsf v131, v131, v248
 vsf v132, v132, v248
 vsf v133, v133, v248
 vsf v134, v134, v248
 vsf v135, v135, v248
 vsf v200, v200, v248
 vsf v201, v201, v248
 vsf v202, v202, v248
 vsf v203, v203, v248
 vsf v204, v204, v248
 vsf v205, v205, v248
 vsf v206, v206, v248
 vsf v207, v207, v248
 vmf v0, v0, v250
 vmf v1, v1, v250
 vmf v2, v2, v250
 vmf v3, v3, v250
 vmf v16, v16, v250
 vmf v17, v17, v250
 vmf v18, v18, v250
 vmf v19, v19, v250
 vmf v32, v32, v250
 vmf v33, v33, v250
 vmf v34, v34, v250
 vmf v35, v35, v250
 vmf v48, v48, v250
 vmf v49, v49, v250
 vmf v50, v50, v250
 vmf v51, v51, v250
 vmf v64, v64, v250
 vmf v65, v65, v250
 vmf v66, v66, v250
 vmf v67, v67, v250
 vmf v80, v80, v250
 vmf v81, v81, v250
 vmf v82, v82, v250
 vmf v83, v83, v250
 vmf v96, v96, v250
 vmf v97, v97, v250
 vmf v98, v98, v250
 vmf v99, v99, v250
 vmf v112, v112, v250
 vmf v113, v113, v250
 vmf v114, v114, v250
 vmf v115, v115, v250
 vmf v240, v240, v250
 vex v232, v128
 vex v233, v129
 s_nop 0
 vaf v236, v232, v233
 cvp v176, v232, v233
 vex v232, v130
 vex v233, v131
 s_nop 0
 vaf v236, v236, v232
 vaf v236, v236, v233
 cvp v177, v232, v233
 vex v232, v132
 vex v233, v133
 s_nop 0
 vaf v236, v236, v232
 vaf v236, v236, v233
 cvp v178, v232, v233
 vex v232, v134
 vex v233, v135
 s_nop 0
 vaf v236, v236, v232
 vaf v236, v236, v233
 cvp v179, v232, v233
 v_max3_f32 v248, v136, v137, v138
 v_max3_f32 v248, v248, v139, v140
 v_max3_f32 v248, v248, v141, v142
 v_max_f32 v248, v248, v143
 v_mov_b32 v249, v248
 s_nop 1
 v_permlane16_swap_b32 v248, v249
 v_max_f32 v248, v248, v249
 v_mov_b32 v249, v248
 s_nop 1
 v_permlane32_swap_b32 v248, v249
 v_max_f32 v248, v248, v249
 v_ceil_f32 v248, v248
 v_max_f32 v248, 0, v248
 vex v250, -v248
 vsf v136, v136, v248
 vsf v137, v137, v248
 vsf v138, v138, v248
 vsf v139, v139, v248
 vsf v140, v140, v248
 vsf v141, v141, v248
 vsf v142, v142, v248
 vsf v143, v143, v248
 vsf v208, v208, v248
 vsf v209, v209, v248
 vsf v210, v210, v248
 vsf v211, v211, v248
 vsf v212, v212, v248
 vsf v213, v213, v248
 vsf v214, v214, v248
 vsf v215, v215, v248
 vmf v4, v4, v250
 vmf v5, v5, v250
 vmf v6, v6, v250
 vmf v7, v7, v250
 vmf v20, v20, v250
 vmf v21, v21, v250
 vmf v22, v22, v250
 vmf v23, v23, v250
 vmf v36, v36, v250
 vmf v37, v37, v250
 vmf v38, v38, v250
 vmf v39, v39, v250
 vmf v52, v52, v250
 vmf v53, v53, v250
 vmf v54, v54, v250
 vmf v55, v55, v250
 vmf v68, v68, v250
 vmf v69, v69, v250
 vmf v70, v70, v250
 vmf v71, v71, v250
 vmf v84, v84, v250
 vmf v85, v85, v250
 vmf v86, v86, v250
 vmf v87, v87, v250
 vmf v100, v100, v250
 vmf v101, v101, v250
 vmf v102, v102, v250
 vmf v103, v103, v250
 vmf v116, v116, v250
 vmf v117, v117, v250
 vmf v118, v118, v250
 vmf v119, v119, v250
 vmf v241, v241, v250
 vex v232, v136
 vex v233, v137
 s_nop 0
 vaf v237, v232, v233
 cvp v180, v232, v233
 vex v232, v138
 vex v233, v139
 s_nop 0
 vaf v237, v237, v232
 vaf v237, v237, v233
 cvp v181, v232, v233
 vex v232, v140
 vex v233, v141
 s_nop 0
 vaf v237, v237, v232
 vaf v237, v237, v233
 cvp v182, v232, v233
 vex v232, v142
 vex v233, v143
 s_nop 0
 vaf v237, v237, v232
 vaf v237, v237, v233
 cvp v183, v232, v233
 vex v232, v152
 vex v233, v153
 s_nop 1
 s_branch K2_BACK_62
K2_SLOW_67:
 s_nop 7
 v_max3_f32 v248, v152, v153, v154
 v_max3_f32 v248, v248, v155, v156
 v_max3_f32 v248, v248, v157, v158
 v_max_f32 v248, v248, v159
 v_mov_b32 v249, v248
 s_nop 1
 v_permlane16_swap_b32 v248, v249
 v_max_f32 v248, v248, v249
 v_mov_b32 v249, v248
 s_nop 1
 v_permlane32_swap_b32 v248, v249
 v_max_f32 v248, v248, v249
 v_ceil_f32 v248, v248
 v_max_f32 v248, 0, v248
 vex v250, -v248
 vsf v152, v152, v248
 vsf v153, v153, v248
 vsf v154, v154, v248
 vsf v155, v155, v248
 vsf v156, v156, v248
 vsf v157, v157, v248
 vsf v158, v158, v248
 vsf v159, v159, v248
 vsf v168, v168, v248
 vsf v169, v169, v248
 vsf v170, v170, v248
 vsf v171, v171, v248
 vsf v172, v172, v248
 vsf v173, v173, v248
 vsf v174, v174, v248
 vsf v175, v175, v248
 vsf v224, v224, v248
 vsf v225, v225, v248
 vsf v226, v226, v248
 vsf v227, v227, v248
 vsf v228, v228, v248
 vsf v229, v229, v248
 vsf v230, v230, v248
 vsf v231, v231, v248
 vmf v12, v12, v250
 vmf v13, v13, v250
 vmf v14, v14, v250
 vmf v15, v15, v250
 vmf v28, v28, v250
 vmf v29, v29, v250
 vmf v30, v30, v250
 vmf v31, v31, v250
 vmf v44, v44, v250
 vmf v45, v45, v250
 vmf v46, v46, v250
 vmf v47, v47, v250
 vmf v60, v60, v250
 vmf v61, v61, v250
 vmf v62, v62, v250
 vmf v63, v63, v250
 vmf v76, v76, v250
 vmf v77, v77, v250
 vmf v78, v78, v250
 vmf v79, v79, v250
 vmf v92, v92, v250
 vmf v93, v93, v250
 vmf v94, v94, v250
 vmf v95, v95, v250
 vmf v108, v108, v250
 vmf v109, v109, v250
 vmf v110, v110, v250
 vmf v111, v111, v250
 vmf v124, v124, v250
 vmf v125, v125, v250
 vmf v126, v126, v250
 vmf v127, v127, v250
 vmf v243, v243, v250
 vex v232, v152
 vex v233, v153
 s_nop 0
 vaf v239, v232, v233
 cvp v196, v232, v233
 vex v232, v154
 vex v233, v155
 s_nop 0
 vaf v239, v239, v232
 vaf v239, v239, v233
 cvp v197, v232, v233
 vex v232, v156
 vex v233, v157
 s_nop 0
 vaf v239, v239, v232
 vaf v239, v239, v233
 cvp v198, v232, v233
 vex v232, v158
 vex v233, v159
 s_nop 0
 vaf v239, v239, v232
 vaf v239, v239, v233
 cvp v199, v232, v233
 vex v232, v128
 vex v233, v129
 s_nop 1
 s_branch K2_BACK_68
K2_SLOW_69:
 s_nop 7
 v_max3_f32 v248, v128, v129, v130
 v_max3_f32 v248, v248, v131, v132
 v_max3_f32 v248, v248, v133, v134
 v_max_f32 v248, v248, v135
 v_mov_b32 v249, v248
 s_nop 1
 v_permlane16_swap_b32 v248, v249
 v_max_f32 v248, v248, v249
 v_mov_b32 v249, v248
 s_nop 1
 v_permlane32_swap_b32 v248, v249
 v_max_f32 v248, v248, v249
 v_ceil_f32 v248, v248
 v_max_f32 v248, 0, v248
 vex v250, -v248
 vsf v128, v128, v248
 vsf v129, v129, v248
 vsf v130, v130, v248
 vsf v131, v131, v248
 vsf v132, v132, v248
 vsf v133, v133, v248
 vsf v134, v134, v248
 vsf v135, v135, v248
 vsf v200, v200, v248
 vsf v201, v201, v248
 vsf v202, v202, v248
 vsf v203, v203, v248
 vsf v204, v204, v248
 vsf v205, v205, v248
 vsf v206, v206, v248
 vsf v207, v207, v248
 vmf v0, v0, v250
 vmf v1, v1, v250
 vmf v2, v2, v250
 vmf v3, v3, v250
 vmf v16, v16, v250
 vmf v17, v17, v250
 vmf v18, v18, v250
 vmf v19, v19, v250
 vmf v32, v32, v250
 vmf v33, v33, v250
 vmf v34, v34, v250
 vmf v35, v35, v250
 vmf v48, v48, v250
 vmf v49, v49, v250
 vmf v50, v50, v250
 vmf v51, v51, v250
 vmf v64, v64, v250
 vmf v65, v65, v250
 vmf v66, v66, v250
 vmf v67, v67, v250
 vmf v80, v80, v250
 vmf v81, v81, v250
 vmf v82, v82, v250
 vmf v83, v83, v250
 vmf v96, v96, v250
 vmf v97, v97, v250
 vmf v98, v98, v250
 vmf v99, v99, v250
 vmf v112, v112, v250
 vmf v113, v113, v250
 vmf v114, v114, v250
 vmf v115, v115, v250
 vmf v240, v240, v250
 vex v232, v128
 vex v233, v129
 s_nop 0
 vaf v236, v232, v233
 cvp v184, v232, v233
 vex v232, v130
 vex v233, v131
 s_nop 0
 vaf v236, v236, v232
 vaf v236, v236, v233
 cvp v185, v232, v233
 vex v232, v132
 vex v233, v133
 s_nop 0
 vaf v236, v236, v232
 vaf v236, v236, v233
 cvp v186, v232, v233
 vex v232, v134
 vex v233, v135
 s_nop 0
 vaf v236, v236, v232
 vaf v236, v236, v233
 cvp v187, v232, v233
 v_max3_f32 v248, v136, v137, v138
 v_max3_f32 v248, v248, v139, v140
 v_max3_f32 v248, v248, v141, v142
 v_max_f32 v248, v248, v143
 v_mov_b32 v249, v248
 s_nop 1
 v_permlane16_swap_b32 v248, v249
 v_max_f32 v248, v248, v249
 v_mov_b32 v249, v248
 s_nop 1
 v_permlane32_swap_b32 v248, v249
 v_max_f32 v248, v248, v249
 v_ceil_f32 v248, v248
 v_max_f32 v248, 0, v248
 vex v250, -v248
 vsf v136, v136, v248
 vsf v137, v137, v248
 vsf v138, v138, v248
 vsf v139, v139, v248
 vsf v140, v140, v248
 vsf v141, v141, v248
 vsf v142, v142, v248
 vsf v143, v143, v248
 vsf v208, v208, v248
 vsf v209, v209, v248
 vsf v210, v210, v248
 vsf v211, v211, v248
 vsf v212, v212, v248
 vsf v213, v213, v248
 vsf v214, v214, v248
 vsf v215, v215, v248
 vmf v4, v4, v250
 vmf v5, v5, v250
 vmf v6, v6, v250
 vmf v7, v7, v250
 vmf v20, v20, v250
 vmf v21, v21, v250
 vmf v22, v22, v250
 vmf v23, v23, v250
 vmf v36, v36, v250
 vmf v37, v37, v250
 vmf v38, v38, v250
 vmf v39, v39, v250
 vmf v52, v52, v250
 vmf v53, v53, v250
 vmf v54, v54, v250
 vmf v55, v55, v250
 vmf v68, v68, v250
 vmf v69, v69, v250
 vmf v70, v70, v250
 vmf v71, v71, v250
 vmf v84, v84, v250
 vmf v85, v85, v250
 vmf v86, v86, v250
 vmf v87, v87, v250
 vmf v100, v100, v250
 vmf v101, v101, v250
 vmf v102, v102, v250
 vmf v103, v103, v250
 vmf v116, v116, v250
 vmf v117, v117, v250
 vmf v118, v118, v250
 vmf v119, v119, v250
 vmf v241, v241, v250
 vex v232, v136
 vex v233, v137
 s_nop 0
 vaf v237, v232, v233
 cvp v188, v232, v233
 vex v232, v138
 vex v233, v139
 s_nop 0
 vaf v237, v237, v232
 vaf v237, v237, v233
 cvp v189, v232, v233
 vex v232, v140
 vex v233, v141
 s_nop 0
 vaf v237, v237, v232
 vaf v237, v237, v233
 cvp v190, v232, v233
 vex v232, v142
 vex v233, v143
 s_nop 0
 vaf v237, v237, v232
 vaf v237, v237, v233
 cvp v191, v232, v233
 vex v232, v168
 vex v233, v169
 s_nop 1
 s_branch K2_BACK_70
K2_HOOK_79:
 s_cmp_eq_u32 s16, 0
 s_cbranch_scc1 K2_PD_71
 s_cmp_gt_u32 s16, 0
 s_cbranch_scc1 K2_PE_72
 v_mov_b32 v200, v255
 v_mov_b32 v201, v255
 v_mov_b32 v202, v255
 v_mov_b32 v203, v255
 s_branch K2_PE_72
K2_PD_71:
 v_cndmask_b32 v200, v255, v200, s[26:27]
 v_cndmask_b32 v201, v255, v201, s[28:29]
 v_cndmask_b32 v202, v255, v202, s[30:31]
 v_cndmask_b32 v203, v255, v203, s[32:33]
K2_PE_72:
 s_cmp_eq_u32 s16, 1
 s_cbranch_scc1 K2_PD_73
 s_cmp_gt_u32 s16, 1
 s_cbranch_scc1 K2_PE_74
 v_mov_b32 v204, v255
 v_mov_b32 v205, v255
 v_mov_b32 v206, v255
 v_mov_b32 v207, v255
 s_branch K2_PE_74
K2_PD_73:
 v_cndmask_b32 v204, v255, v204, s[26:27]
 v_cndmask_b32 v205, v255, v205, s[28:29]
 v_cndmask_b32 v206, v255, v206, s[30:31]
 v_cndmask_b32 v207, v255, v207, s[32:33]
K2_PE_74:
 s_nop 1
 s_cmp_eq_u32 s16, 2
 s_cbranch_scc1 K2_PD_75
 s_cmp_gt_u32 s16, 2
 s_cbranch_scc1 K2_PE_76
 v_mov_b32 v216, v255
 v_mov_b32 v217, v255
 v_mov_b32 v218, v255
 v_mov_b32 v219, v255
 s_branch K2_PE_76
K2_PD_75:
 v_cndmask_b32 v216, v255, v216, s[26:27]
 v_cndmask_b32 v217, v255, v217, s[28:29]
 v_cndmask_b32 v218, v255, v218, s[30:31]
 v_cndmask_b32 v219, v255, v219, s[32:33]
K2_PE_76:
 s_cmp_eq_u32 s16, 3
 s_cbranch_scc1 K2_PD_77
 s_cmp_gt_u32 s16, 3
 s_cbranch_scc1 K2_PE_78
 v_mov_b32 v220, v255
 v_mov_b32 v221, v255
 v_mov_b32 v222, v255
 v_mov_b32 v223, v255
 s_branch K2_PE_78
K2_PD_77:
 v_cndmask_b32 v220, v255, v220, s[26:27]
 v_cndmask_b32 v221, v255, v221, s[28:29]
 v_cndmask_b32 v222, v255, v222, s[30:31]
 v_cndmask_b32 v223, v255, v223, s[32:33]
K2_PE_78:
 s_nop 1
 s_branch K2_HB_80
K2_SLOW_81:
 s_nop 7
 v_max3_f32 v248, v168, v169, v170
 v_max3_f32 v248, v248, v171, v172
 v_max3_f32 v248, v248, v173, v174
 v_max_f32 v248, v248, v175
 v_mov_b32 v249, v248
 s_nop 1
 v_permlane16_swap_b32 v248, v249
 v_max_f32 v248, v248, v249
 v_mov_b32 v249, v248
 s_nop 1
 v_permlane32_swap_b32 v248, v249
 v_max_f32 v248, v248, v249
 v_ceil_f32 v248, v248
 v_max_f32 v248, 0, v248
 vex v250, -v248
 vsf v168, v168, v248
 vsf v169, v169, v248
 vsf v170, v170, v248
 vsf v171, v171, v248
 vsf v172, v172, v248
 vsf v173, v173, v248
 vsf v174, v174, v248
 vsf v175, v175, v248
 vmf v12, v12, v250
 vmf v13, v13, v250
 vmf v14, v14, v250
 vmf v15, v15, v250
 vmf v28, v28, v250
 vmf v29, v29, v250
 vmf v30, v30, v250
 vmf v31, v31, v250
 vmf v44, v44, v250
 vmf v45, v45, v250
 vmf v46, v46, v250
 vmf v47, v47, v250
 vmf v60, v60, v250
 vmf v61, v61, v250
 vmf v62, v62, v250
 vmf v63, v63, v250
 vmf v76, v76, v250
 vmf v77, v77, v250
 vmf v78, v78, v250
 vmf v79, v79, v250
 vmf v92, v92, v250
 vmf v93, v93, v250
 vmf v94, v94, v250
 vmf v95, v95, v250
 vmf v108, v108, v250
 vmf v109, v109, v250
 vmf v110, v110, v250
 vmf v111, v111, v250
 vmf v124, v124, v250
 vmf v125, v125, v250
 vmf v126, v126, v250
 vmf v127, v127, v250
 vmf v243, v243, v250
 vex v232, v168
 vex v233, v169
 s_nop 0
 vaf v239, v232, v233
 cvp v196, v232, v233
 vex v232, v170
 vex v233, v171
 s_nop 0
 vaf v239, v239, v232
 vaf v239, v239, v233
 cvp v197, v232, v233
 vex v232, v172
 vex v233, v173
 s_nop 0
 vaf v239, v239, v232
 vaf v239, v239, v233
 cvp v198, v232, v233
 vex v232, v174
 vex v233, v175
 s_nop 0
 vaf v239, v239, v232
 vaf v239, v239, v233
 cvp v199, v232, v233
 vex v232, v128
 vex v233, v129
 s_nop 1
 s_branch K2_BACK_82
K2_SLOW_83:
 s_nop 7
 v_max3_f32 v248, v128, v129, v130
 v_max3_f32 v248, v248, v131, v132
 v_max3_f32 v248, v248, v133, v134
 v_max_f32 v248, v248, v135
 v_mov_b32 v249, v248
 s_nop 1
 v_permlane16_swap_b32 v248, v249
 v_max_f32 v248, v248, v249
 v_mov_b32 v249, v248
 s_nop 1
 v_permlane32_swap_b32 v248, v249
 v_max_f32 v248, v248, v249
 v_ceil_f32 v248, v248
 v_max_f32 v248, 0, v248
 vex v250, -v248
 vsf v128, v128, v248
 vsf v129, v129, v248
 vsf v130, v130, v248
 vsf v131, v131, v248
 vsf v132, v132, v248
 vsf v133, v133, v248
 vsf v134, v134, v248
 vsf v135, v135, v248
 vsf v200, v200, v248
 vsf v201, v201, v248
 vsf v202, v202, v248
 vsf v203, v203, v248
 vsf v204, v204, v248
 vsf v205, v205, v248
 vsf v206, v206, v248
 vsf v207, v207, v248
 vsf v144, v144, v248
 vsf v145, v145, v248
 vsf v146, v146, v248
 vsf v147, v147, v248
 vsf v148, v148, v248
 vsf v149, v149, v248
 vsf v150, v150, v248
 vsf v151, v151, v248
 vsf v216, v216, v248
 vsf v217, v217, v248
 vsf v218, v218, v248
 vsf v219, v219, v248
 vsf v220, v220, v248
 vsf v221, v221, v248
 vsf v222, v222, v248
 vsf v223, v223, v248
 vmf v0, v0, v250
 vmf v1, v1, v250
 vmf v2, v2, v250
 vmf v3, v3, v250
 vmf v16, v16, v250
 vmf v17, v17, v250
 vmf v18, v18, v250
 vmf v19, v19, v250
 vmf v32, v32, v250
 vmf v33, v33, v250
 vmf v34, v34, v250
 vmf v35, v35, v250
 vmf v48, v48, v250
 vmf v49, v49, v250
 vmf v50, v50, v250
 vmf v51, v51, v250
 vmf v64, v64, v250
 vmf v65, v65, v250
 vmf v66, v66, v250
 vmf v67, v67, v250
 vmf v80, v80, v250
 vmf v81, v81, v250
 vmf v82, v82, v250
 vmf v83, v83, v250
 vmf v96, v96, v250
 vmf v97, v97, v250
 vmf v98, v98, v250
 vmf v99, v99, v250
 vmf v112, v112, v250
 vmf v113, v113, v250
 vmf v114, v114, v250
 vmf v115, v115, v250
 vmf v240, v240, v250
 vex v232, v128
 vex v233, v129
 s_nop 0
 vaf v236, v232, v233
 cvp v176, v232, v233
 vex v232, v130
 vex v233, v131
 s_nop 0
 vaf v236, v236, v232
 vaf v236, v236, v233
 cvp v177, v232, v233
 vex v232, v132
 vex v233, v133
 s_nop 0
 vaf v236, v236, v232
 vaf v236, v236, v233
 cvp v178, v232, v233
 vex v232, v134
 vex v233, v135
 s_nop 0
 vaf v236, v236, v232
 vaf v236, v236, v233
 cvp v179, v232, v233
 v_max3_f32 v248, v136, v137, v138
 v_max3_f32 v248, v248, v139, v140
 v_max3_f32 v248, v248, v141, v142
 v_max_f32 v248, v248, v143
 v_mov_b32 v249, v248
 s_nop 1
 v_permlane16_swap_b32 v248, v249
 v_max_f32 v248, v248, v249
 v_mov_b32 v249, v248
 s_nop 1
 v_permlane32_swap_b32 v248, v249
 v_max_f32 v248, v248, v249
 v_ceil_f32 v248, v248
 v_max_f32 v248, 0, v248
 vex v250, -v248
 vsf v136, v136, v248
 vsf v137, v137, v248
 vsf v138, v138, v248
 vsf v139, v139, v248
 vsf v140, v140, v248
 vsf v141, v141, v248
 vsf v142, v142, v248
 vsf v143, v143, v248
 vsf v208, v208, v248
 vsf v209, v209, v248
 vsf v210, v210, v248
 vsf v211, v211, v248
 vsf v212, v212, v248
 vsf v213, v213, v248
 vsf v214, v214, v248
 vsf v215, v215, v248
 vsf v152, v152, v248
 vsf v153, v153, v248
 vsf v154, v154, v248
 vsf v155, v155, v248
 vsf v156, v156, v248
 vsf v157, v157, v248
 vsf v158, v158, v248
 vsf v159, v159, v248
 vsf v224, v224, v248
 vsf v225, v225, v248
 vsf v226, v226, v248
 vsf v227, v227, v248
 vsf v228, v228, v248
 vsf v229, v229, v248
 vsf v230, v230, v248
 vsf v231, v231, v248
 vmf v4, v4, v250
 vmf v5, v5, v250
 vmf v6, v6, v250
 vmf v7, v7, v250
 vmf v20, v20, v250
 vmf v21, v21, v250
 vmf v22, v22, v250
 vmf v23, v23, v250
 vmf v36, v36, v250
 vmf v37, v37, v250
 vmf v38, v38, v250
 vmf v39, v39, v250
 vmf v52, v52, v250
 vmf v53, v53, v250
 vmf v54, v54, v250
 vmf v55, v55, v250
 vmf v68, v68, v250
 vmf v69, v69, v250
 vmf v70, v70, v250
 vmf v71, v71, v250
 vmf v84, v84, v250
 vmf v85, v85, v250
 vmf v86, v86, v250
 vmf v87, v87, v250
 vmf v100, v100, v250
 vmf v101, v101, v250
 vmf v102, v102, v250
 vmf v103, v103, v250
 vmf v116, v116, v250
 vmf v117, v117, v250
 vmf v118, v118, v250
 vmf v119, v119, v250
 vmf v241, v241, v250
 vex v232, v136
 vex v233, v137
 s_nop 0
 vaf v237, v232, v233
 cvp v180, v232, v233
 vex v232, v138
 vex v233, v139
 s_nop 0
 vaf v237, v237, v232
 vaf v237, v237, v233
 cvp v181, v232, v233
 vex v232, v140
 vex v233, v141
 s_nop 0
 vaf v237, v237, v232
 vaf v237, v237, v233
 cvp v182, v232, v233
 vex v232, v142
 vex v233, v143
 s_nop 0
 vaf v237, v237, v232
 vaf v237, v237, v233
 cvp v183, v232, v233
 vex v232, v144
 vex v233, v145
 s_nop 1
 s_branch K2_BACK_84
K2_SLOW_85:
 s_nop 7
 v_max3_f32 v248, v144, v145, v146
 v_max3_f32 v248, v248, v147, v148
 v_max3_f32 v248, v248, v149, v150
 v_max_f32 v248, v248, v151
 v_mov_b32 v249, v248
 s_nop 1
 v_permlane16_swap_b32 v248, v249
 v_max_f32 v248, v248, v249
 v_mov_b32 v249, v248
 s_nop 1
 v_permlane32_swap_b32 v248, v249
 v_max_f32 v248, v248, v249
 v_ceil_f32 v248, v248
 v_max_f32 v248, 0, v248
 vex v250, -v248
 vsf v144, v144, v248
 vsf v145, v145, v248
 vsf v146, v146, v248
 vsf v147, v147, v248
 vsf v148, v148, v248
 vsf v149, v149, v248
 vsf v150, v150, v248
 vsf v151, v151, v248
 vsf v200, v200, v248
 vsf v201, v201, v248
 vsf v202, v202, v248
 vsf v203, v203, v248
 vsf v204, v204, v248
 vsf v205, v205, v248
 vsf v206, v206, v248
 vsf v207, v207, v248
 vsf v216, v216, v248
 vsf v217, v217, v248
 vsf v218, v218, v248
 vsf v219, v219, v248
 vsf v220, v220, v248
 vsf v221, v221, v248
 vsf v222, v222, v248
 vsf v223, v223, v248
 vsf v128, v128, v248
 vsf v129, v129, v248
 vsf v130, v130, v248
 vsf v131, v131, v248
 vsf v132, v132, v248
 vsf v133, v133, v248
 vsf v134, v134, v248
 vsf v135, v135, v248
 vsf v160, v160, v248
 vsf v161, v161, v248
 vsf v162, v162, v248
 vsf v163, v163, v248
 vsf v164, v164, v248
 vsf v165, v165, v248
 vsf v166, v166, v248
 vsf v167, v167, v248
 vmf v0, v0, v250
 vmf v1, v1, v250
 vmf v2, v2, v250
 vmf v3, v3, v250
 vmf v16, v16, v250
 vmf v17, v17, v250
 vmf v18, v18, v250
 vmf v19, v19, v250
 vmf v32, v32, v250
 vmf v33, v33, v250
 vmf v34, v34, v250
 vmf v35, v35, v250
 vmf v48, v48, v250
 vmf v49, v49, v250
 vmf v50, v50, v250
 vmf v51, v51, v250
 vmf v64, v64, v250
 vmf v65, v65, v250
 vmf v66, v66, v250
 vmf v67, v67, v250
 vmf v80, v80, v250
 vmf v81, v81, v250
 vmf v82, v82, v250
 vmf v83, v83, v250
 vmf v96, v96, v250
 vmf v97, v97, v250
 vmf v98, v98, v250
 vmf v99, v99, v250
 vmf v112, v112, v250
 vmf v113, v113, v250
 vmf v114, v114, v250
 vmf v115, v115, v250
 vmf v240, v240, v250
 v_lshlrev_b32 v249, 16, v176
 v_and_b32 v176, 0xffff0000, v176
 vmf v249, v249, v250
 vmf v176, v176, v250
 cvp v176, v249, v176
 v_lshlrev_b32 v249, 16, v177
 v_and_b32 v177, 0xffff0000, v177
 vmf v249, v249, v250
 vmf v177, v177, v250
 cvp v177, v249, v177
 v_lshlrev_b32 v249, 16, v178
 v_and_b32 v178, 0xffff0000, v178
 vmf v249, v249, v250
 vmf v178, v178, v250
 cvp v178, v249, v178
 v_lshlrev_b32 v249, 16, v179
 v_and_b32 v179, 0xffff0000, v179
 vmf v249, v249, v250
 vmf v179, v179, v250
 cvp v179, v249, v179
 vex v232, v144
 vex v233, v145
 s_nop 0
 vaf v238, v232, v233
 cvp v192, v232, v233
 vex v232, v146
 vex v233, v147
 s_nop 0
 vaf v238, v238, v232
 vaf v238, v238, v233
 cvp v193, v232, v233
 vex v232, v148
 vex v233, v149
 s_nop 0
 vaf v238, v238, v232
 vaf v238, v238, v233
 cvp v194, v232, v233
 vex v232, v150
 vex v233, v151
 s_nop 0
 vaf v238, v238, v232
 vaf v238, v238, v233
 cvp v195, v232, v233
 v_max3_f32 v248, v152, v153, v154
 v_max3_f32 v248, v248, v155, v156
 v_max3_f32 v248, v248, v157, v158
 v_max_f32 v248, v248, v159
 v_mov_b32 v249, v248
 s_nop 1
 v_permlane16_swap_b32 v248, v249
 v_max_f32 v248, v248, v249
 v_mov_b32 v249, v248
 s_nop 1
 v_permlane32_swap_b32 v248, v249
 v_max_f32 v248, v248, v249
 v_ceil_f32 v248, v248
 v_max_f32 v248, 0, v248
 vex v250, -v248
 vsf v152, v152, v248
 vsf v153, v153, v248
 vsf v154, v154, v248
 vsf v155, v155, v248
 vsf v156, v156, v248
 vsf v157, v157, v248
 vsf v158, v158, v248
 vsf v159, v159, v248
 vsf v208, v208, v248
 vsf v209, v209, v248
 vsf v210, v210, v248
 vsf v211, v211, v248
 vsf v212, v212, v248
 vsf v213, v213, v248
 vsf v214, v214, v248
 vsf v215, v215, v248
 vsf v224, v224, v248
 vsf v225, v225, v248
 vsf v226, v226, v248
 vsf v227, v227, v248
 vsf v228, v228, v248
 vsf v229, v229, v248
 vsf v230, v230, v248
 vsf v231, v231, v248
 vsf v136, v136, v248
 vsf v137, v137, v248
 vsf v138, v138, v248
 vsf v139, v139, v248
 vsf v140, v140, v248
 vsf v141, v141, v248
 vsf v142, v142, v248
 vsf v143, v143, v248
 vsf v168, v168, v248
 vsf v169, v169, v248
 vsf v170, v170, v248
 vsf v171, v171, v248
 vsf v172, v172, v248
 vsf v173, v173, v248
 vsf v174, v174, v248
 vsf v175, v175, v248
 vmf v4, v4, v250
 vmf v5, v5, v250
 vmf v6, v6, v250
 vmf v7, v7, v250
 vmf v20, v20, v250
 vmf v21, v21, v250
 vmf v22, v22, v250
 vmf v23, v23, v250
 vmf v36, v36, v250
 vmf v37, v37, v250
 vmf v38, v38, v250
 vmf v39, v39, v250
 vmf v52, v52, v250
 vmf v53, v53, v250
 vmf v54, v54, v250
 vmf v55, v55, v250
 vmf v68, v68, v250
 vmf v69, v69, v250
 vmf v70, v70, v250
 vmf v71, v71, v250
 vmf v84, v84, v250
 vmf v85, v85, v250
 vmf v86, v86, v250
 vmf v87, v87, v250
 vmf v100, v100, v250
 vmf v101, v101, v250
 vmf v102, v102, v250
 vmf v103, v103, v250
 vmf v116, v116, v250
 vmf v117, v117, v250
 vmf v118, v118, v250
 vmf v119, v119, v250
 vmf v241, v241, v250
 v_lshlrev_b32 v249, 16, v180
 v_and_b32 v180, 0xffff0000, v180
 vmf v249, v249, v250
 vmf v180, v180, v250
 cvp v180, v249, v180
 v_lshlrev_b32 v249, 16, v181
 v_and_b32 v181, 0xffff0000, v181
 vmf v249, v249, v250
 vmf v181, v181, v250
 cvp v181, v249, v181
 v_lshlrev_b32 v249, 16, v182
 v_and_b32 v182, 0xffff0000, v182
 vmf v249, v249, v250
 vmf v182, v182, v250
 cvp v182, v249, v182
 v_lshlrev_b32 v249, 16, v183
 v_and_b32 v183, 0xffff0000, v183
 vmf v249, v249, v250
 vmf v183, v183, v250
 cvp v183, v249, v183
 vex v232, v152
 vex v233, v153
 s_nop 0
 vaf v239, v232, v233
 cvp v196, v232, v233
 vex v232, v154
 vex v233, v155
 s_nop 0
 vaf v239, v239, v232
 vaf v239, v239, v233
 cvp v197, v232, v233
 vex v232, v156
 vex v233, v157
 s_nop 0
 vaf v239, v239, v232
 vaf v239, v239, v233
 cvp v198, v232, v233
 vex v232, v158
 vex v233, v159
 s_nop 0
 vaf v239, v239, v232
 vaf v239, v239, v233
 cvp v199, v232, v233
 vex v232, v128
 vex v233, v129
 s_nop 1
 s_branch K2_BACK_86
K2_SLOW_87:
 s_nop 7
 v_max3_f32 v248, v128, v129, v130
 v_max3_f32 v248, v248, v131, v132
 v_max3_f32 v248, v248, v133, v134
 v_max_f32 v248, v248, v135
 v_mov_b32 v249, v248
 s_nop 1
 v_permlane16_swap_b32 v248, v249
 v_max_f32 v248, v248, v249
 v_mov_b32 v249, v248
 s_nop 1
 v_permlane32_swap_b32 v248, v249
 v_max_f32 v248, v248, v249
 v_ceil_f32 v248, v248
 v_max_f32 v248, 0, v248
 vex v250, -v248
 vsf v128, v128, v248
 vsf v129, v129, v248
 vsf v130, v130, v248
 vsf v131, v131, v248
 vsf v132, v132, v248
 vsf v133, v133, v248
 vsf v134, v134, v248
 vsf v135, v135, v248
 vsf v200, v200, v248
 vsf v201, v201, v248
 vsf v202, v202, v248
 vsf v203, v203, v248
 vsf v204, v204, v248
 vsf v205, v205, v248
 vsf v206, v206, v248
 vsf v207, v207, v248
 vsf v160, v160, v248
 vsf v161, v161, v248
 vsf v162, v162, v248
 vsf v163, v163, v248
 vsf v164, v164, v248
 vsf v165, v165, v248
 vsf v166, v166, v248
 vsf v167, v167, v248
 vsf v216, v216, v248
 vsf v217, v217, v248
 vsf v218, v218, v248
 vsf v219, v219, v248
 vsf v220, v220, v248
 vsf v221, v221, v248
 vsf v222, v222, v248
 vsf v223, v223, v248
 vmf v0, v0, v250
 vmf v1, v1, v250
 vmf v2, v2, v250
 vmf v3, v3, v250
 vmf v16, v16, v250
 vmf v17, v17, v250
 vmf v18, v18, v250
 vmf v19, v19, v250
 vmf v32, v32, v250
 vmf v33, v33, v250
 vmf v34, v34, v250
 vmf v35, v35, v250
 vmf v48, v48, v250
 vmf v49, v49, v250
 vmf v50, v50, v250
 vmf v51, v51, v250
 vmf v64, v64, v250
 vmf v65, v65, v250
 vmf v66, v66, v250
 vmf v67, v67, v250
 vmf v80, v80, v250
 vmf v81, v81, v250
 vmf v82, v82, v250
 vmf v83, v83, v250
 vmf v96, v96, v250
 vmf v97, v97, v250
 vmf v98, v98, v250
 vmf v99, v99, v250
 vmf v112, v112, v250
 vmf v113, v113, v250
 vmf v114, v114, v250
 vmf v115, v115, v250
 vmf v240, v240, v250
 vex v232, v128
 vex v233, v129
 s_nop 0
 vaf v236, v232, v233
 cvp v184, v232, v233
 vex v232, v130
 vex v233, v131
 s_nop 0
 vaf v236, v236, v232
 vaf v236, v236, v233
 cvp v185, v232, v233
 vex v232, v132
 vex v233, v133
 s_nop 0
 vaf v236, v236, v232
 vaf v236, v236, v233
 cvp v186, v232, v233
 vex v232, v134
 vex v233, v135
 s_nop 0
 vaf v236, v236, v232
 vaf v236, v236, v233
 cvp v187, v232, v233
 v_max3_f32 v248, v136, v137, v138
 v_max3_f32 v248, v248, v139, v140
 v_max3_f32 v248, v248, v141, v142
 v_max_f32 v248, v248, v143
 v_mov_b32 v249, v248
 s_nop 1
 v_permlane16_swap_b32 v248, v249
 v_max_f32 v248, v248, v249
 v_mov_b32 v249, v248
 s_nop 1
 v_permlane32_swap_b32 v248, v249
 v_max_f32 v248, v248, v249
 v_ceil_f32 v248, v248
 v_max_f32 v248, 0, v248
 vex v250, -v248
 vsf v136, v136, v248
 vsf v137, v137, v248
 vsf v138, v138, v248
 vsf v139, v139, v248
 vsf v140, v140, v248
 vsf v141, v141, v248
 vsf v142, v142, v248
 vsf v143, v143, v248
 vsf v208, v208, v248
 vsf v209, v209, v248
 vsf v210, v210, v248
 vsf v211, v211, v248
 vsf v212, v212, v248
 vsf v213, v213, v248
 vsf v214, v214, v248
 vsf v215, v215, v248
 vsf v168, v168, v248
 vsf v169, v169, v248
 vsf v170, v170, v248
 vsf v171, v171, v248
 vsf v172, v172, v248
 vsf v173, v173, v248
 vsf v174, v174, v248
 vsf v175, v175, v248
 vsf v224, v224, v248
 vsf v225, v225, v248
 vsf v226, v226, v248
 vsf v227, v227, v248
 vsf v228, v228, v248
 vsf v229, v229, v248
 vsf v230, v230, v248
 vsf v231, v231, v248
 vmf v4, v4, v250
 vmf v5, v5, v250
 vmf v6, v6, v250
 vmf v7, v7, v250
 vmf v20, v20, v250
 vmf v21, v21, v250
 vmf v22, v22, v250
 vmf v23, v23, v250
 vmf v36, v36, v250
 vmf v37, v37, v250
 vmf v38, v38, v250
 vmf v39, v39, v250
 vmf v52, v52, v250
 vmf v53, v53, v250
 vmf v54, v54, v250
 vmf v55, v55, v250
 vmf v68, v68, v250
 vmf v69, v69, v250
 vmf v70, v70, v250
 vmf v71, v71, v250
 vmf v84, v84, v250
 vmf v85, v85, v250
 vmf v86, v86, v250
 vmf v87, v87, v250
 vmf v100, v100, v250
 vmf v101, v101, v250
 vmf v102, v102, v250
 vmf v103, v103, v250
 vmf v116, v116, v250
 vmf v117, v117, v250
 vmf v118, v118, v250
 vmf v119, v119, v250
 vmf v241, v241, v250
 vex v232, v136
 vex v233, v137
 s_nop 0
 vaf v237, v232, v233
 cvp v188, v232, v233
 vex v232, v138
 vex v233, v139
 s_nop 0
 vaf v237, v237, v232
 vaf v237, v237, v233
 cvp v189, v232, v233
 vex v232, v140
 vex v233, v141
 s_nop 0
 vaf v237, v237, v232
 vaf v237, v237, v233
 cvp v190, v232, v233
 vex v232, v142
 vex v233, v143
 s_nop 0
 vaf v237, v237, v232
 vaf v237, v237, v233
 cvp v191, v232, v233
 vex v232, v160
 vex v233, v161
 s_nop 1
 s_branch K2_BACK_88
K2_HOOK_97:
 s_cmp_eq_u32 s16, 0
 s_cbranch_scc1 K2_PD_89
 s_cmp_gt_u32 s16, 0
 s_cbranch_scc1 K2_PE_90
 v_mov_b32 v200, v255
 v_mov_b32 v201, v255
 v_mov_b32 v202, v255
 v_mov_b32 v203, v255
 s_branch K2_PE_90
K2_PD_89:
 v_cndmask_b32 v200, v255, v200, s[26:27]
 v_cndmask_b32 v201, v255, v201, s[28:29]
 v_cndmask_b32 v202, v255, v202, s[30:31]
 v_cndmask_b32 v203, v255, v203, s[32:33]
K2_PE_90:
 s_cmp_eq_u32 s16, 1
 s_cbranch_scc1 K2_PD_91
 s_cmp_gt_u32 s16, 1
 s_cbranch_scc1 K2_PE_92
 v_mov_b32 v204, v255
 v_mov_b32 v205, v255
 v_mov_b32 v206, v255
 v_mov_b32 v207, v255
 s_branch K2_PE_92
K2_PD_91:
 v_cndmask_b32 v204, v255, v204, s[26:27]
 v_cndmask_b32 v205, v255, v205, s[28:29]
 v_cndmask_b32 v206, v255, v206, s[30:31]
 v_cndmask_b32 v207, v255, v207, s[32:33]
K2_PE_92:
 s_nop 1
 s_cmp_eq_u32 s16, 2
 s_cbranch_scc1 K2_PD_93
 s_cmp_gt_u32 s16, 2
 s_cbranch_scc1 K2_PE_94
 v_mov_b32 v216, v255
 v_mov_b32 v217, v255
 v_mov_b32 v218, v255
 v_mov_b32 v219, v255
 s_branch K2_PE_94
K2_PD_93:
 v_cndmask_b32 v216, v255, v216, s[26:27]
 v_cndmask_b32 v217, v255, v217, s[28:29]
 v_cndmask_b32 v218, v255, v218, s[30:31]
 v_cndmask_b32 v219, v255, v219, s[32:33]
K2_PE_94:
 s_cmp_eq_u32 s16, 3
 s_cbranch_scc1 K2_PD_95
 s_cmp_gt_u32 s16, 3
 s_cbranch_scc1 K2_PE_96
 v_mov_b32 v220, v255
 v_mov_b32 v221, v255
 v_mov_b32 v222, v255
 v_mov_b32 v223, v255
 s_branch K2_PE_96
K2_PD_95:
 v_cndmask_b32 v220, v255, v220, s[26:27]
 v_cndmask_b32 v221, v255, v221, s[28:29]
 v_cndmask_b32 v222, v255, v222, s[30:31]
 v_cndmask_b32 v223, v255, v223, s[32:33]
K2_PE_96:
 s_nop 1
 s_branch K2_HB_98
K2_SLOW_99:
 s_nop 7
 v_max3_f32 v248, v160, v161, v162
 v_max3_f32 v248, v248, v163, v164
 v_max3_f32 v248, v248, v165, v166
 v_max_f32 v248, v248, v167
 v_mov_b32 v249, v248
 s_nop 1
 v_permlane16_swap_b32 v248, v249
 v_max_f32 v248, v248, v249
 v_mov_b32 v249, v248
 s_nop 1
 v_permlane32_swap_b32 v248, v249
 v_max_f32 v248, v248, v249
 v_ceil_f32 v248, v248
 v_max_f32 v248, 0, v248
 vex v250, -v248
 vsf v160, v160, v248
 vsf v161, v161, v248
 vsf v162, v162, v248
 vsf v163, v163, v248
 vsf v164, v164, v248
 vsf v165, v165, v248
 vsf v166, v166, v248
 vsf v167, v167, v248
 vsf v200, v200, v248
 vsf v201, v201, v248
 vsf v202, v202, v248
 vsf v203, v203, v248
 vsf v204, v204, v248
 vsf v205, v205, v248
 vsf v206, v206, v248
 vsf v207, v207, v248
 vsf v216, v216, v248
 vsf v217, v217, v248
 vsf v218, v218, v248
 vsf v219, v219, v248
 vsf v220, v220, v248
 vsf v221, v221, v248
 vsf v222, v222, v248
 vsf v223, v223, v248
 vsf v128, v128, v248
 vsf v129, v129, v248
 vsf v130, v130, v248
 vsf v131, v131, v248
 vsf v132, v132, v248
 vsf v133, v133, v248
 vsf v134, v134, v248
 vsf v135, v135, v248
 vsf v144, v144, v248
 vsf v145, v145, v248
 vsf v146, v146, v248
 vsf v147, v147, v248
 vsf v148, v148, v248
 vsf v149, v149, v248
 vsf v150, v150, v248
 vsf v151, v151, v248
 vmf v0, v0, v250
 vmf v1, v1, v250
 vmf v2, v2, v250
 vmf v3, v3, v250
 vmf v16, v16, v250
 vmf v17, v17, v250
 vmf v18, v18, v250
 vmf v19, v19, v250
 vmf v32, v32, v250
 vmf v33, v33, v250
 vmf v34, v34, v250
 vmf v35, v35, v250
 vmf v48, v48, v250
 vmf v49, v49, v250
 vmf v50, v50, v250
 vmf v51, v51, v250
 vmf v64, v64, v250
 vmf v65, v65, v250
 vmf v66, v66, v250
 vmf v67, v67, v250
 vmf v80, v80, v250
 vmf v81, v81, v250
 vmf v82, v82, v250
 vmf v83, v83, v250
 vmf v96, v96, v250
 vmf v97, v97, v250
 vmf v98, v98, v250
 vmf v99, v99, v250
 vmf v112, v112, v250
 vmf v113, v113, v250
 vmf v114, v114, v250
 vmf v115, v115, v250
 vmf v240, v240, v250
 v_lshlrev_b32 v249, 16, v184
 v_and_b32 v184, 0xffff0000, v184
 vmf v249, v249, v250
 vmf v184, v184, v250
 cvp v184, v249, v184
 v_lshlrev_b32 v249, 16, v185
 v_and_b32 v185, 0xffff0000, v185
 vmf v249, v249, v250
 vmf v185, v185, v250
 cvp v185, v249, v185
 v_lshlrev_b32 v249, 16, v186
 v_and_b32 v186, 0xffff0000, v186
 vmf v249, v249, v250
 vmf v186, v186, v250
 cvp v186, v249, v186
 v_lshlrev_b32 v249, 16, v187
 v_and_b32 v187, 0xffff0000, v187
 vmf v249, v249, v250
 vmf v187, v187, v250
 cvp v187, v249, v187
 vex v232, v160
 vex v233, v161
 s_nop 0
 vaf v238, v232, v233
 cvp v192, v232, v233
 vex v232, v162
 vex v233, v163
 s_nop 0
 vaf v238, v238, v232
 vaf v238, v238, v233
 cvp v193, v232, v233
 vex v232, v164
 vex v233, v165
 s_nop 0
 vaf v238, v238, v232
 vaf v238, v238, v233
 cvp v194, v232, v233
 vex v232, v166
 vex v233, v167
 s_nop 0
 vaf v238, v238, v232
 vaf v238, v238, v233
 cvp v195, v232, v233
 v_max3_f32 v248, v168, v169, v170
 v_max3_f32 v248, v248, v171, v172
 v_max3_f32 v248, v248, v173, v174
 v_max_f32 v248, v248, v175
 v_mov_b32 v249, v248
 s_nop 1
 v_permlane16_swap_b32 v248, v249
 v_max_f32 v248, v248, v249
 v_mov_b32 v249, v248
 s_nop 1
 v_permlane32_swap_b32 v248, v249
 v_max_f32 v248, v248, v249
 v_ceil_f32 v248, v248
 v_max_f32 v248, 0, v248
 vex v250, -v248
 vsf v168, v168, v248
 vsf v169, v169, v248
 vsf v170, v170, v248
 vsf v171, v171, v248
 vsf v172, v172, v248
 vsf v173, v173, v248
 vsf v174, v174, v248
 vsf v175, v175, v248
 vsf v208, v208, v248
 vsf v209, v209, v248
 vsf v210, v210, v248
 vsf v211, v211, v248
 vsf v212, v212, v248
 vsf v213, v213, v248
 vsf v214, v214, v248
 vsf v215, v215, v248
 vsf v224, v224, v248
 vsf v225, v225, v248
 vsf v226, v226, v248
 vsf v227, v227, v248
 vsf v228, v228, v248
 vsf v229, v229, v248
 vsf v230, v230, v248
 vsf v231, v231, v248
 vsf v136, v136, v248
 vsf v137, v137, v248
 vsf v138, v138, v248
 vsf v139, v139, v248
 vsf v140, v140, v248
 vsf v141, v141, v248
 vsf v142, v142, v248
 vsf v143, v143, v248
 vsf v152, v152, v248
 vsf v153, v153, v248
 vsf v154, v154, v248
 vsf v155, v155, v248
 vsf v156, v156, v248
 vsf v157, v157, v248
 vsf v158, v158, v248
 vsf v159, v159, v248
 vmf v4, v4, v250
 vmf v5, v5, v250
 vmf v6, v6, v250
 vmf v7, v7, v250
 vmf v20, v20, v250
 vmf v21, v21, v250
 vmf v22, v22, v250
 vmf v23, v23, v250
 vmf v36, v36, v250
 vmf v37, v37, v250
 vmf v38, v38, v250
 vmf v39, v39, v250
 vmf v52, v52, v250
 vmf v53, v53, v250
 vmf v54, v54, v250
 vmf v55, v55, v250
 vmf v68, v68, v250
 vmf v69, v69, v250
 vmf v70, v70, v250
 vmf v71, v71, v250
 vmf v84, v84, v250
 vmf v85, v85, v250
 vmf v86, v86, v250
 vmf v87, v87, v250
 vmf v100, v100, v250
 vmf v101, v101, v250
 vmf v102, v102, v250
 vmf v103, v103, v250
 vmf v116, v116, v250
 vmf v117, v117, v250
 vmf v118, v118, v250
 vmf v119, v119, v250
 vmf v241, v241, v250
 v_lshlrev_b32 v249, 16, v188
 v_and_b32 v188, 0xffff0000, v188
 vmf v249, v249, v250
 vmf v188, v188, v250
 cvp v188, v249, v188
 v_lshlrev_b32 v249, 16, v189
 v_and_b32 v189, 0xffff0000, v189
 vmf v249, v249, v250
 vmf v189, v189, v250
 cvp v189, v249, v189
 v_lshlrev_b32 v249, 16, v190
 v_and_b32 v190, 0xffff0000, v190
 vmf v249, v249, v250
 vmf v190, v190, v250
 cvp v190, v249, v190
 v_lshlrev_b32 v249, 16, v191
 v_and_b32 v191, 0xffff0000, v191
 vmf v249, v249, v250
 vmf v191, v191, v250
 cvp v191, v249, v191
 vex v232, v168
 vex v233, v169
 s_nop 0
 vaf v239, v232, v233
 cvp v196, v232, v233
 vex v232, v170
 vex v233, v171
 s_nop 0
 vaf v239, v239, v232
 vaf v239, v239, v233
 cvp v197, v232, v233
 vex v232, v172
 vex v233, v173
 s_nop 0
 vaf v239, v239, v232
 vaf v239, v239, v233
 cvp v198, v232, v233
 vex v232, v174
 vex v233, v175
 s_nop 0
 vaf v239, v239, v232
 vaf v239, v239, v233
 cvp v199, v232, v233
 vex v232, v128
 vex v233, v129
 s_nop 1
 s_branch K2_BACK_100
K2_SLOW_101:
 s_nop 7
 v_max3_f32 v248, v128, v129, v130
 v_max3_f32 v248, v248, v131, v132
 v_max3_f32 v248, v248, v133, v134
 v_max_f32 v248, v248, v135
 v_mov_b32 v249, v248
 s_nop 1
 v_permlane16_swap_b32 v248, v249
 v_max_f32 v248, v248, v249
 v_mov_b32 v249, v248
 s_nop 1
 v_permlane32_swap_b32 v248, v249
 v_max_f32 v248, v248, v249
 v_ceil_f32 v248, v248
 v_max_f32 v248, 0, v248
 vex v250, -v248
 vsf v128, v128, v248
 vsf v129, v129, v248
 vsf v130, v130, v248
 vsf v131, v131, v248
 vsf v132, v132, v248
 vsf v133, v133, v248
 vsf v134, v134, v248
 vsf v135, v135, v248
 vsf v200, v200, v248
 vsf v201, v201, v248
 vsf v202, v202, v248
 vsf v203, v203, v248
 vsf v204, v204, v248
 vsf v205, v205, v248
 vsf v206, v206, v248
 vsf v207, v207, v248
 vsf v144, v144, v248
 vsf v145, v145, v248
 vsf v146, v146, v248
 vsf v147, v147, v248
 vsf v148, v148, v248
 vsf v149, v149, v248
 vsf v150, v150, v248
 vsf v151, v151, v248
 vsf v216, v216, v248
 vsf v217, v217, v248
 vsf v218, v218, v248
 vsf v219, v219, v248
 vsf v220, v220, v248
 vsf v221, v221, v248
 vsf v222, v222, v248
 vsf v223, v223, v248
 vmf v0, v0, v250
 vmf v1, v1, v250
 vmf v2, v2, v250
 vmf v3, v3, v250
 vmf v16, v16, v250
 vmf v17, v17, v250
 vmf v18, v18, v250
 vmf v19, v19, v250
 vmf v32, v32, v250
 vmf v33, v33, v250
 vmf v34, v34, v250
 vmf v35, v35, v250
 vmf v48, v48, v250
 vmf v49, v49, v250
 vmf v50, v50, v250
 vmf v51, v51, v250
 vmf v64, v64, v250
 vmf v65, v65, v250
 vmf v66, v66, v250
 vmf v67, v67, v250
 vmf v80, v80, v250
 vmf v81, v81, v250
 vmf v82, v82, v250
 vmf v83, v83, v250
 vmf v96, v96, v250
 vmf v97, v97, v250
 vmf v98, v98, v250
 vmf v99, v99, v250
 vmf v112, v112, v250
 vmf v113, v113, v250
 vmf v114, v114, v250
 vmf v115, v115, v250
 vmf v240, v240, v250
 vex v232, v128
 vex v233, v129
 s_nop 0
 vaf v236, v232, v233
 cvp v176, v232, v233
 vex v232, v130
 vex v233, v131
 s_nop 0
 vaf v236, v236, v232
 vaf v236, v236, v233
 cvp v177, v232, v233
 vex v232, v132
 vex v233, v133
 s_nop 0
 vaf v236, v236, v232
 vaf v236, v236, v233
 cvp v178, v232, v233
 vex v232, v134
 vex v233, v135
 s_nop 0
 vaf v236, v236, v232
 vaf v236, v236, v233
 cvp v179, v232, v233
 v_max3_f32 v248, v136, v137, v138
 v_max3_f32 v248, v248, v139, v140
 v_max3_f32 v248, v248, v141, v142
 v_max_f32 v248, v248, v143
 v_mov_b32 v249, v248
 s_nop 1
 v_permlane16_swap_b32 v248, v249
 v_max_f32 v248, v248, v249
 v_mov_b32 v249, v248
 s_nop 1
 v_permlane32_swap_b32 v248, v249
 v_max_f32 v248, v248, v249
 v_ceil_f32 v248, v248
 v_max_f32 v248, 0, v248
 vex v250, -v248
 vsf v136, v136, v248
 vsf v137, v137, v248
 vsf v138, v138, v248
 vsf v139, v139, v248
 vsf v140, v140, v248
 vsf v141, v141, v248
 vsf v142, v142, v248
 vsf v143, v143, v248
 vsf v208, v208, v248
 vsf v209, v209, v248
 vsf v210, v210, v248
 vsf v211, v211, v248
 vsf v212, v212, v248
 vsf v213, v213, v248
 vsf v214, v214, v248
 vsf v215, v215, v248
 vsf v152, v152, v248
 vsf v153, v153, v248
 vsf v154, v154, v248
 vsf v155, v155, v248
 vsf v156, v156, v248
 vsf v157, v157, v248
 vsf v158, v158, v248
 vsf v159, v159, v248
 vsf v224, v224, v248
 vsf v225, v225, v248
 vsf v226, v226, v248
 vsf v227, v227, v248
 vsf v228, v228, v248
 vsf v229, v229, v248
 vsf v230, v230, v248
 vsf v231, v231, v248
 vmf v4, v4, v250
 vmf v5, v5, v250
 vmf v6, v6, v250
 vmf v7, v7, v250
 vmf v20, v20, v250
 vmf v21, v21, v250
 vmf v22, v22, v250
 vmf v23, v23, v250
 vmf v36, v36, v250
 vmf v37, v37, v250
 vmf v38, v38, v250
 vmf v39, v39, v250
 vmf v52, v52, v250
 vmf v53, v53, v250
 vmf v54, v54, v250
 vmf v55, v55, v250
 vmf v68, v68, v250
 vmf v69, v69, v250
 vmf v70, v70, v250
 vmf v71, v71, v250
 vmf v84, v84, v250
 vmf v85, v85, v250
 vmf v86, v86, v250
 vmf v87, v87, v250
 vmf v100, v100, v250
 vmf v101, v101, v250
 vmf v102, v102, v250
 vmf v103, v103, v250
 vmf v116, v116, v250
 vmf v117, v117, v250
 vmf v118, v118, v250
 vmf v119, v119, v250
 vmf v241, v241, v250
 vex v232, v136
 vex v233, v137
 s_nop 0
 vaf v237, v232, v233
 cvp v180, v232, v233
 vex v232, v138
 vex v233, v139
 s_nop 0
 vaf v237, v237, v232
 vaf v237, v237, v233
 cvp v181, v232, v233
 vex v232, v140
 vex v233, v141
 s_nop 0
 vaf v237, v237, v232
 vaf v237, v237, v233
 cvp v182, v232, v233
 vex v232, v142
 vex v233, v143
 s_nop 0
 vaf v237, v237, v232
 vaf v237, v237, v233
 cvp v183, v232, v233
 vex v232, v144
 vex v233, v145
 s_nop 1
 s_branch K2_BACK_102
K2_HOOK_103:
 s_mov_b32 s39, 61865984
 s_lshl_b32 s19, s18, 7
 v_mov_b32 v252, s19
 v_mov_b32 v253, 1
 s_mov_b64 exec, 1
 buffer_atomic_add v253, v252, s[12:15], s39 offen sc1
 s_mov_b64 exec, -1
 s_branch K2_HB_104
K2_SLOW_113:
 s_nop 7
 v_max3_f32 v248, v144, v145, v146
 v_max3_f32 v248, v248, v147, v148
 v_max3_f32 v248, v248, v149, v150
 v_max_f32 v248, v248, v151
 v_mov_b32 v249, v248
 s_nop 1
 v_permlane16_swap_b32 v248, v249
 v_max_f32 v248, v248, v249
 v_mov_b32 v249, v248
 s_nop 1
 v_permlane32_swap_b32 v248, v249
 v_max_f32 v248, v248, v249
 v_ceil_f32 v248, v248
 v_max_f32 v248, 0, v248
 vex v250, -v248
 vsf v144, v144, v248
 vsf v145, v145, v248
 vsf v146, v146, v248
 vsf v147, v147, v248
 vsf v148, v148, v248
 vsf v149, v149, v248
 vsf v150, v150, v248
 vsf v151, v151, v248
 vsf v200, v200, v248
 vsf v201, v201, v248
 vsf v202, v202, v248
 vsf v203, v203, v248
 vsf v204, v204, v248
 vsf v205, v205, v248
 vsf v206, v206, v248
 vsf v207, v207, v248
 vsf v216, v216, v248
 vsf v217, v217, v248
 vsf v218, v218, v248
 vsf v219, v219, v248
 vsf v220, v220, v248
 vsf v221, v221, v248
 vsf v222, v222, v248
 vsf v223, v223, v248
 vsf v128, v128, v248
 vsf v129, v129, v248
 vsf v130, v130, v248
 vsf v131, v131, v248
 vsf v132, v132, v248
 vsf v133, v133, v248
 vsf v134, v134, v248
 vsf v135, v135, v248
 vsf v160, v160, v248
 vsf v161, v161, v248
 vsf v162, v162, v248
 vsf v163, v163, v248
 vsf v164, v164, v248
 vsf v165, v165, v248
 vsf v166, v166, v248
 vsf v167, v167, v248
 vmf v0, v0, v250
 vmf v1, v1, v250
 vmf v2, v2, v250
 vmf v3, v3, v250
 vmf v16, v16, v250
 vmf v17, v17, v250
 vmf v18, v18, v250
 vmf v19, v19, v250
 vmf v32, v32, v250
 vmf v33, v33, v250
 vmf v34, v34, v250
 vmf v35, v35, v250
 vmf v48, v48, v250
 vmf v49, v49, v250
 vmf v50, v50, v250
 vmf v51, v51, v250
 vmf v64, v64, v250
 vmf v65, v65, v250
 vmf v66, v66, v250
 vmf v67, v67, v250
 vmf v80, v80, v250
 vmf v81, v81, v250
 vmf v82, v82, v250
 vmf v83, v83, v250
 vmf v96, v96, v250
 vmf v97, v97, v250
 vmf v98, v98, v250
 vmf v99, v99, v250
 vmf v112, v112, v250
 vmf v113, v113, v250
 vmf v114, v114, v250
 vmf v115, v115, v250
 vmf v240, v240, v250
 v_lshlrev_b32 v249, 16, v176
 v_and_b32 v176, 0xffff0000, v176
 vmf v249, v249, v250
 vmf v176, v176, v250
 cvp v176, v249, v176
 v_lshlrev_b32 v249, 16, v177
 v_and_b32 v177, 0xffff0000, v177
 vmf v249, v249, v250
 vmf v177, v177, v250
 cvp v177, v249, v177
 v_lshlrev_b32 v249, 16, v178
 v_and_b32 v178, 0xffff0000, v178
 vmf v249, v249, v250
 vmf v178, v178, v250
 cvp v178, v249, v178
 v_lshlrev_b32 v249, 16, v179
 v_and_b32 v179, 0xffff0000, v179
 vmf v249, v249, v250
 vmf v179, v179, v250
 cvp v179, v249, v179
 vex v232, v144
 vex v233, v145
 s_nop 0
 vaf v238, v232, v233
 cvp v192, v232, v233
 vex v232, v146
 vex v233, v147
 s_nop 0
 vaf v238, v238, v232
 vaf v238, v238, v233
 cvp v193, v232, v233
 vex v232, v148
 vex v233, v149
 s_nop 0
 vaf v238, v238, v232
 vaf v238, v238, v233
 cvp v194, v232, v233
 vex v232, v150
 vex v233, v151
 s_nop 0
 vaf v238, v238, v232
 vaf v238, v238, v233
 cvp v195, v232, v233
 v_max3_f32 v248, v152, v153, v154
 v_max3_f32 v248, v248, v155, v156
 v_max3_f32 v248, v248, v157, v158
 v_max_f32 v248, v248, v159
 v_mov_b32 v249, v248
 s_nop 1
 v_permlane16_swap_b32 v248, v249
 v_max_f32 v248, v248, v249
 v_mov_b32 v249, v248
 s_nop 1
 v_permlane32_swap_b32 v248, v249
 v_max_f32 v248, v248, v249
 v_ceil_f32 v248, v248
 v_max_f32 v248, 0, v248
 vex v250, -v248
 vsf v152, v152, v248
 vsf v153, v153, v248
 vsf v154, v154, v248
 vsf v155, v155, v248
 vsf v156, v156, v248
 vsf v157, v157, v248
 vsf v158, v158, v248
 vsf v159, v159, v248
 vsf v208, v208, v248
 vsf v209, v209, v248
 vsf v210, v210, v248
 vsf v211, v211, v248
 vsf v212, v212, v248
 vsf v213, v213, v248
 vsf v214, v214, v248
 vsf v215, v215, v248
 vsf v224, v224, v248
 vsf v225, v225, v248
 vsf v226, v226, v248
 vsf v227, v227, v248
 vsf v228, v228, v248
 vsf v229, v229, v248
 vsf v230, v230, v248
 vsf v231, v231, v248
 vsf v136, v136, v248
 vsf v137, v137, v248
 vsf v138, v138, v248
 vsf v139, v139, v248
 vsf v140, v140, v248
 vsf v141, v141, v248
 vsf v142, v142, v248
 vsf v143, v143, v248
 vsf v168, v168, v248
 vsf v169, v169, v248
 vsf v170, v170, v248
 vsf v171, v171, v248
 vsf v172, v172, v248
 vsf v173, v173, v248
 vsf v174, v174, v248
 vsf v175, v175, v248
 vmf v4, v4, v250
 vmf v5, v5, v250
 vmf v6, v6, v250
 vmf v7, v7, v250
 vmf v20, v20, v250
 vmf v21, v21, v250
 vmf v22, v22, v250
 vmf v23, v23, v250
 vmf v36, v36, v250
 vmf v37, v37, v250
 vmf v38, v38, v250
 vmf v39, v39, v250
 vmf v52, v52, v250
 vmf v53, v53, v250
 vmf v54, v54, v250
 vmf v55, v55, v250
 vmf v68, v68, v250
 vmf v69, v69, v250
 vmf v70, v70, v250
 vmf v71, v71, v250
 vmf v84, v84, v250
 vmf v85, v85, v250
 vmf v86, v86, v250
 vmf v87, v87, v250
 vmf v100, v100, v250
 vmf v101, v101, v250
 vmf v102, v102, v250
 vmf v103, v103, v250
 vmf v116, v116, v250
 vmf v117, v117, v250
 vmf v118, v118, v250
 vmf v119, v119, v250
 vmf v241, v241, v250
 v_lshlrev_b32 v249, 16, v180
 v_and_b32 v180, 0xffff0000, v180
 vmf v249, v249, v250
 vmf v180, v180, v250
 cvp v180, v249, v180
 v_lshlrev_b32 v249, 16, v181
 v_and_b32 v181, 0xffff0000, v181
 vmf v249, v249, v250
 vmf v181, v181, v250
 cvp v181, v249, v181
 v_lshlrev_b32 v249, 16, v182
 v_and_b32 v182, 0xffff0000, v182
 vmf v249, v249, v250
 vmf v182, v182, v250
 cvp v182, v249, v182
 v_lshlrev_b32 v249, 16, v183
 v_and_b32 v183, 0xffff0000, v183
 vmf v249, v249, v250
 vmf v183, v183, v250
 cvp v183, v249, v183
 vex v232, v152
 vex v233, v153
 s_nop 0
 vaf v239, v232, v233
 cvp v196, v232, v233
 vex v232, v154
 vex v233, v155
 s_nop 0
 vaf v239, v239, v232
 vaf v239, v239, v233
 cvp v197, v232, v233
 vex v232, v156
 vex v233, v157
 s_nop 0
 vaf v239, v239, v232
 vaf v239, v239, v233
 cvp v198, v232, v233
 vex v232, v158
 vex v233, v159
 s_nop 0
 vaf v239, v239, v232
 vaf v239, v239, v233
 cvp v199, v232, v233
 vex v232, v136
 vex v233, v137
 s_nop 1
 s_branch K2_BACK_114
K2_SLOW_115:
 s_nop 7
 v_max3_f32 v248, v136, v137, v138
 v_max3_f32 v248, v248, v139, v140
 v_max3_f32 v248, v248, v141, v142
 v_max_f32 v248, v248, v143
 v_mov_b32 v249, v248
 s_nop 1
 v_permlane16_swap_b32 v248, v249
 v_max_f32 v248, v248, v249
 v_mov_b32 v249, v248
 s_nop 1
 v_permlane32_swap_b32 v248, v249
 v_max_f32 v248, v248, v249
 v_ceil_f32 v248, v248
 v_max_f32 v248, 0, v248
 vex v250, -v248
 vsf v136, v136, v248
 vsf v137, v137, v248
 vsf v138, v138, v248
 vsf v139, v139, v248
 vsf v140, v140, v248
 vsf v141, v141, v248
 vsf v142, v142, v248
 vsf v143, v143, v248
 vsf v208, v208, v248
 vsf v209, v209, v248
 vsf v210, v210, v248
 vsf v211, v211, v248
 vsf v212, v212, v248
 vsf v213, v213, v248
 vsf v214, v214, v248
 vsf v215, v215, v248
 vsf v168, v168, v248
 vsf v169, v169, v248
 vsf v170, v170, v248
 vsf v171, v171, v248
 vsf v172, v172, v248
 vsf v173, v173, v248
 vsf v174, v174, v248
 vsf v175, v175, v248
 vsf v224, v224, v248
 vsf v225, v225, v248
 vsf v226, v226, v248
 vsf v227, v227, v248
 vsf v228, v228, v248
 vsf v229, v229, v248
 vsf v230, v230, v248
 vsf v231, v231, v248
 vmf v4, v4, v250
 vmf v5, v5, v250
 vmf v6, v6, v250
 vmf v7, v7, v250
 vmf v20, v20, v250
 vmf v21, v21, v250
 vmf v22, v22, v250
 vmf v23, v23, v250
 vmf v36, v36, v250
 vmf v37, v37, v250
 vmf v38, v38, v250
 vmf v39, v39, v250
 vmf v52, v52, v250
 vmf v53, v53, v250
 vmf v54, v54, v250
 vmf v55, v55, v250
 vmf v68, v68, v250
 vmf v69, v69, v250
 vmf v70, v70, v250
 vmf v71, v71, v250
 vmf v84, v84, v250
 vmf v85, v85, v250
 vmf v86, v86, v250
 vmf v87, v87, v250
 vmf v100, v100, v250
 vmf v101, v101, v250
 vmf v102, v102, v250
 vmf v103, v103, v250
 vmf v116, v116, v250
 vmf v117, v117, v250
 vmf v118, v118, v250
 vmf v119, v119, v250
 vmf v241, v241, v250
 vex v232, v136
 vex v233, v137
 s_nop 0
 vaf v237, v232, v233
 cvp v188, v232, v233
 vex v232, v138
 vex v233, v139
 s_nop 0
 vaf v237, v237, v232
 vaf v237, v237, v233
 cvp v189, v232, v233
 vex v232, v140
 vex v233, v141
 s_nop 0
 vaf v237, v237, v232
 vaf v237, v237, v233
 cvp v190, v232, v233
 vex v232, v142
 vex v233, v143
 s_nop 0
 vaf v237, v237, v232
 vaf v237, v237, v233
 cvp v191, v232, v233
 vex v232, v168
 vex v233, v169
 s_nop 1
 s_branch K2_BACK_116
K2_SLOW_117:
 s_nop 7
 v_max3_f32 v248, v168, v169, v170
 v_max3_f32 v248, v248, v171, v172
 v_max3_f32 v248, v248, v173, v174
 v_max_f32 v248, v248, v175
 v_mov_b32 v249, v248
 s_nop 1
 v_permlane16_swap_b32 v248, v249
 v_max_f32 v248, v248, v249
 v_mov_b32 v249, v248
 s_nop 1
 v_permlane32_swap_b32 v248, v249
 v_max_f32 v248, v248, v249
 v_ceil_f32 v248, v248
 v_max_f32 v248, 0, v248
 vex v250, -v248
 vsf v168, v168, v248
 vsf v169, v169, v248
 vsf v170, v170, v248
 vsf v171, v171, v248
 vsf v172, v172, v248
 vsf v173, v173, v248
 vsf v174, v174, v248
 vsf v175, v175, v248
 vsf v208, v208, v248
 vsf v209, v209, v248
 vsf v210, v210, v248
 vsf v211, v211, v248
 vsf v212, v212, v248
 vsf v213, v213, v248
 vsf v214, v214, v248
 vsf v215, v215, v248
 vsf v224, v224, v248
 vsf v225, v225, v248
 vsf v226, v226, v248
 vsf v227, v227, v248
 vsf v228, v228, v248
 vsf v229, v229, v248
 vsf v230, v230, v248
 vsf v231, v231, v248
 vmf v4, v4, v250
 vmf v5, v5, v250
 vmf v6, v6, v250
 vmf v7, v7, v250
 vmf v20, v20, v250
 vmf v21, v21, v250
 vmf v22, v22, v250
 vmf v23, v23, v250
 vmf v36, v36, v250
 vmf v37, v37, v250
 vmf v38, v38, v250
 vmf v39, v39, v250
 vmf v52, v52, v250
 vmf v53, v53, v250
 vmf v54, v54, v250
 vmf v55, v55, v250
 vmf v68, v68, v250
 vmf v69, v69, v250
 vmf v70, v70, v250
 vmf v71, v71, v250
 vmf v84, v84, v250
 vmf v85, v85, v250
 vmf v86, v86, v250
 vmf v87, v87, v250
 vmf v100, v100, v250
 vmf v101, v101, v250
 vmf v102, v102, v250
 vmf v103, v103, v250
 vmf v116, v116, v250
 vmf v117, v117, v250
 vmf v118, v118, v250
 vmf v119, v119, v250
 vmf v241, v241, v250
 v_lshlrev_b32 v249, 16, v188
 v_and_b32 v188, 0xffff0000, v188
 vmf v249, v249, v250
 vmf v188, v188, v250
 cvp v188, v249, v188
 v_lshlrev_b32 v249, 16, v189
 v_and_b32 v189, 0xffff0000, v189
 vmf v249, v249, v250
 vmf v189, v189, v250
 cvp v189, v249, v189
 v_lshlrev_b32 v249, 16, v190
 v_and_b32 v190, 0xffff0000, v190
 vmf v249, v249, v250
 vmf v190, v190, v250
 cvp v190, v249, v190
 v_lshlrev_b32 v249, 16, v191
 v_and_b32 v191, 0xffff0000, v191
 vmf v249, v249, v250
 vmf v191, v191, v250
 cvp v191, v249, v191
 vex v232, v168
 vex v233, v169
 s_nop 0
 vaf v239, v232, v233
 cvp v196, v232, v233
 vex v232, v170
 vex v233, v171
 s_nop 0
 vaf v239, v239, v232
 vaf v239, v239, v233
 cvp v197, v232, v233
 vex v232, v172
 vex v233, v173
 s_nop 0
 vaf v239, v239, v232
 vaf v239, v239, v233
 cvp v198, v232, v233
 vex v232, v174
 vex v233, v175
 s_nop 0
 vaf v239, v239, v232
 vaf v239, v239, v233
 cvp v199, v232, v233
 s_nop 1
 s_branch K2_BACK_118
K3_LSPIN_F:
 s_mov_b32 s20, 0
 s_branch K3_LSPIN_N
K3_LSPIN:
 s_mov_b32 s20, 0
K3_LSPIN_L:
 s_sleep 4
K3_LSPIN_N:
 buffer_load_dword v246, v250, s[12:15], s39 offen offset:0 sc1
 swc vmcnt(0)
 v_cmp_ne_u32 vcc, 32, v246
 sad s20, s20, 1
 s_cmp_ge_u32 s20, 0x8000
 s_cbranch_scc1 K3_LSPIN_B
 s_cbranch_vccnz K3_LSPIN_L
 s_branch K3_LSPIN_B
K3_HSPIN_F:
 s_mov_b32 s20, 0
 s_branch K3_HSPIN_N
K3_HSPIN:
 s_mov_b32 s20, 0
K3_HSPIN_L:
 s_sleep 4
K3_HSPIN_N:
 buffer_load_dword v246, v250, s[12:15], s39 offen offset:0 sc1
 swc vmcnt(0)
 v_cmp_ne_u32 vcc, 32, v246
 sad s20, s20, 1
 s_cmp_ge_u32 s20, 0x8000
 s_cbranch_scc1 K3_HSPIN_B
 s_cbranch_vccnz K3_HSPIN_L
 s_branch K3_HSPIN_B
K3_HSPIN_B:
 sad s19, s24, 11206656
 bl4 v[208:211], v244, s[12:15], s19 offen offset:0 sc1
 bl4 v[212:215], v244, s[12:15], s19 offen offset:1024 sc1
 sad s19, s24, 11210752
 bl4 v[216:219], v244, s[12:15], s19 offen offset:0 sc1
 bl4 v[220:223], v244, s[12:15], s19 offen offset:1024 sc1
 sad s19, s24, 11214848
 bl4 v[160:163], v244, s[12:15], s19 offen offset:0 sc1
 bl4 v[164:167], v244, s[12:15], s19 offen offset:1024 sc1
 sad s19, s24, 11218944
 bl4 v[168:171], v244, s[12:15], s19 offen offset:0 sc1
 bl4 v[172:175], v244, s[12:15], s19 offen offset:1024 sc1
 s_branch K3_HOK
K4_LSPIN_F:
 s_mov_b32 s20, 0
 s_branch K4_LSPIN_N
K4_LSPIN:
 s_mov_b32 s20, 0
K4_LSPIN_L:
 s_sleep 4
K4_LSPIN_N:
 buffer_load_dword v246, v251, s[12:15], s39 offen offset:0 sc1
 swc vmcnt(0)
 v_cmp_ne_u32 vcc, 8, v246
 sad s20, s20, 1
 s_cmp_ge_u32 s20, 0x8000
 s_cbranch_scc1 K4_LSPIN_B
 s_cbranch_vccnz K4_LSPIN_L
 s_branch K4_LSPIN_B
K4_TSPIN_F:
 s_mov_b32 s20, 0
 s_branch K4_TSPIN_N
K4_TSPIN:
 s_mov_b32 s20, 0
K4_TSPIN_L:
 s_sleep 4
K4_TSPIN_N:
 buffer_load_dword v246, v252, s[12:15], s39 offen offset:0 sc1
 swc vmcnt(0)
 v_cmp_ne_u32 vcc, 8, v246
 sad s20, s20, 1
 s_cmp_ge_u32 s20, 0x8000
 s_cbranch_scc1 K4_TSPIN_B
 s_cbranch_vccnz K4_TSPIN_L
 s_branch K4_TSPIN_B
.section .rodata,"a"
.p2align 6
.amdhsa_kernel k12_kernel
  .amdhsa_next_free_vgpr 512
  .amdhsa_next_free_sgpr 102
  .amdhsa_accum_offset 256
  .amdhsa_group_segment_fixed_size 0
  .amdhsa_kernarg_size 104
  .amdhsa_user_sgpr_count 2
  .amdhsa_user_sgpr_kernarg_segment_ptr 1
  .amdhsa_system_sgpr_workgroup_id_x 1
.end_amdhsa_kernel
```
